```python
import torch

def _softmax(x, axis=-1):
    return torch.softmax(x, dim=axis)
def _gelu(x):
    return torch.nn.functional.gelu(x, approximate="tanh")
def _silu(x):
    return torch.nn.functional.silu(x)
def _sigmoid(x):
    return torch.sigmoid(x)
def _layernorm(x, axis=-1, eps=1e-5):
    m = x.mean(dim=axis, keepdim=True)
    v = x.var(dim=axis, keepdim=True, unbiased=False)
    return (x - m) / torch.sqrt(v + eps)
def _scatter_add(tgt, idx, src, axis=0):
    return tgt.clone().index_add_(axis, idx, src)
def _segment_sum(src, seg, n):
    out = torch.zeros((n,) + src.shape[1:], dtype=src.dtype)
    return out.index_add_(0, seg, src)
def _pad(x, pw):
    flat = tuple(v for pair in reversed(pw) for v in pair)
    return torch.nn.functional.pad(x, flat)

kernel_name = 'sequential_preLN__sliding_block__swiglu_ffn__prompt'

def setup_inputs():

    _w = (lambda a: (lambda t: t.to(torch.bfloat16) if t.is_floating_point() else t)(torch.as_tensor(a)))
    def _A_setup():
        B, S, D = 1, 2048, 576
        return {
            "x": _w((lambda *s: torch.randn(*s, dtype=torch.bfloat16) * 0.05)(B, S, D)),
            "wqkv": _w((lambda *s: torch.randn(*s, dtype=torch.bfloat16) * 0.05)(D, 3 * D)),
            "wo": _w((lambda *s: torch.randn(*s, dtype=torch.bfloat16) * 0.05)(D, D)),
        }
    _A_in = _A_setup()

    def _B_setup():
        B, S, D, F = 1, 2048, 576, 4608
        return {
            "x": _w((lambda *s: torch.randn(*s, dtype=torch.bfloat16) * 0.05)(B, S, D)),
            "w_gate": _w((lambda *s: torch.randn(*s, dtype=torch.bfloat16) * 0.05)(D, F)),
            "w_up": _w((lambda *s: torch.randn(*s, dtype=torch.bfloat16) * 0.05)(D, F)),
            "w_down": _w((lambda *s: torch.randn(*s, dtype=torch.bfloat16) * 0.05)(F, D)),
        }
    _B_in = _B_setup()

    return {
        "A_x": _A_in["x"],
        "A_wqkv": _A_in["wqkv"],
        "A_wo": _A_in["wo"],
        "B_x": _B_in["x"],
        "B_w_gate": _B_in["w_gate"],
        "B_w_up": _B_in["w_up"],
        "B_w_down": _B_in["w_down"],
    }

def reference(A_x, A_wqkv, A_wo, B_x, B_w_gate, B_w_up, B_w_down):
    def _A_ref(x, wqkv, wo):
        B, S, D = x.shape
        H = 32; Dh = D // H; W = 256
        qkv = (lambda x, *d: x.permute(*d))((x @ wqkv).reshape(B, S, 3, H, Dh), 2, 0, 3, 1, 4)
        q, k, v = qkv[0], qkv[1], qkv[2]
        scores = torch.einsum("bhqd,bhkd->bhqk", q, k) * (Dh ** -0.5)
        idx = torch.arange(S)
        mask = (idx[:, None] - idx[None, :] >= 0) & (idx[:, None] - idx[None, :] < W)
        scores = torch.where(mask[None, None], scores, -1e9)
        p = _softmax(scores, axis=-1)
        o = torch.einsum("bhqk,bhkd->bhqd", p, v)
        return (lambda x, *d: x.permute(*d))(o, 0, 2, 1, 3).reshape(B, S, D) @ wo

    def _B_ref(x, w_gate, w_up, w_down):
        g = _silu(x @ w_gate)
        u = x @ w_up
        return (g * u) @ w_down

    x = A_x
    h = x + _A_ref(_layernorm(x, axis=-1), A_wqkv, A_wo)
    h2 = h + _B_ref(_layernorm(h, axis=-1), B_w_gate, B_w_up, B_w_down)
    return h2
```

```asm
; @launch grid=(256,1,1) block=(256,1,1) lds=163840
.amdgcn_target "amdgcn-amd-amdhsa--gfx950"
.text
.globl sequential_preLN__sliding_block__swiglu_ffn__prompt_kernel
.p2align 12
.p2align 8
.type sequential_preLN__sliding_block__swiglu_ffn__prompt_kernel,@function
sequential_preLN__sliding_block__swiglu_ffn__prompt_kernel:
L_main:
L_s1:
 s_cmp_ge_u32 s2, 256
 s_cbranch_scc1 L_exit
 s_load_dwordx4 s[4:7], s[0:1], 0
 s_load_dwordx2 s[92:93], s[0:1], 64
 s_load_dwordx2 s[20:21], s[0:1], 72
 v_and_b32 v1, 63, v0
 v_lshrrev_b32 v2, 6, v0
 s_nop 0
 v_readfirstlane_b32 s22, v2
 s_mov_b32 s100, 400000
 s_and_b32 s26, s2, 1
 s_lshl_b32 s26, s26, 2
 s_lshr_b32 s23, s2, 6
 s_add_u32 s23, s23, s26
 s_bfe_u32 s24, s2, 0x30003
 s_bfe_u32 s25, s2, 0x20003
 s_add_u32 s25, s25, s26
 s_cmp_ge_u32 s2, 192
 s_cselect_b32 s23, 3, s23
 s_cselect_b32 s24, s25, s24
 s_bfe_u32 s25, s2, 0x20001
 s_lshl_b32 s25, s25, 3
 s_add_u32 s24, s24, s25
 s_lshl_b32 s25, s23, 2
 s_add_u32 s25, s25, s22
 v_lshrrev_b32 v3, 3, v1
 v_and_b32 v4, 7, v1
 v_mul_u32_u24 v5, 1152, v3
 v_lshl_add_u32 v5, v4, 4, v5
 s_lshl_b32 s26, s24, 6
 s_lshl_b32 s27, s22, 4
 s_add_u32 s26, s26, s27
 s_mul_i32 s26, s26, 1152
 v_add_u32 v15, 9216, v5
 s_and_b32 s27, s24, 3
 s_mul_i32 s27, s27, 5
 s_lshr_b32 s27, s27, 1
 v_lshrrev_b32 v6, 2, v3
 v_lshlrev_b32 v6, 3, v6
 v_and_b32 v7, 3, v3
 v_add_u32 v6, v6, v7
 v_mul_u32_u24 v6, 3456, v6
 v_lshrrev_b32 v7, 1, v3
 v_lshlrev_b32 v7, 1, v7
 v_xor_b32 v7, v7, v4
 v_lshl_add_u32 v6, v7, 4, v6
 v_add_u32 v251, 0, v6
 v_add_u32 v252, 54272, v6
 v_add_u32 v253, 11776, v6
 v_add_u32 v254, 66048, v6
 s_lshl_b32 s30, s25, 7
 s_mul_i32 s28, s27, 221184
 s_add_u32 s28, s28, s30
 s_add_u32 s31, s30, 1990656
 s_lshl_b32 s27, s27, 7
 s_add_u32 s27, s27, s26
 s_add_u32 s101, s26, 1152
 s_mul_i32 s29, s22, 20480
 s_add_u32 s29, s29, 73728
 s_waitcnt lgkmcnt(0)
 s_cmp_ge_u32 s2, 224
 s_cbranch_scc1 L_pf0
 s_mov_b32 s8, s4
 s_and_b32 s9, s5, 0xffff
 s_mov_b32 s10, 0x240000
 s_mov_b32 s11, 0x20000
 buffer_load_dwordx4 v[16:19], v5, s[8:11], s27 offen
 buffer_load_dwordx4 v[52:55], v15, s[8:11], s27 offen
 s_add_u32 s27, s27, 128
 s_cmp_eq_u32 s27, s101
 s_cselect_b32 s27, s26, s27
 buffer_load_dwordx4 v[20:23], v5, s[8:11], s27 offen
 buffer_load_dwordx4 v[56:59], v15, s[8:11], s27 offen
 s_add_u32 s27, s27, 128
 s_cmp_eq_u32 s27, s101
 s_cselect_b32 s27, s26, s27
 buffer_load_dwordx4 v[24:27], v5, s[8:11], s27 offen
 buffer_load_dwordx4 v[60:63], v15, s[8:11], s27 offen
 s_add_u32 s27, s27, 128
 s_cmp_eq_u32 s27, s101
 s_cselect_b32 s27, s26, s27
 buffer_load_dwordx4 v[28:31], v5, s[8:11], s27 offen
 buffer_load_dwordx4 v[64:67], v15, s[8:11], s27 offen
 s_add_u32 s27, s27, 128
 s_cmp_eq_u32 s27, s101
 s_cselect_b32 s27, s26, s27
 buffer_load_dwordx4 v[32:35], v5, s[8:11], s27 offen
 buffer_load_dwordx4 v[68:71], v15, s[8:11], s27 offen
 s_add_u32 s27, s27, 128
 s_cmp_eq_u32 s27, s101
 s_cselect_b32 s27, s26, s27
 buffer_load_dwordx4 v[36:39], v5, s[8:11], s27 offen
 buffer_load_dwordx4 v[72:75], v15, s[8:11], s27 offen
 s_add_u32 s27, s27, 128
 s_cmp_eq_u32 s27, s101
 s_cselect_b32 s27, s26, s27
 buffer_load_dwordx4 v[40:43], v5, s[8:11], s27 offen
 buffer_load_dwordx4 v[76:79], v15, s[8:11], s27 offen
 s_add_u32 s27, s27, 128
 s_cmp_eq_u32 s27, s101
 s_cselect_b32 s27, s26, s27
 buffer_load_dwordx4 v[44:47], v5, s[8:11], s27 offen
 buffer_load_dwordx4 v[80:83], v15, s[8:11], s27 offen
 s_add_u32 s27, s27, 128
 s_cmp_eq_u32 s27, s101
 s_cselect_b32 s27, s26, s27
 buffer_load_dwordx4 v[48:51], v5, s[8:11], s27 offen
 buffer_load_dwordx4 v[84:87], v15, s[8:11], s27 offen
 s_mov_b32 s26, s30
 s_mov_b32 s27, s31
 s_mov_b32 s12, s6
 s_and_b32 s13, s7, 0xffff
 s_mov_b32 s14, 0x1e6000
 s_mov_b32 s15, 0x20000
 s_add_u32 s96, s20, 0xe00000
 s_addc_u32 s97, s21, 0
 s_and_b32 s97, s97, 0xffff
 s_mov_b32 s98, 0x110000
 s_mov_b32 s99, 0x20000
 s_cmp_eq_u32 s22, 0
 s_cbranch_scc1 L_c1_p0
 s_cmp_eq_u32 s22, 1
 s_cbranch_scc1 L_c1_p1
 s_cmp_eq_u32 s22, 2
 s_cbranch_scc1 L_c1_ret
 s_branch L_c1_ret
L_c1_ret:
 s_load_dwordx2 s[90:91], s[0:1], 16
 s_lshr_b32 s80, s2, 5
 s_and_b32 s81, s2, 7
 s_lshl_b32 s81, s81, 2
 s_bfe_u32 s68, s2, 0x20003
 s_add_u32 s81, s81, s68
 s_mul_i32 s68, s81, 18
 s_and_b32 s82, s68, 3
 s_lshr_b32 s68, s68, 2
 s_add_u32 s83, s68, 144
 s_mul_i32 s83, s83, 16512
 s_lshl_b32 s84, s80, 1
 s_add_u32 s84, s84, s22
 s_cmp_lt_u32 s84, 2
 s_cselect_b32 s69, 0, 2
 s_sub_u32 s84, s84, s69
 s_lshl_b32 s84, s84, 10
 s_add_u32 s83, s83, s84
 s_lshl_b32 s84, s22, 10
 s_mul_i32 s85, s68, 16512
 s_lshl_b32 s69, s80, 11
 s_add_u32 s85, s85, s69
 s_lshl_b32 s87, s22, 9
 s_add_u32 s85, s85, s87
 s_mul_i32 s86, s22, 3072
 s_add_u32 s86, s86, 151552
 v_lshrrev_b32 v12, 5, v1
 v_lshlrev_b32 v12, 3, v12
 v_and_b32 v13, 31, v1
 v_sub_u32 v12, v13, v12
 v_cmp_le_i32 s[36:37], 0, v12
 v_cmp_le_i32 s[38:39], 1, v12
 v_cmp_le_i32 s[40:41], 2, v12
 v_cmp_le_i32 s[42:43], 3, v12
 v_cmp_le_i32 s[44:45], 4, v12
 v_cmp_le_i32 s[46:47], 5, v12
 v_cmp_le_i32 s[48:49], 6, v12
 v_cmp_le_i32 s[50:51], 7, v12
 v_cmp_le_i32 s[52:53], 16, v12
 v_cmp_le_i32 s[54:55], 17, v12
 v_cmp_le_i32 s[56:57], 18, v12
 v_cmp_le_i32 s[58:59], 19, v12
 v_cmp_le_i32 s[60:61], 20, v12
 v_cmp_le_i32 s[62:63], 21, v12
 v_cmp_le_i32 s[64:65], 22, v12
 v_cmp_le_i32 s[66:67], 23, v12
 s_lshl_b32 s68, s80, 8
 s_lshl_b32 s69, s22, 6
 s_add_u32 s68, s68, s69
 s_mul_i32 s69, s81, 68096
 s_lshl_b32 s70, s68, 4
 s_add_u32 s69, s69, s70
 s_mul_i32 s70, s81, 8448
 s_lshl_b32 s68, s68, 2
 s_add_u32 s70, s70, s68
 s_lshr_b32 s73, s2, 5
 s_mul_i32 s72, s73, 192
 s_and_b32 s73, s73, 1
 s_lshl_b32 s74, s73, 6
 s_xor_b32 s73, s73, 1
 s_lshl_b32 s73, s73, 7
 s_add_u32 s73, s73, s72
 s_add_u32 s72, s72, s74
 s_lshl_b32 s71, s80, 1
 s_lshr_b32 s74, s22, 1
 s_add_u32 s71, s71, s74
 s_cmp_eq_u32 s71, 0
 s_cselect_b32 s71, 0xff7fff7f, 0
 s_mov_b32 s75, 0xbeae1a93
 s_mov_b32 s88, 0x3eae1a93
 s_mov_b32 s89, s88
 s_waitcnt lgkmcnt(0)
 s_mov_b32 s76, s90
 s_and_b32 s77, s91, 0xffff
 s_mov_b32 s78, 0xa2000
 s_mov_b32 s79, 0x20000
 s_cmp_ge_u32 s2, 192
 s_cselect_b32 s78, 0, s78
 s_mul_i32 s90, s22, 41472
 s_mul_i32 s91, s22, 6144
 s_add_u32 s91, s91, 53248
 s_mov_b32 s16, s20
 s_and_b32 s17, s21, 0xffff
 s_mov_b32 s18, 0x6cd800
 s_mov_b32 s19, 0x20000
 s_lshr_b32 s30, s22, 1
 s_lshl_b32 s30, s30, 1
 v_lshrrev_b32 v7, 5, v1
 v_add_u32 v7, s30, v7
 v_mul_u32_u24 v7, 18, v7
 v_lshrrev_b32 v10, 2, v4
 v_add_u32 v7, v7, v10
 v_lshlrev_b32 v7, 10, v7
 v_and_b32 v10, 3, v4
 v_lshl_add_u32 v7, v10, 8, v7
 s_and_b32 s30, s22, 1
 s_lshl_b32 s30, s30, 3
 v_and_b32 v10, 3, v3
 v_add_u32 v10, s30, v10
 v_xor_b32 v11, v10, v4
 v_lshl_add_u32 v8, v11, 4, v7
 v_add_u32 v10, 4, v10
 v_xor_b32 v11, v10, v4
 v_lshl_add_u32 v9, v11, 4, v7
 v_and_b32 v10, 15, v1
 v_lshrrev_b32 v11, 4, v1
 v_xor_b32 v12, v10, v11
 v_lshlrev_b32 v12, 4, v12
 v_lshl_add_u32 v247, v11, 8, v12
 v_bfe_u32 v12, v1, 2, 3
 v_lshrrev_b32 v13, 5, v1
 v_lshlrev_b32 v13, 10, v13
 v_lshl_add_u32 v13, v12, 7, v13
 v_and_b32 v14, 3, v1
 v_lshl_add_u32 v13, v14, 3, v13
 v_add_u32 v13, s29, v13
 v_lshrrev_b32 v12, 1, v12
 v_xor_b32 v14, 0, v12
 v_lshl_add_u32 v240, v14, 5, v13
 v_xor_b32 v14, 1, v12
 v_lshl_add_u32 v241, v14, 5, v13
 v_xor_b32 v14, 2, v12
 v_lshl_add_u32 v242, v14, 5, v13
 v_xor_b32 v14, 3, v12
 v_lshl_add_u32 v243, v14, 5, v13
 s_mov_b32 s31, 16512
 v_lshrrev_b32 v12, 2, v10
 v_mul_lo_u32 v12, v12, s31
 v_lshl_add_u32 v12, v11, 6, v12
 v_and_b32 v13, 3, v10
 v_lshl_add_u32 v244, v13, 4, v12
 s_cmp_ge_u32 s25, 27
 s_cselect_b32 s30, 0x7fff0000, 0
 v_add_u32 v244, s30, v244
 v_lshlrev_b32 v245, 5, v11
 v_add_u32 v245, 155648, v245
 s_lshl_b32 s30, s22, 6
 s_add_u32 s30, s30, 155648
 v_lshl_add_u32 v246, v3, 2, s30
 v_mov_b32 v12, 0x7fff0000
 v_cmp_eq_u32 vcc, 0, v1
 s_nop 1
 v_cndmask_b32 v250, v12, v1, vcc
 s_mov_b32 s32, 0x3f803f80
 s_mov_b32 s33, 0x00003f80
 s_mov_b32 s34, 0x3f800000
 s_mov_b32 s35, 0x3ae38e39
 v_mov_b32 v88, 0
 v_mov_b32 v89, 0
 v_mov_b32 v90, 0
 v_mov_b32 v91, 0
 v_mov_b32 v92, 0
 v_mov_b32 v93, 0
 v_mov_b32 v94, 0
 v_mov_b32 v95, 0
 s_waitcnt vmcnt(17)
 v_dot2c_f32_bf16 v88, s32, v16
 v_dot2c_f32_bf16 v92, v16, v16
 s_waitcnt vmcnt(16)
 v_dot2c_f32_bf16 v90, s32, v52
 v_dot2c_f32_bf16 v94, v52, v52
 v_dot2c_f32_bf16 v89, s32, v17
 v_dot2c_f32_bf16 v93, v17, v17
 v_dot2c_f32_bf16 v91, s32, v53
 v_dot2c_f32_bf16 v95, v53, v53
 v_dot2c_f32_bf16 v88, s32, v18
 v_dot2c_f32_bf16 v92, v18, v18
 v_dot2c_f32_bf16 v90, s32, v54
 v_dot2c_f32_bf16 v94, v54, v54
 v_dot2c_f32_bf16 v89, s32, v19
 v_dot2c_f32_bf16 v93, v19, v19
 v_dot2c_f32_bf16 v91, s32, v55
 v_dot2c_f32_bf16 v95, v55, v55
 s_waitcnt vmcnt(15)
 v_dot2c_f32_bf16 v88, s32, v20
 v_dot2c_f32_bf16 v92, v20, v20
 s_waitcnt vmcnt(14)
 v_dot2c_f32_bf16 v90, s32, v56
 v_dot2c_f32_bf16 v94, v56, v56
 v_dot2c_f32_bf16 v89, s32, v21
 v_dot2c_f32_bf16 v93, v21, v21
 v_dot2c_f32_bf16 v91, s32, v57
 v_dot2c_f32_bf16 v95, v57, v57
 v_dot2c_f32_bf16 v88, s32, v22
 v_dot2c_f32_bf16 v92, v22, v22
 v_dot2c_f32_bf16 v90, s32, v58
 v_dot2c_f32_bf16 v94, v58, v58
 v_dot2c_f32_bf16 v89, s32, v23
 v_dot2c_f32_bf16 v93, v23, v23
 v_dot2c_f32_bf16 v91, s32, v59
 v_dot2c_f32_bf16 v95, v59, v59
 s_waitcnt vmcnt(13)
 v_dot2c_f32_bf16 v88, s32, v24
 v_dot2c_f32_bf16 v92, v24, v24
 s_waitcnt vmcnt(12)
 v_dot2c_f32_bf16 v90, s32, v60
 v_dot2c_f32_bf16 v94, v60, v60
 v_dot2c_f32_bf16 v89, s32, v25
 v_dot2c_f32_bf16 v93, v25, v25
 v_dot2c_f32_bf16 v91, s32, v61
 v_dot2c_f32_bf16 v95, v61, v61
 v_dot2c_f32_bf16 v88, s32, v26
 v_dot2c_f32_bf16 v92, v26, v26
 v_dot2c_f32_bf16 v90, s32, v62
 v_dot2c_f32_bf16 v94, v62, v62
 v_dot2c_f32_bf16 v89, s32, v27
 v_dot2c_f32_bf16 v93, v27, v27
 v_dot2c_f32_bf16 v91, s32, v63
 v_dot2c_f32_bf16 v95, v63, v63
 s_waitcnt vmcnt(11)
 v_dot2c_f32_bf16 v88, s32, v28
 v_dot2c_f32_bf16 v92, v28, v28
 s_waitcnt vmcnt(10)
 v_dot2c_f32_bf16 v90, s32, v64
 v_dot2c_f32_bf16 v94, v64, v64
 v_dot2c_f32_bf16 v89, s32, v29
 v_dot2c_f32_bf16 v93, v29, v29
 v_dot2c_f32_bf16 v91, s32, v65
 v_dot2c_f32_bf16 v95, v65, v65
 v_dot2c_f32_bf16 v88, s32, v30
 v_dot2c_f32_bf16 v92, v30, v30
 v_dot2c_f32_bf16 v90, s32, v66
 v_dot2c_f32_bf16 v94, v66, v66
 v_dot2c_f32_bf16 v89, s32, v31
 v_dot2c_f32_bf16 v93, v31, v31
 v_dot2c_f32_bf16 v91, s32, v67
 v_dot2c_f32_bf16 v95, v67, v67
 s_waitcnt vmcnt(9)
 v_dot2c_f32_bf16 v88, s32, v32
 v_dot2c_f32_bf16 v92, v32, v32
 s_waitcnt vmcnt(8)
 v_dot2c_f32_bf16 v90, s32, v68
 v_dot2c_f32_bf16 v94, v68, v68
 v_dot2c_f32_bf16 v89, s32, v33
 v_dot2c_f32_bf16 v93, v33, v33
 v_dot2c_f32_bf16 v91, s32, v69
 v_dot2c_f32_bf16 v95, v69, v69
 v_dot2c_f32_bf16 v88, s32, v34
 v_dot2c_f32_bf16 v92, v34, v34
 v_dot2c_f32_bf16 v90, s32, v70
 v_dot2c_f32_bf16 v94, v70, v70
 v_dot2c_f32_bf16 v89, s32, v35
 v_dot2c_f32_bf16 v93, v35, v35
 v_dot2c_f32_bf16 v91, s32, v71
 v_dot2c_f32_bf16 v95, v71, v71
 s_waitcnt vmcnt(7)
 v_dot2c_f32_bf16 v88, s32, v36
 v_dot2c_f32_bf16 v92, v36, v36
 s_waitcnt vmcnt(6)
 v_dot2c_f32_bf16 v90, s32, v72
 v_dot2c_f32_bf16 v94, v72, v72
 v_dot2c_f32_bf16 v89, s32, v37
 v_dot2c_f32_bf16 v93, v37, v37
 v_dot2c_f32_bf16 v91, s32, v73
 v_dot2c_f32_bf16 v95, v73, v73
 v_dot2c_f32_bf16 v88, s32, v38
 v_dot2c_f32_bf16 v92, v38, v38
 v_dot2c_f32_bf16 v90, s32, v74
 v_dot2c_f32_bf16 v94, v74, v74
 v_dot2c_f32_bf16 v89, s32, v39
 v_dot2c_f32_bf16 v93, v39, v39
 v_dot2c_f32_bf16 v91, s32, v75
 v_dot2c_f32_bf16 v95, v75, v75
 s_add_u32 m0, s29, 0
 s_nop 0
 buffer_load_dwordx4 v251, s[12:15], s28 offen offset:0 lds
 s_waitcnt vmcnt(6)
 v_dot2c_f32_bf16 v88, s32, v40
 v_dot2c_f32_bf16 v92, v40, v40
 s_waitcnt vmcnt(5)
 v_dot2c_f32_bf16 v90, s32, v76
 v_dot2c_f32_bf16 v94, v76, v76
 v_dot2c_f32_bf16 v89, s32, v41
 v_dot2c_f32_bf16 v93, v41, v41
 v_dot2c_f32_bf16 v91, s32, v77
 v_dot2c_f32_bf16 v95, v77, v77
 v_dot2c_f32_bf16 v88, s32, v42
 v_dot2c_f32_bf16 v92, v42, v42
 v_dot2c_f32_bf16 v90, s32, v78
 v_dot2c_f32_bf16 v94, v78, v78
 v_dot2c_f32_bf16 v89, s32, v43
 v_dot2c_f32_bf16 v93, v43, v43
 v_dot2c_f32_bf16 v91, s32, v79
 v_dot2c_f32_bf16 v95, v79, v79
 buffer_load_dwordx4 v252, s[12:15], s28 offen offset:1024 lds
 s_waitcnt vmcnt(5)
 v_dot2c_f32_bf16 v88, s32, v44
 v_dot2c_f32_bf16 v92, v44, v44
 s_waitcnt vmcnt(4)
 v_dot2c_f32_bf16 v90, s32, v80
 v_dot2c_f32_bf16 v94, v80, v80
 v_dot2c_f32_bf16 v89, s32, v45
 v_dot2c_f32_bf16 v93, v45, v45
 v_dot2c_f32_bf16 v91, s32, v81
 v_dot2c_f32_bf16 v95, v81, v81
 v_dot2c_f32_bf16 v88, s32, v46
 v_dot2c_f32_bf16 v92, v46, v46
 v_dot2c_f32_bf16 v90, s32, v82
 v_dot2c_f32_bf16 v94, v82, v82
 v_dot2c_f32_bf16 v89, s32, v47
 v_dot2c_f32_bf16 v93, v47, v47
 v_dot2c_f32_bf16 v91, s32, v83
 v_dot2c_f32_bf16 v95, v83, v83
 buffer_load_dwordx4 v253, s[12:15], s28 offen offset:2048 lds
 s_waitcnt vmcnt(4)
 v_dot2c_f32_bf16 v88, s32, v48
 v_dot2c_f32_bf16 v92, v48, v48
 s_waitcnt vmcnt(3)
 v_dot2c_f32_bf16 v90, s32, v84
 v_dot2c_f32_bf16 v94, v84, v84
 v_dot2c_f32_bf16 v89, s32, v49
 v_dot2c_f32_bf16 v93, v49, v49
 v_dot2c_f32_bf16 v91, s32, v85
 v_dot2c_f32_bf16 v95, v85, v85
 v_dot2c_f32_bf16 v88, s32, v50
 v_dot2c_f32_bf16 v92, v50, v50
 v_dot2c_f32_bf16 v90, s32, v86
 v_dot2c_f32_bf16 v94, v86, v86
 v_dot2c_f32_bf16 v89, s32, v51
 v_dot2c_f32_bf16 v93, v51, v51
 v_dot2c_f32_bf16 v91, s32, v87
 v_dot2c_f32_bf16 v95, v87, v87
 buffer_load_dwordx4 v254, s[12:15], s28 offen offset:3072 lds
 s_add_u32 s28, s28, 110592
 s_cmp_eq_u32 s28, s27
 s_cselect_b32 s28, s26, s28
 v_add_f32 v88, v88, v89
 v_add_f32 v90, v90, v91
 s_nop 0
 v_add_f32_dpp v88, v88, v88 quad_perm:[1,0,3,2] row_mask:0xf bank_mask:0xf
 v_add_f32_dpp v90, v90, v90 quad_perm:[1,0,3,2] row_mask:0xf bank_mask:0xf
 s_nop 0
 v_add_f32_dpp v88, v88, v88 quad_perm:[2,3,0,1] row_mask:0xf bank_mask:0xf
 v_add_f32_dpp v90, v90, v90 quad_perm:[2,3,0,1] row_mask:0xf bank_mask:0xf
 s_nop 0
 v_add_f32_dpp v88, v88, v88 row_half_mirror row_mask:0xf bank_mask:0xf
 v_add_f32_dpp v90, v90, v90 row_half_mirror row_mask:0xf bank_mask:0xf
 v_mul_f32 v88, s35, v88
 v_cvt_pk_bf16_f32 v89, v88, v88
 v_and_b32 v89, 0xffff0000, v89
 v_sub_f32 v89, 0, v89
 v_mul_f32 v90, s35, v90
 v_cvt_pk_bf16_f32 v91, v90, v90
 v_and_b32 v91, 0xffff0000, v91
 v_sub_f32 v91, 0, v91
 v_dot2_f32_bf16 v96, v16, s33, v89
 v_dot2_f32_bf16 v97, v16, s34, v89
 v_dot2_f32_bf16 v98, v17, s33, v89
 v_dot2_f32_bf16 v99, v17, s34, v89
 v_dot2_f32_bf16 v100, v18, s33, v89
 v_dot2_f32_bf16 v101, v18, s34, v89
 v_dot2_f32_bf16 v102, v19, s33, v89
 v_add_f32 v92, v92, v93
 v_dot2_f32_bf16 v103, v19, s34, v89
 v_cvt_pk_bf16_f32 v16, v96, v97
 v_cvt_pk_bf16_f32 v17, v98, v99
 v_cvt_pk_bf16_f32 v18, v100, v101
 v_cvt_pk_bf16_f32 v19, v102, v103
 ds_write_b128 v8, v[16:19] offset:0
 s_add_u32 m0, s29, 4096
 s_nop 0
 buffer_load_dwordx4 v251, s[12:15], s28 offen offset:0 lds
 v_dot2_f32_bf16 v96, v52, s33, v91
 v_dot2_f32_bf16 v97, v52, s34, v91
 v_dot2_f32_bf16 v98, v53, s33, v91
 v_dot2_f32_bf16 v99, v53, s34, v91
 v_dot2_f32_bf16 v100, v54, s33, v91
 v_dot2_f32_bf16 v101, v54, s34, v91
 v_add_f32 v94, v94, v95
 v_dot2_f32_bf16 v102, v55, s33, v91
 v_dot2_f32_bf16 v103, v55, s34, v91
 v_cvt_pk_bf16_f32 v52, v96, v97
 v_cvt_pk_bf16_f32 v53, v98, v99
 v_cvt_pk_bf16_f32 v54, v100, v101
 v_cvt_pk_bf16_f32 v55, v102, v103
 ds_write_b128 v9, v[52:55] offset:0
 v_add_f32_dpp v92, v92, v92 quad_perm:[1,0,3,2] row_mask:0xf bank_mask:0xf
 buffer_load_dwordx4 v252, s[12:15], s28 offen offset:1024 lds
 v_dot2_f32_bf16 v96, v20, s33, v89
 v_dot2_f32_bf16 v97, v20, s34, v89
 v_dot2_f32_bf16 v98, v21, s33, v89
 v_dot2_f32_bf16 v99, v21, s34, v89
 v_dot2_f32_bf16 v100, v22, s33, v89
 v_dot2_f32_bf16 v101, v22, s34, v89
 v_add_f32_dpp v94, v94, v94 quad_perm:[1,0,3,2] row_mask:0xf bank_mask:0xf
 v_dot2_f32_bf16 v102, v23, s33, v89
 v_dot2_f32_bf16 v103, v23, s34, v89
 v_cvt_pk_bf16_f32 v20, v96, v97
 v_cvt_pk_bf16_f32 v21, v98, v99
 v_cvt_pk_bf16_f32 v22, v100, v101
 v_cvt_pk_bf16_f32 v23, v102, v103
 ds_write_b128 v8, v[20:23] offset:2048
 v_add_f32_dpp v92, v92, v92 quad_perm:[2,3,0,1] row_mask:0xf bank_mask:0xf
 buffer_load_dwordx4 v253, s[12:15], s28 offen offset:2048 lds
 v_dot2_f32_bf16 v96, v56, s33, v91
 v_dot2_f32_bf16 v97, v56, s34, v91
 v_dot2_f32_bf16 v98, v57, s33, v91
 v_dot2_f32_bf16 v99, v57, s34, v91
 v_dot2_f32_bf16 v100, v58, s33, v91
 v_dot2_f32_bf16 v101, v58, s34, v91
 v_add_f32_dpp v94, v94, v94 quad_perm:[2,3,0,1] row_mask:0xf bank_mask:0xf
 v_dot2_f32_bf16 v102, v59, s33, v91
 v_dot2_f32_bf16 v103, v59, s34, v91
 v_cvt_pk_bf16_f32 v56, v96, v97
 v_cvt_pk_bf16_f32 v57, v98, v99
 v_cvt_pk_bf16_f32 v58, v100, v101
 v_cvt_pk_bf16_f32 v59, v102, v103
 ds_write_b128 v9, v[56:59] offset:2048
 v_add_f32_dpp v92, v92, v92 row_half_mirror row_mask:0xf bank_mask:0xf
 buffer_load_dwordx4 v254, s[12:15], s28 offen offset:3072 lds
 s_add_u32 s28, s28, 110592
 s_cmp_eq_u32 s28, s27
 s_cselect_b32 s28, s26, s28
 v_dot2_f32_bf16 v96, v24, s33, v89
 v_dot2_f32_bf16 v97, v24, s34, v89
 v_dot2_f32_bf16 v98, v25, s33, v89
 v_add_f32_dpp v94, v94, v94 row_half_mirror row_mask:0xf bank_mask:0xf
 v_dot2_f32_bf16 v99, v25, s34, v89
 v_dot2_f32_bf16 v100, v26, s33, v89
 v_dot2_f32_bf16 v101, v26, s34, v89
 v_dot2_f32_bf16 v102, v27, s33, v89
 v_dot2_f32_bf16 v103, v27, s34, v89
 v_cvt_pk_bf16_f32 v24, v96, v97
 v_cvt_pk_bf16_f32 v25, v98, v99
 v_mul_f32 v88, v88, v88
 v_cvt_pk_bf16_f32 v26, v100, v101
 v_cvt_pk_bf16_f32 v27, v102, v103
 ds_write_b128 v8, v[24:27] offset:4096
 s_add_u32 m0, s29, 8192
 s_nop 0
 buffer_load_dwordx4 v251, s[12:15], s28 offen offset:0 lds
 v_dot2_f32_bf16 v96, v60, s33, v91
 v_dot2_f32_bf16 v97, v60, s34, v91
 v_fma_f32 v92, v92, s35, -v88
 v_dot2_f32_bf16 v98, v61, s33, v91
 v_dot2_f32_bf16 v99, v61, s34, v91
 v_dot2_f32_bf16 v100, v62, s33, v91
 v_dot2_f32_bf16 v101, v62, s34, v91
 v_dot2_f32_bf16 v102, v63, s33, v91
 v_dot2_f32_bf16 v103, v63, s34, v91
 v_cvt_pk_bf16_f32 v60, v96, v97
 v_max_f32 v92, 0, v92
 v_cvt_pk_bf16_f32 v61, v98, v99
 v_cvt_pk_bf16_f32 v62, v100, v101
 v_cvt_pk_bf16_f32 v63, v102, v103
 ds_write_b128 v9, v[60:63] offset:4096
 buffer_load_dwordx4 v252, s[12:15], s28 offen offset:1024 lds
 v_dot2_f32_bf16 v96, v28, s33, v89
 v_dot2_f32_bf16 v97, v28, s34, v89
 v_cvt_pk_bf16_f32 v92, v92, v92
 v_dot2_f32_bf16 v98, v29, s33, v89
 v_dot2_f32_bf16 v99, v29, s34, v89
 v_dot2_f32_bf16 v100, v30, s33, v89
 v_dot2_f32_bf16 v101, v30, s34, v89
 v_dot2_f32_bf16 v102, v31, s33, v89
 v_dot2_f32_bf16 v103, v31, s34, v89
 v_cvt_pk_bf16_f32 v28, v96, v97
 v_and_b32 v92, 0xffff0000, v92
 v_cvt_pk_bf16_f32 v29, v98, v99
 v_cvt_pk_bf16_f32 v30, v100, v101
 v_cvt_pk_bf16_f32 v31, v102, v103
 s_branch L_c1_p0_s
L_c1_p0:
 s_branch L_c1_ret
L_c1_p0_s:
 ds_write_b128 v8, v[28:31] offset:6144
 buffer_load_dwordx4 v253, s[12:15], s28 offen offset:2048 lds
 v_dot2_f32_bf16 v96, v64, s33, v91
 v_dot2_f32_bf16 v97, v64, s34, v91
 v_add_f32 v92, 0x3727c5ac, v92
 v_dot2_f32_bf16 v98, v65, s33, v91
 v_dot2_f32_bf16 v99, v65, s34, v91
 v_dot2_f32_bf16 v100, v66, s33, v91
 v_dot2_f32_bf16 v101, v66, s34, v91
 v_dot2_f32_bf16 v102, v67, s33, v91
 v_dot2_f32_bf16 v103, v67, s34, v91
 v_cvt_pk_bf16_f32 v64, v96, v97
 v_cvt_pk_bf16_f32 v92, v92, v92
 v_cvt_pk_bf16_f32 v65, v98, v99
 v_cvt_pk_bf16_f32 v66, v100, v101
 v_cvt_pk_bf16_f32 v67, v102, v103
 ds_write_b128 v9, v[64:67] offset:6144
 buffer_load_dwordx4 v254, s[12:15], s28 offen offset:3072 lds
 s_add_u32 s28, s28, 110592
 s_cmp_eq_u32 s28, s27
 s_cselect_b32 s28, s26, s28
 v_dot2_f32_bf16 v96, v32, s33, v89
 v_dot2_f32_bf16 v97, v32, s34, v89
 v_dot2_f32_bf16 v98, v33, s33, v89
 v_dot2_f32_bf16 v99, v33, s34, v89
 v_dot2_f32_bf16 v100, v34, s33, v89
 v_dot2_f32_bf16 v101, v34, s34, v89
 v_and_b32 v92, 0xffff0000, v92
 v_dot2_f32_bf16 v102, v35, s33, v89
 v_dot2_f32_bf16 v103, v35, s34, v89
 v_cvt_pk_bf16_f32 v32, v96, v97
 v_cvt_pk_bf16_f32 v33, v98, v99
 v_cvt_pk_bf16_f32 v34, v100, v101
 v_cvt_pk_bf16_f32 v35, v102, v103
 ds_write_b128 v8, v[32:35] offset:8192
 v_sqrt_f32 v92, v92
 s_add_u32 m0, s29, 12288
 s_nop 0
 buffer_load_dwordx4 v251, s[12:15], s28 offen offset:0 lds
 v_dot2_f32_bf16 v96, v68, s33, v91
 v_dot2_f32_bf16 v97, v68, s34, v91
 v_dot2_f32_bf16 v98, v69, s33, v91
 v_dot2_f32_bf16 v99, v69, s34, v91
 v_dot2_f32_bf16 v100, v70, s33, v91
 v_cvt_pk_bf16_f32 v92, v92, v92
 v_dot2_f32_bf16 v101, v70, s34, v91
 v_dot2_f32_bf16 v102, v71, s33, v91
 v_dot2_f32_bf16 v103, v71, s34, v91
 v_cvt_pk_bf16_f32 v68, v96, v97
 v_cvt_pk_bf16_f32 v69, v98, v99
 v_cvt_pk_bf16_f32 v70, v100, v101
 v_cvt_pk_bf16_f32 v71, v102, v103
 v_and_b32 v92, 0xffff0000, v92
 ds_write_b128 v9, v[68:71] offset:8192
 buffer_load_dwordx4 v252, s[12:15], s28 offen offset:1024 lds
 v_dot2_f32_bf16 v96, v36, s33, v89
 v_dot2_f32_bf16 v97, v36, s34, v89
 v_dot2_f32_bf16 v98, v37, s33, v89
 v_dot2_f32_bf16 v99, v37, s34, v89
 v_dot2_f32_bf16 v100, v38, s33, v89
 v_rcp_f32 v92, v92
 v_dot2_f32_bf16 v101, v38, s34, v89
 v_dot2_f32_bf16 v102, v39, s33, v89
 v_dot2_f32_bf16 v103, v39, s34, v89
 v_cvt_pk_bf16_f32 v36, v96, v97
 v_cvt_pk_bf16_f32 v37, v98, v99
 v_cvt_pk_bf16_f32 v38, v100, v101
 v_cvt_pk_bf16_f32 v39, v102, v103
 ds_write_b32 v246, v92 offset:0
 ds_write_b128 v8, v[36:39] offset:10240
 buffer_load_dwordx4 v253, s[12:15], s28 offen offset:2048 lds
 v_dot2_f32_bf16 v96, v72, s33, v91
 v_dot2_f32_bf16 v97, v72, s34, v91
 v_dot2_f32_bf16 v98, v73, s33, v91
 v_dot2_f32_bf16 v99, v73, s34, v91
 v_dot2_f32_bf16 v100, v74, s33, v91
 v_mul_f32 v90, v90, v90
 v_dot2_f32_bf16 v101, v74, s34, v91
 v_dot2_f32_bf16 v102, v75, s33, v91
 v_dot2_f32_bf16 v103, v75, s34, v91
 v_cvt_pk_bf16_f32 v72, v96, v97
 v_cvt_pk_bf16_f32 v73, v98, v99
 v_cvt_pk_bf16_f32 v74, v100, v101
 v_cvt_pk_bf16_f32 v75, v102, v103
 v_fma_f32 v94, v94, s35, -v90
 ds_write_b128 v9, v[72:75] offset:10240
 buffer_load_dwordx4 v254, s[12:15], s28 offen offset:3072 lds
 s_add_u32 s28, s28, 110592
 s_cmp_eq_u32 s28, s27
 s_cselect_b32 s28, s26, s28
 v_dot2_f32_bf16 v96, v40, s33, v89
 v_dot2_f32_bf16 v97, v40, s34, v89
 v_max_f32 v94, 0, v94
 v_dot2_f32_bf16 v98, v41, s33, v89
 v_dot2_f32_bf16 v99, v41, s34, v89
 v_dot2_f32_bf16 v100, v42, s33, v89
 v_dot2_f32_bf16 v101, v42, s34, v89
 v_dot2_f32_bf16 v102, v43, s33, v89
 v_dot2_f32_bf16 v103, v43, s34, v89
 v_cvt_pk_bf16_f32 v40, v96, v97
 v_cvt_pk_bf16_f32 v94, v94, v94
 v_cvt_pk_bf16_f32 v41, v98, v99
 v_cvt_pk_bf16_f32 v42, v100, v101
 v_cvt_pk_bf16_f32 v43, v102, v103
 ds_write_b128 v8, v[40:43] offset:12288
 s_add_u32 m0, s29, 16384
 s_nop 0
 buffer_load_dwordx4 v251, s[12:15], s28 offen offset:0 lds
 v_dot2_f32_bf16 v96, v76, s33, v91
 v_and_b32 v94, 0xffff0000, v94
 v_dot2_f32_bf16 v97, v76, s34, v91
 v_dot2_f32_bf16 v98, v77, s33, v91
 v_dot2_f32_bf16 v99, v77, s34, v91
 v_dot2_f32_bf16 v100, v78, s33, v91
 v_dot2_f32_bf16 v101, v78, s34, v91
 v_dot2_f32_bf16 v102, v79, s33, v91
 v_dot2_f32_bf16 v103, v79, s34, v91
 v_add_f32 v94, 0x3727c5ac, v94
 v_cvt_pk_bf16_f32 v76, v96, v97
 v_cvt_pk_bf16_f32 v77, v98, v99
 v_cvt_pk_bf16_f32 v78, v100, v101
 v_cvt_pk_bf16_f32 v79, v102, v103
 ds_write_b128 v9, v[76:79] offset:12288
 buffer_load_dwordx4 v252, s[12:15], s28 offen offset:1024 lds
 v_dot2_f32_bf16 v96, v44, s33, v89
 v_cvt_pk_bf16_f32 v94, v94, v94
 v_dot2_f32_bf16 v97, v44, s34, v89
 v_dot2_f32_bf16 v98, v45, s33, v89
 v_dot2_f32_bf16 v99, v45, s34, v89
 v_dot2_f32_bf16 v100, v46, s33, v89
 v_dot2_f32_bf16 v101, v46, s34, v89
 v_dot2_f32_bf16 v102, v47, s33, v89
 v_dot2_f32_bf16 v103, v47, s34, v89
 v_and_b32 v94, 0xffff0000, v94
 v_cvt_pk_bf16_f32 v44, v96, v97
 v_cvt_pk_bf16_f32 v45, v98, v99
 v_cvt_pk_bf16_f32 v46, v100, v101
 v_cvt_pk_bf16_f32 v47, v102, v103
 ds_write_b128 v8, v[44:47] offset:14336
 buffer_load_dwordx4 v253, s[12:15], s28 offen offset:2048 lds
 v_dot2_f32_bf16 v96, v80, s33, v91
 v_sqrt_f32 v94, v94
 v_dot2_f32_bf16 v97, v80, s34, v91
 v_dot2_f32_bf16 v98, v81, s33, v91
 v_dot2_f32_bf16 v99, v81, s34, v91
 v_dot2_f32_bf16 v100, v82, s33, v91
 v_dot2_f32_bf16 v101, v82, s34, v91
 v_dot2_f32_bf16 v102, v83, s33, v91
 v_dot2_f32_bf16 v103, v83, s34, v91
 v_cvt_pk_bf16_f32 v94, v94, v94
 v_cvt_pk_bf16_f32 v80, v96, v97
 v_cvt_pk_bf16_f32 v81, v98, v99
 v_cvt_pk_bf16_f32 v82, v100, v101
 v_cvt_pk_bf16_f32 v83, v102, v103
 ds_write_b128 v9, v[80:83] offset:14336
 buffer_load_dwordx4 v254, s[12:15], s28 offen offset:3072 lds
 s_add_u32 s28, s28, 110592
 s_cmp_eq_u32 s28, s27
 s_cselect_b32 s28, s26, s28
 v_dot2_f32_bf16 v96, v48, s33, v89
 v_dot2_f32_bf16 v97, v48, s34, v89
 v_dot2_f32_bf16 v98, v49, s33, v89
 v_dot2_f32_bf16 v99, v49, s34, v89
 v_dot2_f32_bf16 v100, v50, s33, v89
 v_and_b32 v94, 0xffff0000, v94
 v_dot2_f32_bf16 v101, v50, s34, v89
 v_dot2_f32_bf16 v102, v51, s33, v89
 v_dot2_f32_bf16 v103, v51, s34, v89
 v_cvt_pk_bf16_f32 v48, v96, v97
 v_cvt_pk_bf16_f32 v49, v98, v99
 v_cvt_pk_bf16_f32 v50, v100, v101
 v_cvt_pk_bf16_f32 v51, v102, v103
 v_rcp_f32 v94, v94
 ds_write_b128 v8, v[48:51] offset:16384
 s_waitcnt vmcnt(16)
 ds_read_b64_tr_b16 a[0:1], v240 offset:0
 ds_read_b64_tr_b16 a[2:3], v240 offset:2048
 ds_read_b64_tr_b16 a[4:5], v241 offset:0
 ds_read_b64_tr_b16 a[6:7], v241 offset:2048
 ds_read_b64_tr_b16 a[8:9], v242 offset:0
 ds_write_b32 v246, v94 offset:32
 ds_read_b64_tr_b16 a[10:11], v242 offset:2048
 ds_read_b64_tr_b16 a[12:13], v243 offset:0
 ds_read_b64_tr_b16 a[14:15], v243 offset:2048
 v_dot2_f32_bf16 v96, v84, s33, v91
 v_dot2_f32_bf16 v97, v84, s34, v91
 v_dot2_f32_bf16 v98, v85, s33, v91
 v_dot2_f32_bf16 v99, v85, s34, v91
 v_dot2_f32_bf16 v100, v86, s33, v91
 v_dot2_f32_bf16 v101, v86, s34, v91
 v_dot2_f32_bf16 v102, v87, s33, v91
 v_dot2_f32_bf16 v103, v87, s34, v91
 v_cvt_pk_bf16_f32 v84, v96, v97
 v_cvt_pk_bf16_f32 v85, v98, v99
 v_cvt_pk_bf16_f32 v86, v100, v101
 v_cvt_pk_bf16_f32 v87, v102, v103
 ds_write_b128 v9, v[84:87] offset:16384
 s_waitcnt lgkmcnt(1)
 s_add_u32 m0, s29, 0
 s_nop 0
 buffer_load_dwordx4 v251, s[12:15], s28 offen offset:0 lds
 buffer_load_dwordx4 v252, s[12:15], s28 offen offset:1024 lds
 buffer_load_dwordx4 v253, s[12:15], s28 offen offset:2048 lds
 buffer_load_dwordx4 v254, s[12:15], s28 offen offset:3072 lds
 s_add_u32 s28, s28, 110592
 s_cmp_eq_u32 s28, s27
 s_cselect_b32 s28, s26, s28
 v_mov_b32 v10, v247
 v_xor_b32 v11, 64, v247
 v_add_u32 v12, 36864, v10
 v_add_u32 v13, 36864, v11
 s_waitcnt lgkmcnt(0)
 s_barrier
 ds_read_b128 v[192:195], v10 offset:0
 ds_read_b128 v[196:199], v10 offset:18432
 s_waitcnt lgkmcnt(1)
 v_mfma_f32_16x16x32_bf16 v[160:163], v[192:195], a[0:3], 0
 ds_read_b128 v[200:203], v11 offset:1024
 s_waitcnt lgkmcnt(1)
 v_mfma_f32_16x16x32_bf16 v[164:167], v[196:199], a[0:3], 0
 ds_read_b128 v[204:207], v11 offset:19456
 v_mfma_f32_16x16x32_bf16 v[168:171], v[192:195], a[4:7], 0
 s_waitcnt vmcnt(16)
 ds_read_b64_tr_b16 a[16:17], v240 offset:4096
 ds_read_b64_tr_b16 a[18:19], v240 offset:6144
 v_mfma_f32_16x16x32_bf16 v[172:175], v[196:199], a[4:7], 0
 ds_read_b64_tr_b16 a[20:21], v241 offset:4096
 ds_read_b64_tr_b16 a[22:23], v241 offset:6144
 v_mfma_f32_16x16x32_bf16 v[176:179], v[192:195], a[8:11], 0
 ds_read_b64_tr_b16 a[24:25], v242 offset:4096
 ds_read_b64_tr_b16 a[26:27], v242 offset:6144
 v_mfma_f32_16x16x32_bf16 v[180:183], v[196:199], a[8:11], 0
 ds_read_b64_tr_b16 a[28:29], v243 offset:4096
 ds_read_b64_tr_b16 a[30:31], v243 offset:6144
 v_mfma_f32_16x16x32_bf16 v[184:187], v[192:195], a[12:15], 0
 ds_read_b128 v[16:19], v12 offset:0
 v_mfma_f32_16x16x32_bf16 v[188:191], v[196:199], a[12:15], 0
 ds_read_b128 v[88:91], v12 offset:18432
 s_waitcnt lgkmcnt(8)
 v_mfma_f32_16x16x32_bf16 v[160:163], v[200:203], a[16:19], v[160:163]
 s_waitcnt lgkmcnt(2)
 s_add_u32 m0, s29, 4096
 s_nop 0
 buffer_load_dwordx4 v251, s[12:15], s28 offen offset:0 lds
 ds_read_b128 v[192:195], v10 offset:2048
 v_mfma_f32_16x16x32_bf16 v[164:167], v[204:207], a[16:19], v[164:167]
 ds_read_b128 v[196:199], v10 offset:20480
 v_mfma_f32_16x16x32_bf16 v[168:171], v[200:203], a[20:23], v[168:171]
 buffer_load_dwordx4 v252, s[12:15], s28 offen offset:1024 lds
 s_waitcnt vmcnt(14)
 ds_read_b64_tr_b16 a[32:33], v240 offset:8192
 ds_read_b64_tr_b16 a[34:35], v240 offset:10240
 v_mfma_f32_16x16x32_bf16 v[172:175], v[204:207], a[20:23], v[172:175]
 ds_read_b64_tr_b16 a[36:37], v241 offset:8192
 ds_read_b64_tr_b16 a[38:39], v241 offset:10240
 v_mfma_f32_16x16x32_bf16 v[176:179], v[200:203], a[24:27], v[176:179]
 buffer_load_dwordx4 v253, s[12:15], s28 offen offset:2048 lds
 ds_read_b64_tr_b16 a[40:41], v242 offset:8192
 ds_read_b64_tr_b16 a[42:43], v242 offset:10240
 v_mfma_f32_16x16x32_bf16 v[180:183], v[204:207], a[24:27], v[180:183]
 ds_read_b64_tr_b16 a[44:45], v243 offset:8192
 ds_read_b64_tr_b16 a[46:47], v243 offset:10240
 v_mfma_f32_16x16x32_bf16 v[184:187], v[200:203], a[28:31], v[184:187]
 buffer_load_dwordx4 v254, s[12:15], s28 offen offset:3072 lds
 s_add_u32 s28, s28, 110592
 s_cmp_eq_u32 s28, s27
 s_cselect_b32 s28, s26, s28
 ds_read_b128 v[20:23], v13 offset:1024
 v_mfma_f32_16x16x32_bf16 v[188:191], v[204:207], a[28:31], v[188:191]
 ds_read_b128 v[92:95], v13 offset:19456
 s_waitcnt lgkmcnt(8)
 v_mfma_f32_16x16x32_bf16 v[160:163], v[192:195], a[32:35], v[160:163]
 s_waitcnt lgkmcnt(2)
 s_add_u32 m0, s29, 8192
 s_nop 0
 buffer_load_dwordx4 v251, s[12:15], s28 offen offset:0 lds
 ds_read_b128 v[200:203], v11 offset:3072
 v_mfma_f32_16x16x32_bf16 v[164:167], v[196:199], a[32:35], v[164:167]
 ds_read_b128 v[204:207], v11 offset:21504
 v_mfma_f32_16x16x32_bf16 v[168:171], v[192:195], a[36:39], v[168:171]
 buffer_load_dwordx4 v252, s[12:15], s28 offen offset:1024 lds
 s_waitcnt vmcnt(14)
 ds_read_b64_tr_b16 a[48:49], v240 offset:12288
 ds_read_b64_tr_b16 a[50:51], v240 offset:14336
 v_mfma_f32_16x16x32_bf16 v[172:175], v[196:199], a[36:39], v[172:175]
 ds_read_b64_tr_b16 a[52:53], v241 offset:12288
 ds_read_b64_tr_b16 a[54:55], v241 offset:14336
 v_mfma_f32_16x16x32_bf16 v[176:179], v[192:195], a[40:43], v[176:179]
 buffer_load_dwordx4 v253, s[12:15], s28 offen offset:2048 lds
 ds_read_b64_tr_b16 a[56:57], v242 offset:12288
 ds_read_b64_tr_b16 a[58:59], v242 offset:14336
 v_mfma_f32_16x16x32_bf16 v[180:183], v[196:199], a[40:43], v[180:183]
 ds_read_b64_tr_b16 a[60:61], v243 offset:12288
 ds_read_b64_tr_b16 a[62:63], v243 offset:14336
 v_mfma_f32_16x16x32_bf16 v[184:187], v[192:195], a[44:47], v[184:187]
 buffer_load_dwordx4 v254, s[12:15], s28 offen offset:3072 lds
 s_add_u32 s28, s28, 110592
 s_cmp_eq_u32 s28, s27
 s_cselect_b32 s28, s26, s28
 ds_read_b128 v[24:27], v12 offset:2048
 v_mfma_f32_16x16x32_bf16 v[188:191], v[196:199], a[44:47], v[188:191]
 ds_read_b128 v[96:99], v12 offset:20480
 s_waitcnt lgkmcnt(8)
 v_mfma_f32_16x16x32_bf16 v[160:163], v[200:203], a[48:51], v[160:163]
 s_waitcnt lgkmcnt(2)
 s_add_u32 m0, s29, 12288
 s_nop 0
 buffer_load_dwordx4 v251, s[12:15], s28 offen offset:0 lds
 ds_read_b128 v[192:195], v10 offset:4096
 v_mfma_f32_16x16x32_bf16 v[164:167], v[204:207], a[48:51], v[164:167]
 ds_read_b128 v[196:199], v10 offset:22528
 v_mfma_f32_16x16x32_bf16 v[168:171], v[200:203], a[52:55], v[168:171]
 buffer_load_dwordx4 v252, s[12:15], s28 offen offset:1024 lds
 s_waitcnt vmcnt(14)
 ds_read_b64_tr_b16 a[64:65], v240 offset:16384
 ds_read_b64_tr_b16 a[66:67], v240 offset:18432
 v_mfma_f32_16x16x32_bf16 v[172:175], v[204:207], a[52:55], v[172:175]
 ds_read_b64_tr_b16 a[68:69], v241 offset:16384
 ds_read_b64_tr_b16 a[70:71], v241 offset:18432
 v_mfma_f32_16x16x32_bf16 v[176:179], v[200:203], a[56:59], v[176:179]
 buffer_load_dwordx4 v253, s[12:15], s28 offen offset:2048 lds
 ds_read_b64_tr_b16 a[72:73], v242 offset:16384
 ds_read_b64_tr_b16 a[74:75], v242 offset:18432
 v_mfma_f32_16x16x32_bf16 v[180:183], v[204:207], a[56:59], v[180:183]
 ds_read_b64_tr_b16 a[76:77], v243 offset:16384
 ds_read_b64_tr_b16 a[78:79], v243 offset:18432
 v_mfma_f32_16x16x32_bf16 v[184:187], v[200:203], a[60:63], v[184:187]
 buffer_load_dwordx4 v254, s[12:15], s28 offen offset:3072 lds
 s_add_u32 s28, s28, 110592
 s_cmp_eq_u32 s28, s27
 s_cselect_b32 s28, s26, s28
 ds_read_b128 v[28:31], v13 offset:3072
 v_mfma_f32_16x16x32_bf16 v[188:191], v[204:207], a[60:63], v[188:191]
 ds_read_b128 v[100:103], v13 offset:21504
 s_waitcnt lgkmcnt(8)
 v_mfma_f32_16x16x32_bf16 v[160:163], v[192:195], a[64:67], v[160:163]
 s_waitcnt lgkmcnt(2)
 s_add_u32 m0, s29, 16384
 s_nop 0
 buffer_load_dwordx4 v251, s[12:15], s28 offen offset:0 lds
 ds_read_b128 v[200:203], v11 offset:5120
 v_mfma_f32_16x16x32_bf16 v[164:167], v[196:199], a[64:67], v[164:167]
 ds_read_b128 v[204:207], v11 offset:23552
 v_mfma_f32_16x16x32_bf16 v[168:171], v[192:195], a[68:71], v[168:171]
 buffer_load_dwordx4 v252, s[12:15], s28 offen offset:1024 lds
 s_waitcnt vmcnt(14)
 ds_read_b64_tr_b16 a[80:81], v240 offset:0
 ds_read_b64_tr_b16 a[82:83], v240 offset:2048
 v_mfma_f32_16x16x32_bf16 v[172:175], v[196:199], a[68:71], v[172:175]
 ds_read_b64_tr_b16 a[84:85], v241 offset:0
 ds_read_b64_tr_b16 a[86:87], v241 offset:2048
 v_mfma_f32_16x16x32_bf16 v[176:179], v[192:195], a[72:75], v[176:179]
 buffer_load_dwordx4 v253, s[12:15], s28 offen offset:2048 lds
 ds_read_b64_tr_b16 a[88:89], v242 offset:0
 ds_read_b64_tr_b16 a[90:91], v242 offset:2048
 v_mfma_f32_16x16x32_bf16 v[180:183], v[196:199], a[72:75], v[180:183]
 ds_read_b64_tr_b16 a[92:93], v243 offset:0
 ds_read_b64_tr_b16 a[94:95], v243 offset:2048
 v_mfma_f32_16x16x32_bf16 v[184:187], v[192:195], a[76:79], v[184:187]
 buffer_load_dwordx4 v254, s[12:15], s28 offen offset:3072 lds
 s_add_u32 s28, s28, 110592
 s_cmp_eq_u32 s28, s27
 s_cselect_b32 s28, s26, s28
 ds_read_b128 v[32:35], v12 offset:4096
 v_mfma_f32_16x16x32_bf16 v[188:191], v[196:199], a[76:79], v[188:191]
 ds_read_b128 v[104:107], v12 offset:22528
 s_waitcnt lgkmcnt(8)
 v_mfma_f32_16x16x32_bf16 v[160:163], v[200:203], a[80:83], v[160:163]
 s_waitcnt lgkmcnt(2)
 s_add_u32 m0, s29, 0
 s_nop 0
 buffer_load_dwordx4 v251, s[12:15], s28 offen offset:0 lds
 ds_read_b128 v[192:195], v10 offset:6144
 v_mfma_f32_16x16x32_bf16 v[164:167], v[204:207], a[80:83], v[164:167]
 ds_read_b128 v[196:199], v10 offset:24576
 v_mfma_f32_16x16x32_bf16 v[168:171], v[200:203], a[84:87], v[168:171]
 buffer_load_dwordx4 v252, s[12:15], s28 offen offset:1024 lds
 s_waitcnt vmcnt(14)
 ds_read_b64_tr_b16 a[96:97], v240 offset:4096
 ds_read_b64_tr_b16 a[98:99], v240 offset:6144
 v_mfma_f32_16x16x32_bf16 v[172:175], v[204:207], a[84:87], v[172:175]
 ds_read_b64_tr_b16 a[100:101], v241 offset:4096
 ds_read_b64_tr_b16 a[102:103], v241 offset:6144
 v_mfma_f32_16x16x32_bf16 v[176:179], v[200:203], a[88:91], v[176:179]
 buffer_load_dwordx4 v253, s[12:15], s28 offen offset:2048 lds
 ds_read_b64_tr_b16 a[104:105], v242 offset:4096
 ds_read_b64_tr_b16 a[106:107], v242 offset:6144
 v_mfma_f32_16x16x32_bf16 v[180:183], v[204:207], a[88:91], v[180:183]
 ds_read_b64_tr_b16 a[108:109], v243 offset:4096
 ds_read_b64_tr_b16 a[110:111], v243 offset:6144
 v_mfma_f32_16x16x32_bf16 v[184:187], v[200:203], a[92:95], v[184:187]
 buffer_load_dwordx4 v254, s[12:15], s28 offen offset:3072 lds
 s_add_u32 s28, s28, 110592
 s_cmp_eq_u32 s28, s27
 s_cselect_b32 s28, s26, s28
 ds_read_b128 v[36:39], v13 offset:5120
 v_mfma_f32_16x16x32_bf16 v[188:191], v[204:207], a[92:95], v[188:191]
 ds_read_b128 v[108:111], v13 offset:23552
 s_waitcnt lgkmcnt(8)
 v_mfma_f32_16x16x32_bf16 v[160:163], v[192:195], a[96:99], v[160:163]
 s_waitcnt lgkmcnt(2)
 s_add_u32 m0, s29, 4096
 s_nop 0
 buffer_load_dwordx4 v251, s[12:15], s28 offen offset:0 lds
 ds_read_b128 v[200:203], v11 offset:7168
 v_mfma_f32_16x16x32_bf16 v[164:167], v[196:199], a[96:99], v[164:167]
 ds_read_b128 v[204:207], v11 offset:25600
 v_mfma_f32_16x16x32_bf16 v[168:171], v[192:195], a[100:103], v[168:171]
 buffer_load_dwordx4 v252, s[12:15], s28 offen offset:1024 lds
 s_waitcnt vmcnt(14)
 ds_read_b64_tr_b16 a[112:113], v240 offset:8192
 ds_read_b64_tr_b16 a[114:115], v240 offset:10240
 v_mfma_f32_16x16x32_bf16 v[172:175], v[196:199], a[100:103], v[172:175]
 ds_read_b64_tr_b16 a[116:117], v241 offset:8192
 ds_read_b64_tr_b16 a[118:119], v241 offset:10240
 v_mfma_f32_16x16x32_bf16 v[176:179], v[192:195], a[104:107], v[176:179]
 buffer_load_dwordx4 v253, s[12:15], s28 offen offset:2048 lds
 ds_read_b64_tr_b16 a[120:121], v242 offset:8192
 ds_read_b64_tr_b16 a[122:123], v242 offset:10240
 v_mfma_f32_16x16x32_bf16 v[180:183], v[196:199], a[104:107], v[180:183]
 ds_read_b64_tr_b16 a[124:125], v243 offset:8192
 ds_read_b64_tr_b16 a[126:127], v243 offset:10240
 v_mfma_f32_16x16x32_bf16 v[184:187], v[192:195], a[108:111], v[184:187]
 buffer_load_dwordx4 v254, s[12:15], s28 offen offset:3072 lds
 s_add_u32 s28, s28, 110592
 s_cmp_eq_u32 s28, s27
 s_cselect_b32 s28, s26, s28
 ds_read_b128 v[40:43], v12 offset:6144
 v_mfma_f32_16x16x32_bf16 v[188:191], v[196:199], a[108:111], v[188:191]
 ds_read_b128 v[112:115], v12 offset:24576
 s_waitcnt lgkmcnt(8)
 v_mfma_f32_16x16x32_bf16 v[160:163], v[200:203], a[112:115], v[160:163]
 s_waitcnt lgkmcnt(2)
 s_add_u32 m0, s29, 8192
 s_nop 0
 buffer_load_dwordx4 v251, s[12:15], s28 offen offset:0 lds
 ds_read_b128 v[192:195], v10 offset:8192
 v_mfma_f32_16x16x32_bf16 v[164:167], v[204:207], a[112:115], v[164:167]
 ds_read_b128 v[196:199], v10 offset:26624
 v_mfma_f32_16x16x32_bf16 v[168:171], v[200:203], a[116:119], v[168:171]
 buffer_load_dwordx4 v252, s[12:15], s28 offen offset:1024 lds
 s_waitcnt vmcnt(14)
 ds_read_b64_tr_b16 a[128:129], v240 offset:12288
 ds_read_b64_tr_b16 a[130:131], v240 offset:14336
 v_mfma_f32_16x16x32_bf16 v[172:175], v[204:207], a[116:119], v[172:175]
 ds_read_b64_tr_b16 a[132:133], v241 offset:12288
 ds_read_b64_tr_b16 a[134:135], v241 offset:14336
 v_mfma_f32_16x16x32_bf16 v[176:179], v[200:203], a[120:123], v[176:179]
 buffer_load_dwordx4 v253, s[12:15], s28 offen offset:2048 lds
 ds_read_b64_tr_b16 a[136:137], v242 offset:12288
 ds_read_b64_tr_b16 a[138:139], v242 offset:14336
 v_mfma_f32_16x16x32_bf16 v[180:183], v[204:207], a[120:123], v[180:183]
 ds_read_b64_tr_b16 a[140:141], v243 offset:12288
 ds_read_b64_tr_b16 a[142:143], v243 offset:14336
 v_mfma_f32_16x16x32_bf16 v[184:187], v[200:203], a[124:127], v[184:187]
 buffer_load_dwordx4 v254, s[12:15], s28 offen offset:3072 lds
 s_add_u32 s28, s28, 110592
 s_cmp_eq_u32 s28, s27
 s_cselect_b32 s28, s26, s28
 ds_read_b128 v[44:47], v13 offset:7168
 v_mfma_f32_16x16x32_bf16 v[188:191], v[204:207], a[124:127], v[188:191]
 ds_read_b128 v[116:119], v13 offset:25600
 s_waitcnt lgkmcnt(8)
 v_mfma_f32_16x16x32_bf16 v[160:163], v[192:195], a[128:131], v[160:163]
 s_waitcnt lgkmcnt(2)
 s_add_u32 m0, s29, 12288
 s_nop 0
 buffer_load_dwordx4 v251, s[12:15], s28 offen offset:0 lds
 ds_read_b128 v[200:203], v11 offset:9216
 v_mfma_f32_16x16x32_bf16 v[164:167], v[196:199], a[128:131], v[164:167]
 ds_read_b128 v[204:207], v11 offset:27648
 v_mfma_f32_16x16x32_bf16 v[168:171], v[192:195], a[132:135], v[168:171]
 buffer_load_dwordx4 v252, s[12:15], s28 offen offset:1024 lds
 s_waitcnt vmcnt(14)
 ds_read_b64_tr_b16 a[144:145], v240 offset:16384
 ds_read_b64_tr_b16 a[146:147], v240 offset:18432
 v_mfma_f32_16x16x32_bf16 v[172:175], v[196:199], a[132:135], v[172:175]
 ds_read_b64_tr_b16 a[148:149], v241 offset:16384
 ds_read_b64_tr_b16 a[150:151], v241 offset:18432
 v_mfma_f32_16x16x32_bf16 v[176:179], v[192:195], a[136:139], v[176:179]
 buffer_load_dwordx4 v253, s[12:15], s28 offen offset:2048 lds
 ds_read_b64_tr_b16 a[152:153], v242 offset:16384
 ds_read_b64_tr_b16 a[154:155], v242 offset:18432
 v_mfma_f32_16x16x32_bf16 v[180:183], v[196:199], a[136:139], v[180:183]
 ds_read_b64_tr_b16 a[156:157], v243 offset:16384
 ds_read_b64_tr_b16 a[158:159], v243 offset:18432
 v_mfma_f32_16x16x32_bf16 v[184:187], v[192:195], a[140:143], v[184:187]
 buffer_load_dwordx4 v254, s[12:15], s28 offen offset:3072 lds
 s_add_u32 s28, s28, 110592
 s_cmp_eq_u32 s28, s27
 s_cselect_b32 s28, s26, s28
 ds_read_b128 v[48:51], v12 offset:8192
 v_mfma_f32_16x16x32_bf16 v[188:191], v[196:199], a[140:143], v[188:191]
 ds_read_b128 v[120:123], v12 offset:26624
 s_waitcnt lgkmcnt(8)
 v_mfma_f32_16x16x32_bf16 v[160:163], v[200:203], a[144:147], v[160:163]
 s_waitcnt lgkmcnt(2)
 s_add_u32 m0, s29, 16384
 s_nop 0
 buffer_load_dwordx4 v251, s[12:15], s28 offen offset:0 lds
 ds_read_b128 v[192:195], v10 offset:10240
 v_mfma_f32_16x16x32_bf16 v[164:167], v[204:207], a[144:147], v[164:167]
 ds_read_b128 v[196:199], v10 offset:28672
 v_mfma_f32_16x16x32_bf16 v[168:171], v[200:203], a[148:151], v[168:171]
 buffer_load_dwordx4 v252, s[12:15], s28 offen offset:1024 lds
 s_waitcnt vmcnt(14)
 ds_read_b64_tr_b16 a[160:161], v240 offset:0
 ds_read_b64_tr_b16 a[162:163], v240 offset:2048
 v_mfma_f32_16x16x32_bf16 v[172:175], v[204:207], a[148:151], v[172:175]
 ds_read_b64_tr_b16 a[164:165], v241 offset:0
 ds_read_b64_tr_b16 a[166:167], v241 offset:2048
 v_mfma_f32_16x16x32_bf16 v[176:179], v[200:203], a[152:155], v[176:179]
 buffer_load_dwordx4 v253, s[12:15], s28 offen offset:2048 lds
 ds_read_b64_tr_b16 a[168:169], v242 offset:0
 ds_read_b64_tr_b16 a[170:171], v242 offset:2048
 v_mfma_f32_16x16x32_bf16 v[180:183], v[204:207], a[152:155], v[180:183]
 ds_read_b64_tr_b16 a[172:173], v243 offset:0
 ds_read_b64_tr_b16 a[174:175], v243 offset:2048
 v_mfma_f32_16x16x32_bf16 v[184:187], v[200:203], a[156:159], v[184:187]
 buffer_load_dwordx4 v254, s[12:15], s28 offen offset:3072 lds
 s_add_u32 s28, s28, 110592
 s_cmp_eq_u32 s28, s27
 s_cselect_b32 s28, s26, s28
 ds_read_b128 v[52:55], v13 offset:9216
 v_mfma_f32_16x16x32_bf16 v[188:191], v[204:207], a[156:159], v[188:191]
 ds_read_b128 v[124:127], v13 offset:27648
 s_waitcnt lgkmcnt(8)
 v_mfma_f32_16x16x32_bf16 v[160:163], v[192:195], a[160:163], v[160:163]
 s_waitcnt lgkmcnt(2)
 s_add_u32 m0, s29, 0
 s_nop 0
 buffer_load_dwordx4 v251, s[12:15], s28 offen offset:0 lds
 ds_read_b128 v[200:203], v11 offset:11264
 v_mfma_f32_16x16x32_bf16 v[164:167], v[196:199], a[160:163], v[164:167]
 ds_read_b128 v[204:207], v11 offset:29696
 v_mfma_f32_16x16x32_bf16 v[168:171], v[192:195], a[164:167], v[168:171]
 buffer_load_dwordx4 v252, s[12:15], s28 offen offset:1024 lds
 s_waitcnt vmcnt(14)
 ds_read_b64_tr_b16 a[176:177], v240 offset:4096
 ds_read_b64_tr_b16 a[178:179], v240 offset:6144
 v_mfma_f32_16x16x32_bf16 v[172:175], v[196:199], a[164:167], v[172:175]
 ds_read_b64_tr_b16 a[180:181], v241 offset:4096
 ds_read_b64_tr_b16 a[182:183], v241 offset:6144
 v_mfma_f32_16x16x32_bf16 v[176:179], v[192:195], a[168:171], v[176:179]
 buffer_load_dwordx4 v253, s[12:15], s28 offen offset:2048 lds
 ds_read_b64_tr_b16 a[184:185], v242 offset:4096
 ds_read_b64_tr_b16 a[186:187], v242 offset:6144
 v_mfma_f32_16x16x32_bf16 v[180:183], v[196:199], a[168:171], v[180:183]
 ds_read_b64_tr_b16 a[188:189], v243 offset:4096
 ds_read_b64_tr_b16 a[190:191], v243 offset:6144
 v_mfma_f32_16x16x32_bf16 v[184:187], v[192:195], a[172:175], v[184:187]
 buffer_load_dwordx4 v254, s[12:15], s28 offen offset:3072 lds
 s_add_u32 s28, s28, 110592
 s_cmp_eq_u32 s28, s27
 s_cselect_b32 s28, s26, s28
 ds_read_b128 v[56:59], v12 offset:10240
 s_branch L_c1_p1_s
L_c1_p1:
 s_branch L_c1_ret
L_c1_p1_s:
 v_mfma_f32_16x16x32_bf16 v[188:191], v[196:199], a[172:175], v[188:191]
 ds_read_b128 v[128:131], v12 offset:28672
 s_waitcnt lgkmcnt(8)
 v_mfma_f32_16x16x32_bf16 v[160:163], v[200:203], a[176:179], v[160:163]
 s_waitcnt lgkmcnt(2)
 s_add_u32 m0, s29, 4096
 s_nop 0
 buffer_load_dwordx4 v251, s[12:15], s28 offen offset:0 lds
 ds_read_b128 v[192:195], v10 offset:12288
 v_mfma_f32_16x16x32_bf16 v[164:167], v[204:207], a[176:179], v[164:167]
 ds_read_b128 v[196:199], v10 offset:30720
 v_mfma_f32_16x16x32_bf16 v[168:171], v[200:203], a[180:183], v[168:171]
 buffer_load_dwordx4 v252, s[12:15], s28 offen offset:1024 lds
 s_waitcnt vmcnt(14)
 ds_read_b64_tr_b16 a[192:193], v240 offset:8192
 ds_read_b64_tr_b16 a[194:195], v240 offset:10240
 v_mfma_f32_16x16x32_bf16 v[172:175], v[204:207], a[180:183], v[172:175]
 ds_read_b64_tr_b16 a[196:197], v241 offset:8192
 ds_read_b64_tr_b16 a[198:199], v241 offset:10240
 v_mfma_f32_16x16x32_bf16 v[176:179], v[200:203], a[184:187], v[176:179]
 buffer_load_dwordx4 v253, s[12:15], s28 offen offset:2048 lds
 ds_read_b64_tr_b16 a[200:201], v242 offset:8192
 ds_read_b64_tr_b16 a[202:203], v242 offset:10240
 v_mfma_f32_16x16x32_bf16 v[180:183], v[204:207], a[184:187], v[180:183]
 ds_read_b64_tr_b16 a[204:205], v243 offset:8192
 ds_read_b64_tr_b16 a[206:207], v243 offset:10240
 v_mfma_f32_16x16x32_bf16 v[184:187], v[200:203], a[188:191], v[184:187]
 buffer_load_dwordx4 v254, s[12:15], s28 offen offset:3072 lds
 s_add_u32 s28, s28, 110592
 s_cmp_eq_u32 s28, s27
 s_cselect_b32 s28, s26, s28
 ds_read_b128 v[60:63], v13 offset:11264
 v_mfma_f32_16x16x32_bf16 v[188:191], v[204:207], a[188:191], v[188:191]
 ds_read_b128 v[132:135], v13 offset:29696
 s_waitcnt lgkmcnt(8)
 v_mfma_f32_16x16x32_bf16 v[160:163], v[192:195], a[192:195], v[160:163]
 s_waitcnt lgkmcnt(2)
 s_add_u32 m0, s29, 8192
 s_nop 0
 buffer_load_dwordx4 v251, s[12:15], s28 offen offset:0 lds
 ds_read_b128 v[200:203], v11 offset:13312
 v_mov_b32 v248, 0
 global_load_dword v248, v248, s[92:93] sc1
 v_mfma_f32_16x16x32_bf16 v[164:167], v[196:199], a[192:195], v[164:167]
 ds_read_b128 v[204:207], v11 offset:31744
 v_mfma_f32_16x16x32_bf16 v[168:171], v[192:195], a[196:199], v[168:171]
 buffer_load_dwordx4 v252, s[12:15], s28 offen offset:1024 lds
 s_waitcnt vmcnt(15)
 ds_read_b64_tr_b16 a[208:209], v240 offset:12288
 ds_read_b64_tr_b16 a[210:211], v240 offset:14336
 v_mfma_f32_16x16x32_bf16 v[172:175], v[196:199], a[196:199], v[172:175]
 ds_read_b64_tr_b16 a[212:213], v241 offset:12288
 ds_read_b64_tr_b16 a[214:215], v241 offset:14336
 v_mfma_f32_16x16x32_bf16 v[176:179], v[192:195], a[200:203], v[176:179]
 buffer_load_dwordx4 v253, s[12:15], s28 offen offset:2048 lds
 ds_read_b64_tr_b16 a[216:217], v242 offset:12288
 ds_read_b64_tr_b16 a[218:219], v242 offset:14336
 v_mfma_f32_16x16x32_bf16 v[180:183], v[196:199], a[200:203], v[180:183]
 ds_read_b64_tr_b16 a[220:221], v243 offset:12288
 ds_read_b64_tr_b16 a[222:223], v243 offset:14336
 v_mfma_f32_16x16x32_bf16 v[184:187], v[192:195], a[204:207], v[184:187]
 buffer_load_dwordx4 v254, s[12:15], s28 offen offset:3072 lds
 s_add_u32 s28, s28, 110592
 s_cmp_eq_u32 s28, s27
 s_cselect_b32 s28, s26, s28
 ds_read_b128 v[64:67], v12 offset:12288
 v_mfma_f32_16x16x32_bf16 v[188:191], v[196:199], a[204:207], v[188:191]
 ds_read_b128 v[136:139], v12 offset:30720
 s_waitcnt lgkmcnt(8)
 v_mfma_f32_16x16x32_bf16 v[160:163], v[200:203], a[208:211], v[160:163]
 ds_read_b128 v[192:195], v10 offset:14336
 v_mfma_f32_16x16x32_bf16 v[164:167], v[204:207], a[208:211], v[164:167]
 ds_read_b128 v[196:199], v10 offset:32768
 s_waitcnt lgkmcnt(8)
 v_mfma_f32_16x16x32_bf16 v[168:171], v[200:203], a[212:215], v[168:171]
 s_waitcnt vmcnt(13)
 ds_read_b64_tr_b16 a[224:225], v240 offset:16384
 ds_read_b64_tr_b16 a[226:227], v240 offset:18432
 v_mfma_f32_16x16x32_bf16 v[172:175], v[204:207], a[212:215], v[172:175]
 ds_read_b64_tr_b16 a[228:229], v241 offset:16384
 ds_read_b64_tr_b16 a[230:231], v241 offset:18432
 s_waitcnt lgkmcnt(10)
 v_mfma_f32_16x16x32_bf16 v[176:179], v[200:203], a[216:219], v[176:179]
 ds_read_b64_tr_b16 a[232:233], v242 offset:16384
 ds_read_b64_tr_b16 a[234:235], v242 offset:18432
 v_mfma_f32_16x16x32_bf16 v[180:183], v[204:207], a[216:219], v[180:183]
 ds_read_b64_tr_b16 a[236:237], v243 offset:16384
 ds_read_b64_tr_b16 a[238:239], v243 offset:18432
 s_waitcnt lgkmcnt(12)
 v_mfma_f32_16x16x32_bf16 v[184:187], v[200:203], a[220:223], v[184:187]
 ds_read_b128 v[68:71], v13 offset:13312
 v_mfma_f32_16x16x32_bf16 v[188:191], v[204:207], a[220:223], v[188:191]
 ds_read_b128 v[140:143], v13 offset:31744
 s_waitcnt lgkmcnt(8)
 v_mfma_f32_16x16x32_bf16 v[160:163], v[192:195], a[224:227], v[160:163]
 ds_read_b128 v[200:203], v11 offset:15360
 v_mfma_f32_16x16x32_bf16 v[164:167], v[196:199], a[224:227], v[164:167]
 ds_read_b128 v[204:207], v11 offset:33792
 s_waitcnt lgkmcnt(8)
 v_mfma_f32_16x16x32_bf16 v[168:171], v[192:195], a[228:231], v[168:171]
 s_waitcnt vmcnt(9)
 ds_read_b64_tr_b16 a[240:241], v240 offset:0
 ds_read_b64_tr_b16 a[242:243], v240 offset:2048
 v_mfma_f32_16x16x32_bf16 v[172:175], v[196:199], a[228:231], v[172:175]
 ds_read_b64_tr_b16 a[244:245], v241 offset:0
 ds_read_b64_tr_b16 a[246:247], v241 offset:2048
 s_waitcnt lgkmcnt(10)
 v_mfma_f32_16x16x32_bf16 v[176:179], v[192:195], a[232:235], v[176:179]
 ds_read_b64_tr_b16 a[248:249], v242 offset:0
 ds_read_b64_tr_b16 a[250:251], v242 offset:2048
 v_mfma_f32_16x16x32_bf16 v[180:183], v[196:199], a[232:235], v[180:183]
 ds_read_b64_tr_b16 a[252:253], v243 offset:0
 ds_read_b64_tr_b16 a[254:255], v243 offset:2048
 s_waitcnt lgkmcnt(12)
 v_mfma_f32_16x16x32_bf16 v[184:187], v[192:195], a[236:239], v[184:187]
 ds_read_b128 v[72:75], v12 offset:14336
 v_mfma_f32_16x16x32_bf16 v[188:191], v[196:199], a[236:239], v[188:191]
 ds_read_b128 v[144:147], v12 offset:32768
 s_waitcnt lgkmcnt(8)
 v_mfma_f32_16x16x32_bf16 v[160:163], v[200:203], a[240:243], v[160:163]
 ds_read_b128 v[192:195], v10 offset:16384
 v_mfma_f32_16x16x32_bf16 v[164:167], v[204:207], a[240:243], v[164:167]
 ds_read_b128 v[196:199], v10 offset:34816
 s_waitcnt lgkmcnt(8)
 v_mfma_f32_16x16x32_bf16 v[168:171], v[200:203], a[244:247], v[168:171]
 s_waitcnt vmcnt(5)
 ds_read_b64_tr_b16 v[208:209], v240 offset:4096
 ds_read_b64_tr_b16 v[210:211], v240 offset:6144
 v_mfma_f32_16x16x32_bf16 v[172:175], v[204:207], a[244:247], v[172:175]
 ds_read_b64_tr_b16 v[212:213], v241 offset:4096
 ds_read_b64_tr_b16 v[214:215], v241 offset:6144
 s_waitcnt lgkmcnt(10)
 v_mfma_f32_16x16x32_bf16 v[176:179], v[200:203], a[248:251], v[176:179]
 ds_read_b64_tr_b16 v[216:217], v242 offset:4096
 ds_read_b64_tr_b16 v[218:219], v242 offset:6144
 v_mfma_f32_16x16x32_bf16 v[180:183], v[204:207], a[248:251], v[180:183]
 ds_read_b64_tr_b16 v[220:221], v243 offset:4096
 ds_read_b64_tr_b16 v[222:223], v243 offset:6144
 s_waitcnt lgkmcnt(12)
 v_mfma_f32_16x16x32_bf16 v[184:187], v[200:203], a[252:255], v[184:187]
 ds_read_b128 v[76:79], v13 offset:15360
 v_mfma_f32_16x16x32_bf16 v[188:191], v[204:207], a[252:255], v[188:191]
 ds_read_b128 v[148:151], v13 offset:33792
 s_waitcnt lgkmcnt(8)
 v_mfma_f32_16x16x32_bf16 v[160:163], v[192:195], v[208:211], v[160:163]
 ds_read_b128 v[200:203], v11 offset:17408
 s_cmp_lt_u32 s25, 9
 s_cselect_b32 s31, s88, 1.0
 v_mfma_f32_16x16x32_bf16 v[164:167], v[196:199], v[208:211], v[164:167]
 ds_read_b128 v[204:207], v11 offset:35840
 s_waitcnt lgkmcnt(8)
 v_mfma_f32_16x16x32_bf16 v[168:171], v[192:195], v[212:215], v[168:171]
 s_waitcnt vmcnt(0)
 ds_read_b64_tr_b16 v[224:225], v240 offset:8192
 ds_read_b64_tr_b16 v[226:227], v240 offset:10240
 v_mfma_f32_16x16x32_bf16 v[172:175], v[196:199], v[212:215], v[172:175]
 ds_read_b64_tr_b16 v[228:229], v241 offset:8192
 ds_read_b64_tr_b16 v[230:231], v241 offset:10240
 s_waitcnt lgkmcnt(10)
 v_mfma_f32_16x16x32_bf16 v[176:179], v[192:195], v[216:219], v[176:179]
 ds_read_b64_tr_b16 v[232:233], v242 offset:8192
 ds_read_b64_tr_b16 v[234:235], v242 offset:10240
 v_mfma_f32_16x16x32_bf16 v[180:183], v[196:199], v[216:219], v[180:183]
 ds_read_b64_tr_b16 v[236:237], v243 offset:8192
 ds_read_b64_tr_b16 v[238:239], v243 offset:10240
 s_waitcnt lgkmcnt(12)
 v_mfma_f32_16x16x32_bf16 v[184:187], v[192:195], v[220:223], v[184:187]
 ds_read_b128 v[80:83], v12 offset:16384
 v_mfma_f32_16x16x32_bf16 v[188:191], v[196:199], v[220:223], v[188:191]
 ds_read_b128 v[152:155], v12 offset:34816
 s_waitcnt lgkmcnt(8)
 v_mfma_f32_16x16x32_bf16 v[160:163], v[200:203], v[224:227], v[160:163]
 ds_read_b128 v[2:5], v245 offset:0
 v_mfma_f32_16x16x32_bf16 v[164:167], v[204:207], v[224:227], v[164:167]
 ds_read_b128 v[6:9], v245 offset:16
 s_waitcnt lgkmcnt(8)
 v_mfma_f32_16x16x32_bf16 v[168:171], v[200:203], v[228:231], v[168:171]
 s_mul_i32 s28, s25, 264192
 s_lshl_b32 s30, s24, 9
 s_add_u32 s28, s28, s30
 v_mfma_f32_16x16x32_bf16 v[172:175], v[204:207], v[228:231], v[172:175]
 s_waitcnt lgkmcnt(6)
 v_mfma_f32_16x16x32_bf16 v[176:179], v[200:203], v[232:235], v[176:179]
 v_mfma_f32_16x16x32_bf16 v[180:183], v[204:207], v[232:235], v[180:183]
 s_waitcnt lgkmcnt(4)
 v_mfma_f32_16x16x32_bf16 v[184:187], v[200:203], v[236:239], v[184:187]
 ds_read_b128 v[84:87], v13 offset:17408
 v_mfma_f32_16x16x32_bf16 v[188:191], v[204:207], v[236:239], v[188:191]
 ds_read_b128 v[156:159], v13 offset:35840
 v_mfma_f32_16x16x32_bf16 v[192:195], v[16:19], a[0:3], 0
 v_mfma_f32_16x16x32_bf16 v[192:195], v[20:23], a[16:19], v[192:195]
 s_waitcnt lgkmcnt(0)
 s_barrier
 v_mfma_f32_16x16x32_bf16 v[192:195], v[24:27], a[32:35], v[192:195]
 v_mul_f32 v2, s31, v2
 v_mul_f32 v3, s31, v3
 v_lshrrev_b32 v12, 3, v1
 v_and_b32 v11, 6, v12
 v_mfma_f32_16x16x32_bf16 v[192:195], v[28:31], a[48:51], v[192:195]
 v_mul_f32 v4, s31, v4
 v_mul_f32 v5, s31, v5
 v_and_b32 v13, 7, v1
 v_mfma_f32_16x16x32_bf16 v[192:195], v[32:35], a[64:67], v[192:195]
 v_mul_f32 v6, s31, v6
 v_mul_f32 v7, s31, v7
 v_xor_b32 v11, v11, v13
 v_mfma_f32_16x16x32_bf16 v[192:195], v[36:39], a[80:83], v[192:195]
 v_mul_f32 v8, s31, v8
 v_mul_f32 v9, s31, v9
 v_lshlrev_b32 v11, 4, v11
 v_mul_u32_u24 v10, 1152, v12
 v_mfma_f32_16x16x32_bf16 v[192:195], v[40:43], a[96:99], v[192:195]
 v_mul_f32 v160, v160, v2
 v_mul_f32 v161, v161, v3
 v_add_u32 v10, v10, v11
 v_mfma_f32_16x16x32_bf16 v[192:195], v[44:47], a[112:115], v[192:195]
 v_mul_f32 v162, v162, v4
 v_mul_f32 v163, v163, v5
 v_add_u32 v240, 0, v10
 v_mfma_f32_16x16x32_bf16 v[192:195], v[48:51], a[128:131], v[192:195]
 v_mul_f32 v164, v164, v6
 v_mul_f32 v165, v165, v7
 v_add_u32 v241, 19712, v10
 v_mfma_f32_16x16x32_bf16 v[192:195], v[52:55], a[144:147], v[192:195]
 v_mul_f32 v166, v166, v8
 v_mul_f32 v167, v167, v9
 v_add_u32 v242, 7168, v10
 v_add_u32 v243, 26880, v10
 v_mfma_f32_16x16x32_bf16 v[192:195], v[56:59], a[160:163], v[192:195]
 v_cvt_pk_bf16_f32 v160, v160, v161
 v_cvt_pk_bf16_f32 v161, v162, v163
 v_lshrrev_b32 v12, 2, v1
 v_mfma_f32_16x16x32_bf16 v[192:195], v[60:63], a[176:179], v[192:195]
 v_cvt_pk_bf16_f32 v162, v164, v165
 v_cvt_pk_bf16_f32 v163, v166, v167
 v_bfe_u32 v11, v1, 4, 1
 v_mfma_f32_16x16x32_bf16 v[192:195], v[64:67], a[192:195], v[192:195]
 s_add_u32 s30, s28, 0
 buffer_store_dwordx4 v[160:163], v244, s[16:19], s30 offen offset:0 sc1
 v_mul_f32 v168, v168, v2
 v_lshlrev_b32 v11, 1, v11
 v_mfma_f32_16x16x32_bf16 v[192:195], v[68:71], a[208:211], v[192:195]
 v_mul_f32 v169, v169, v3
 v_mul_f32 v170, v170, v4
 v_and_b32 v13, 3, v1
 v_xor_b32 v11, v11, v13
 v_mfma_f32_16x16x32_bf16 v[192:195], v[72:75], a[224:227], v[192:195]
 v_mul_f32 v171, v171, v5
 v_mul_f32 v172, v172, v6
 v_lshlrev_b32 v11, 4, v11
 v_mfma_f32_16x16x32_bf16 v[192:195], v[76:79], a[240:243], v[192:195]
 v_mul_f32 v173, v173, v7
 v_mul_f32 v174, v174, v8
 v_lshrrev_b32 v10, 3, v12
 v_mfma_f32_16x16x32_bf16 v[192:195], v[80:83], v[208:211], v[192:195]
 v_mul_f32 v175, v175, v9
 v_cvt_pk_bf16_f32 v168, v168, v169
 v_mul_u32_u24 v10, 18, v10
 v_mfma_f32_16x16x32_bf16 v[192:195], v[84:87], v[224:227], v[192:195]
 v_cvt_pk_bf16_f32 v169, v170, v171
 v_and_b32 v13, 7, v12
 v_add_u32 v10, v10, v13
 v_mfma_f32_16x16x32_bf16 v[196:199], v[88:91], a[0:3], 0
 v_cvt_pk_bf16_f32 v170, v172, v173
 v_cvt_pk_bf16_f32 v171, v174, v175
 v_mul_u32_u24 v10, 1152, v10
 v_mfma_f32_16x16x32_bf16 v[196:199], v[92:95], a[16:19], v[196:199]
 s_add_u32 s30, s28, 66048
 buffer_store_dwordx4 v[168:171], v244, s[16:19], s30 offen offset:0 sc1
 v_mul_f32 v176, v176, v2
 v_add_u32 v251, v10, v11
 v_mfma_f32_16x16x32_bf16 v[196:199], v[96:99], a[32:35], v[196:199]
 v_mul_f32 v177, v177, v3
 v_mul_f32 v178, v178, v4
 v_add_u32 v252, 8192, v251
 v_mfma_f32_16x16x32_bf16 v[196:199], v[100:103], a[48:51], v[196:199]
 v_mul_f32 v179, v179, v5
 v_mul_f32 v180, v180, v6
 v_mfma_f32_16x16x32_bf16 v[196:199], v[104:107], a[64:67], v[196:199]
 v_mul_f32 v181, v181, v7
 v_mul_f32 v182, v182, v8
 v_mfma_f32_16x16x32_bf16 v[196:199], v[108:111], a[80:83], v[196:199]
 v_mul_f32 v183, v183, v9
 v_cvt_pk_bf16_f32 v176, v176, v177
 v_mfma_f32_16x16x32_bf16 v[196:199], v[112:115], a[96:99], v[196:199]
 v_cvt_pk_bf16_f32 v177, v178, v179
 v_cvt_pk_bf16_f32 v178, v180, v181
 s_add_u32 m0, s91, 0
 s_add_u32 s101, s90, s72
 buffer_load_dwordx4 v240, s[76:79], s101 offen offset:0 lds
 v_mfma_f32_16x16x32_bf16 v[196:199], v[116:119], a[112:115], v[196:199]
 v_cvt_pk_bf16_f32 v179, v182, v183
 s_add_u32 s30, s28, 132096
 buffer_store_dwordx4 v[176:179], v244, s[16:19], s30 offen offset:0 sc1
 v_mfma_f32_16x16x32_bf16 v[196:199], v[120:123], a[128:131], v[196:199]
 v_mul_f32 v184, v184, v2
 v_mul_f32 v185, v185, v3
 v_mfma_f32_16x16x32_bf16 v[196:199], v[124:127], a[144:147], v[196:199]
 v_mul_f32 v186, v186, v4
 v_mul_f32 v187, v187, v5
 v_mfma_f32_16x16x32_bf16 v[196:199], v[128:131], a[160:163], v[196:199]
 v_mul_f32 v188, v188, v6
 v_mul_f32 v189, v189, v7
 v_mfma_f32_16x16x32_bf16 v[196:199], v[132:135], a[176:179], v[196:199]
 v_mul_f32 v190, v190, v8
 v_mul_f32 v191, v191, v9
 v_mfma_f32_16x16x32_bf16 v[196:199], v[136:139], a[192:195], v[196:199]
 v_cvt_pk_bf16_f32 v184, v184, v185
 v_cvt_pk_bf16_f32 v185, v186, v187
 v_mfma_f32_16x16x32_bf16 v[196:199], v[140:143], a[208:211], v[196:199]
 v_cvt_pk_bf16_f32 v186, v188, v189
 v_cvt_pk_bf16_f32 v187, v190, v191
 v_mfma_f32_16x16x32_bf16 v[196:199], v[144:147], a[224:227], v[196:199]
 s_add_u32 s30, s28, 198144
 buffer_store_dwordx4 v[184:187], v244, s[16:19], s30 offen offset:0 sc1
 ds_read_b128 v[2:5], v245 offset:128
 buffer_load_dwordx4 v241, s[76:79], s101 offen offset:1024 lds
 v_mfma_f32_16x16x32_bf16 v[196:199], v[148:151], a[240:243], v[196:199]
 ds_read_b128 v[6:9], v245 offset:144
 v_mfma_f32_16x16x32_bf16 v[196:199], v[152:155], v[208:211], v[196:199]
 v_mfma_f32_16x16x32_bf16 v[196:199], v[156:159], v[224:227], v[196:199]
 s_waitcnt lgkmcnt(1)
 v_mul_f32 v2, s31, v2
 v_mul_f32 v3, s31, v3
 v_mfma_f32_16x16x32_bf16 v[200:203], v[16:19], a[4:7], 0
 v_mul_f32 v4, s31, v4
 v_mul_f32 v5, s31, v5
 v_mfma_f32_16x16x32_bf16 v[200:203], v[20:23], a[20:23], v[200:203]
 s_waitcnt lgkmcnt(0)
 v_mul_f32 v6, s31, v6
 v_mul_f32 v7, s31, v7
 v_mfma_f32_16x16x32_bf16 v[200:203], v[24:27], a[36:39], v[200:203]
 v_mul_f32 v8, s31, v8
 v_mul_f32 v9, s31, v9
 v_mfma_f32_16x16x32_bf16 v[200:203], v[28:31], a[52:55], v[200:203]
 v_mul_f32 v192, v192, v2
 v_mfma_f32_16x16x32_bf16 v[200:203], v[32:35], a[68:71], v[200:203]
 v_mul_f32 v193, v193, v3
 buffer_load_dwordx4 v242, s[76:79], s101 offen offset:2048 lds
 v_mfma_f32_16x16x32_bf16 v[200:203], v[36:39], a[84:87], v[200:203]
 v_mul_f32 v194, v194, v4
 v_mfma_f32_16x16x32_bf16 v[200:203], v[40:43], a[100:103], v[200:203]
 v_mfma_f32_16x16x32_bf16 v[200:203], v[44:47], a[116:119], v[200:203]
 v_mul_f32 v195, v195, v5
 v_mfma_f32_16x16x32_bf16 v[200:203], v[48:51], a[132:135], v[200:203]
 v_mul_f32 v196, v196, v6
 v_mfma_f32_16x16x32_bf16 v[200:203], v[52:55], a[148:151], v[200:203]
 v_mul_f32 v197, v197, v7
 v_mfma_f32_16x16x32_bf16 v[200:203], v[56:59], a[164:167], v[200:203]
 v_mfma_f32_16x16x32_bf16 v[200:203], v[60:63], a[180:183], v[200:203]
 v_mul_f32 v198, v198, v8
 v_mfma_f32_16x16x32_bf16 v[200:203], v[64:67], a[196:199], v[200:203]
 v_mul_f32 v199, v199, v9
 buffer_load_dwordx4 v243, s[76:79], s101 offen offset:3072 lds
 v_mfma_f32_16x16x32_bf16 v[200:203], v[68:71], a[212:215], v[200:203]
 v_mfma_f32_16x16x32_bf16 v[200:203], v[72:75], a[228:231], v[200:203]
 v_cvt_pk_bf16_f32 v192, v192, v193
 v_mfma_f32_16x16x32_bf16 v[200:203], v[76:79], a[244:247], v[200:203]
 v_cvt_pk_bf16_f32 v193, v194, v195
 v_mfma_f32_16x16x32_bf16 v[200:203], v[80:83], v[212:215], v[200:203]
 v_cvt_pk_bf16_f32 v194, v196, v197
 v_mfma_f32_16x16x32_bf16 v[200:203], v[84:87], v[228:231], v[200:203]
 v_mfma_f32_16x16x32_bf16 v[204:207], v[88:91], a[4:7], 0
 v_cvt_pk_bf16_f32 v195, v198, v199
 v_mfma_f32_16x16x32_bf16 v[204:207], v[92:95], a[20:23], v[204:207]
 s_add_u32 s30, s28, 0
 buffer_store_dwordx4 v[192:195], v244, s[16:19], s30 offen offset:256 sc1
 v_mfma_f32_16x16x32_bf16 v[204:207], v[96:99], a[36:39], v[204:207]
 s_add_u32 m0, s91, 4096
 s_add_u32 s101, s90, s73
 buffer_load_dwordx4 v251, s[76:79], s101 offen offset:0 lds
 v_mfma_f32_16x16x32_bf16 v[204:207], v[100:103], a[52:55], v[204:207]
 v_mfma_f32_16x16x32_bf16 v[204:207], v[104:107], a[68:71], v[204:207]
 v_mfma_f32_16x16x32_bf16 v[204:207], v[108:111], a[84:87], v[204:207]
 v_mfma_f32_16x16x32_bf16 v[204:207], v[112:115], a[100:103], v[204:207]
 v_mfma_f32_16x16x32_bf16 v[204:207], v[116:119], a[116:119], v[204:207]
 v_mfma_f32_16x16x32_bf16 v[204:207], v[120:123], a[132:135], v[204:207]
 v_mfma_f32_16x16x32_bf16 v[204:207], v[124:127], a[148:151], v[204:207]
 v_mfma_f32_16x16x32_bf16 v[204:207], v[128:131], a[164:167], v[204:207]
 buffer_load_dwordx4 v252, s[76:79], s101 offen offset:1024 lds
 s_add_u32 s90, s90, 165888
 v_mfma_f32_16x16x32_bf16 v[204:207], v[132:135], a[180:183], v[204:207]
 v_mfma_f32_16x16x32_bf16 v[204:207], v[136:139], a[196:199], v[204:207]
 v_mfma_f32_16x16x32_bf16 v[204:207], v[140:143], a[212:215], v[204:207]
 v_mfma_f32_16x16x32_bf16 v[204:207], v[144:147], a[228:231], v[204:207]
 v_mfma_f32_16x16x32_bf16 v[204:207], v[148:151], a[244:247], v[204:207]
 v_mfma_f32_16x16x32_bf16 v[204:207], v[152:155], v[212:215], v[204:207]
 v_mfma_f32_16x16x32_bf16 v[204:207], v[156:159], v[228:231], v[204:207]
 v_mfma_f32_16x16x32_bf16 v[192:195], v[16:19], a[8:11], 0
 s_add_u32 m0, s91, 24576
 s_add_u32 s101, s90, s72
 buffer_load_dwordx4 v240, s[76:79], s101 offen offset:0 lds
 v_mfma_f32_16x16x32_bf16 v[192:195], v[20:23], a[24:27], v[192:195]
 v_mfma_f32_16x16x32_bf16 v[192:195], v[24:27], a[40:43], v[192:195]
 v_mfma_f32_16x16x32_bf16 v[192:195], v[28:31], a[56:59], v[192:195]
 v_mul_f32 v200, v200, v2
 v_mfma_f32_16x16x32_bf16 v[192:195], v[32:35], a[72:75], v[192:195]
 v_mul_f32 v201, v201, v3
 v_mfma_f32_16x16x32_bf16 v[192:195], v[36:39], a[88:91], v[192:195]
 v_mul_f32 v202, v202, v4
 v_mfma_f32_16x16x32_bf16 v[192:195], v[40:43], a[104:107], v[192:195]
 v_mfma_f32_16x16x32_bf16 v[192:195], v[44:47], a[120:123], v[192:195]
 v_mul_f32 v203, v203, v5
 v_mfma_f32_16x16x32_bf16 v[192:195], v[48:51], a[136:139], v[192:195]
 v_mul_f32 v204, v204, v6
 buffer_load_dwordx4 v241, s[76:79], s101 offen offset:1024 lds
 v_mfma_f32_16x16x32_bf16 v[192:195], v[52:55], a[152:155], v[192:195]
 v_mul_f32 v205, v205, v7
 v_mfma_f32_16x16x32_bf16 v[192:195], v[56:59], a[168:171], v[192:195]
 v_mfma_f32_16x16x32_bf16 v[192:195], v[60:63], a[184:187], v[192:195]
 v_mul_f32 v206, v206, v8
 v_mfma_f32_16x16x32_bf16 v[192:195], v[64:67], a[200:203], v[192:195]
 v_mul_f32 v207, v207, v9
 v_mfma_f32_16x16x32_bf16 v[192:195], v[68:71], a[216:219], v[192:195]
 v_mfma_f32_16x16x32_bf16 v[192:195], v[72:75], a[232:235], v[192:195]
 v_cvt_pk_bf16_f32 v200, v200, v201
 v_mfma_f32_16x16x32_bf16 v[192:195], v[76:79], a[248:251], v[192:195]
 v_cvt_pk_bf16_f32 v201, v202, v203
 v_mfma_f32_16x16x32_bf16 v[192:195], v[80:83], v[216:219], v[192:195]
 v_cvt_pk_bf16_f32 v202, v204, v205
 buffer_load_dwordx4 v242, s[76:79], s101 offen offset:2048 lds
 v_mfma_f32_16x16x32_bf16 v[192:195], v[84:87], v[232:235], v[192:195]
 v_mfma_f32_16x16x32_bf16 v[196:199], v[88:91], a[8:11], 0
 v_cvt_pk_bf16_f32 v203, v206, v207
 v_mfma_f32_16x16x32_bf16 v[196:199], v[92:95], a[24:27], v[196:199]
 s_add_u32 s30, s28, 66048
 buffer_store_dwordx4 v[200:203], v244, s[16:19], s30 offen offset:256 sc1
 v_mfma_f32_16x16x32_bf16 v[196:199], v[96:99], a[40:43], v[196:199]
 v_mfma_f32_16x16x32_bf16 v[196:199], v[100:103], a[56:59], v[196:199]
 v_mfma_f32_16x16x32_bf16 v[196:199], v[104:107], a[72:75], v[196:199]
 v_mfma_f32_16x16x32_bf16 v[196:199], v[108:111], a[88:91], v[196:199]
 v_mfma_f32_16x16x32_bf16 v[196:199], v[112:115], a[104:107], v[196:199]
 buffer_load_dwordx4 v243, s[76:79], s101 offen offset:3072 lds
 v_mfma_f32_16x16x32_bf16 v[196:199], v[116:119], a[120:123], v[196:199]
 v_mfma_f32_16x16x32_bf16 v[196:199], v[120:123], a[136:139], v[196:199]
 v_mfma_f32_16x16x32_bf16 v[196:199], v[124:127], a[152:155], v[196:199]
 v_mfma_f32_16x16x32_bf16 v[196:199], v[128:131], a[168:171], v[196:199]
 v_mfma_f32_16x16x32_bf16 v[196:199], v[132:135], a[184:187], v[196:199]
 v_mfma_f32_16x16x32_bf16 v[196:199], v[136:139], a[200:203], v[196:199]
 v_mfma_f32_16x16x32_bf16 v[196:199], v[140:143], a[216:219], v[196:199]
 v_mfma_f32_16x16x32_bf16 v[196:199], v[144:147], a[232:235], v[196:199]
 s_add_u32 m0, s91, 28672
 s_add_u32 s101, s90, s73
 buffer_load_dwordx4 v251, s[76:79], s101 offen offset:0 lds
 v_mfma_f32_16x16x32_bf16 v[196:199], v[148:151], a[248:251], v[196:199]
 v_mfma_f32_16x16x32_bf16 v[196:199], v[152:155], v[216:219], v[196:199]
 v_mfma_f32_16x16x32_bf16 v[196:199], v[156:159], v[232:235], v[196:199]
 v_mfma_f32_16x16x32_bf16 v[200:203], v[16:19], a[12:15], 0
 v_mfma_f32_16x16x32_bf16 v[200:203], v[20:23], a[28:31], v[200:203]
 v_mfma_f32_16x16x32_bf16 v[200:203], v[24:27], a[44:47], v[200:203]
 v_mfma_f32_16x16x32_bf16 v[200:203], v[28:31], a[60:63], v[200:203]
 v_mul_f32 v192, v192, v2
 v_mfma_f32_16x16x32_bf16 v[200:203], v[32:35], a[76:79], v[200:203]
 v_mul_f32 v193, v193, v3
 buffer_load_dwordx4 v252, s[76:79], s101 offen offset:1024 lds
 s_add_u32 s90, s90, 165888
 v_mfma_f32_16x16x32_bf16 v[200:203], v[36:39], a[92:95], v[200:203]
 v_mul_f32 v194, v194, v4
 v_mfma_f32_16x16x32_bf16 v[200:203], v[40:43], a[108:111], v[200:203]
 v_mfma_f32_16x16x32_bf16 v[200:203], v[44:47], a[124:127], v[200:203]
 v_mul_f32 v195, v195, v5
 v_mfma_f32_16x16x32_bf16 v[200:203], v[48:51], a[140:143], v[200:203]
 v_mul_f32 v196, v196, v6
 v_mfma_f32_16x16x32_bf16 v[200:203], v[52:55], a[156:159], v[200:203]
 v_mul_f32 v197, v197, v7
 v_mfma_f32_16x16x32_bf16 v[200:203], v[56:59], a[172:175], v[200:203]
 v_mfma_f32_16x16x32_bf16 v[200:203], v[60:63], a[188:191], v[200:203]
 v_mul_f32 v198, v198, v8
 v_mfma_f32_16x16x32_bf16 v[200:203], v[64:67], a[204:207], v[200:203]
 v_mul_f32 v199, v199, v9
 v_mfma_f32_16x16x32_bf16 v[200:203], v[68:71], a[220:223], v[200:203]
 v_mfma_f32_16x16x32_bf16 v[200:203], v[72:75], a[236:239], v[200:203]
 v_cvt_pk_bf16_f32 v192, v192, v193
 v_mfma_f32_16x16x32_bf16 v[200:203], v[76:79], a[252:255], v[200:203]
 v_cvt_pk_bf16_f32 v193, v194, v195
 v_mfma_f32_16x16x32_bf16 v[200:203], v[80:83], v[220:223], v[200:203]
 v_cvt_pk_bf16_f32 v194, v196, v197
 v_mfma_f32_16x16x32_bf16 v[200:203], v[84:87], v[236:239], v[200:203]
 v_mfma_f32_16x16x32_bf16 v[204:207], v[88:91], a[12:15], 0
 v_cvt_pk_bf16_f32 v195, v198, v199
 v_mfma_f32_16x16x32_bf16 v[204:207], v[92:95], a[28:31], v[204:207]
 s_add_u32 s30, s28, 132096
 buffer_store_dwordx4 v[192:195], v244, s[16:19], s30 offen offset:256 sc1
 v_mfma_f32_16x16x32_bf16 v[204:207], v[96:99], a[44:47], v[204:207]
 v_mfma_f32_16x16x32_bf16 v[204:207], v[100:103], a[60:63], v[204:207]
 v_mfma_f32_16x16x32_bf16 v[204:207], v[104:107], a[76:79], v[204:207]
 v_mfma_f32_16x16x32_bf16 v[204:207], v[108:111], a[92:95], v[204:207]
 v_mfma_f32_16x16x32_bf16 v[204:207], v[112:115], a[108:111], v[204:207]
 v_mfma_f32_16x16x32_bf16 v[204:207], v[116:119], a[124:127], v[204:207]
 v_mfma_f32_16x16x32_bf16 v[204:207], v[120:123], a[140:143], v[204:207]
 v_mfma_f32_16x16x32_bf16 v[204:207], v[124:127], a[156:159], v[204:207]
 v_mfma_f32_16x16x32_bf16 v[204:207], v[128:131], a[172:175], v[204:207]
 v_mfma_f32_16x16x32_bf16 v[204:207], v[132:135], a[188:191], v[204:207]
 v_mfma_f32_16x16x32_bf16 v[204:207], v[136:139], a[204:207], v[204:207]
 v_mfma_f32_16x16x32_bf16 v[204:207], v[140:143], a[220:223], v[204:207]
 v_mfma_f32_16x16x32_bf16 v[204:207], v[144:147], a[236:239], v[204:207]
 v_mfma_f32_16x16x32_bf16 v[204:207], v[148:151], a[252:255], v[204:207]
 v_mfma_f32_16x16x32_bf16 v[204:207], v[152:155], v[220:223], v[204:207]
 v_mfma_f32_16x16x32_bf16 v[204:207], v[156:159], v[236:239], v[204:207]
 v_mul_f32 v200, v200, v2
 v_mul_f32 v201, v201, v3
 v_mul_f32 v202, v202, v4
 v_mul_f32 v203, v203, v5
 s_nop 3
 v_mul_f32 v204, v204, v6
 v_mul_f32 v205, v205, v7
 v_mul_f32 v206, v206, v8
 v_mul_f32 v207, v207, v9
 v_cvt_pk_bf16_f32 v200, v200, v201
 v_cvt_pk_bf16_f32 v201, v202, v203
 v_cvt_pk_bf16_f32 v202, v204, v205
 v_cvt_pk_bf16_f32 v203, v206, v207
 s_add_u32 s30, s28, 198144
 buffer_store_dwordx4 v[200:203], v244, s[16:19], s30 offen offset:256 sc1
 v_readfirstlane_b32 s3, v248
 s_nop 0
 s_cmp_eq_u32 s3, 0
 s_cbranch_scc1 L_tagslow_p1
L_tagback_p1:
 s_lshl_b32 s30, s24, 12
 s_lshl_b32 s31, s25, 7
 s_add_u32 s30, s30, s31
L_p2v:
 s_cmp_eq_u32 s22, 0
 s_cbranch_scc1 L_c2_p0
 s_cmp_eq_u32 s22, 1
 s_cbranch_scc1 L_c2_p1
 s_cmp_eq_u32 s22, 2
 s_cbranch_scc1 L_c2_ret
 s_branch L_c2_ret
L_c2_ret:
 v_lshrrev_b32 v2, 3, v1
 s_lshl_b32 s28, s80, 2
 s_cmp_eq_u32 s80, 0
 s_cselect_b32 s29, 3, 7
 s_cselect_b32 s27, 0, 4
 s_sub_u32 s28, s28, s27
 v_and_b32 v2, s29, v2
 v_add_u32 v2, s28, v2
 v_lshlrev_b32 v2, 12, v2
 s_mul_i32 s27, s81, 18
 v_and_b32 v3, 7, v1
 v_min_u32 v3, 5, v3
 v_and_b32 v4, 1, v3
 v_mul_u32_u24 v4, 17, v4
 v_add_u32 v4, s27, v4
 v_lshrrev_b32 v4, 6, v4
 v_lshrrev_b32 v3, 1, v3
 v_mul_u32_u24 v3, 9, v3
 v_add_u32 v3, v3, v4
 v_lshl_add_u32 v14, v3, 7, v2
 v_lshlrev_b32 v3, 4, v1
 v_lshrrev_b32 v5, 5, v1
 v_mul_u32_u24 v4, 16512, v5
 v_and_b32 v10, 31, v1
 v_lshl_add_u32 v4, v10, 4, v4
 v_lshlrev_b32 v15, 4, v10
 v_bfe_u32 v6, v1, 4, 1
 v_bfe_u32 v7, v1, 2, 2
 v_and_b32 v8, 3, v1
 v_and_b32 v9, 1, v8
 v_lshl_add_u32 v9, v6, 1, v9
 v_lshlrev_b32 v9, 6, v9
 v_lshrrev_b32 v11, 1, v8
 v_lshl_add_u32 v9, v11, 3, v9
 v_lshrrev_b32 v13, 1, v8
 v_lshl_add_u32 v13, v6, 1, v13
 v_lshlrev_b32 v13, 6, v13
 v_and_b32 v11, 1, v8
 v_lshl_add_u32 v13, v11, 3, v13
 v_lshl_add_u32 v11, v5, 3, v7
 v_add_u32 v11, s82, v11
 v_lshrrev_b32 v12, 2, v11
 v_and_b32 v11, 3, v11
 v_lshlrev_b32 v11, 4, v11
 v_mul_u32_u24 v2, 4160, v12
 v_add3_u32 v2, v2, v11, v9
 v_add_u32 v232, s87, v2
 v_lshl_add_u32 v2, v12, 9, v11
 v_add3_u32 v234, v2, v13, s86
 v_min_u32 v11, 1, v7
 v_add_u32 v11, s82, v11
 v_lshlrev_b32 v11, 4, v11
 v_add3_u32 v2, v11, v9, s87
 v_add_u32 v2, 16640, v2
 v_add_u32 v12, s87, v9
 v_add_u32 v12, 41600, v12
 v_cmp_gt_u32 vcc, 2, v7
 s_nop 1
 v_cndmask_b32 v233, v12, v2, vcc
 v_add3_u32 v2, v11, v13, s86
 v_add_u32 v235, 2048, v2
 v_add_u32 v11, s82, v10
 v_lshrrev_b32 v12, 2, v11
 v_and_b32 v11, 3, v11
 v_mul_u32_u24 v12, 4160, v12
 v_lshl_add_u32 v12, v11, 4, v12
 v_add_u32 v12, 20800, v12
 v_mov_b32 v11, 41616
 v_cmp_gt_u32 vcc, 18, v10
 s_nop 1
 v_cndmask_b32 v12, v11, v12, vcc
 v_lshl_add_u32 v12, v5, 6, v12
 v_add_u32 v236, s87, v12
 v_mul_u32_u24 v237, 34048, v5
 v_lshl_add_u32 v237, v10, 4, v237
 v_lshlrev_b32 v2, 2, v10
 v_mov_b32 v6, 0x7fff0000
 v_cmp_gt_u32 vcc, 32, v1
 s_nop 1
 v_cndmask_b32 v238, v6, v2, vcc
 s_cmp_ge_u32 s2, 224
 s_cbranch_scc1 L_p2
 s_waitcnt vmcnt(0)
 v_mov_b32 v2, s3
 buffer_store_dword v2, v250, s[96:99], s30 offen sc1
L_s2:
L_p2:
 s_mov_b32 s8, s20
 s_and_b32 s9, s21, 0xffff
 s_mov_b32 s10, 0x6cd800
 s_mov_b32 s11, 0x20000
 s_add_u32 s12, s20, 0x700000
 s_addc_u32 s13, s21, 0
 s_and_b32 s13, s13, 0xffff
 s_mov_b32 s14, 0x214000
 s_mov_b32 s15, 0x20000
 s_branch L_c2_p0_s
L_c2_p0:
 s_branch L_c2_ret
L_c2_p0_s:
 s_add_u32 s16, s20, 0x940000
 s_addc_u32 s17, s21, 0
 s_and_b32 s17, s17, 0xffff
 s_mov_b32 s18, 0x42000
 s_mov_b32 s19, 0x20000
 s_barrier
 v_and_b32 v2, 3, v1
 v_lshl_add_u32 v6, v1, 4, s84
 v_mov_b32 v7, s71
 v_mov_b32 v8, 0x3f803f80
 v_cmp_eq_u32 vcc, 0, v2
 s_nop 1
 v_cndmask_b32 v8, v8, v7, vcc
 v_mov_b32 v9, v8
 v_mov_b32 v10, v8
 v_mov_b32 v11, v8
 ds_write_b128 v6, v[8:11] offset:41600
 v_lshrrev_b32 v8, 3, v1
 v_and_b32 v7, 6, v8
 v_and_b32 v9, 7, v1
 v_xor_b32 v7, v7, v9
 v_lshlrev_b32 v7, 4, v7
 v_mul_u32_u24 v6, 1152, v8
 v_add_u32 v6, v6, v7
 v_add_u32 v240, 0, v6
 v_add_u32 v241, 19712, v6
 v_add_u32 v242, 7168, v6
 v_add_u32 v243, 26880, v6
 v_lshrrev_b32 v6, 2, v8
 v_lshlrev_b32 v6, 2, v6
 v_bfe_u32 v9, v8, 1, 1
 v_add_u32 v6, v6, v9
 v_mul_u32_u24 v6, 18, v6
 v_and_b32 v9, 1, v8
 v_add_u32 v6, v6, v9
 v_mul_u32_u24 v6, 1152, v6
 v_add_u32 v6, v6, v7
 v_add_u32 v244, 18432, v6
 v_add_u32 v245, 183296, v6
 v_add_u32 v246, 57856, v6
 v_add_u32 v247, 222720, v6
 v_lshrrev_b32 v8, 2, v1
 v_bfe_u32 v7, v1, 4, 1
 v_lshlrev_b32 v7, 1, v7
 v_and_b32 v9, 3, v1
 v_xor_b32 v7, v7, v9
 v_lshlrev_b32 v7, 4, v7
 v_lshrrev_b32 v6, 3, v8
 v_mul_u32_u24 v6, 18, v6
 v_and_b32 v9, 7, v8
 v_add_u32 v6, v6, v9
 v_mul_u32_u24 v6, 1152, v6
 v_add_u32 v251, v6, v7
 v_add_u32 v252, 8192, v251
 v_lshrrev_b32 v6, 2, v8
 v_lshlrev_b32 v6, 2, v6
 v_bfe_u32 v9, v8, 1, 1
 v_add_u32 v6, v6, v9
 v_mul_u32_u24 v6, 18, v6
 v_and_b32 v9, 1, v8
 v_add3_u32 v6, v6, v9, 16
 v_mul_u32_u24 v6, 1152, v6
 v_add_u32 v253, v6, v7
 v_add_u32 v254, 40448, v253
 v_mov_b32 v12, 0xffff
 v_mov_b32 v13, 0xffff0000
 v_cndmask_b32 v2, 0, v12, s[36:37]
 v_cndmask_b32 v6, 0, v13, s[38:39]
 v_or_b32 v208, v2, v6
 v_cndmask_b32 v2, 0, v12, s[40:41]
 v_cndmask_b32 v6, 0, v13, s[42:43]
 v_or_b32 v209, v2, v6
 v_cndmask_b32 v2, 0, v12, s[44:45]
 v_cndmask_b32 v6, 0, v13, s[46:47]
 v_or_b32 v210, v2, v6
 v_cndmask_b32 v2, 0, v12, s[48:49]
 v_cndmask_b32 v6, 0, v13, s[50:51]
 v_or_b32 v211, v2, v6
 v_cndmask_b32 v2, 0, v12, s[52:53]
 v_cndmask_b32 v6, 0, v13, s[54:55]
 v_or_b32 v212, v2, v6
 v_cndmask_b32 v2, 0, v12, s[56:57]
 v_cndmask_b32 v6, 0, v13, s[58:59]
 v_or_b32 v213, v2, v6
 v_cndmask_b32 v2, 0, v12, s[60:61]
 v_cndmask_b32 v6, 0, v13, s[62:63]
 v_or_b32 v214, v2, v6
 v_cndmask_b32 v2, 0, v12, s[64:65]
 v_cndmask_b32 v6, 0, v13, s[66:67]
 v_or_b32 v215, v2, v6
 v_accvgpr_write_b32 a6, 0
 v_accvgpr_write_b32 a7, 0
 v_accvgpr_write_b32 a14, 0
 v_accvgpr_write_b32 a15, 0
 v_accvgpr_write_b32 a22, 0
 v_accvgpr_write_b32 a23, 0
 v_accvgpr_write_b32 a30, 0
 v_accvgpr_write_b32 a31, 0
 v_accvgpr_write_b32 a38, 0
 v_accvgpr_write_b32 a39, 0
 v_accvgpr_write_b32 a46, 0
 v_accvgpr_write_b32 a47, 0
 v_accvgpr_write_b32 a54, 0
 v_accvgpr_write_b32 a55, 0
 v_accvgpr_write_b32 a62, 0
 v_accvgpr_write_b32 a63, 0
 v_accvgpr_write_b32 a70, 0
 v_accvgpr_write_b32 a71, 0
 v_accvgpr_write_b32 a78, 0
 v_accvgpr_write_b32 a79, 0
 v_accvgpr_write_b32 a166, 0
 v_accvgpr_write_b32 a167, 0
 v_accvgpr_write_b32 a174, 0
 v_accvgpr_write_b32 a175, 0
 v_mov_b32 v2, 0x3f80
 v_cmp_gt_u32 vcc, 32, v1
 s_nop 1
 v_cndmask_b32 v2, 0, v2, vcc
 v_accvgpr_write_b32 a165, v2
 v_accvgpr_write_b32 a173, v2
 v_accvgpr_write_b32 a209, v2
 v_mov_b32 v6, 0x3f803f80
 v_cndmask_b32 v6, 0, v6, vcc
 v_accvgpr_write_b32 a208, v6
 v_accvgpr_write_b32 a210, 0
 v_accvgpr_write_b32 a211, 0
 v_accvgpr_write_b32 a214, 0
 v_accvgpr_write_b32 a215, 0
 v_accvgpr_write_b32 a218, 0
 v_accvgpr_write_b32 a219, 0
 s_cmp_eq_u32 s22, 0
 s_cbranch_scc1 L_c3_p0
 s_cmp_eq_u32 s22, 1
 s_cbranch_scc1 L_c3_p1
 s_cmp_eq_u32 s22, 2
 s_cbranch_scc1 L_c3_p2
 s_branch L_c3_p3
L_c3_ret:
 s_cmp_lg_u32 s22, 0
 s_cbranch_scc1 L_p2w
 buffer_load_dword v16, v14, s[96:99], 0 offen sc1
 s_waitcnt vmcnt(0)
 v_cmp_ne_u32 vcc, s3, v16
 s_nop 4
 s_cbranch_vccnz L_slow_p2
L_back_p2:
L_p2w:
 s_barrier
 s_mov_b32 m0, s86
 s_nop 0
 buffer_load_dwordx4 v4, s[8:11], s85 offen sc1 lds
 s_add_u32 m0, s86, 1024
 s_add_u32 s85, s85, 33024
 buffer_load_dwordx4 v4, s[8:11], s85 offen sc1 lds
 s_add_u32 m0, s86, 2048
 s_add_u32 s85, s85, 33024
 buffer_load_dwordx4 v15, s[8:11], s85 offen sc1 lds
 s_add_u32 m0, s84, 0
 s_nop 0
 buffer_load_dwordx4 v3, s[8:11], s83 offen sc1 lds
 s_add_u32 s83, s83, 16512
 s_add_u32 m0, s84, 4160
 s_nop 0
 buffer_load_dwordx4 v3, s[8:11], s83 offen sc1 lds
 s_add_u32 s83, s83, 16512
 s_add_u32 m0, s84, 8320
 s_nop 0
 buffer_load_dwordx4 v3, s[8:11], s83 offen sc1 lds
 s_add_u32 s83, s83, 16512
 s_add_u32 m0, s84, 12480
 s_nop 0
 buffer_load_dwordx4 v3, s[8:11], s83 offen sc1 lds
 s_add_u32 s83, s83, 16512
 s_add_u32 m0, s84, 16640
 s_nop 0
 buffer_load_dwordx4 v3, s[8:11], s83 offen sc1 lds
 s_add_u32 s83, s83, 2311680
 s_add_u32 m0, s84, 20800
 s_nop 0
 buffer_load_dwordx4 v3, s[8:11], s83 offen sc1 lds
 s_add_u32 s83, s83, 16512
 s_add_u32 m0, s84, 24960
 s_nop 0
 buffer_load_dwordx4 v3, s[8:11], s83 offen sc1 lds
 s_add_u32 s83, s83, 16512
 s_add_u32 m0, s84, 29120
 s_nop 0
 buffer_load_dwordx4 v3, s[8:11], s83 offen sc1 lds
 s_add_u32 s83, s83, 16512
 s_add_u32 m0, s84, 33280
 s_nop 0
 buffer_load_dwordx4 v3, s[8:11], s83 offen sc1 lds
 s_add_u32 s83, s83, 16512
 s_add_u32 m0, s84, 37440
 s_nop 0
 buffer_load_dwordx4 v3, s[8:11], s83 offen sc1 lds
 s_add_u32 s83, s83, 2311680
 s_load_dwordx4 s[4:7], s[0:1], 32
 s_lshl_b32 s26, s2, 2
 s_add_u32 s26, s26, s22
 s_mul_i32 s27, s26, 1088
 s_and_b32 s27, s27, 0xffffff80
 s_add_u32 s27, s27, 0x400000
 s_mul_i32 s26, s26, 5184
 s_and_b32 s26, s26, 0xffffff80
 v_lshlrev_b32 v229, 7, v1
 v_mov_b32 v6, 0x7fff0000
 v_cmp_gt_u32 vcc, 14, v1
 s_nop 1
 v_cndmask_b32 v229, v6, v229, vcc
 s_waitcnt vmcnt(10)
 ds_read_b64_tr_b16 a[160:161], v234 offset:0
 ds_read_b64_tr_b16 a[162:163], v234 offset:512
 ds_read_b64_tr_b16 v[6:7], v235 offset:0
 ds_read_b64_tr_b16 a[168:169], v234 offset:256
 ds_read_b64_tr_b16 a[170:171], v234 offset:768
 ds_read_b64_tr_b16 v[8:9], v235 offset:256
 v_cmp_gt_u32 vcc, 32, v1
 s_waitcnt lgkmcnt(0)
 s_nop 0
 v_cndmask_b32 v6, 0, v6, vcc
 v_accvgpr_write_b32 a164, v6
 v_cndmask_b32 v8, 0, v8, vcc
 v_accvgpr_write_b32 a172, v8
 s_waitcnt vmcnt(5)
 s_barrier
 ds_read_b64_tr_b16 a[0:1], v232 offset:0
 ds_read_b64_tr_b16 a[2:3], v232 offset:4160
 ds_read_b64_tr_b16 a[4:5], v233 offset:0
 ds_read_b64_tr_b16 a[64:65], v232 offset:2048
 ds_read_b64_tr_b16 a[66:67], v232 offset:6208
 ds_read_b64_tr_b16 a[68:69], v233 offset:2048
 ds_read_b64_tr_b16 a[8:9], v232 offset:256
 ds_read_b64_tr_b16 a[10:11], v232 offset:4416
 ds_read_b64_tr_b16 a[12:13], v233 offset:256
 ds_read_b64_tr_b16 a[16:17], v232 offset:512
 ds_read_b64_tr_b16 a[18:19], v232 offset:4672
 ds_read_b64_tr_b16 a[20:21], v233 offset:512
 s_waitcnt lgkmcnt(10)
 v_mfma_f32_32x32x16_bf16 v[16:31], a[0:3], a[160:163], 0
 ds_read_b64_tr_b16 a[24:25], v232 offset:768
 ds_read_b64_tr_b16 a[26:27], v232 offset:4928
 ds_read_b64_tr_b16 a[28:29], v233 offset:768
 s_waitcnt lgkmcnt(12)
 v_mfma_f32_32x32x16_bf16 v[16:31], a[4:7], a[164:167], v[16:31]
 s_waitcnt lgkmcnt(10)
 v_mfma_f32_32x32x16_bf16 v[144:159], a[64:67], a[160:163], 0
 ds_read_b64_tr_b16 a[32:33], v232 offset:1024
 ds_read_b64_tr_b16 a[34:35], v232 offset:5184
 ds_read_b64_tr_b16 a[36:37], v233 offset:1024
 s_waitcnt lgkmcnt(12)
 v_mfma_f32_32x32x16_bf16 v[144:159], a[68:71], a[164:167], v[144:159]
 s_waitcnt lgkmcnt(10)
 v_mfma_f32_32x32x16_bf16 v[32:47], a[8:11], a[160:163], 0
 ds_read_b64_tr_b16 a[40:41], v232 offset:1280
 ds_read_b64_tr_b16 a[42:43], v232 offset:5440
 ds_read_b64_tr_b16 a[44:45], v233 offset:1280
 s_waitcnt lgkmcnt(12)
 v_mfma_f32_32x32x16_bf16 v[32:47], a[12:15], a[164:167], v[32:47]
 s_nop 4
 v_cndmask_b32 v16, v16, v144, s[36:37]
 v_cndmask_b32 v17, v17, v145, s[38:39]
 v_cndmask_b32 v18, v18, v146, s[40:41]
 v_cndmask_b32 v19, v19, v147, s[42:43]
 v_cndmask_b32 v20, v20, v148, s[44:45]
 v_cndmask_b32 v21, v21, v149, s[46:47]
 v_cndmask_b32 v22, v22, v150, s[48:49]
 v_cndmask_b32 v23, v23, v151, s[50:51]
 v_cndmask_b32 v24, v24, v152, s[52:53]
 v_cndmask_b32 v25, v25, v153, s[54:55]
 v_cndmask_b32 v26, v26, v154, s[56:57]
 v_cndmask_b32 v27, v27, v155, s[58:59]
 v_cndmask_b32 v28, v28, v156, s[60:61]
 v_cndmask_b32 v29, v29, v157, s[62:63]
 v_cndmask_b32 v30, v30, v158, s[64:65]
 v_cndmask_b32 v31, v31, v159, s[66:67]
 v_max3_f32 v216, v16, v17, v18
 v_max3_f32 v217, v19, v20, v21
 v_max3_f32 v216, v216, v22, v23
 v_max3_f32 v217, v217, v24, v25
 v_max3_f32 v216, v216, v26, v27
 v_max3_f32 v217, v217, v28, v29
 v_max3_f32 v216, v216, v30, v31
 s_waitcnt lgkmcnt(10)
 v_mfma_f32_32x32x16_bf16 v[48:63], a[16:19], a[160:163], 0
 ds_read_b64_tr_b16 a[48:49], v232 offset:1536
 ds_read_b64_tr_b16 a[50:51], v232 offset:5696
 ds_read_b64_tr_b16 a[52:53], v233 offset:1536
 s_waitcnt lgkmcnt(12)
 v_mfma_f32_32x32x16_bf16 v[48:63], a[20:23], a[164:167], v[48:63]
 s_waitcnt lgkmcnt(10)
 v_mfma_f32_32x32x16_bf16 v[64:79], a[24:27], a[160:163], 0
 ds_read_b64_tr_b16 a[56:57], v232 offset:1792
 ds_read_b64_tr_b16 a[58:59], v232 offset:5952
 ds_read_b64_tr_b16 a[60:61], v233 offset:1792
 s_waitcnt lgkmcnt(12)
 v_mfma_f32_32x32x16_bf16 v[64:79], a[28:31], a[164:167], v[64:79]
 v_max3_f32 v216, v216, v32, v33
 v_max3_f32 v217, v217, v34, v35
 v_max3_f32 v216, v216, v36, v37
 v_max3_f32 v217, v217, v38, v39
 v_max3_f32 v216, v216, v40, v41
 v_max3_f32 v217, v217, v42, v43
 v_max3_f32 v216, v216, v44, v45
 v_max3_f32 v217, v217, v46, v47
 s_waitcnt lgkmcnt(10)
 v_mfma_f32_32x32x16_bf16 v[80:95], a[32:35], a[160:163], 0
 ds_read_b64_tr_b16 a[72:73], v232 offset:2304
 ds_read_b64_tr_b16 a[74:75], v232 offset:6464
 ds_read_b64_tr_b16 a[76:77], v233 offset:2304
 s_waitcnt lgkmcnt(12)
 v_mfma_f32_32x32x16_bf16 v[80:95], a[36:39], a[164:167], v[80:95]
 v_max3_f32 v216, v216, v48, v49
 v_max3_f32 v217, v217, v50, v51
 v_max3_f32 v216, v216, v52, v53
 v_max3_f32 v217, v217, v54, v55
 v_max3_f32 v216, v216, v56, v57
 v_max3_f32 v217, v217, v58, v59
 v_max3_f32 v216, v216, v60, v61
 v_max3_f32 v217, v217, v62, v63
 s_waitcnt lgkmcnt(10)
 v_mfma_f32_32x32x16_bf16 v[96:111], a[40:43], a[160:163], 0
 s_waitcnt lgkmcnt(9)
 v_mfma_f32_32x32x16_bf16 v[96:111], a[44:47], a[164:167], v[96:111]
 v_max3_f32 v216, v216, v64, v65
 v_max3_f32 v217, v217, v66, v67
 v_max3_f32 v216, v216, v68, v69
 v_max3_f32 v217, v217, v70, v71
 v_max3_f32 v216, v216, v72, v73
 v_max3_f32 v217, v217, v74, v75
 v_max3_f32 v216, v216, v76, v77
 v_max3_f32 v217, v217, v78, v79
 s_waitcnt lgkmcnt(7)
 v_mfma_f32_32x32x16_bf16 v[112:127], a[48:51], a[160:163], 0
 s_waitcnt lgkmcnt(6)
 v_mfma_f32_32x32x16_bf16 v[112:127], a[52:55], a[164:167], v[112:127]
 v_max3_f32 v216, v216, v80, v81
 v_max3_f32 v217, v217, v82, v83
 v_max3_f32 v216, v216, v84, v85
 v_max3_f32 v217, v217, v86, v87
 v_max3_f32 v216, v216, v88, v89
 v_max3_f32 v217, v217, v90, v91
 v_max3_f32 v216, v216, v92, v93
 v_max3_f32 v217, v217, v94, v95
 s_waitcnt lgkmcnt(4)
 v_mfma_f32_32x32x16_bf16 v[128:143], a[56:59], a[160:163], 0
 s_waitcnt lgkmcnt(3)
 v_mfma_f32_32x32x16_bf16 v[128:143], a[60:63], a[164:167], v[128:143]
 v_max3_f32 v216, v216, v96, v97
 v_max3_f32 v217, v217, v98, v99
 v_max3_f32 v216, v216, v100, v101
 v_max3_f32 v217, v217, v102, v103
 v_max3_f32 v216, v216, v104, v105
 v_max3_f32 v217, v217, v106, v107
 v_max3_f32 v216, v216, v108, v109
 v_max3_f32 v217, v217, v110, v111
 v_max3_f32 v216, v216, v112, v113
 v_max3_f32 v217, v217, v114, v115
 v_max3_f32 v216, v216, v116, v117
 v_max3_f32 v217, v217, v118, v119
 v_max3_f32 v216, v216, v120, v121
 v_max3_f32 v217, v217, v122, v123
 v_max3_f32 v216, v216, v124, v125
 v_max3_f32 v217, v217, v126, v127
 v_max3_f32 v216, v216, v128, v129
 v_max3_f32 v217, v217, v130, v131
 v_max3_f32 v216, v216, v132, v133
 v_max3_f32 v217, v217, v134, v135
 v_max3_f32 v216, v216, v136, v137
 v_max3_f32 v217, v217, v138, v139
 v_max3_f32 v216, v216, v140, v141
 v_max3_f32 v217, v217, v142, v143
 s_waitcnt vmcnt(0)
 s_barrier
 s_mov_b32 s28, s4
 s_and_b32 s29, s5, 0xffff
 s_mov_b32 s30, 0x510000
 s_mov_b32 s31, 0x20000
 s_mov_b32 s32, s6
 s_and_b32 s33, s7, 0xffff
 s_mov_b32 s34, 0x510000
 s_mov_b32 s35, 0x20000
 ds_read_b128 a[80:83], v236 offset:0
 ds_read_b128 a[84:87], v236 offset:128
 ds_read_b128 a[144:147], v236 offset:2048
 ds_read_b128 a[148:151], v236 offset:2176
 ds_read_b128 a[88:91], v236 offset:256
 ds_read_b128 a[92:95], v236 offset:384
 v_max_f32 v216, v216, v217
 v_mov_b32 v217, v216
 s_nop 1
 v_permlane32_swap_b32 v216, v217
 v_max_f32 v216, v216, v217
 v_xor_b32 v216, 0x80000000, v216
 v_and_b32 v217, 0xffff0000, v216
 v_sub_f32 v216, v216, v217
 v_and_b32 v218, 0xffff0000, v216
 v_sub_f32 v216, v216, v218
 v_alignbit_b32 v217, v219, v217, 16
 v_and_b32 v217, 0xffff, v217
 v_or_b32 v217, v217, v218
 v_lshrrev_b32 v216, 16, v216
 v_accvgpr_write_b32 a212, v217
 v_accvgpr_write_b32 a213, v216
 s_nop 1
 v_mfma_f32_32x32x16_bf16 v[16:31], a[208:211], a[212:215], v[16:31]
 v_mfma_f32_32x32x16_bf16 v[32:47], a[208:211], a[212:215], v[32:47]
 s_nop 10
 v_exp_f32 v16, v16
 ds_read_b128 a[96:99], v236 offset:512
 v_exp_f32 v17, v17
 v_exp_f32 v18, v18
 v_mfma_f32_32x32x16_bf16 v[48:63], a[208:211], a[212:215], v[48:63]
 v_exp_f32 v19, v19
 s_add_u32 m0, s91, 49152
 s_add_u32 s101, s90, s72
 buffer_load_dwordx4 v240, s[76:79], s101 offen offset:0 lds
 v_exp_f32 v20, v20
 v_exp_f32 v21, v21
 ds_read_b128 a[100:103], v236 offset:640
 v_exp_f32 v22, v22
 v_exp_f32 v23, v23
 v_mfma_f32_32x32x16_bf16 v[160:175], a[8:11], a[168:171], 0
 v_cvt_pk_bf16_f32 v16, v16, v17
 v_cvt_pk_bf16_f32 v17, v18, v19
 v_cvt_pk_bf16_f32 v18, v20, v21
 ds_read_b128 a[104:107], v236 offset:768
 v_cvt_pk_bf16_f32 v19, v22, v23
 v_exp_f32 v24, v24
 v_mfma_f32_32x32x16_bf16 v[160:175], a[12:15], a[172:175], v[160:175]
 v_exp_f32 v25, v25
 v_exp_f32 v26, v26
 v_exp_f32 v27, v27
 ds_read_b128 a[108:111], v236 offset:896
 buffer_load_dwordx4 v241, s[76:79], s101 offen offset:1024 lds
 v_exp_f32 v28, v28
 v_exp_f32 v29, v29
 s_waitcnt lgkmcnt(11)
 v_mfma_f32_32x32x16_bf16 v[176:191], a[72:75], a[168:171], 0
 v_exp_f32 v30, v30
 v_exp_f32 v31, v31
 v_cvt_pk_bf16_f32 v20, v24, v25
 v_cvt_pk_bf16_f32 v21, v26, v27
 v_cvt_pk_bf16_f32 v22, v28, v29
 s_waitcnt lgkmcnt(10)
 v_mfma_f32_32x32x16_bf16 v[176:191], a[76:79], a[172:175], v[176:191]
 v_cvt_pk_bf16_f32 v23, v30, v31
 v_and_b32 v144, v16, v208
 v_xor_b32 v16, v16, v144
 v_and_b32 v145, v17, v209
 v_xor_b32 v17, v17, v145
 v_mfma_f32_32x32x16_bf16 v[192:207], a[16:19], a[168:171], 0
 buffer_load_dwordx4 v242, s[76:79], s101 offen offset:2048 lds
 v_and_b32 v146, v18, v210
 v_xor_b32 v18, v18, v146
 v_and_b32 v147, v19, v211
 v_xor_b32 v19, v19, v147
 v_and_b32 v148, v20, v212
 v_mfma_f32_32x32x16_bf16 v[192:207], a[20:23], a[172:175], v[192:207]
 v_xor_b32 v20, v20, v148
 v_and_b32 v149, v21, v213
 v_xor_b32 v21, v21, v149
 v_and_b32 v150, v22, v214
 v_xor_b32 v22, v22, v150
 v_and_b32 v151, v23, v215
 v_xor_b32 v23, v23, v151
 v_exp_f32 v32, v32
 ds_read_b128 a[112:115], v236 offset:1024
 v_exp_f32 v33, v33
 v_exp_f32 v34, v34
 v_mfma_f32_32x32x16_bf16 v[64:79], a[208:211], a[212:215], v[64:79]
 v_exp_f32 v35, v35
 buffer_load_dwordx4 v243, s[76:79], s101 offen offset:3072 lds
 v_exp_f32 v36, v36
 v_exp_f32 v37, v37
 s_waitcnt lgkmcnt(10)
 v_mfma_f32_32x32x16_bf16 a[176:191], a[80:83], v[16:19], 0
 ds_read_b128 a[116:119], v236 offset:1152
 v_exp_f32 v38, v38
 v_exp_f32 v39, v39
 v_cvt_pk_bf16_f32 v32, v32, v33
 v_cvt_pk_bf16_f32 v33, v34, v35
 s_waitcnt lgkmcnt(10)
 v_mfma_f32_32x32x16_bf16 a[176:191], a[84:87], v[20:23], a[176:191]
 v_cvt_pk_bf16_f32 v34, v36, v37
 ds_read_b128 a[120:123], v236 offset:1280
 s_add_u32 m0, s91, 53248
 s_add_u32 s101, s90, s73
 buffer_load_dwordx4 v251, s[76:79], s101 offen offset:0 lds
 v_cvt_pk_bf16_f32 v35, v38, v39
 v_exp_f32 v40, v40
 v_exp_f32 v41, v41
 s_waitcnt lgkmcnt(10)
 v_mfma_f32_32x32x16_bf16 a[176:191], a[144:147], v[144:147], a[176:191]
 v_exp_f32 v42, v42
 v_exp_f32 v43, v43
 ds_read_b128 a[124:127], v236 offset:1408
 v_exp_f32 v44, v44
 v_exp_f32 v45, v45
 s_waitcnt lgkmcnt(10)
 v_mfma_f32_32x32x16_bf16 a[176:191], a[148:151], v[148:151], a[176:191]
 buffer_load_dwordx4 v252, s[76:79], s101 offen offset:1024 lds
 s_add_u32 s90, s90, 165888
 v_exp_f32 v46, v46
 v_exp_f32 v47, v47
 v_cvt_pk_bf16_f32 v36, v40, v41
 v_cvt_pk_bf16_f32 v37, v42, v43
 v_cvt_pk_bf16_f32 v38, v44, v45
 v_cvt_pk_bf16_f32 v39, v46, v47
 v_cndmask_b32 v160, v160, v176, s[36:37]
 v_cndmask_b32 v161, v161, v177, s[38:39]
 v_cndmask_b32 v162, v162, v178, s[40:41]
 v_cndmask_b32 v163, v163, v179, s[42:43]
 v_cndmask_b32 v164, v164, v180, s[44:45]
 v_cndmask_b32 v165, v165, v181, s[46:47]
 v_cndmask_b32 v166, v166, v182, s[48:49]
 v_cndmask_b32 v167, v167, v183, s[50:51]
 v_cndmask_b32 v168, v168, v184, s[52:53]
 v_cndmask_b32 v169, v169, v185, s[54:55]
 v_cndmask_b32 v170, v170, v186, s[56:57]
 v_cndmask_b32 v171, v171, v187, s[58:59]
 v_cndmask_b32 v172, v172, v188, s[60:61]
 v_cndmask_b32 v173, v173, v189, s[62:63]
 v_cndmask_b32 v174, v174, v190, s[64:65]
 v_cndmask_b32 v175, v175, v191, s[66:67]
 v_max3_f32 v220, v160, v161, v162
 v_max3_f32 v221, v163, v164, v165
 v_max3_f32 v220, v220, v166, v167
 v_max3_f32 v221, v221, v168, v169
 v_max3_f32 v220, v220, v170, v171
 v_max3_f32 v221, v221, v172, v173
 v_max3_f32 v220, v220, v174, v175
 v_max3_f32 v220, v220, v192, v193
 v_max3_f32 v221, v221, v194, v195
 v_max3_f32 v220, v220, v196, v197
 v_max3_f32 v221, v221, v198, v199
 v_max3_f32 v220, v220, v200, v201
 v_max3_f32 v221, v221, v202, v203
 v_max3_f32 v220, v220, v204, v205
 v_max3_f32 v221, v221, v206, v207
 v_exp_f32 v48, v48
 ds_read_b128 a[128:131], v236 offset:1536
 v_exp_f32 v49, v49
 v_exp_f32 v50, v50
 v_mfma_f32_32x32x16_bf16 v[80:95], a[208:211], a[212:215], v[80:95]
 v_exp_f32 v51, v51
 s_add_u32 m0, s91, 73728
 s_add_u32 s101, s90, s72
 buffer_load_dwordx4 v240, s[76:79], s101 offen offset:0 lds
 v_exp_f32 v52, v52
 s_waitcnt lgkmcnt(10)
 v_mfma_f32_32x32x16_bf16 a[176:191], a[88:91], v[32:35], a[176:191]
 v_exp_f32 v53, v53
 ds_read_b128 a[132:135], v236 offset:1664
 v_exp_f32 v54, v54
 v_exp_f32 v55, v55
 s_waitcnt lgkmcnt(10)
 v_mfma_f32_32x32x16_bf16 a[176:191], a[92:95], v[36:39], a[176:191]
 v_cvt_pk_bf16_f32 v48, v48, v49
 v_cvt_pk_bf16_f32 v49, v50, v51
 v_cvt_pk_bf16_f32 v50, v52, v53
 v_mfma_f32_32x32x16_bf16 v[16:31], a[24:27], a[168:171], 0
 ds_read_b128 a[136:139], v236 offset:1792
 buffer_load_dwordx4 v241, s[76:79], s101 offen offset:1024 lds
 v_cvt_pk_bf16_f32 v51, v54, v55
 v_exp_f32 v56, v56
 v_mfma_f32_32x32x16_bf16 v[16:31], a[28:31], a[172:175], v[16:31]
 v_exp_f32 v57, v57
 v_exp_f32 v58, v58
 v_exp_f32 v59, v59
 v_mfma_f32_32x32x16_bf16 v[144:159], a[32:35], a[168:171], 0
 ds_read_b128 a[140:143], v236 offset:1920
 v_exp_f32 v60, v60
 v_exp_f32 v61, v61
 buffer_load_dwordx4 v242, s[76:79], s101 offen offset:2048 lds
 v_exp_f32 v62, v62
 v_mfma_f32_32x32x16_bf16 v[144:159], a[36:39], a[172:175], v[144:159]
 v_exp_f32 v63, v63
 v_cvt_pk_bf16_f32 v52, v56, v57
 v_cvt_pk_bf16_f32 v53, v58, v59
 v_cvt_pk_bf16_f32 v54, v60, v61
 v_cvt_pk_bf16_f32 v55, v62, v63
 v_exp_f32 v64, v64
 ds_read_b128 a[152:155], v236 offset:2304
 v_exp_f32 v65, v65
 v_exp_f32 v66, v66
 v_mfma_f32_32x32x16_bf16 v[96:111], a[208:211], a[212:215], v[96:111]
 v_exp_f32 v67, v67
 buffer_load_dwordx4 v243, s[76:79], s101 offen offset:3072 lds
 v_exp_f32 v68, v68
 v_exp_f32 v69, v69
 s_waitcnt lgkmcnt(12)
 v_mfma_f32_32x32x16_bf16 a[176:191], a[96:99], v[48:51], a[176:191]
 v_exp_f32 v70, v70
 v_exp_f32 v71, v71
 v_cvt_pk_bf16_f32 v64, v64, v65
 v_cvt_pk_bf16_f32 v65, v66, v67
 s_waitcnt lgkmcnt(11)
 v_mfma_f32_32x32x16_bf16 a[176:191], a[100:103], v[52:55], a[176:191]
 v_cvt_pk_bf16_f32 v66, v68, v69
 ds_read_b128 a[156:159], v236 offset:2432
 s_add_u32 m0, s91, 77824
 s_add_u32 s101, s90, s73
 buffer_load_dwordx4 v251, s[76:79], s101 offen offset:0 lds
 v_cvt_pk_bf16_f32 v67, v70, v71
 v_exp_f32 v72, v72
 v_exp_f32 v73, v73
 v_mfma_f32_32x32x16_bf16 v[32:47], a[40:43], a[168:171], 0
 v_exp_f32 v74, v74
 v_exp_f32 v75, v75
 v_exp_f32 v76, v76
 v_exp_f32 v77, v77
 v_mfma_f32_32x32x16_bf16 v[32:47], a[44:47], a[172:175], v[32:47]
 buffer_load_dwordx4 v252, s[76:79], s101 offen offset:1024 lds
 v_exp_f32 v78, v78
 v_exp_f32 v79, v79
 v_cvt_pk_bf16_f32 v68, v72, v73
 v_cvt_pk_bf16_f32 v69, v74, v75
 v_cvt_pk_bf16_f32 v70, v76, v77
 v_cvt_pk_bf16_f32 v71, v78, v79
 v_max3_f32 v220, v220, v16, v17
 v_max3_f32 v221, v221, v18, v19
 v_max3_f32 v220, v220, v20, v21
 v_max3_f32 v221, v221, v22, v23
 s_branch L_c2_p1_s
L_c2_p1:
 s_branch L_c2_ret
L_c2_p1_s:
 v_max3_f32 v220, v220, v24, v25
 v_max3_f32 v221, v221, v26, v27
 v_max3_f32 v220, v220, v28, v29
 v_max3_f32 v221, v221, v30, v31
 v_max3_f32 v220, v220, v144, v145
 v_max3_f32 v221, v221, v146, v147
 v_max3_f32 v220, v220, v148, v149
 v_max3_f32 v221, v221, v150, v151
 v_max3_f32 v220, v220, v152, v153
 v_max3_f32 v221, v221, v154, v155
 v_max3_f32 v220, v220, v156, v157
 v_max3_f32 v221, v221, v158, v159
 v_exp_f32 v80, v80
 v_exp_f32 v81, v81
 v_exp_f32 v82, v82
 v_mfma_f32_32x32x16_bf16 v[112:127], a[208:211], a[212:215], v[112:127]
 v_exp_f32 v83, v83
 s_and_b32 s90, s22, 1
 s_mul_i32 s91, s90, 6144
 s_add_u32 s91, s91, 53248
 s_mul_i32 s90, s90, 331776
 s_add_u32 m0, s91, 98304
 s_add_u32 s101, s90, s72
 buffer_load_dwordx4 v244, s[76:79], s101 offen offset:0 lds
 v_exp_f32 v84, v84
 v_exp_f32 v85, v85
 s_waitcnt lgkmcnt(11)
 v_mfma_f32_32x32x16_bf16 a[176:191], a[104:107], v[64:67], a[176:191]
 v_exp_f32 v86, v86
 v_exp_f32 v87, v87
 v_cvt_pk_bf16_f32 v80, v80, v81
 v_cvt_pk_bf16_f32 v81, v82, v83
 s_waitcnt lgkmcnt(10)
 v_mfma_f32_32x32x16_bf16 a[176:191], a[108:111], v[68:71], a[176:191]
 v_cvt_pk_bf16_f32 v82, v84, v85
 buffer_load_dwordx4 v245, s[76:79], s101 offen offset:1024 lds
 v_cvt_pk_bf16_f32 v83, v86, v87
 v_exp_f32 v88, v88
 v_exp_f32 v89, v89
 v_mfma_f32_32x32x16_bf16 v[48:63], a[48:51], a[168:171], 0
 v_exp_f32 v90, v90
 v_exp_f32 v91, v91
 v_exp_f32 v92, v92
 v_exp_f32 v93, v93
 v_mfma_f32_32x32x16_bf16 v[48:63], a[52:55], a[172:175], v[48:63]
 buffer_load_dwordx4 v246, s[76:79], s101 offen offset:2048 lds
 v_exp_f32 v94, v94
 v_exp_f32 v95, v95
 v_cvt_pk_bf16_f32 v84, v88, v89
 v_cvt_pk_bf16_f32 v85, v90, v91
 v_cvt_pk_bf16_f32 v86, v92, v93
 v_cvt_pk_bf16_f32 v87, v94, v95
 v_max3_f32 v220, v220, v32, v33
 v_max3_f32 v221, v221, v34, v35
 v_max3_f32 v220, v220, v36, v37
 v_max3_f32 v221, v221, v38, v39
 v_max3_f32 v220, v220, v40, v41
 v_max3_f32 v221, v221, v42, v43
 v_max3_f32 v220, v220, v44, v45
 v_max3_f32 v221, v221, v46, v47
 v_exp_f32 v96, v96
 v_exp_f32 v97, v97
 v_exp_f32 v98, v98
 v_mfma_f32_32x32x16_bf16 v[128:143], a[208:211], a[212:215], v[128:143]
 v_exp_f32 v99, v99
 buffer_load_dwordx4 v247, s[76:79], s101 offen offset:3072 lds
 v_exp_f32 v100, v100
 v_exp_f32 v101, v101
 s_waitcnt lgkmcnt(9)
 v_mfma_f32_32x32x16_bf16 a[176:191], a[112:115], v[80:83], a[176:191]
 v_exp_f32 v102, v102
 v_exp_f32 v103, v103
 v_cvt_pk_bf16_f32 v96, v96, v97
 v_cvt_pk_bf16_f32 v97, v98, v99
 s_waitcnt lgkmcnt(8)
 v_mfma_f32_32x32x16_bf16 a[176:191], a[116:119], v[84:87], a[176:191]
 v_cvt_pk_bf16_f32 v98, v100, v101
 s_add_u32 m0, s91, 102400
 s_add_u32 s101, s90, s73
 buffer_load_dwordx4 v253, s[76:79], s101 offen offset:0 lds
 v_cvt_pk_bf16_f32 v99, v102, v103
 v_exp_f32 v104, v104
 v_exp_f32 v105, v105
 v_mfma_f32_32x32x16_bf16 v[64:79], a[56:59], a[168:171], 0
 v_exp_f32 v106, v106
 v_exp_f32 v107, v107
 v_exp_f32 v108, v108
 v_exp_f32 v109, v109
 v_mfma_f32_32x32x16_bf16 v[64:79], a[60:63], a[172:175], v[64:79]
 buffer_load_dwordx4 v254, s[76:79], s101 offen offset:1024 lds
 v_exp_f32 v110, v110
 v_exp_f32 v111, v111
 v_cvt_pk_bf16_f32 v100, v104, v105
 v_cvt_pk_bf16_f32 v101, v106, v107
 v_cvt_pk_bf16_f32 v102, v108, v109
 v_cvt_pk_bf16_f32 v103, v110, v111
 v_max3_f32 v220, v220, v48, v49
 v_max3_f32 v221, v221, v50, v51
 v_max3_f32 v220, v220, v52, v53
 v_max3_f32 v221, v221, v54, v55
 v_max3_f32 v220, v220, v56, v57
 v_max3_f32 v221, v221, v58, v59
 v_max3_f32 v220, v220, v60, v61
 v_max3_f32 v221, v221, v62, v63
 v_exp_f32 v112, v112
 v_exp_f32 v113, v113
 v_exp_f32 v114, v114
 s_waitcnt lgkmcnt(7)
 v_mfma_f32_32x32x16_bf16 a[176:191], a[120:123], v[96:99], a[176:191]
 v_exp_f32 v115, v115
 buffer_load_dword a240, v229, s[28:31], s27 offen
 v_exp_f32 v116, v116
 v_exp_f32 v117, v117
 v_exp_f32 v118, v118
 s_waitcnt lgkmcnt(6)
 v_mfma_f32_32x32x16_bf16 a[176:191], a[124:127], v[100:103], a[176:191]
 v_exp_f32 v119, v119
 v_cvt_pk_bf16_f32 v112, v112, v113
 v_cvt_pk_bf16_f32 v113, v114, v115
 v_cvt_pk_bf16_f32 v114, v116, v117
 buffer_load_dword a241, v229, s[32:35], s26 offen offset:0
 v_cvt_pk_bf16_f32 v115, v118, v119
 v_mfma_f32_32x32x16_bf16 v[80:95], a[64:67], a[168:171], 0
 v_exp_f32 v120, v120
 v_exp_f32 v121, v121
 v_exp_f32 v122, v122
 v_exp_f32 v123, v123
 v_exp_f32 v124, v124
 v_mfma_f32_32x32x16_bf16 v[80:95], a[68:71], a[172:175], v[80:95]
 v_exp_f32 v125, v125
 buffer_load_dword a242, v229, s[32:35], s26 offen offset:1792
 v_exp_f32 v126, v126
 v_exp_f32 v127, v127
 v_cvt_pk_bf16_f32 v116, v120, v121
 v_cvt_pk_bf16_f32 v117, v122, v123
 v_cvt_pk_bf16_f32 v118, v124, v125
 v_cvt_pk_bf16_f32 v119, v126, v127
 v_max3_f32 v220, v220, v64, v65
 v_max3_f32 v221, v221, v66, v67
 v_max3_f32 v220, v220, v68, v69
 v_max3_f32 v221, v221, v70, v71
 v_max3_f32 v220, v220, v72, v73
 v_max3_f32 v221, v221, v74, v75
 v_max3_f32 v220, v220, v76, v77
 v_max3_f32 v221, v221, v78, v79
 v_exp_f32 v128, v128
 v_exp_f32 v129, v129
 v_exp_f32 v130, v130
 s_waitcnt lgkmcnt(5)
 v_mfma_f32_32x32x16_bf16 a[176:191], a[128:131], v[112:115], a[176:191]
 v_exp_f32 v131, v131
 buffer_load_dword a243, v229, s[32:35], s26 offen offset:3584
 v_exp_f32 v132, v132
 v_exp_f32 v133, v133
 v_exp_f32 v134, v134
 v_exp_f32 v135, v135
 v_cvt_pk_bf16_f32 v128, v128, v129
 v_cvt_pk_bf16_f32 v129, v130, v131
 v_cvt_pk_bf16_f32 v130, v132, v133
 v_cvt_pk_bf16_f32 v131, v134, v135
 s_waitcnt lgkmcnt(4)
 v_mfma_f32_32x32x16_bf16 a[176:191], a[132:135], v[116:119], a[176:191]
 v_exp_f32 v136, v136
 v_exp_f32 v137, v137
 v_exp_f32 v138, v138
 v_exp_f32 v139, v139
 v_exp_f32 v140, v140
 v_exp_f32 v141, v141
 v_exp_f32 v142, v142
 v_exp_f32 v143, v143
 v_cvt_pk_bf16_f32 v132, v136, v137
 v_cvt_pk_bf16_f32 v133, v138, v139
 v_cvt_pk_bf16_f32 v134, v140, v141
 v_cvt_pk_bf16_f32 v135, v142, v143
 v_max3_f32 v220, v220, v80, v81
 v_max3_f32 v221, v221, v82, v83
 v_max3_f32 v220, v220, v84, v85
 v_max3_f32 v221, v221, v86, v87
 v_max3_f32 v220, v220, v88, v89
 v_max3_f32 v221, v221, v90, v91
 v_max3_f32 v220, v220, v92, v93
 v_max3_f32 v221, v221, v94, v95
 v_max_f32 v220, v220, v221
 v_mov_b32 v221, v220
 s_nop 1
 v_permlane32_swap_b32 v220, v221
 v_max_f32 v220, v220, v221
 v_xor_b32 v220, 0x80000000, v220
 v_and_b32 v221, 0xffff0000, v220
 v_sub_f32 v220, v220, v221
 v_and_b32 v222, 0xffff0000, v220
 v_sub_f32 v220, v220, v222
 v_alignbit_b32 v221, v223, v221, 16
 v_and_b32 v221, 0xffff, v221
 v_or_b32 v221, v221, v222
 v_lshrrev_b32 v220, 16, v220
 v_accvgpr_write_b32 a216, v221
 v_accvgpr_write_b32 a217, v220
 s_nop 1
 v_mfma_f32_32x32x16_bf16 v[160:175], a[208:211], a[216:219], v[160:175]
 s_waitcnt lgkmcnt(3)
 v_mfma_f32_32x32x16_bf16 a[176:191], a[136:139], v[128:131], a[176:191]
 s_waitcnt lgkmcnt(2)
 v_mfma_f32_32x32x16_bf16 a[176:191], a[140:143], v[132:135], a[176:191]
 v_mfma_f32_32x32x16_bf16 v[192:207], a[208:211], a[216:219], v[192:207]
 s_nop 6
 v_exp_f32 v160, v160
 v_exp_f32 v161, v161
 v_exp_f32 v162, v162
 v_mfma_f32_32x32x16_bf16 v[16:31], a[208:211], a[216:219], v[16:31]
 v_exp_f32 v163, v163
 v_exp_f32 v164, v164
 v_exp_f32 v165, v165
 v_exp_f32 v166, v166
 v_exp_f32 v167, v167
 v_cvt_pk_bf16_f32 v160, v160, v161
 v_cvt_pk_bf16_f32 v161, v162, v163
 v_cvt_pk_bf16_f32 v162, v164, v165
 v_cvt_pk_bf16_f32 v163, v166, v167
 v_exp_f32 v168, v168
 v_exp_f32 v169, v169
 v_exp_f32 v170, v170
 v_exp_f32 v171, v171
 v_exp_f32 v172, v172
 v_exp_f32 v173, v173
 v_exp_f32 v174, v174
 v_exp_f32 v175, v175
 v_cvt_pk_bf16_f32 v164, v168, v169
 v_cvt_pk_bf16_f32 v165, v170, v171
 v_cvt_pk_bf16_f32 v166, v172, v173
 v_cvt_pk_bf16_f32 v167, v174, v175
 v_and_b32 v176, v160, v208
 v_xor_b32 v160, v160, v176
 v_and_b32 v177, v161, v209
 v_xor_b32 v161, v161, v177
 v_and_b32 v178, v162, v210
 v_xor_b32 v162, v162, v178
 v_and_b32 v179, v163, v211
 v_xor_b32 v163, v163, v179
 v_and_b32 v180, v164, v212
 v_xor_b32 v164, v164, v180
 v_and_b32 v181, v165, v213
 v_xor_b32 v165, v165, v181
 v_and_b32 v182, v166, v214
 v_xor_b32 v166, v166, v182
 v_and_b32 v183, v167, v215
 v_xor_b32 v167, v167, v183
 v_exp_f32 v192, v192
 v_exp_f32 v193, v193
 v_exp_f32 v194, v194
 v_mfma_f32_32x32x16_bf16 v[144:159], a[208:211], a[216:219], v[144:159]
 v_exp_f32 v195, v195
 v_exp_f32 v196, v196
 v_exp_f32 v197, v197
 v_mfma_f32_32x32x16_bf16 a[192:207], a[88:91], v[160:163], 0
 v_exp_f32 v198, v198
 v_exp_f32 v199, v199
 v_cvt_pk_bf16_f32 v192, v192, v193
 v_cvt_pk_bf16_f32 v193, v194, v195
 v_mfma_f32_32x32x16_bf16 a[192:207], a[92:95], v[164:167], a[192:207]
 v_cvt_pk_bf16_f32 v194, v196, v197
 v_cvt_pk_bf16_f32 v195, v198, v199
 v_exp_f32 v200, v200
 v_exp_f32 v201, v201
 s_waitcnt lgkmcnt(1)
 v_mfma_f32_32x32x16_bf16 a[192:207], a[152:155], v[176:179], a[192:207]
 v_exp_f32 v202, v202
 v_exp_f32 v203, v203
 v_exp_f32 v204, v204
 v_exp_f32 v205, v205
 s_waitcnt lgkmcnt(0)
 v_mfma_f32_32x32x16_bf16 a[192:207], a[156:159], v[180:183], a[192:207]
 v_exp_f32 v206, v206
 v_exp_f32 v207, v207
 v_cvt_pk_bf16_f32 v196, v200, v201
 v_cvt_pk_bf16_f32 v197, v202, v203
 v_cvt_pk_bf16_f32 v198, v204, v205
 v_cvt_pk_bf16_f32 v199, v206, v207
 v_accvgpr_read_b32 v2, a188
 v_rcp_f32 v2, v2
 v_accvgpr_read_b32 v4, a176
 v_accvgpr_read_b32 v5, a177
 v_accvgpr_read_b32 v6, a178
 v_accvgpr_read_b32 v7, a179
 v_accvgpr_read_b32 v8, a180
 v_accvgpr_read_b32 v9, a181
 v_accvgpr_read_b32 v10, a182
 v_accvgpr_read_b32 v11, a183
 v_accvgpr_read_b32 v12, a184
 v_accvgpr_read_b32 v13, a185
 v_mul_f32 v4, v4, v2
 v_mul_f32 v5, v5, v2
 v_mul_f32 v6, v6, v2
 v_mul_f32 v7, v7, v2
 v_mul_f32 v8, v8, v2
 v_mul_f32 v9, v9, v2
 v_mul_f32 v10, v10, v2
 v_mul_f32 v11, v11, v2
 v_mul_f32 v12, v12, v2
 v_mul_f32 v13, v13, v2
 v_cvt_pk_bf16_f32 v96, v4, v5
 v_cvt_pk_bf16_f32 v97, v6, v7
 v_cvt_pk_bf16_f32 v98, v8, v9
 v_cvt_pk_bf16_f32 v99, v10, v11
 v_cvt_pk_bf16_f32 v100, v12, v13
 v_exp_f32 v16, v16
 v_exp_f32 v17, v17
 v_exp_f32 v18, v18
 v_mfma_f32_32x32x16_bf16 v[32:47], a[208:211], a[216:219], v[32:47]
 v_exp_f32 v19, v19
 v_exp_f32 v20, v20
 v_exp_f32 v21, v21
 v_exp_f32 v22, v22
 v_exp_f32 v23, v23
 v_cvt_pk_bf16_f32 v16, v16, v17
 v_mfma_f32_32x32x16_bf16 a[192:207], a[96:99], v[192:195], a[192:207]
 v_cvt_pk_bf16_f32 v17, v18, v19
 v_cvt_pk_bf16_f32 v18, v20, v21
 v_cvt_pk_bf16_f32 v19, v22, v23
 v_exp_f32 v24, v24
 v_exp_f32 v25, v25
 v_exp_f32 v26, v26
 v_mfma_f32_32x32x16_bf16 a[192:207], a[100:103], v[196:199], a[192:207]
 v_exp_f32 v27, v27
 v_exp_f32 v28, v28
 v_exp_f32 v29, v29
 v_exp_f32 v30, v30
 v_exp_f32 v31, v31
 v_cvt_pk_bf16_f32 v20, v24, v25
 v_cvt_pk_bf16_f32 v21, v26, v27
 v_cvt_pk_bf16_f32 v22, v28, v29
 v_cvt_pk_bf16_f32 v23, v30, v31
 v_exp_f32 v144, v144
 v_exp_f32 v145, v145
 v_exp_f32 v146, v146
 v_mfma_f32_32x32x16_bf16 v[48:63], a[208:211], a[216:219], v[48:63]
 v_exp_f32 v147, v147
 v_exp_f32 v148, v148
 v_exp_f32 v149, v149
 v_exp_f32 v150, v150
 v_exp_f32 v151, v151
 v_cvt_pk_bf16_f32 v144, v144, v145
 v_mfma_f32_32x32x16_bf16 a[192:207], a[104:107], v[16:19], a[192:207]
 v_cvt_pk_bf16_f32 v145, v146, v147
 v_cvt_pk_bf16_f32 v146, v148, v149
 v_cvt_pk_bf16_f32 v147, v150, v151
 v_exp_f32 v152, v152
 v_exp_f32 v153, v153
 v_exp_f32 v154, v154
 v_mfma_f32_32x32x16_bf16 a[192:207], a[108:111], v[20:23], a[192:207]
 v_exp_f32 v155, v155
 v_exp_f32 v156, v156
 v_exp_f32 v157, v157
 v_exp_f32 v158, v158
 v_exp_f32 v159, v159
 v_cvt_pk_bf16_f32 v148, v152, v153
 v_cvt_pk_bf16_f32 v149, v154, v155
 v_cvt_pk_bf16_f32 v150, v156, v157
 v_cvt_pk_bf16_f32 v151, v158, v159
 v_exp_f32 v32, v32
 v_exp_f32 v33, v33
 v_exp_f32 v34, v34
 v_mfma_f32_32x32x16_bf16 v[64:79], a[208:211], a[216:219], v[64:79]
 v_exp_f32 v35, v35
 v_exp_f32 v36, v36
 v_exp_f32 v37, v37
 v_exp_f32 v38, v38
 v_exp_f32 v39, v39
 v_cvt_pk_bf16_f32 v32, v32, v33
 v_mfma_f32_32x32x16_bf16 a[192:207], a[112:115], v[144:147], a[192:207]
 v_cvt_pk_bf16_f32 v33, v34, v35
 v_cvt_pk_bf16_f32 v34, v36, v37
 v_cvt_pk_bf16_f32 v35, v38, v39
 v_exp_f32 v40, v40
 v_exp_f32 v41, v41
 v_exp_f32 v42, v42
 v_mfma_f32_32x32x16_bf16 a[192:207], a[116:119], v[148:151], a[192:207]
 v_exp_f32 v43, v43
 v_exp_f32 v44, v44
 v_exp_f32 v45, v45
 v_exp_f32 v46, v46
 v_exp_f32 v47, v47
 v_cvt_pk_bf16_f32 v36, v40, v41
 v_cvt_pk_bf16_f32 v37, v42, v43
 v_cvt_pk_bf16_f32 v38, v44, v45
 v_cvt_pk_bf16_f32 v39, v46, v47
 v_exp_f32 v48, v48
 v_exp_f32 v49, v49
 v_exp_f32 v50, v50
 v_mfma_f32_32x32x16_bf16 v[80:95], a[208:211], a[216:219], v[80:95]
 v_exp_f32 v51, v51
 v_exp_f32 v52, v52
 v_exp_f32 v53, v53
 v_exp_f32 v54, v54
 v_exp_f32 v55, v55
 v_cvt_pk_bf16_f32 v48, v48, v49
 v_mfma_f32_32x32x16_bf16 a[192:207], a[120:123], v[32:35], a[192:207]
 v_cvt_pk_bf16_f32 v49, v50, v51
 v_cvt_pk_bf16_f32 v50, v52, v53
 v_cvt_pk_bf16_f32 v51, v54, v55
 v_exp_f32 v56, v56
 v_exp_f32 v57, v57
 v_exp_f32 v58, v58
 v_mfma_f32_32x32x16_bf16 a[192:207], a[124:127], v[36:39], a[192:207]
 v_exp_f32 v59, v59
 v_exp_f32 v60, v60
 v_exp_f32 v61, v61
 v_exp_f32 v62, v62
 v_exp_f32 v63, v63
 v_cvt_pk_bf16_f32 v52, v56, v57
 v_cvt_pk_bf16_f32 v53, v58, v59
 v_cvt_pk_bf16_f32 v54, v60, v61
 v_cvt_pk_bf16_f32 v55, v62, v63
 v_exp_f32 v64, v64
 v_exp_f32 v65, v65
 v_exp_f32 v66, v66
 v_mfma_f32_32x32x16_bf16 a[192:207], a[128:131], v[48:51], a[192:207]
 v_exp_f32 v67, v67
 v_exp_f32 v68, v68
 v_exp_f32 v69, v69
 v_exp_f32 v70, v70
 v_exp_f32 v71, v71
 v_cvt_pk_bf16_f32 v64, v64, v65
 v_cvt_pk_bf16_f32 v65, v66, v67
 v_cvt_pk_bf16_f32 v66, v68, v69
 v_cvt_pk_bf16_f32 v67, v70, v71
 v_mfma_f32_32x32x16_bf16 a[192:207], a[132:135], v[52:55], a[192:207]
 v_exp_f32 v72, v72
 v_exp_f32 v73, v73
 v_exp_f32 v74, v74
 v_exp_f32 v75, v75
 v_exp_f32 v76, v76
 v_exp_f32 v77, v77
 v_exp_f32 v78, v78
 v_exp_f32 v79, v79
 v_cvt_pk_bf16_f32 v68, v72, v73
 v_cvt_pk_bf16_f32 v69, v74, v75
 v_cvt_pk_bf16_f32 v70, v76, v77
 v_cvt_pk_bf16_f32 v71, v78, v79
 v_exp_f32 v80, v80
 v_exp_f32 v81, v81
 v_exp_f32 v82, v82
 v_mfma_f32_32x32x16_bf16 a[192:207], a[136:139], v[64:67], a[192:207]
 v_exp_f32 v83, v83
 v_exp_f32 v84, v84
 v_exp_f32 v85, v85
 v_exp_f32 v86, v86
 v_exp_f32 v87, v87
 v_cvt_pk_bf16_f32 v80, v80, v81
 v_cvt_pk_bf16_f32 v81, v82, v83
 v_cvt_pk_bf16_f32 v82, v84, v85
 v_cvt_pk_bf16_f32 v83, v86, v87
 v_mfma_f32_32x32x16_bf16 a[192:207], a[140:143], v[68:71], a[192:207]
 v_exp_f32 v88, v88
 v_exp_f32 v89, v89
 v_exp_f32 v90, v90
 v_exp_f32 v91, v91
 v_exp_f32 v92, v92
 v_exp_f32 v93, v93
 v_exp_f32 v94, v94
 v_exp_f32 v95, v95
 v_cvt_pk_bf16_f32 v84, v88, v89
 v_cvt_pk_bf16_f32 v85, v90, v91
 v_cvt_pk_bf16_f32 v86, v92, v93
 v_cvt_pk_bf16_f32 v87, v94, v95
 buffer_store_dwordx4 v[96:99], v237, s[12:15], s69 offen offset:0 sc1
 buffer_store_dword v100, v238, s[16:19], s70 offen offset:0 sc1
 v_mfma_f32_32x32x16_bf16 a[192:207], a[144:147], v[80:83], a[192:207]
 v_mfma_f32_32x32x16_bf16 a[192:207], a[148:151], v[84:87], a[192:207]
 s_nop 11
 v_accvgpr_read_b32 v2, a204
 v_rcp_f32 v2, v2
 v_accvgpr_read_b32 v4, a192
 v_accvgpr_read_b32 v5, a193
 v_accvgpr_read_b32 v6, a194
 v_accvgpr_read_b32 v7, a195
 v_accvgpr_read_b32 v8, a196
 v_accvgpr_read_b32 v9, a197
 v_accvgpr_read_b32 v10, a198
 v_accvgpr_read_b32 v11, a199
 v_accvgpr_read_b32 v12, a200
 v_accvgpr_read_b32 v13, a201
 v_mul_f32 v4, v4, v2
 v_mul_f32 v5, v5, v2
 v_mul_f32 v6, v6, v2
 v_mul_f32 v7, v7, v2
 v_mul_f32 v8, v8, v2
 v_mul_f32 v9, v9, v2
 v_mul_f32 v10, v10, v2
 v_mul_f32 v11, v11, v2
 v_mul_f32 v12, v12, v2
 v_mul_f32 v13, v13, v2
 v_cvt_pk_bf16_f32 v224, v4, v5
 v_cvt_pk_bf16_f32 v225, v6, v7
 v_cvt_pk_bf16_f32 v226, v8, v9
 v_cvt_pk_bf16_f32 v227, v10, v11
 v_cvt_pk_bf16_f32 v228, v12, v13
 buffer_store_dwordx4 v[224:227], v237, s[12:15], s69 offen offset:512 sc1
 buffer_store_dword v228, v238, s[16:19], s70 offen offset:128 sc1
L_s3:
 s_load_dwordx2 s[56:57], s[0:1], 0
 s_load_dwordx4 s[36:39], s[0:1], 48
 s_lshl_b32 s30, s80, 2
 s_add_u32 s30, s30, s22
 s_lshl_b32 s30, s30, 12
 s_lshl_b32 s31, s81, 7
 s_add_u32 s30, s30, s31
 s_add_u32 s30, s30, 131072
 s_lshr_b32 s80, s2, 5
 s_and_b32 s81, s2, 7
 s_lshl_b32 s81, s81, 2
 s_bfe_u32 s82, s2, 0x20003
 s_add_u32 s81, s81, s82
 s_lshl_b32 s82, s81, 2
 s_add_u32 s82, s82, s22
 v_and_b32 v6, 15, v1
 v_lshrrev_b32 v7, 4, v1
 s_mov_b32 s26, 53248
 v_bfe_u32 v2, v1, 2, 3
 v_lshrrev_b32 v3, 5, v1
 v_lshlrev_b32 v3, 10, v3
 v_lshl_add_u32 v3, v2, 7, v3
 v_and_b32 v4, 3, v1
 v_lshl_add_u32 v3, v4, 3, v3
 v_add_u32 v3, s26, v3
 v_lshrrev_b32 v2, 1, v2
 v_xor_b32 v4, 0, v2
 v_lshl_add_u32 v220, v4, 5, v3
 v_xor_b32 v4, 1, v2
 v_lshl_add_u32 v221, v4, 5, v3
 v_xor_b32 v4, 2, v2
 v_lshl_add_u32 v222, v4, 5, v3
 v_xor_b32 v4, 3, v2
 v_lshl_add_u32 v223, v4, 5, v3
 v_lshrrev_b32 v2, 2, v1
 v_lshlrev_b32 v2, 6, v2
 v_and_b32 v3, 3, v1
 v_lshl_add_u32 v2, v3, 3, v2
 v_bfe_u32 v3, v1, 4, 1
 v_lshl_add_u32 v246, v3, 5, v2
 v_add_u32 v246, 57344, v246
 v_xor_b32 v247, 32, v246
 v_mul_u32_u24 v10, 1152, v6
 v_lshl_add_u32 v10, v7, 3, v10
 s_mul_i32 s28, s82, 18432
 s_add_u32 s29, s28, s73
 s_add_u32 s28, s28, s72
 s_waitcnt vmcnt(0)
 v_mov_b32 v2, s3
 buffer_store_dword v2, v250, s[96:99], s30 offen sc1
 s_waitcnt lgkmcnt(0)
 s_barrier
 s_cmp_ge_u32 s2, 192
 s_cbranch_scc1 L_pf3
 v_and_b32 v11, 31, v1
 v_lshlrev_b32 v11, 7, v11
 s_lshl_b32 s83, s81, 12
 s_add_u32 s83, s83, 131072
 s_mov_b32 s52, s56
 s_and_b32 s53, s57, 0xffff
 s_mov_b32 s54, 0x240000
 s_mov_b32 s55, 0x20000
 buffer_load_dwordx2 v[208:209], v10, s[52:55], s28 offen offset:0
 buffer_load_dwordx2 v[210:211], v10, s[52:55], s28 offen offset:32
 buffer_load_dwordx2 v[212:213], v10, s[52:55], s28 offen offset:64
 buffer_load_dwordx2 v[214:215], v10, s[52:55], s28 offen offset:96
 buffer_load_dwordx2 v[216:217], v10, s[52:55], s29 offen offset:0
 buffer_load_dwordx2 v[218:219], v10, s[52:55], s29 offen offset:32
 ds_read_b64_tr_b16 a[0:1], v220 offset:0
 ds_read_b64_tr_b16 a[2:3], v220 offset:2048
 ds_read_b64_tr_b16 a[4:5], v221 offset:0
 ds_read_b64_tr_b16 a[6:7], v221 offset:2048
 ds_read_b64_tr_b16 a[8:9], v222 offset:0
 ds_read_b64_tr_b16 a[10:11], v222 offset:2048
 ds_read_b64_tr_b16 a[12:13], v223 offset:0
 ds_read_b64_tr_b16 a[14:15], v223 offset:2048
 ds_read_b64_tr_b16 a[16:17], v246 offset:0
 ds_read_b64_tr_b16 a[18:19], v246 offset:1024
 ds_read_b64_tr_b16 a[20:21], v247 offset:0
 ds_read_b64_tr_b16 a[22:23], v247 offset:1024
 ds_read_b64_tr_b16 a[24:25], v220 offset:6144
 ds_read_b64_tr_b16 a[26:27], v220 offset:8192
 ds_read_b64_tr_b16 a[28:29], v221 offset:6144
 ds_read_b64_tr_b16 a[30:31], v221 offset:8192
 ds_read_b64_tr_b16 a[32:33], v222 offset:6144
 ds_read_b64_tr_b16 a[34:35], v222 offset:8192
 ds_read_b64_tr_b16 a[36:37], v223 offset:6144
 ds_read_b64_tr_b16 a[38:39], v223 offset:8192
 ds_read_b64_tr_b16 a[40:41], v246 offset:6144
 ds_read_b64_tr_b16 a[42:43], v246 offset:7168
 ds_read_b64_tr_b16 a[44:45], v247 offset:6144
 ds_read_b64_tr_b16 a[46:47], v247 offset:7168
 ds_read_b64_tr_b16 a[48:49], v220 offset:12288
 ds_read_b64_tr_b16 a[50:51], v220 offset:14336
 ds_read_b64_tr_b16 a[52:53], v221 offset:12288
 ds_read_b64_tr_b16 a[54:55], v221 offset:14336
 ds_read_b64_tr_b16 a[56:57], v222 offset:12288
 ds_read_b64_tr_b16 a[58:59], v222 offset:14336
 ds_read_b64_tr_b16 a[60:61], v223 offset:12288
 ds_read_b64_tr_b16 a[62:63], v223 offset:14336
 ds_read_b64_tr_b16 a[64:65], v246 offset:12288
 ds_read_b64_tr_b16 a[66:67], v246 offset:13312
 ds_read_b64_tr_b16 a[68:69], v247 offset:12288
 ds_read_b64_tr_b16 a[70:71], v247 offset:13312
 ds_read_b64_tr_b16 a[72:73], v220 offset:18432
 ds_read_b64_tr_b16 a[74:75], v220 offset:20480
 ds_read_b64_tr_b16 a[76:77], v221 offset:18432
 ds_read_b64_tr_b16 a[78:79], v221 offset:20480
 ds_read_b64_tr_b16 a[80:81], v222 offset:18432
 ds_read_b64_tr_b16 a[82:83], v222 offset:20480
 ds_read_b64_tr_b16 a[84:85], v223 offset:18432
 ds_read_b64_tr_b16 a[86:87], v223 offset:20480
 ds_read_b64_tr_b16 a[88:89], v246 offset:18432
 ds_read_b64_tr_b16 a[90:91], v246 offset:19456
 ds_read_b64_tr_b16 a[92:93], v247 offset:18432
 ds_read_b64_tr_b16 a[94:95], v247 offset:19456
 ds_read_b64_tr_b16 a[96:97], v220 offset:24576
 ds_read_b64_tr_b16 a[98:99], v220 offset:26624
 ds_read_b64_tr_b16 a[100:101], v221 offset:24576
 ds_read_b64_tr_b16 a[102:103], v221 offset:26624
 ds_read_b64_tr_b16 a[104:105], v222 offset:24576
 ds_read_b64_tr_b16 a[106:107], v222 offset:26624
 ds_read_b64_tr_b16 a[108:109], v223 offset:24576
 ds_read_b64_tr_b16 a[110:111], v223 offset:26624
 ds_read_b64_tr_b16 a[112:113], v246 offset:24576
 ds_read_b64_tr_b16 a[114:115], v246 offset:25600
 ds_read_b64_tr_b16 a[116:117], v247 offset:24576
 ds_read_b64_tr_b16 a[118:119], v247 offset:25600
 ds_read_b64_tr_b16 a[120:121], v220 offset:30720
 ds_read_b64_tr_b16 a[122:123], v220 offset:32768
 ds_read_b64_tr_b16 a[124:125], v221 offset:30720
 ds_read_b64_tr_b16 a[126:127], v221 offset:32768
 ds_read_b64_tr_b16 a[128:129], v222 offset:30720
 ds_read_b64_tr_b16 a[130:131], v222 offset:32768
 ds_read_b64_tr_b16 a[132:133], v223 offset:30720
 ds_read_b64_tr_b16 a[134:135], v223 offset:32768
 ds_read_b64_tr_b16 a[136:137], v246 offset:30720
 ds_read_b64_tr_b16 a[138:139], v246 offset:31744
 ds_read_b64_tr_b16 a[140:141], v247 offset:30720
 ds_read_b64_tr_b16 a[142:143], v247 offset:31744
 ds_read_b64_tr_b16 a[144:145], v220 offset:36864
 ds_read_b64_tr_b16 a[146:147], v220 offset:38912
 ds_read_b64_tr_b16 a[148:149], v221 offset:36864
 ds_read_b64_tr_b16 a[150:151], v221 offset:38912
 ds_read_b64_tr_b16 a[152:153], v222 offset:36864
 ds_read_b64_tr_b16 a[154:155], v222 offset:38912
 ds_read_b64_tr_b16 a[156:157], v223 offset:36864
 ds_read_b64_tr_b16 a[158:159], v223 offset:38912
 ds_read_b64_tr_b16 a[160:161], v246 offset:36864
 ds_read_b64_tr_b16 a[162:163], v246 offset:37888
 ds_read_b64_tr_b16 a[164:165], v247 offset:36864
 ds_read_b64_tr_b16 a[166:167], v247 offset:37888
 ds_read_b64_tr_b16 a[168:169], v220 offset:43008
 ds_read_b64_tr_b16 a[170:171], v220 offset:45056
 ds_read_b64_tr_b16 a[172:173], v221 offset:43008
 ds_read_b64_tr_b16 a[174:175], v221 offset:45056
 ds_read_b64_tr_b16 a[176:177], v222 offset:43008
 ds_read_b64_tr_b16 a[178:179], v222 offset:45056
 ds_read_b64_tr_b16 a[180:181], v223 offset:43008
 s_branch L_c3_p0_s
L_c3_p0:
 s_branch L_c3_p4
L_c3_p0_s:
 ds_read_b64_tr_b16 a[182:183], v223 offset:45056
 ds_read_b64_tr_b16 a[184:185], v246 offset:43008
 ds_read_b64_tr_b16 a[186:187], v246 offset:44032
 ds_read_b64_tr_b16 a[188:189], v247 offset:43008
 ds_read_b64_tr_b16 a[190:191], v247 offset:44032
 ds_read_b64_tr_b16 a[192:193], v220 offset:49152
 ds_read_b64_tr_b16 a[194:195], v220 offset:51200
 ds_read_b64_tr_b16 a[196:197], v221 offset:49152
 ds_read_b64_tr_b16 a[198:199], v221 offset:51200
 ds_read_b64_tr_b16 a[200:201], v222 offset:49152
 ds_read_b64_tr_b16 a[202:203], v222 offset:51200
 ds_read_b64_tr_b16 a[204:205], v223 offset:49152
 ds_read_b64_tr_b16 a[206:207], v223 offset:51200
 ds_read_b64_tr_b16 a[208:209], v246 offset:49152
 ds_read_b64_tr_b16 a[210:211], v246 offset:50176
 ds_read_b64_tr_b16 a[212:213], v247 offset:49152
 ds_read_b64_tr_b16 a[214:215], v247 offset:50176
 ds_read_b64_tr_b16 a[216:217], v220 offset:55296
 ds_read_b64_tr_b16 a[218:219], v220 offset:57344
 ds_read_b64_tr_b16 a[220:221], v221 offset:55296
 ds_read_b64_tr_b16 a[222:223], v221 offset:57344
 ds_read_b64_tr_b16 a[224:225], v222 offset:55296
 ds_read_b64_tr_b16 a[226:227], v222 offset:57344
 ds_read_b64_tr_b16 a[228:229], v223 offset:55296
 ds_read_b64_tr_b16 a[230:231], v223 offset:57344
 ds_read_b64_tr_b16 a[232:233], v246 offset:55296
 ds_read_b64_tr_b16 a[234:235], v246 offset:56320
 ds_read_b64_tr_b16 a[236:237], v247 offset:55296
 ds_read_b64_tr_b16 a[238:239], v247 offset:56320
 v_add_u32 v220, 61440, v220
 v_add_u32 v221, 61440, v221
 v_add_u32 v222, 61440, v222
 v_add_u32 v223, 61440, v223
 v_add_u32 v246, 61440, v246
 v_add_u32 v247, 61440, v247
 ds_read_b64_tr_b16 v[112:113], v220 offset:0
 ds_read_b64_tr_b16 v[114:115], v220 offset:2048
 ds_read_b64_tr_b16 v[116:117], v221 offset:0
 ds_read_b64_tr_b16 v[118:119], v221 offset:2048
 ds_read_b64_tr_b16 v[120:121], v222 offset:0
 ds_read_b64_tr_b16 v[122:123], v222 offset:2048
 ds_read_b64_tr_b16 v[124:125], v223 offset:0
 ds_read_b64_tr_b16 v[126:127], v223 offset:2048
 ds_read_b64_tr_b16 v[128:129], v246 offset:0
 ds_read_b64_tr_b16 v[130:131], v246 offset:1024
 ds_read_b64_tr_b16 v[132:133], v247 offset:0
 ds_read_b64_tr_b16 v[134:135], v247 offset:1024
 ds_read_b64_tr_b16 v[136:137], v220 offset:6144
 ds_read_b64_tr_b16 v[138:139], v220 offset:8192
 ds_read_b64_tr_b16 v[140:141], v221 offset:6144
 ds_read_b64_tr_b16 v[142:143], v221 offset:8192
 ds_read_b64_tr_b16 v[144:145], v222 offset:6144
 ds_read_b64_tr_b16 v[146:147], v222 offset:8192
 ds_read_b64_tr_b16 v[148:149], v223 offset:6144
 ds_read_b64_tr_b16 v[150:151], v223 offset:8192
 ds_read_b64_tr_b16 v[152:153], v246 offset:6144
 ds_read_b64_tr_b16 v[154:155], v246 offset:7168
 ds_read_b64_tr_b16 v[156:157], v247 offset:6144
 ds_read_b64_tr_b16 v[158:159], v247 offset:7168
 ds_read_b64_tr_b16 v[160:161], v220 offset:12288
 ds_read_b64_tr_b16 v[162:163], v220 offset:14336
 ds_read_b64_tr_b16 v[164:165], v221 offset:12288
 ds_read_b64_tr_b16 v[166:167], v221 offset:14336
 ds_read_b64_tr_b16 v[168:169], v222 offset:12288
 ds_read_b64_tr_b16 v[170:171], v222 offset:14336
 ds_read_b64_tr_b16 v[172:173], v223 offset:12288
 ds_read_b64_tr_b16 v[174:175], v223 offset:14336
 ds_read_b64_tr_b16 v[176:177], v246 offset:12288
 ds_read_b64_tr_b16 v[178:179], v246 offset:13312
 ds_read_b64_tr_b16 v[180:181], v247 offset:12288
 ds_read_b64_tr_b16 v[182:183], v247 offset:13312
 ds_read_b64_tr_b16 v[184:185], v220 offset:18432
 ds_read_b64_tr_b16 v[186:187], v220 offset:20480
 ds_read_b64_tr_b16 v[188:189], v221 offset:18432
 ds_read_b64_tr_b16 v[190:191], v221 offset:20480
 ds_read_b64_tr_b16 v[192:193], v222 offset:18432
 ds_read_b64_tr_b16 v[194:195], v222 offset:20480
 ds_read_b64_tr_b16 v[196:197], v223 offset:18432
 ds_read_b64_tr_b16 v[198:199], v223 offset:20480
 ds_read_b64_tr_b16 v[200:201], v246 offset:18432
 ds_read_b64_tr_b16 v[202:203], v246 offset:19456
 ds_read_b64_tr_b16 v[204:205], v247 offset:18432
 ds_read_b64_tr_b16 v[206:207], v247 offset:19456
 v_mul_u32_u24 v8, 34048, v7
 v_lshl_add_u32 v8, v6, 4, v8
 v_mul_u32_u24 v9, 33792, v7
 v_lshl_add_u32 v9, v6, 2, v9
 s_lshl_b32 s84, s82, 8
 s_lshl_b32 s85, s82, 6
 s_add_u32 s8, s20, 0xa00000
 s_addc_u32 s9, s21, 0
 s_and_b32 s9, s9, 0xffff
 s_mov_b32 s10, 0x240000
 s_mov_b32 s11, 0x20000
 s_add_u32 s76, s20, 0xd00000
 s_addc_u32 s77, s21, 0
 s_and_b32 s77, s77, 0xffff
 s_mov_b32 s78, 0x18000
 s_mov_b32 s79, 0x20000
 s_mov_b32 s86, 0x3f803f80
 s_mul_i32 s91, s82, 18432
 s_lshl_b32 s71, s73, 4
 s_add_u32 s71, s71, s91
 s_lshl_b32 s74, s72, 4
 s_add_u32 s91, s91, s74
 s_lshl_b32 s74, s80, 14
 s_lshl_b32 s87, s82, 7
 s_add_u32 s74, s74, s87
 s_lshl_b32 s101, s82, 10
 s_lshl_b32 s87, s80, 7
 s_add_u32 s101, s101, s87
 s_add_u32 s101, s101, 262144
 v_lshlrev_b32 v13, 4, v1
 v_lshlrev_b32 v14, 3, v1
 v_mov_b32 v2, 0x7fff0000
 v_cmp_gt_u32 vcc, 16, v1
 s_nop 1
 v_cndmask_b32 v14, v2, v14, vcc
 s_waitcnt vmcnt(5)
 v_lshlrev_b32 v88, 16, v208
 v_and_b32 v89, 0xffff0000, v208
 v_lshlrev_b32 v90, 16, v209
 v_and_b32 v91, 0xffff0000, v209
 s_waitcnt vmcnt(4)
 v_lshlrev_b32 v92, 16, v210
 v_and_b32 v93, 0xffff0000, v210
 v_lshlrev_b32 v94, 16, v211
 v_and_b32 v95, 0xffff0000, v211
 s_waitcnt vmcnt(3)
 v_lshlrev_b32 v96, 16, v212
 v_and_b32 v97, 0xffff0000, v212
 v_lshlrev_b32 v98, 16, v213
 v_and_b32 v99, 0xffff0000, v213
 s_waitcnt vmcnt(2)
 v_lshlrev_b32 v100, 16, v214
 v_and_b32 v101, 0xffff0000, v214
 v_lshlrev_b32 v102, 16, v215
 v_and_b32 v103, 0xffff0000, v215
 s_waitcnt vmcnt(1)
 v_lshlrev_b32 v104, 16, v216
 v_and_b32 v105, 0xffff0000, v216
 v_lshlrev_b32 v106, 16, v217
 v_and_b32 v107, 0xffff0000, v217
 s_waitcnt vmcnt(0)
 v_lshlrev_b32 v108, 16, v218
 v_and_b32 v109, 0xffff0000, v218
 v_lshlrev_b32 v110, 16, v219
 v_and_b32 v111, 0xffff0000, v219
 s_cmp_lg_u32 s22, 0
 s_cbranch_scc1 L_p3w
 buffer_load_dword v15, v11, s[96:99], s83 offen sc1
 s_waitcnt vmcnt(0)
 v_cmp_ne_u32 vcc, s3, v15
 s_nop 4
 s_cbranch_vccnz L_slow_p3
L_back_p3:
L_p3w:
 s_barrier
 buffer_load_dwordx4 v[16:19], v8, s[12:15], s84 offen sc1
 s_add_u32 s84, s84, 136192
 buffer_load_dwordx4 v[20:23], v8, s[12:15], s84 offen sc1
 s_add_u32 s84, s84, 136192
 buffer_load_dwordx4 v[24:27], v8, s[12:15], s84 offen sc1
 s_add_u32 s84, s84, 136192
 buffer_load_dwordx4 v[28:31], v8, s[12:15], s84 offen sc1
 s_add_u32 s84, s84, 136192
 buffer_load_dwordx4 v[32:35], v8, s[12:15], s84 offen sc1
 s_add_u32 s84, s84, 136192
 buffer_load_dwordx4 v[36:39], v8, s[12:15], s84 offen sc1
 s_add_u32 s84, s84, 136192
 buffer_load_dwordx4 v[40:43], v8, s[12:15], s84 offen sc1
 s_add_u32 s84, s84, 136192
 buffer_load_dwordx4 v[44:47], v8, s[12:15], s84 offen sc1
 s_add_u32 s84, s84, 136192
 buffer_load_dwordx4 v[48:51], v8, s[12:15], s84 offen sc1
 s_add_u32 s84, s84, 136192
 buffer_load_dwordx4 v[52:55], v8, s[12:15], s84 offen sc1
 s_add_u32 s84, s84, 136192
 buffer_load_dwordx4 v[56:59], v8, s[12:15], s84 offen sc1
 s_add_u32 s84, s84, 136192
 buffer_load_dwordx4 v[60:63], v8, s[12:15], s84 offen sc1
 s_add_u32 s84, s84, 136192
 buffer_load_dwordx4 v[64:67], v8, s[12:15], s84 offen sc1
 s_add_u32 s84, s84, 136192
 buffer_load_dwordx4 v[68:71], v8, s[12:15], s84 offen sc1
 s_add_u32 s84, s84, 136192
 buffer_load_dwordx4 v[72:75], v8, s[12:15], s84 offen sc1
 s_add_u32 s84, s84, 136192
 buffer_load_dwordx4 v[76:79], v8, s[12:15], s84 offen sc1
 s_add_u32 s84, s84, 136192
 buffer_load_dword v80, v9, s[16:19], s85 offen sc1
 s_add_u32 s85, s85, 8448
 buffer_load_dword v81, v9, s[16:19], s85 offen sc1
 s_add_u32 s85, s85, 8448
 buffer_load_dword v82, v9, s[16:19], s85 offen sc1
 s_add_u32 s85, s85, 8448
 buffer_load_dword v83, v9, s[16:19], s85 offen sc1
 s_add_u32 s85, s85, 109824
 buffer_load_dword v84, v9, s[16:19], s85 offen sc1
 s_add_u32 s85, s85, 8448
 buffer_load_dword v85, v9, s[16:19], s85 offen sc1
 s_add_u32 s85, s85, 8448
 buffer_load_dword v86, v9, s[16:19], s85 offen sc1
 s_add_u32 s85, s85, 8448
 buffer_load_dword v87, v9, s[16:19], s85 offen sc1
 s_add_u32 s85, s85, 109824
 s_waitcnt vmcnt(23) lgkmcnt(15)
 v_mfma_f32_16x16x32_bf16 v[88:91], a[0:3], v[16:19], v[88:91]
 s_and_b32 s23, s2, 1
 s_lshl_b32 s23, s23, 3
 v_mfma_f32_16x16x32_bf16 v[92:95], a[4:7], v[16:19], v[92:95]
 s_bfe_u32 s25, s2, 0x30003
 v_mfma_f32_16x16x32_bf16 v[96:99], a[8:11], v[16:19], v[96:99]
 s_add_u32 s23, s23, s25
 s_bfe_u32 s24, s2, 0x20001
 v_mfma_f32_16x16x32_bf16 v[100:103], a[12:15], v[16:19], v[100:103]
 s_lshl_b32 s24, s24, 2
 v_mfma_f32_16x16x32_bf16 v[104:107], a[16:19], v[16:19], v[104:107]
 s_lshr_b32 s25, s2, 6
 v_mfma_f32_16x16x32_bf16 v[108:111], a[20:23], v[16:19], v[108:111]
 s_add_u32 s24, s24, s25
 s_and_b32 s25, s24, 1
 s_waitcnt vmcnt(22)
 v_mfma_f32_16x16x32_bf16 v[88:91], a[24:27], v[20:23], v[88:91]
 ds_read_b64_tr_b16 a[0:1], v220 offset:24576
 s_mul_i32 s26, s24, 576
 v_mfma_f32_16x16x32_bf16 v[92:95], a[28:31], v[20:23], v[92:95]
 ds_read_b64_tr_b16 a[2:3], v220 offset:26624
 s_lshl_b32 s27, s25, 6
 v_mfma_f32_16x16x32_bf16 v[96:99], a[32:35], v[20:23], v[96:99]
 ds_read_b64_tr_b16 a[4:5], v221 offset:24576
 s_add_u32 s27, s27, s26
 s_xor_b32 s25, s25, 1
 s_lshl_b32 s25, s25, 9
 v_mfma_f32_16x16x32_bf16 v[100:103], a[36:39], v[20:23], v[100:103]
 ds_read_b64_tr_b16 a[6:7], v221 offset:26624
 s_add_u32 s28, s25, s26
 s_lshl_b32 s29, s23, 3
 v_mfma_f32_16x16x32_bf16 v[104:107], a[40:43], v[20:23], v[104:107]
 ds_read_b64_tr_b16 a[8:9], v222 offset:24576
 s_lshl_b32 s30, s22, 1
 v_mfma_f32_16x16x32_bf16 v[108:111], a[44:47], v[20:23], v[108:111]
 ds_read_b64_tr_b16 a[10:11], v222 offset:26624
 s_add_u32 s29, s29, s30
 v_lshrrev_b32 v2, 3, v1
 s_waitcnt vmcnt(21)
 v_mfma_f32_16x16x32_bf16 v[88:91], a[48:51], v[24:27], v[88:91]
 ds_read_b64_tr_b16 a[12:13], v223 offset:24576
 v_and_b32 v4, 6, v2
 v_mfma_f32_16x16x32_bf16 v[92:95], a[52:55], v[24:27], v[92:95]
 ds_read_b64_tr_b16 a[14:15], v223 offset:26624
 v_and_b32 v3, 7, v1
 v_mfma_f32_16x16x32_bf16 v[96:99], a[56:59], v[24:27], v[96:99]
 ds_read_b64_tr_b16 a[16:17], v246 offset:24576
 v_xor_b32 v4, v4, v3
 v_mfma_f32_16x16x32_bf16 v[100:103], a[60:63], v[24:27], v[100:103]
 ds_read_b64_tr_b16 a[18:19], v246 offset:25600
 v_lshlrev_b32 v4, 4, v4
 v_mfma_f32_16x16x32_bf16 v[104:107], a[64:67], v[24:27], v[104:107]
 ds_read_b64_tr_b16 a[20:21], v247 offset:24576
 v_mul_u32_u24 v5, 9216, v2
 v_add_u32 v5, v5, v4
 v_mfma_f32_16x16x32_bf16 v[108:111], a[68:71], v[24:27], v[108:111]
 ds_read_b64_tr_b16 a[22:23], v247 offset:25600
 v_add_u32 v224, 0, v5
 s_waitcnt vmcnt(20)
 v_mfma_f32_16x16x32_bf16 v[88:91], a[72:75], v[28:31], v[88:91]
 v_add_u32 v225, 72704, v5
 v_mfma_f32_16x16x32_bf16 v[92:95], a[76:79], v[28:31], v[92:95]
 v_add_u32 v226, 145408, v5
 v_mfma_f32_16x16x32_bf16 v[96:99], a[80:83], v[28:31], v[96:99]
 ds_read_b64_tr_b16 a[24:25], v220 offset:30720
 v_add_u32 v227, 218112, v5
 v_mfma_f32_16x16x32_bf16 v[100:103], a[84:87], v[28:31], v[100:103]
 ds_read_b64_tr_b16 a[26:27], v220 offset:32768
 s_mul_i32 s56, s22, 589824
 v_mfma_f32_16x16x32_bf16 v[104:107], a[88:91], v[28:31], v[104:107]
 ds_read_b64_tr_b16 a[28:29], v221 offset:30720
 s_add_u32 s56, s56, s27
 s_mul_i32 s57, s22, 73728
 v_mfma_f32_16x16x32_bf16 v[108:111], a[92:95], v[28:31], v[108:111]
 ds_read_b64_tr_b16 a[30:31], v221 offset:32768
 s_add_u32 s57, s57, s27
 s_add_u32 s57, s57, 2359296
 s_lshl_b32 s58, s22, 13
 s_waitcnt vmcnt(19)
 v_mfma_f32_16x16x32_bf16 v[88:91], a[96:99], v[32:35], v[88:91]
 ds_read_b64_tr_b16 a[32:33], v222 offset:30720
 s_lshl_b32 s59, s22, 10
 v_mfma_f32_16x16x32_bf16 v[92:95], a[100:103], v[32:35], v[92:95]
 ds_read_b64_tr_b16 a[34:35], v222 offset:32768
 s_add_u32 s59, s59, 32768
 s_mov_b32 s40, s4
 s_and_b32 s41, s5, 0xffff
 v_mfma_f32_16x16x32_bf16 v[96:99], a[104:107], v[32:35], v[96:99]
 ds_read_b64_tr_b16 a[36:37], v223 offset:30720
 s_mov_b32 s42, 0x510000
 v_mfma_f32_16x16x32_bf16 v[100:103], a[108:111], v[32:35], v[100:103]
 ds_read_b64_tr_b16 a[38:39], v223 offset:32768
 s_mov_b32 s43, 0x20000
 v_mfma_f32_16x16x32_bf16 v[104:107], a[112:115], v[32:35], v[104:107]
 ds_read_b64_tr_b16 a[40:41], v246 offset:30720
 s_mov_b32 s44, s6
 v_mfma_f32_16x16x32_bf16 v[108:111], a[116:119], v[32:35], v[108:111]
 ds_read_b64_tr_b16 a[42:43], v246 offset:31744
 s_and_b32 s45, s7, 0xffff
 s_waitcnt vmcnt(18)
 v_mfma_f32_16x16x32_bf16 v[88:91], a[120:123], v[36:39], v[88:91]
 ds_read_b64_tr_b16 a[44:45], v247 offset:30720
 s_mov_b32 s46, 0x510000
 v_mfma_f32_16x16x32_bf16 v[92:95], a[124:127], v[36:39], v[92:95]
 ds_read_b64_tr_b16 a[46:47], v247 offset:31744
 s_mov_b32 s47, 0x20000
 v_mfma_f32_16x16x32_bf16 v[96:99], a[128:131], v[36:39], v[96:99]
 s_lshl_b32 s30, s29, 7
 v_mfma_f32_16x16x32_bf16 v[100:103], a[132:135], v[36:39], v[100:103]
 s_mul_i32 s31, s29, 18432
 s_add_u32 s48, s20, 0x3400000
 s_addc_u32 s49, s21, 0
 v_mfma_f32_16x16x32_bf16 v[104:107], a[136:139], v[36:39], v[104:107]
 ds_read_b64_tr_b16 a[48:49], v220 offset:36864
 s_and_b32 s49, s49, 0xffff
 v_mfma_f32_16x16x32_bf16 v[108:111], a[140:143], v[36:39], v[108:111]
 ds_read_b64_tr_b16 a[50:51], v220 offset:38912
 s_mov_b32 s50, 0x510000
 s_waitcnt vmcnt(17)
 v_mfma_f32_16x16x32_bf16 v[88:91], a[144:147], v[40:43], v[88:91]
 ds_read_b64_tr_b16 a[52:53], v221 offset:36864
 s_mov_b32 s51, 0x20000
 v_mfma_f32_16x16x32_bf16 v[92:95], a[148:151], v[40:43], v[92:95]
 ds_read_b64_tr_b16 a[54:55], v221 offset:38912
 s_cmp_lt_u32 s22, 2
 s_cselect_b32 s52, s40, s44
 s_cselect_b32 s53, s41, s45
 s_mov_b32 s54, 0x510000
 v_mfma_f32_16x16x32_bf16 v[96:99], a[152:155], v[40:43], v[96:99]
 ds_read_b64_tr_b16 a[56:57], v222 offset:36864
 s_mov_b32 s55, 0x20000
 v_mfma_f32_16x16x32_bf16 v[100:103], a[156:159], v[40:43], v[100:103]
 ds_read_b64_tr_b16 a[58:59], v222 offset:38912
 v_lshrrev_b32 v2, 2, v1
 v_mfma_f32_16x16x32_bf16 v[104:107], a[160:163], v[40:43], v[104:107]
 ds_read_b64_tr_b16 a[60:61], v223 offset:36864
 v_mul_u32_u24 v5, 9216, v2
 v_mfma_f32_16x16x32_bf16 v[108:111], a[164:167], v[40:43], v[108:111]
 ds_read_b64_tr_b16 a[62:63], v223 offset:38912
 v_bfe_u32 v3, v1, 4, 1
 s_waitcnt vmcnt(16)
 v_mfma_f32_16x16x32_bf16 v[88:91], a[168:171], v[44:47], v[88:91]
 ds_read_b64_tr_b16 a[64:65], v246 offset:36864
 v_lshlrev_b32 v3, 1, v3
 v_and_b32 v4, 3, v1
 v_mfma_f32_16x16x32_bf16 v[92:95], a[172:175], v[44:47], v[92:95]
 ds_read_b64_tr_b16 a[66:67], v246 offset:37888
 v_xor_b32 v3, v3, v4
 v_mfma_f32_16x16x32_bf16 v[96:99], a[176:179], v[44:47], v[96:99]
 ds_read_b64_tr_b16 a[68:69], v247 offset:36864
 v_lshl_add_u32 v5, v3, 4, v5
 v_mfma_f32_16x16x32_bf16 v[100:103], a[180:183], v[44:47], v[100:103]
 ds_read_b64_tr_b16 a[70:71], v247 offset:37888
 v_add_u32 v228, 0, v5
 v_mfma_f32_16x16x32_bf16 v[104:107], a[184:187], v[44:47], v[104:107]
 v_add_u32 v229, 146432, v5
 v_mfma_f32_16x16x32_bf16 v[108:111], a[188:191], v[44:47], v[108:111]
 v_add_u32 v230, 292864, v5
 s_waitcnt vmcnt(15)
 v_mfma_f32_16x16x32_bf16 v[88:91], a[192:195], v[48:51], v[88:91]
 ds_read_b64_tr_b16 a[72:73], v220 offset:43008
 v_add_u32 v231, 439296, v5
 v_mfma_f32_16x16x32_bf16 v[92:95], a[196:199], v[48:51], v[92:95]
 ds_read_b64_tr_b16 a[74:75], v220 offset:45056
 s_mul_i32 s61, s22, 9216
 v_mfma_f32_16x16x32_bf16 v[96:99], a[200:203], v[48:51], v[96:99]
 ds_read_b64_tr_b16 a[76:77], v221 offset:43008
 s_and_b32 s62, s22, 1
 s_mul_i32 s62, s62, 1327104
 v_mfma_f32_16x16x32_bf16 v[100:103], a[204:207], v[48:51], v[100:103]
 ds_read_b64_tr_b16 a[78:79], v221 offset:45056
 s_add_u32 s62, s62, s28
 s_lshr_b32 s25, s24, 2
 v_mfma_f32_16x16x32_bf16 v[104:107], a[208:211], v[48:51], v[104:107]
 ds_read_b64_tr_b16 a[80:81], v222 offset:43008
 s_and_b32 s26, s24, 3
 v_mfma_f32_16x16x32_bf16 v[108:111], a[212:215], v[48:51], v[108:111]
 ds_read_b64_tr_b16 a[82:83], v222 offset:45056
 s_and_b32 s35, s26, 1
 s_waitcnt vmcnt(14)
 v_mfma_f32_16x16x32_bf16 v[88:91], a[216:219], v[52:55], v[88:91]
 ds_read_b64_tr_b16 a[84:85], v223 offset:43008
 s_mul_i32 s34, s26, 288
 v_mfma_f32_16x16x32_bf16 v[92:95], a[220:223], v[52:55], v[92:95]
 ds_read_b64_tr_b16 a[86:87], v223 offset:45056
 s_lshl_b32 s67, s35, 5
 v_mfma_f32_16x16x32_bf16 v[96:99], a[224:227], v[52:55], v[96:99]
 ds_read_b64_tr_b16 a[88:89], v246 offset:43008
 s_add_u32 s33, s34, s67
 s_xor_b32 s67, s35, 1
 v_mfma_f32_16x16x32_bf16 v[100:103], a[228:231], v[52:55], v[100:103]
 ds_read_b64_tr_b16 a[90:91], v246 offset:44032
 s_lshl_b32 s67, s67, 8
 v_mfma_f32_16x16x32_bf16 v[104:107], a[232:235], v[52:55], v[104:107]
 ds_read_b64_tr_b16 a[92:93], v247 offset:43008
 s_add_u32 s34, s34, s67
 s_add_u32 s63, s26, s22
 s_and_b32 s63, s63, 3
 s_and_b32 s67, s24, 12
 v_mfma_f32_16x16x32_bf16 v[108:111], a[236:239], v[52:55], v[108:111]
 ds_read_b64_tr_b16 a[94:95], v247 offset:44032
 s_add_u32 s67, s67, s63
 s_mul_i32 s63, s67, 288
 s_waitcnt vmcnt(13)
 v_mfma_f32_16x16x32_bf16 v[88:91], v[112:115], v[56:59], v[88:91]
 s_and_b32 s67, s67, 1
 v_mfma_f32_16x16x32_bf16 v[92:95], v[116:119], v[56:59], v[92:95]
 s_xor_b32 s64, s67, 1
 v_mfma_f32_16x16x32_bf16 v[96:99], v[120:123], v[56:59], v[96:99]
 s_lshl_b32 s64, s64, 8
 v_mfma_f32_16x16x32_bf16 v[100:103], v[124:127], v[56:59], v[100:103]
 s_add_u32 s64, s64, s63
 s_lshl_b32 s67, s67, 5
 v_mfma_f32_16x16x32_bf16 v[104:107], v[128:131], v[56:59], v[104:107]
 s_add_u32 s63, s63, s67
 s_mul_i32 s67, s26, 9216
 v_mfma_f32_16x16x32_bf16 v[108:111], v[132:135], v[56:59], v[108:111]
 s_mul_i32 s63, s63, 1152
 s_waitcnt vmcnt(12)
 v_mfma_f32_16x16x32_bf16 v[88:91], v[136:139], v[60:63], v[88:91]
 s_add_u32 s63, s63, s67
 s_mul_i32 s64, s64, 1152
 v_mfma_f32_16x16x32_bf16 v[92:95], v[140:143], v[60:63], v[92:95]
 s_add_u32 s64, s64, s67
 v_bfe_u32 v2, v1, 2, 3
 v_lshrrev_b32 v3, 5, v1
 v_mfma_f32_16x16x32_bf16 v[96:99], v[144:147], v[60:63], v[96:99]
 v_lshlrev_b32 v3, 10, v3
 v_mfma_f32_16x16x32_bf16 v[100:103], v[148:151], v[60:63], v[100:103]
 v_lshl_add_u32 v3, v2, 7, v3
 v_mfma_f32_16x16x32_bf16 v[104:107], v[152:155], v[60:63], v[104:107]
 v_and_b32 v4, 3, v1
 v_mfma_f32_16x16x32_bf16 v[108:111], v[156:159], v[60:63], v[108:111]
 v_lshl_add_u32 v3, v4, 3, v3
 s_waitcnt vmcnt(11)
 v_mfma_f32_16x16x32_bf16 v[88:91], v[160:163], v[64:67], v[88:91]
 v_lshrrev_b32 v2, 1, v2
 v_mfma_f32_16x16x32_bf16 v[92:95], v[164:167], v[64:67], v[92:95]
 v_xor_b32 v4, 0, v2
 v_mfma_f32_16x16x32_bf16 v[96:99], v[168:171], v[64:67], v[96:99]
 v_lshl_add_u32 v236, v4, 5, v3
 v_mfma_f32_16x16x32_bf16 v[100:103], v[172:175], v[64:67], v[100:103]
 v_xor_b32 v4, 1, v2
 v_lshl_add_u32 v237, v4, 5, v3
 s_waitcnt lgkmcnt(15)
 v_mfma_f32_16x16x32_bf16 v[104:107], v[176:179], v[64:67], v[104:107]
 v_xor_b32 v4, 2, v2
 v_mfma_f32_16x16x32_bf16 v[108:111], v[180:183], v[64:67], v[108:111]
 v_lshl_add_u32 v238, v4, 5, v3
 s_waitcnt vmcnt(10)
 v_mfma_f32_16x16x32_bf16 v[88:91], v[184:187], v[68:71], v[88:91]
 v_xor_b32 v4, 3, v2
 v_mfma_f32_16x16x32_bf16 v[92:95], v[188:191], v[68:71], v[92:95]
 v_lshl_add_u32 v239, v4, 5, v3
 v_mfma_f32_16x16x32_bf16 v[96:99], v[192:195], v[68:71], v[96:99]
 v_lshrrev_b32 v2, 2, v1
 v_mfma_f32_16x16x32_bf16 v[100:103], v[196:199], v[68:71], v[100:103]
 v_lshlrev_b32 v2, 6, v2
 v_mfma_f32_16x16x32_bf16 v[104:107], v[200:203], v[68:71], v[104:107]
 v_and_b32 v3, 3, v1
 v_mfma_f32_16x16x32_bf16 v[108:111], v[204:207], v[68:71], v[108:111]
 v_lshl_add_u32 v2, v3, 3, v2
 s_waitcnt lgkmcnt(0)
 s_barrier
 s_waitcnt vmcnt(9)
 v_mfma_f32_16x16x32_bf16 v[88:91], a[0:3], v[72:75], v[88:91]
 v_bfe_u32 v3, v1, 4, 1
 v_lshl_add_u32 v240, v3, 5, v2
 v_mfma_f32_16x16x32_bf16 v[92:95], a[4:7], v[72:75], v[92:95]
 v_xor_b32 v241, 32, v240
 v_mfma_f32_16x16x32_bf16 v[96:99], a[8:11], v[72:75], v[96:99]
 s_mov_b32 s88, 0x00003f80
 v_mfma_f32_16x16x32_bf16 v[100:103], a[12:15], v[72:75], v[100:103]
 s_mov_b32 s89, 0x3f800000
 v_mfma_f32_16x16x32_bf16 v[104:107], a[16:19], v[72:75], v[104:107]
 s_mov_b32 s65, 0x3ae38e39
 v_mfma_f32_16x16x32_bf16 v[108:111], a[20:23], v[72:75], v[108:111]
 s_lshl_b32 s67, s23, 4
 s_waitcnt vmcnt(8)
 v_mfma_f32_16x16x32_bf16 v[88:91], a[24:27], v[76:79], v[88:91]
 s_add_u32 s66, s67, s24
 s_lshl_b32 s66, s66, 2
 v_mfma_f32_16x16x32_bf16 v[92:95], a[28:31], v[76:79], v[92:95]
 s_add_u32 s66, s66, s22
 s_mul_i32 s66, s66, 18432
 v_mfma_f32_16x16x32_bf16 v[96:99], a[32:35], v[76:79], v[96:99]
 s_and_b32 s68, s24, 12
 s_add_u32 s68, s68, s67
 s_lshl_b32 s68, s68, 2
 v_mfma_f32_16x16x32_bf16 v[100:103], a[36:39], v[76:79], v[100:103]
 s_add_u32 s68, s68, s22
 s_mul_i32 s68, s68, 18432
 v_mfma_f32_16x16x32_bf16 v[104:107], a[40:43], v[76:79], v[104:107]
 s_lshl_b32 s69, s23, 2
 v_mfma_f32_16x16x32_bf16 v[108:111], a[44:47], v[76:79], v[108:111]
 s_add_u32 s69, s69, s22
 s_lshl_b32 s69, s69, 11
 s_waitcnt vmcnt(4)
 v_mfma_f32_16x16x32_bf16 v[88:91], a[48:51], v[80:83], v[88:91]
 s_add_u32 s69, s69, 393216
 s_and_b32 s70, s24, 12
 v_mfma_f32_16x16x32_bf16 v[92:95], a[52:55], v[80:83], v[92:95]
 s_lshl_b32 s70, s70, 7
 v_mfma_f32_16x16x32_bf16 v[96:99], a[56:59], v[80:83], v[96:99]
 s_add_u32 s70, s70, s69
 s_lshl_b32 s67, s24, 7
 v_mfma_f32_16x16x32_bf16 v[100:103], a[60:63], v[80:83], v[100:103]
 s_add_u32 s69, s69, s67
 s_lshl_b32 s75, s29, 10
 v_mfma_f32_16x16x32_bf16 v[104:107], a[64:67], v[80:83], v[104:107]
 s_add_u32 s75, s75, 262144
 v_mfma_f32_16x16x32_bf16 v[108:111], a[68:71], v[80:83], v[108:111]
 s_waitcnt vmcnt(0)
 v_mfma_f32_16x16x32_bf16 v[88:91], a[72:75], v[84:87], v[88:91]
 v_mfma_f32_16x16x32_bf16 v[92:95], a[76:79], v[84:87], v[92:95]
 v_mfma_f32_16x16x32_bf16 v[96:99], a[80:83], v[84:87], v[96:99]
 v_mfma_f32_16x16x32_bf16 v[100:103], a[84:87], v[84:87], v[100:103]
 v_mfma_f32_16x16x32_bf16 v[104:107], a[88:91], v[84:87], v[104:107]
 v_mfma_f32_16x16x32_bf16 v[108:111], a[92:95], v[84:87], v[108:111]
 v_mov_b32 v4, 0
 v_mov_b32 v5, 0
 s_nop 0
 v_cvt_pk_bf16_f32 v16, v88, v89
 v_cvt_pk_bf16_f32 v17, v90, v91
 v_cvt_pk_bf16_f32 v18, v92, v93
 v_cvt_pk_bf16_f32 v19, v94, v95
 buffer_store_dwordx4 v[16:19], v13, s[8:11], s91 offen offset:0 sc1
 v_cvt_pk_bf16_f32 v20, v96, v97
 v_cvt_pk_bf16_f32 v21, v98, v99
 v_cvt_pk_bf16_f32 v22, v100, v101
 v_cvt_pk_bf16_f32 v23, v102, v103
 buffer_store_dwordx4 v[20:23], v13, s[8:11], s91 offen offset:1024 sc1
 v_cvt_pk_bf16_f32 v24, v104, v105
 v_cvt_pk_bf16_f32 v25, v106, v107
 v_cvt_pk_bf16_f32 v26, v108, v109
 v_cvt_pk_bf16_f32 v27, v110, v111
 buffer_store_dwordx4 v[24:27], v13, s[8:11], s71 offen offset:0 sc1
 v_dot2c_f32_bf16 v4, s86, v16
 v_dot2c_f32_bf16 v5, v16, v16
 v_dot2c_f32_bf16 v4, s86, v17
 v_dot2c_f32_bf16 v5, v17, v17
 v_dot2c_f32_bf16 v4, s86, v18
 v_dot2c_f32_bf16 v5, v18, v18
 v_dot2c_f32_bf16 v4, s86, v19
 v_dot2c_f32_bf16 v5, v19, v19
 v_dot2c_f32_bf16 v4, s86, v20
 v_dot2c_f32_bf16 v5, v20, v20
 v_dot2c_f32_bf16 v4, s86, v21
 v_dot2c_f32_bf16 v5, v21, v21
 v_dot2c_f32_bf16 v4, s86, v22
 v_dot2c_f32_bf16 v5, v22, v22
 v_dot2c_f32_bf16 v4, s86, v23
 v_dot2c_f32_bf16 v5, v23, v23
 v_dot2c_f32_bf16 v4, s86, v24
 v_dot2c_f32_bf16 v5, v24, v24
 v_dot2c_f32_bf16 v4, s86, v25
 v_dot2c_f32_bf16 v5, v25, v25
 v_dot2c_f32_bf16 v4, s86, v26
 v_dot2c_f32_bf16 v5, v26, v26
 v_dot2c_f32_bf16 v4, s86, v27
 v_dot2c_f32_bf16 v5, v27, v27
 s_nop 1
 v_mov_b32 v2, v4
 v_mov_b32 v3, v5
 s_nop 0
 v_permlane16_swap_b32 v4, v2
 v_permlane16_swap_b32 v5, v3
 v_add_f32 v4, v4, v2
 v_add_f32 v5, v5, v3
 v_mov_b32 v2, v4
 v_mov_b32 v3, v5
 s_nop 0
 v_permlane32_swap_b32 v4, v2
 v_permlane32_swap_b32 v5, v3
 v_add_f32 v4, v4, v2
 v_add_f32 v5, v5, v3
 buffer_store_dwordx2 v[4:5], v14, s[76:79], s74 offen sc1
L_p4:
 s_add_u32 m0, s58, 0
 s_add_u32 s60, s56, 0
 buffer_load_dwordx4 v224, s[40:43], s60 offen offset:0 lds
 buffer_load_dwordx4 v225, s[40:43], s60 offen offset:1024 lds
 buffer_load_dwordx4 v226, s[40:43], s60 offen offset:2048 lds
 buffer_load_dwordx4 v227, s[40:43], s60 offen offset:3072 lds
 s_cmp_ge_u32 s2, 192
 s_cbranch_scc1 L_p4nf
 s_waitcnt vmcnt(4)
 v_mov_b32 v5, s3
 buffer_store_dword v5, v250, s[96:99], s101 offen sc1
L_p4nf:
 s_add_u32 m0, s58, 4096
 s_add_u32 s60, s56, 294912
 buffer_load_dwordx4 v224, s[40:43], s60 offen offset:0 lds
 buffer_load_dwordx4 v225, s[40:43], s60 offen offset:1024 lds
 buffer_load_dwordx4 v226, s[40:43], s60 offen offset:2048 lds
 buffer_load_dwordx4 v227, s[40:43], s60 offen offset:3072 lds
 s_add_u32 m0, s59, 0
 s_add_u32 s60, s57, 0
 buffer_load_dwordx4 v224, s[40:43], s60 offen lds
 s_add_u32 m0, s58, 36864
 s_add_u32 s60, s56, 2654208
 buffer_load_dwordx4 v224, s[40:43], s60 offen offset:0 lds
 buffer_load_dwordx4 v225, s[40:43], s60 offen offset:1024 lds
 buffer_load_dwordx4 v226, s[40:43], s60 offen offset:2048 lds
 buffer_load_dwordx4 v227, s[40:43], s60 offen offset:3072 lds
 s_add_u32 m0, s58, 40960
 s_add_u32 s60, s56, 2949120
 buffer_load_dwordx4 v224, s[40:43], s60 offen offset:0 lds
 buffer_load_dwordx4 v225, s[40:43], s60 offen offset:1024 lds
 buffer_load_dwordx4 v226, s[40:43], s60 offen offset:2048 lds
 s_branch L_c3_p1_s
L_c3_p1:
 s_branch L_c3_p5
L_c3_p1_s:
 buffer_load_dwordx4 v227, s[40:43], s60 offen offset:3072 lds
 s_add_u32 m0, s59, 36864
 s_add_u32 s60, s57, 2654208
 buffer_load_dwordx4 v224, s[40:43], s60 offen lds
 v_lshl_add_u32 v8, v7, 11, v6
 v_lshlrev_b32 v8, 3, v8
 v_lshlrev_b32 v9, 4, v1
 v_add_u32 v12, 0x10000, v8
 v_mov_b32 v3, v250
 s_add_u32 s8, s20, 0xd00000
 s_addc_u32 s9, s21, 0
 s_and_b32 s9, s9, 0xffff
 s_mov_b32 s10, 0x18000
 s_mov_b32 s11, 0x20000
 s_add_u32 s12, s20, 0xa00000
 s_addc_u32 s13, s21, 0
 s_and_b32 s13, s13, 0xffff
 s_mov_b32 s14, 0x240000
 s_mov_b32 s15, 0x20000
 s_mov_b32 s16, s38
 s_and_b32 s17, s39, 0xffff
 s_mov_b32 s18, 0x240000
 s_mov_b32 s19, 0x20000
 v_and_b32 v14, 7, v1
 v_min_u32 v14, 5, v14
 v_lshlrev_b32 v14, 7, v14
 v_bfe_u32 v15, v1, 3, 1
 v_lshl_add_u32 v14, v15, 10, v14
 s_cmp_eq_u32 s22, 0
 s_cbranch_scc1 L_c4_p0
 s_cmp_eq_u32 s22, 1
 s_cbranch_scc1 L_c4_p1
 s_cmp_eq_u32 s22, 2
 s_cbranch_scc1 L_c4_p2
 s_branch L_c4_p3
L_c4_ret:
 buffer_load_dword v13, v14, s[96:99], s75 offen sc1
 s_waitcnt vmcnt(0)
 v_cmp_ne_u32 vcc, s3, v13
 s_nop 4
 s_cbranch_vccnz L_slow_p4
L_back_p4:
 s_cmp_lt_u32 s2, 192
 s_cbranch_scc1 L_nowf
 s_waitcnt vmcnt(0)
 v_mov_b32 v5, s3
 buffer_store_dword v5, v250, s[96:99], s101 offen sc1
L_nowf:
 buffer_load_dwordx2 v[192:193], v8, s[8:11], s30 offen offset:0 sc1
 buffer_load_dwordx2 v[194:195], v12, s[8:11], s30 offen offset:0 sc1
 buffer_load_dwordx2 v[198:199], v8, s[8:11], s30 offen offset:128 sc1
 buffer_load_dwordx2 v[200:201], v12, s[8:11], s30 offen offset:128 sc1
 s_add_u32 s32, s31, 0
 buffer_load_dwordx4 v[16:19], v9, s[12:15], s32 offen offset:0 sc1
 s_add_u32 s32, s31, 16384
 buffer_load_dwordx4 v[88:91], v9, s[12:15], s32 offen offset:2048 sc1
 s_add_u32 s32, s31, 0
 buffer_load_dwordx4 v[20:23], v9, s[12:15], s32 offen offset:1024 sc1
 s_add_u32 s32, s31, 16384
 buffer_load_dwordx4 v[92:95], v9, s[12:15], s32 offen offset:3072 sc1
 s_add_u32 s32, s31, 0
 buffer_load_dwordx4 v[24:27], v9, s[12:15], s32 offen offset:2048 sc1
 s_add_u32 s32, s31, 20480
 buffer_load_dwordx4 v[96:99], v9, s[12:15], s32 offen offset:0 sc1
 s_add_u32 s32, s31, 0
 buffer_load_dwordx4 v[28:31], v9, s[12:15], s32 offen offset:3072 sc1
 s_add_u32 s32, s31, 20480
 buffer_load_dwordx4 v[100:103], v9, s[12:15], s32 offen offset:1024 sc1
 s_add_u32 s32, s31, 4096
 buffer_load_dwordx4 v[32:35], v9, s[12:15], s32 offen offset:0 sc1
 s_add_u32 s32, s31, 20480
 buffer_load_dwordx4 v[104:107], v9, s[12:15], s32 offen offset:2048 sc1
 s_add_u32 s32, s31, 4096
 buffer_load_dwordx4 v[36:39], v9, s[12:15], s32 offen offset:1024 sc1
 s_add_u32 s32, s31, 20480
 buffer_load_dwordx4 v[108:111], v9, s[12:15], s32 offen offset:3072 sc1
 v_and_b32 v12, 3, v1
 v_lshlrev_b32 v12, 7, v12
 s_add_u32 s8, s20, 0x1000000
 s_addc_u32 s9, s21, 0
 s_and_b32 s9, s9, 0xffff
 s_mov_b32 s10, 0x1200000
 s_mov_b32 s11, 0x20000
 s_waitcnt vmcnt(14)
 v_add_f32 v192, v192, v194
 v_add_f32 v193, v193, v195
 v_mov_b32 v194, v192
 v_mov_b32 v195, v193
 s_nop 0
 v_permlane16_swap_b32 v192, v194
 v_permlane16_swap_b32 v193, v195
 v_add_f32 v192, v192, v194
 v_add_f32 v193, v193, v195
 v_mov_b32 v194, v192
 v_mov_b32 v195, v193
 s_nop 0
 v_permlane32_swap_b32 v192, v194
 v_permlane32_swap_b32 v193, v195
 v_add_f32 v192, v192, v194
 v_add_f32 v193, v193, v195
 v_mul_f32 v192, s65, v192
 v_mul_f32 v194, v192, v192
 v_fma_f32 v193, v193, s65, -v194
 v_max_f32 v193, 0, v193
 v_cvt_pk_bf16_f32 v192, v192, v192
 v_and_b32 v192, 0xffff0000, v192
 v_sub_f32 v10, 0, v192
 v_cvt_pk_bf16_f32 v193, v193, v193
 v_and_b32 v193, 0xffff0000, v193
 v_add_f32 v193, 0x3727c5ac, v193
 v_cvt_pk_bf16_f32 v193, v193, v193
 v_and_b32 v193, 0xffff0000, v193
 v_sqrt_f32 v193, v193
 s_nop 1
 v_cvt_pk_bf16_f32 v193, v193, v193
 v_and_b32 v193, 0xffff0000, v193
 v_mul_f32 v244, v193, v193
 v_rcp_f32 v193, v193
 s_nop 1
 v_mul_f32 v242, 0xbfb8aa3b, v193
 s_waitcnt vmcnt(12)
 v_add_f32 v198, v198, v200
 v_add_f32 v199, v199, v201
 v_mov_b32 v200, v198
 v_mov_b32 v201, v199
 s_nop 0
 v_permlane16_swap_b32 v198, v200
 v_permlane16_swap_b32 v199, v201
 v_add_f32 v198, v198, v200
 v_add_f32 v199, v199, v201
 v_mov_b32 v200, v198
 v_mov_b32 v201, v199
 s_nop 0
 v_permlane32_swap_b32 v198, v200
 v_permlane32_swap_b32 v199, v201
 v_add_f32 v198, v198, v200
 v_add_f32 v199, v199, v201
 v_mul_f32 v198, s65, v198
 v_mul_f32 v200, v198, v198
 v_fma_f32 v199, v199, s65, -v200
 v_max_f32 v199, 0, v199
 v_cvt_pk_bf16_f32 v198, v198, v198
 v_and_b32 v198, 0xffff0000, v198
 v_sub_f32 v11, 0, v198
 v_cvt_pk_bf16_f32 v199, v199, v199
 v_and_b32 v199, 0xffff0000, v199
 v_add_f32 v199, 0x3727c5ac, v199
 v_cvt_pk_bf16_f32 v199, v199, v199
 v_and_b32 v199, 0xffff0000, v199
 v_sqrt_f32 v199, v199
 s_nop 1
 v_cvt_pk_bf16_f32 v199, v199, v199
 v_and_b32 v199, 0xffff0000, v199
 v_mul_f32 v245, v199, v199
 v_rcp_f32 v199, v199
 s_nop 1
 v_mul_f32 v243, 0xbfb8aa3b, v199
 s_add_u32 s32, s31, 4096
 buffer_load_dwordx4 v[40:43], v9, s[12:15], s32 offen offset:2048 sc1
 s_waitcnt vmcnt(12)
 v_dot2_f32_bf16 v246, v16, s88, v10
 v_dot2_f32_bf16 v247, v16, s89, v10
 v_dot2_f32_bf16 v248, v17, s88, v10
 v_dot2_f32_bf16 v249, v17, s89, v10
 v_dot2_f32_bf16 v250, v18, s88, v10
 v_dot2_f32_bf16 v251, v18, s89, v10
 v_dot2_f32_bf16 v252, v19, s88, v10
 v_dot2_f32_bf16 v253, v19, s89, v10
 v_cvt_pk_bf16_f32 v16, v246, v247
 v_cvt_pk_bf16_f32 v17, v248, v249
 v_cvt_pk_bf16_f32 v18, v250, v251
 v_cvt_pk_bf16_f32 v19, v252, v253
 s_add_u32 s32, s31, 24576
 buffer_load_dwordx4 v[112:115], v9, s[12:15], s32 offen offset:0 sc1
 s_waitcnt vmcnt(12)
 v_dot2_f32_bf16 v246, v88, s88, v11
 v_dot2_f32_bf16 v247, v88, s89, v11
 v_dot2_f32_bf16 v248, v89, s88, v11
 v_dot2_f32_bf16 v249, v89, s89, v11
 v_dot2_f32_bf16 v250, v90, s88, v11
 v_dot2_f32_bf16 v251, v90, s89, v11
 v_dot2_f32_bf16 v252, v91, s88, v11
 v_dot2_f32_bf16 v253, v91, s89, v11
 v_cvt_pk_bf16_f32 v88, v246, v247
 v_cvt_pk_bf16_f32 v89, v248, v249
 v_cvt_pk_bf16_f32 v90, v250, v251
 v_cvt_pk_bf16_f32 v91, v252, v253
 s_add_u32 s32, s31, 4096
 buffer_load_dwordx4 v[44:47], v9, s[12:15], s32 offen offset:3072 sc1
 s_waitcnt vmcnt(12)
 v_dot2_f32_bf16 v246, v20, s88, v10
 v_dot2_f32_bf16 v247, v20, s89, v10
 v_dot2_f32_bf16 v248, v21, s88, v10
 v_dot2_f32_bf16 v249, v21, s89, v10
 v_dot2_f32_bf16 v250, v22, s88, v10
 v_dot2_f32_bf16 v251, v22, s89, v10
 v_dot2_f32_bf16 v252, v23, s88, v10
 v_dot2_f32_bf16 v253, v23, s89, v10
 v_cvt_pk_bf16_f32 v20, v246, v247
 v_cvt_pk_bf16_f32 v21, v248, v249
 v_cvt_pk_bf16_f32 v22, v250, v251
 v_cvt_pk_bf16_f32 v23, v252, v253
 s_add_u32 s32, s31, 24576
 buffer_load_dwordx4 v[116:119], v9, s[12:15], s32 offen offset:1024 sc1
 s_waitcnt vmcnt(12)
 v_dot2_f32_bf16 v246, v92, s88, v11
 v_dot2_f32_bf16 v247, v92, s89, v11
 v_dot2_f32_bf16 v248, v93, s88, v11
 v_dot2_f32_bf16 v249, v93, s89, v11
 v_dot2_f32_bf16 v250, v94, s88, v11
 v_dot2_f32_bf16 v251, v94, s89, v11
 v_dot2_f32_bf16 v252, v95, s88, v11
 v_dot2_f32_bf16 v253, v95, s89, v11
 v_cvt_pk_bf16_f32 v92, v246, v247
 v_cvt_pk_bf16_f32 v93, v248, v249
 v_cvt_pk_bf16_f32 v94, v250, v251
 v_cvt_pk_bf16_f32 v95, v252, v253
 s_add_u32 s32, s31, 8192
 buffer_load_dwordx4 v[48:51], v9, s[12:15], s32 offen offset:0 sc1
 s_waitcnt vmcnt(12)
 v_dot2_f32_bf16 v246, v24, s88, v10
 v_dot2_f32_bf16 v247, v24, s89, v10
 v_dot2_f32_bf16 v248, v25, s88, v10
 v_dot2_f32_bf16 v249, v25, s89, v10
 v_dot2_f32_bf16 v250, v26, s88, v10
 v_dot2_f32_bf16 v251, v26, s89, v10
 v_dot2_f32_bf16 v252, v27, s88, v10
 v_dot2_f32_bf16 v253, v27, s89, v10
 v_cvt_pk_bf16_f32 v24, v246, v247
 v_cvt_pk_bf16_f32 v25, v248, v249
 v_cvt_pk_bf16_f32 v26, v250, v251
 v_cvt_pk_bf16_f32 v27, v252, v253
 s_add_u32 s32, s31, 24576
 buffer_load_dwordx4 v[120:123], v9, s[12:15], s32 offen offset:2048 sc1
 s_waitcnt vmcnt(12)
 v_dot2_f32_bf16 v246, v96, s88, v11
 v_dot2_f32_bf16 v247, v96, s89, v11
 v_dot2_f32_bf16 v248, v97, s88, v11
 v_dot2_f32_bf16 v249, v97, s89, v11
 v_dot2_f32_bf16 v250, v98, s88, v11
 v_dot2_f32_bf16 v251, v98, s89, v11
 v_dot2_f32_bf16 v252, v99, s88, v11
 v_dot2_f32_bf16 v253, v99, s89, v11
 v_cvt_pk_bf16_f32 v96, v246, v247
 v_cvt_pk_bf16_f32 v97, v248, v249
 v_cvt_pk_bf16_f32 v98, v250, v251
 v_cvt_pk_bf16_f32 v99, v252, v253
 s_add_u32 s32, s31, 8192
 buffer_load_dwordx4 v[52:55], v9, s[12:15], s32 offen offset:1024 sc1
 s_waitcnt vmcnt(12)
 v_dot2_f32_bf16 v246, v28, s88, v10
 v_dot2_f32_bf16 v247, v28, s89, v10
 v_dot2_f32_bf16 v248, v29, s88, v10
 v_dot2_f32_bf16 v249, v29, s89, v10
 v_dot2_f32_bf16 v250, v30, s88, v10
 v_dot2_f32_bf16 v251, v30, s89, v10
 v_dot2_f32_bf16 v252, v31, s88, v10
 v_dot2_f32_bf16 v253, v31, s89, v10
 v_cvt_pk_bf16_f32 v28, v246, v247
 v_cvt_pk_bf16_f32 v29, v248, v249
 v_cvt_pk_bf16_f32 v30, v250, v251
 v_cvt_pk_bf16_f32 v31, v252, v253
 s_add_u32 s32, s31, 24576
 buffer_load_dwordx4 v[124:127], v9, s[12:15], s32 offen offset:3072 sc1
 s_waitcnt vmcnt(12)
 v_dot2_f32_bf16 v246, v100, s88, v11
 v_dot2_f32_bf16 v247, v100, s89, v11
 v_dot2_f32_bf16 v248, v101, s88, v11
 v_dot2_f32_bf16 v249, v101, s89, v11
 v_dot2_f32_bf16 v250, v102, s88, v11
 v_dot2_f32_bf16 v251, v102, s89, v11
 v_dot2_f32_bf16 v252, v103, s88, v11
 v_dot2_f32_bf16 v253, v103, s89, v11
 v_cvt_pk_bf16_f32 v100, v246, v247
 v_cvt_pk_bf16_f32 v101, v248, v249
 v_cvt_pk_bf16_f32 v102, v250, v251
 v_cvt_pk_bf16_f32 v103, v252, v253
 s_add_u32 s32, s31, 8192
 buffer_load_dwordx4 v[56:59], v9, s[12:15], s32 offen offset:2048 sc1
 s_waitcnt vmcnt(12)
 v_dot2_f32_bf16 v246, v32, s88, v10
 v_dot2_f32_bf16 v247, v32, s89, v10
 v_dot2_f32_bf16 v248, v33, s88, v10
 v_dot2_f32_bf16 v249, v33, s89, v10
 v_dot2_f32_bf16 v250, v34, s88, v10
 v_dot2_f32_bf16 v251, v34, s89, v10
 v_dot2_f32_bf16 v252, v35, s88, v10
 v_dot2_f32_bf16 v253, v35, s89, v10
 v_cvt_pk_bf16_f32 v32, v246, v247
 v_cvt_pk_bf16_f32 v33, v248, v249
 v_cvt_pk_bf16_f32 v34, v250, v251
 v_cvt_pk_bf16_f32 v35, v252, v253
 s_add_u32 s32, s31, 28672
 buffer_load_dwordx4 v[128:131], v9, s[12:15], s32 offen offset:0 sc1
 s_waitcnt vmcnt(12)
 v_dot2_f32_bf16 v246, v104, s88, v11
 v_dot2_f32_bf16 v247, v104, s89, v11
 v_dot2_f32_bf16 v248, v105, s88, v11
 v_dot2_f32_bf16 v249, v105, s89, v11
 v_dot2_f32_bf16 v250, v106, s88, v11
 v_dot2_f32_bf16 v251, v106, s89, v11
 v_dot2_f32_bf16 v252, v107, s88, v11
 v_dot2_f32_bf16 v253, v107, s89, v11
 v_cvt_pk_bf16_f32 v104, v246, v247
 v_cvt_pk_bf16_f32 v105, v248, v249
 v_cvt_pk_bf16_f32 v106, v250, v251
 v_cvt_pk_bf16_f32 v107, v252, v253
 s_add_u32 s32, s31, 8192
 buffer_load_dwordx4 v[60:63], v9, s[12:15], s32 offen offset:3072 sc1
 s_waitcnt vmcnt(12)
 v_dot2_f32_bf16 v246, v36, s88, v10
 v_dot2_f32_bf16 v247, v36, s89, v10
 v_dot2_f32_bf16 v248, v37, s88, v10
 v_dot2_f32_bf16 v249, v37, s89, v10
 v_dot2_f32_bf16 v250, v38, s88, v10
 v_dot2_f32_bf16 v251, v38, s89, v10
 v_dot2_f32_bf16 v252, v39, s88, v10
 v_dot2_f32_bf16 v253, v39, s89, v10
 v_cvt_pk_bf16_f32 v36, v246, v247
 v_cvt_pk_bf16_f32 v37, v248, v249
 v_cvt_pk_bf16_f32 v38, v250, v251
 v_cvt_pk_bf16_f32 v39, v252, v253
 s_add_u32 s32, s31, 28672
 buffer_load_dwordx4 v[132:135], v9, s[12:15], s32 offen offset:1024 sc1
 s_waitcnt vmcnt(12)
 v_dot2_f32_bf16 v246, v108, s88, v11
 v_dot2_f32_bf16 v247, v108, s89, v11
 v_dot2_f32_bf16 v248, v109, s88, v11
 v_dot2_f32_bf16 v249, v109, s89, v11
 v_dot2_f32_bf16 v250, v110, s88, v11
 v_dot2_f32_bf16 v251, v110, s89, v11
 v_dot2_f32_bf16 v252, v111, s88, v11
 v_dot2_f32_bf16 v253, v111, s89, v11
 v_cvt_pk_bf16_f32 v108, v246, v247
 v_cvt_pk_bf16_f32 v109, v248, v249
 v_cvt_pk_bf16_f32 v110, v250, v251
 v_cvt_pk_bf16_f32 v111, v252, v253
 s_add_u32 s32, s31, 12288
 buffer_load_dwordx4 v[64:67], v9, s[12:15], s32 offen offset:0 sc1
 s_waitcnt vmcnt(12)
 v_dot2_f32_bf16 v246, v40, s88, v10
 v_dot2_f32_bf16 v247, v40, s89, v10
 v_dot2_f32_bf16 v248, v41, s88, v10
 v_dot2_f32_bf16 v249, v41, s89, v10
 v_dot2_f32_bf16 v250, v42, s88, v10
 v_dot2_f32_bf16 v251, v42, s89, v10
 v_dot2_f32_bf16 v252, v43, s88, v10
 v_dot2_f32_bf16 v253, v43, s89, v10
 v_cvt_pk_bf16_f32 v40, v246, v247
 v_cvt_pk_bf16_f32 v41, v248, v249
 v_cvt_pk_bf16_f32 v42, v250, v251
 v_cvt_pk_bf16_f32 v43, v252, v253
 s_add_u32 s32, s31, 28672
 buffer_load_dwordx4 v[136:139], v9, s[12:15], s32 offen offset:2048 sc1
 s_waitcnt vmcnt(12)
 v_dot2_f32_bf16 v246, v112, s88, v11
 v_dot2_f32_bf16 v247, v112, s89, v11
 v_dot2_f32_bf16 v248, v113, s88, v11
 v_dot2_f32_bf16 v249, v113, s89, v11
 v_dot2_f32_bf16 v250, v114, s88, v11
 v_dot2_f32_bf16 v251, v114, s89, v11
 v_dot2_f32_bf16 v252, v115, s88, v11
 v_dot2_f32_bf16 v253, v115, s89, v11
 v_cvt_pk_bf16_f32 v112, v246, v247
 v_cvt_pk_bf16_f32 v113, v248, v249
 v_cvt_pk_bf16_f32 v114, v250, v251
 v_cvt_pk_bf16_f32 v115, v252, v253
 s_add_u32 s32, s31, 12288
 buffer_load_dwordx4 v[68:71], v9, s[12:15], s32 offen offset:1024 sc1
 s_waitcnt vmcnt(12)
 v_dot2_f32_bf16 v246, v44, s88, v10
 v_dot2_f32_bf16 v247, v44, s89, v10
 v_dot2_f32_bf16 v248, v45, s88, v10
 v_dot2_f32_bf16 v249, v45, s89, v10
 v_dot2_f32_bf16 v250, v46, s88, v10
 v_dot2_f32_bf16 v251, v46, s89, v10
 v_dot2_f32_bf16 v252, v47, s88, v10
 v_dot2_f32_bf16 v253, v47, s89, v10
 v_cvt_pk_bf16_f32 v44, v246, v247
 v_cvt_pk_bf16_f32 v45, v248, v249
 v_cvt_pk_bf16_f32 v46, v250, v251
 v_cvt_pk_bf16_f32 v47, v252, v253
 s_add_u32 s32, s31, 28672
 buffer_load_dwordx4 v[140:143], v9, s[12:15], s32 offen offset:3072 sc1
 s_waitcnt vmcnt(12)
 v_dot2_f32_bf16 v246, v116, s88, v11
 v_dot2_f32_bf16 v247, v116, s89, v11
 v_dot2_f32_bf16 v248, v117, s88, v11
 v_dot2_f32_bf16 v249, v117, s89, v11
 v_dot2_f32_bf16 v250, v118, s88, v11
 v_dot2_f32_bf16 v251, v118, s89, v11
 v_dot2_f32_bf16 v252, v119, s88, v11
 v_dot2_f32_bf16 v253, v119, s89, v11
 v_cvt_pk_bf16_f32 v116, v246, v247
 v_cvt_pk_bf16_f32 v117, v248, v249
 v_cvt_pk_bf16_f32 v118, v250, v251
 v_cvt_pk_bf16_f32 v119, v252, v253
 s_add_u32 s32, s31, 12288
 buffer_load_dwordx4 v[72:75], v9, s[12:15], s32 offen offset:2048 sc1
 s_waitcnt vmcnt(12)
 v_dot2_f32_bf16 v246, v48, s88, v10
 v_dot2_f32_bf16 v247, v48, s89, v10
 v_dot2_f32_bf16 v248, v49, s88, v10
 v_dot2_f32_bf16 v249, v49, s89, v10
 v_dot2_f32_bf16 v250, v50, s88, v10
 v_dot2_f32_bf16 v251, v50, s89, v10
 v_dot2_f32_bf16 v252, v51, s88, v10
 v_dot2_f32_bf16 v253, v51, s89, v10
 v_cvt_pk_bf16_f32 v48, v246, v247
 v_cvt_pk_bf16_f32 v49, v248, v249
 v_cvt_pk_bf16_f32 v50, v250, v251
 v_cvt_pk_bf16_f32 v51, v252, v253
 s_add_u32 s32, s31, 32768
 buffer_load_dwordx4 v[144:147], v9, s[12:15], s32 offen offset:0 sc1
 s_waitcnt vmcnt(12)
 v_dot2_f32_bf16 v246, v120, s88, v11
 v_dot2_f32_bf16 v247, v120, s89, v11
 v_dot2_f32_bf16 v248, v121, s88, v11
 v_dot2_f32_bf16 v249, v121, s89, v11
 v_dot2_f32_bf16 v250, v122, s88, v11
 v_dot2_f32_bf16 v251, v122, s89, v11
 v_dot2_f32_bf16 v252, v123, s88, v11
 v_dot2_f32_bf16 v253, v123, s89, v11
 v_cvt_pk_bf16_f32 v120, v246, v247
 v_cvt_pk_bf16_f32 v121, v248, v249
 v_cvt_pk_bf16_f32 v122, v250, v251
 v_cvt_pk_bf16_f32 v123, v252, v253
 s_add_u32 s32, s31, 12288
 buffer_load_dwordx4 v[76:79], v9, s[12:15], s32 offen offset:3072 sc1
 s_waitcnt vmcnt(12)
 v_dot2_f32_bf16 v246, v52, s88, v10
 v_dot2_f32_bf16 v247, v52, s89, v10
 v_dot2_f32_bf16 v248, v53, s88, v10
 v_dot2_f32_bf16 v249, v53, s89, v10
 v_dot2_f32_bf16 v250, v54, s88, v10
 v_dot2_f32_bf16 v251, v54, s89, v10
 v_dot2_f32_bf16 v252, v55, s88, v10
 v_dot2_f32_bf16 v253, v55, s89, v10
 v_cvt_pk_bf16_f32 v52, v246, v247
 v_cvt_pk_bf16_f32 v53, v248, v249
 v_cvt_pk_bf16_f32 v54, v250, v251
 v_cvt_pk_bf16_f32 v55, v252, v253
 s_add_u32 s32, s31, 32768
 buffer_load_dwordx4 v[148:151], v9, s[12:15], s32 offen offset:1024 sc1
 s_waitcnt vmcnt(12)
 v_dot2_f32_bf16 v246, v124, s88, v11
 v_dot2_f32_bf16 v247, v124, s89, v11
 v_dot2_f32_bf16 v248, v125, s88, v11
 v_dot2_f32_bf16 v249, v125, s89, v11
 v_dot2_f32_bf16 v250, v126, s88, v11
 v_dot2_f32_bf16 v251, v126, s89, v11
 v_dot2_f32_bf16 v252, v127, s88, v11
 v_dot2_f32_bf16 v253, v127, s89, v11
 v_cvt_pk_bf16_f32 v124, v246, v247
 v_cvt_pk_bf16_f32 v125, v248, v249
 v_cvt_pk_bf16_f32 v126, v250, v251
 v_cvt_pk_bf16_f32 v127, v252, v253
 s_add_u32 s32, s31, 16384
 buffer_load_dwordx4 v[80:83], v9, s[12:15], s32 offen offset:0 sc1
 s_waitcnt vmcnt(12)
 v_dot2_f32_bf16 v246, v56, s88, v10
 v_dot2_f32_bf16 v247, v56, s89, v10
 v_dot2_f32_bf16 v248, v57, s88, v10
 v_dot2_f32_bf16 v249, v57, s89, v10
 v_dot2_f32_bf16 v250, v58, s88, v10
 v_dot2_f32_bf16 v251, v58, s89, v10
 v_dot2_f32_bf16 v252, v59, s88, v10
 v_dot2_f32_bf16 v253, v59, s89, v10
 v_cvt_pk_bf16_f32 v56, v246, v247
 v_cvt_pk_bf16_f32 v57, v248, v249
 v_cvt_pk_bf16_f32 v58, v250, v251
 v_cvt_pk_bf16_f32 v59, v252, v253
 s_add_u32 s32, s31, 32768
 buffer_load_dwordx4 v[152:155], v9, s[12:15], s32 offen offset:2048 sc1
 s_waitcnt vmcnt(12)
 v_dot2_f32_bf16 v246, v128, s88, v11
 v_dot2_f32_bf16 v247, v128, s89, v11
 v_dot2_f32_bf16 v248, v129, s88, v11
 v_dot2_f32_bf16 v249, v129, s89, v11
 v_dot2_f32_bf16 v250, v130, s88, v11
 v_dot2_f32_bf16 v251, v130, s89, v11
 v_dot2_f32_bf16 v252, v131, s88, v11
 v_dot2_f32_bf16 v253, v131, s89, v11
 v_cvt_pk_bf16_f32 v128, v246, v247
 v_cvt_pk_bf16_f32 v129, v248, v249
 v_cvt_pk_bf16_f32 v130, v250, v251
 v_cvt_pk_bf16_f32 v131, v252, v253
 s_add_u32 s32, s31, 16384
 buffer_load_dwordx4 v[84:87], v9, s[12:15], s32 offen offset:1024 sc1
 s_waitcnt vmcnt(12)
 v_dot2_f32_bf16 v246, v60, s88, v10
 v_dot2_f32_bf16 v247, v60, s89, v10
 v_dot2_f32_bf16 v248, v61, s88, v10
 v_dot2_f32_bf16 v249, v61, s89, v10
 v_dot2_f32_bf16 v250, v62, s88, v10
 v_dot2_f32_bf16 v251, v62, s89, v10
 v_dot2_f32_bf16 v252, v63, s88, v10
 v_dot2_f32_bf16 v253, v63, s89, v10
 v_cvt_pk_bf16_f32 v60, v246, v247
 v_cvt_pk_bf16_f32 v61, v248, v249
 v_cvt_pk_bf16_f32 v62, v250, v251
 v_cvt_pk_bf16_f32 v63, v252, v253
 s_add_u32 s32, s31, 32768
 buffer_load_dwordx4 v[156:159], v9, s[12:15], s32 offen offset:3072 sc1
 s_waitcnt vmcnt(12)
 v_dot2_f32_bf16 v246, v132, s88, v11
 v_dot2_f32_bf16 v247, v132, s89, v11
 v_dot2_f32_bf16 v248, v133, s88, v11
 v_dot2_f32_bf16 v249, v133, s89, v11
 v_dot2_f32_bf16 v250, v134, s88, v11
 v_dot2_f32_bf16 v251, v134, s89, v11
 v_dot2_f32_bf16 v252, v135, s88, v11
 v_dot2_f32_bf16 v253, v135, s89, v11
 v_cvt_pk_bf16_f32 v132, v246, v247
 v_cvt_pk_bf16_f32 v133, v248, v249
 v_cvt_pk_bf16_f32 v134, v250, v251
 v_cvt_pk_bf16_f32 v135, v252, v253
 s_waitcnt vmcnt(11)
 v_dot2_f32_bf16 v246, v64, s88, v10
 v_dot2_f32_bf16 v247, v64, s89, v10
 v_dot2_f32_bf16 v248, v65, s88, v10
 v_dot2_f32_bf16 v249, v65, s89, v10
 v_dot2_f32_bf16 v250, v66, s88, v10
 v_dot2_f32_bf16 v251, v66, s89, v10
 v_dot2_f32_bf16 v252, v67, s88, v10
 v_dot2_f32_bf16 v253, v67, s89, v10
 v_cvt_pk_bf16_f32 v64, v246, v247
 v_cvt_pk_bf16_f32 v65, v248, v249
 v_cvt_pk_bf16_f32 v66, v250, v251
 v_cvt_pk_bf16_f32 v67, v252, v253
 s_waitcnt vmcnt(10)
 v_dot2_f32_bf16 v246, v136, s88, v11
 v_dot2_f32_bf16 v247, v136, s89, v11
 v_dot2_f32_bf16 v248, v137, s88, v11
 v_dot2_f32_bf16 v249, v137, s89, v11
 v_dot2_f32_bf16 v250, v138, s88, v11
 v_dot2_f32_bf16 v251, v138, s89, v11
 v_dot2_f32_bf16 v252, v139, s88, v11
 v_dot2_f32_bf16 v253, v139, s89, v11
 v_cvt_pk_bf16_f32 v136, v246, v247
 v_cvt_pk_bf16_f32 v137, v248, v249
 v_cvt_pk_bf16_f32 v138, v250, v251
 v_cvt_pk_bf16_f32 v139, v252, v253
 s_waitcnt vmcnt(9)
 v_dot2_f32_bf16 v246, v68, s88, v10
 v_dot2_f32_bf16 v247, v68, s89, v10
 v_dot2_f32_bf16 v248, v69, s88, v10
 v_dot2_f32_bf16 v249, v69, s89, v10
 v_dot2_f32_bf16 v250, v70, s88, v10
 v_dot2_f32_bf16 v251, v70, s89, v10
 v_dot2_f32_bf16 v252, v71, s88, v10
 v_dot2_f32_bf16 v253, v71, s89, v10
 v_cvt_pk_bf16_f32 v68, v246, v247
 v_cvt_pk_bf16_f32 v69, v248, v249
 v_cvt_pk_bf16_f32 v70, v250, v251
 v_cvt_pk_bf16_f32 v71, v252, v253
 s_waitcnt vmcnt(8)
 v_dot2_f32_bf16 v246, v140, s88, v11
 v_dot2_f32_bf16 v247, v140, s89, v11
 v_dot2_f32_bf16 v248, v141, s88, v11
 v_dot2_f32_bf16 v249, v141, s89, v11
 v_dot2_f32_bf16 v250, v142, s88, v11
 v_dot2_f32_bf16 v251, v142, s89, v11
 v_dot2_f32_bf16 v252, v143, s88, v11
 v_dot2_f32_bf16 v253, v143, s89, v11
 v_cvt_pk_bf16_f32 v140, v246, v247
 v_cvt_pk_bf16_f32 v141, v248, v249
 v_cvt_pk_bf16_f32 v142, v250, v251
 v_cvt_pk_bf16_f32 v143, v252, v253
 s_branch L_c3_p2_s
L_c3_p2:
 s_branch L_c3_p6
L_c3_p2_s:
 s_waitcnt vmcnt(7)
 v_dot2_f32_bf16 v246, v72, s88, v10
 v_dot2_f32_bf16 v247, v72, s89, v10
 v_dot2_f32_bf16 v248, v73, s88, v10
 v_dot2_f32_bf16 v249, v73, s89, v10
 v_dot2_f32_bf16 v250, v74, s88, v10
 v_dot2_f32_bf16 v251, v74, s89, v10
 v_dot2_f32_bf16 v252, v75, s88, v10
 v_dot2_f32_bf16 v253, v75, s89, v10
 v_cvt_pk_bf16_f32 v72, v246, v247
 v_cvt_pk_bf16_f32 v73, v248, v249
 v_cvt_pk_bf16_f32 v74, v250, v251
 v_cvt_pk_bf16_f32 v75, v252, v253
 s_waitcnt vmcnt(6)
 v_dot2_f32_bf16 v246, v144, s88, v11
 v_dot2_f32_bf16 v247, v144, s89, v11
 v_dot2_f32_bf16 v248, v145, s88, v11
 v_dot2_f32_bf16 v249, v145, s89, v11
 v_dot2_f32_bf16 v250, v146, s88, v11
 v_dot2_f32_bf16 v251, v146, s89, v11
 v_dot2_f32_bf16 v252, v147, s88, v11
 v_dot2_f32_bf16 v253, v147, s89, v11
 v_cvt_pk_bf16_f32 v144, v246, v247
 v_cvt_pk_bf16_f32 v145, v248, v249
 v_cvt_pk_bf16_f32 v146, v250, v251
 v_cvt_pk_bf16_f32 v147, v252, v253
 s_waitcnt vmcnt(5)
 v_dot2_f32_bf16 v246, v76, s88, v10
 v_dot2_f32_bf16 v247, v76, s89, v10
 v_dot2_f32_bf16 v248, v77, s88, v10
 v_dot2_f32_bf16 v249, v77, s89, v10
 v_dot2_f32_bf16 v250, v78, s88, v10
 v_dot2_f32_bf16 v251, v78, s89, v10
 v_dot2_f32_bf16 v252, v79, s88, v10
 v_dot2_f32_bf16 v253, v79, s89, v10
 v_cvt_pk_bf16_f32 v76, v246, v247
 v_cvt_pk_bf16_f32 v77, v248, v249
 v_cvt_pk_bf16_f32 v78, v250, v251
 v_cvt_pk_bf16_f32 v79, v252, v253
 s_waitcnt vmcnt(4)
 v_dot2_f32_bf16 v246, v148, s88, v11
 v_dot2_f32_bf16 v247, v148, s89, v11
 v_dot2_f32_bf16 v248, v149, s88, v11
 v_dot2_f32_bf16 v249, v149, s89, v11
 v_dot2_f32_bf16 v250, v150, s88, v11
 v_dot2_f32_bf16 v251, v150, s89, v11
 v_dot2_f32_bf16 v252, v151, s88, v11
 v_dot2_f32_bf16 v253, v151, s89, v11
 v_cvt_pk_bf16_f32 v148, v246, v247
 v_cvt_pk_bf16_f32 v149, v248, v249
 v_cvt_pk_bf16_f32 v150, v250, v251
 v_cvt_pk_bf16_f32 v151, v252, v253
 s_waitcnt vmcnt(3)
 v_dot2_f32_bf16 v246, v80, s88, v10
 v_dot2_f32_bf16 v247, v80, s89, v10
 v_dot2_f32_bf16 v248, v81, s88, v10
 v_dot2_f32_bf16 v249, v81, s89, v10
 v_dot2_f32_bf16 v250, v82, s88, v10
 v_dot2_f32_bf16 v251, v82, s89, v10
 v_dot2_f32_bf16 v252, v83, s88, v10
 v_dot2_f32_bf16 v253, v83, s89, v10
 v_cvt_pk_bf16_f32 v80, v246, v247
 v_cvt_pk_bf16_f32 v81, v248, v249
 v_cvt_pk_bf16_f32 v82, v250, v251
 v_cvt_pk_bf16_f32 v83, v252, v253
 s_waitcnt vmcnt(2)
 v_dot2_f32_bf16 v246, v152, s88, v11
 v_dot2_f32_bf16 v247, v152, s89, v11
 v_dot2_f32_bf16 v248, v153, s88, v11
 v_dot2_f32_bf16 v249, v153, s89, v11
 v_dot2_f32_bf16 v250, v154, s88, v11
 v_dot2_f32_bf16 v251, v154, s89, v11
 v_dot2_f32_bf16 v252, v155, s88, v11
 v_dot2_f32_bf16 v253, v155, s89, v11
 v_cvt_pk_bf16_f32 v152, v246, v247
 v_cvt_pk_bf16_f32 v153, v248, v249
 v_cvt_pk_bf16_f32 v154, v250, v251
 v_cvt_pk_bf16_f32 v155, v252, v253
 s_waitcnt vmcnt(1)
 v_dot2_f32_bf16 v246, v84, s88, v10
 v_dot2_f32_bf16 v247, v84, s89, v10
 v_dot2_f32_bf16 v248, v85, s88, v10
 v_dot2_f32_bf16 v249, v85, s89, v10
 v_dot2_f32_bf16 v250, v86, s88, v10
 v_dot2_f32_bf16 v251, v86, s89, v10
 v_dot2_f32_bf16 v252, v87, s88, v10
 v_dot2_f32_bf16 v253, v87, s89, v10
 v_cvt_pk_bf16_f32 v84, v246, v247
 v_cvt_pk_bf16_f32 v85, v248, v249
 v_cvt_pk_bf16_f32 v86, v250, v251
 v_cvt_pk_bf16_f32 v87, v252, v253
 s_waitcnt vmcnt(0)
 v_dot2_f32_bf16 v246, v156, s88, v11
 v_dot2_f32_bf16 v247, v156, s89, v11
 v_dot2_f32_bf16 v248, v157, s88, v11
 v_dot2_f32_bf16 v249, v157, s89, v11
 v_dot2_f32_bf16 v250, v158, s88, v11
 v_dot2_f32_bf16 v251, v158, s89, v11
 v_dot2_f32_bf16 v252, v159, s88, v11
 v_dot2_f32_bf16 v253, v159, s89, v11
 v_cvt_pk_bf16_f32 v156, v246, v247
 v_cvt_pk_bf16_f32 v157, v248, v249
 v_cvt_pk_bf16_f32 v158, v250, v251
 v_cvt_pk_bf16_f32 v159, v252, v253
 s_barrier
 ds_read_b64_tr_b16 a[0:1], v236 offset:0
 ds_read_b64_tr_b16 a[2:3], v236 offset:2048
 ds_read_b64_tr_b16 a[4:5], v236 offset:4096
 ds_read_b64_tr_b16 a[6:7], v236 offset:6144
 ds_read_b64_tr_b16 a[8:9], v236 offset:8192
 ds_read_b64_tr_b16 a[10:11], v236 offset:10240
 ds_read_b64_tr_b16 a[12:13], v236 offset:12288
 ds_read_b64_tr_b16 a[14:15], v236 offset:14336
 ds_read_b64_tr_b16 a[16:17], v236 offset:16384
 ds_read_b64_tr_b16 a[18:19], v236 offset:18432
 ds_read_b64_tr_b16 a[20:21], v236 offset:20480
 ds_read_b64_tr_b16 a[22:23], v236 offset:22528
 ds_read_b64_tr_b16 a[24:25], v236 offset:24576
 ds_read_b64_tr_b16 a[26:27], v236 offset:26624
 ds_read_b64_tr_b16 a[28:29], v236 offset:28672
 ds_read_b64_tr_b16 a[30:31], v236 offset:30720
 ds_read_b64_tr_b16 a[32:33], v236 offset:32768
 ds_read_b64_tr_b16 a[34:35], v236 offset:34816
 s_waitcnt lgkmcnt(10)
 v_mfma_f32_16x16x32_bf16 v[160:163], a[0:3], v[16:19], 0
 ds_read_b64_tr_b16 a[36:37], v237 offset:0
 ds_read_b64_tr_b16 a[38:39], v237 offset:2048
 v_mfma_f32_16x16x32_bf16 v[160:163], a[4:7], v[20:23], v[160:163]
 ds_read_b64_tr_b16 a[40:41], v237 offset:4096
 s_add_u32 m0, s58, 73728
 s_add_u32 s60, s56, 0
 buffer_load_dwordx4 v224, s[44:47], s60 offen offset:0 lds
 v_mfma_f32_16x16x32_bf16 v[160:163], a[8:11], v[24:27], v[160:163]
 ds_read_b64_tr_b16 a[42:43], v237 offset:6144
 v_mfma_f32_16x16x32_bf16 v[160:163], a[12:15], v[28:31], v[160:163]
 s_waitcnt lgkmcnt(4)
 ds_read_b64_tr_b16 a[44:45], v237 offset:8192
 buffer_load_dwordx4 v225, s[44:47], s60 offen offset:1024 lds
 v_mfma_f32_16x16x32_bf16 v[160:163], a[16:19], v[32:35], v[160:163]
 ds_read_b64_tr_b16 a[46:47], v237 offset:10240
 v_mfma_f32_16x16x32_bf16 v[160:163], a[20:23], v[36:39], v[160:163]
 ds_read_b64_tr_b16 a[48:49], v237 offset:12288
 v_mfma_f32_16x16x32_bf16 v[160:163], a[24:27], v[40:43], v[160:163]
 ds_read_b64_tr_b16 a[50:51], v237 offset:14336
 buffer_load_dwordx4 v226, s[44:47], s60 offen offset:2048 lds
 v_mfma_f32_16x16x32_bf16 v[160:163], a[28:31], v[44:47], v[160:163]
 ds_read_b64_tr_b16 a[52:53], v237 offset:16384
 v_mfma_f32_16x16x32_bf16 v[160:163], a[32:35], v[48:51], v[160:163]
 ds_read_b64_tr_b16 a[54:55], v237 offset:18432
 ds_read_b64_tr_b16 a[56:57], v237 offset:20480
 v_mfma_f32_16x16x32_bf16 v[164:167], a[32:35], v[120:123], 0
 ds_read_b64_tr_b16 a[58:59], v237 offset:22528
 buffer_load_dwordx4 v227, s[44:47], s60 offen offset:3072 lds
 v_mfma_f32_16x16x32_bf16 v[164:167], a[28:31], v[116:119], v[164:167]
 ds_read_b64_tr_b16 a[60:61], v237 offset:24576
 v_mfma_f32_16x16x32_bf16 v[164:167], a[24:27], v[112:115], v[164:167]
 ds_read_b64_tr_b16 a[62:63], v237 offset:26624
 v_mfma_f32_16x16x32_bf16 v[164:167], a[20:23], v[108:111], v[164:167]
 ds_read_b64_tr_b16 a[64:65], v237 offset:28672
 s_add_u32 m0, s58, 77824
 s_add_u32 s60, s56, 294912
 buffer_load_dwordx4 v224, s[44:47], s60 offen offset:0 lds
 v_mfma_f32_16x16x32_bf16 v[164:167], a[16:19], v[104:107], v[164:167]
 ds_read_b64_tr_b16 a[66:67], v237 offset:30720
 v_mfma_f32_16x16x32_bf16 v[164:167], a[12:15], v[100:103], v[164:167]
 ds_read_b64_tr_b16 a[68:69], v237 offset:32768
 v_mfma_f32_16x16x32_bf16 v[164:167], a[8:11], v[96:99], v[164:167]
 ds_read_b64_tr_b16 a[70:71], v237 offset:34816
 buffer_load_dwordx4 v225, s[44:47], s60 offen offset:1024 lds
 v_mfma_f32_16x16x32_bf16 v[164:167], a[4:7], v[92:95], v[164:167]
 v_mfma_f32_16x16x32_bf16 v[164:167], a[0:3], v[88:91], v[164:167]
 s_waitcnt lgkmcnt(10)
 v_mfma_f32_16x16x32_bf16 v[168:171], a[36:39], v[16:19], 0
 ds_read_b64_tr_b16 a[0:1], v238 offset:0
 ds_read_b64_tr_b16 a[2:3], v238 offset:2048
 buffer_load_dwordx4 v226, s[44:47], s60 offen offset:2048 lds
 v_mfma_f32_16x16x32_bf16 v[168:171], a[40:43], v[20:23], v[168:171]
 ds_read_b64_tr_b16 a[4:5], v238 offset:4096
 v_mfma_f32_16x16x32_bf16 v[168:171], a[44:47], v[24:27], v[168:171]
 ds_read_b64_tr_b16 a[6:7], v238 offset:6144
 v_mfma_f32_16x16x32_bf16 v[168:171], a[48:51], v[28:31], v[168:171]
 s_waitcnt lgkmcnt(4)
 ds_read_b64_tr_b16 a[8:9], v238 offset:8192
 buffer_load_dwordx4 v227, s[44:47], s60 offen offset:3072 lds
 v_mfma_f32_16x16x32_bf16 v[168:171], a[52:55], v[32:35], v[168:171]
 ds_read_b64_tr_b16 a[10:11], v238 offset:10240
 v_mfma_f32_16x16x32_bf16 v[168:171], a[56:59], v[36:39], v[168:171]
 ds_read_b64_tr_b16 a[12:13], v238 offset:12288
 v_mfma_f32_16x16x32_bf16 v[168:171], a[60:63], v[40:43], v[168:171]
 ds_read_b64_tr_b16 a[14:15], v238 offset:14336
 s_add_u32 m0, s59, 73728
 s_add_u32 s60, s57, 0
 buffer_load_dwordx4 v224, s[44:47], s60 offen lds
 v_mfma_f32_16x16x32_bf16 v[168:171], a[64:67], v[44:47], v[168:171]
 ds_read_b64_tr_b16 a[16:17], v238 offset:16384
 v_mfma_f32_16x16x32_bf16 v[168:171], a[68:71], v[48:51], v[168:171]
 ds_read_b64_tr_b16 a[18:19], v238 offset:18432
 ds_read_b64_tr_b16 a[20:21], v238 offset:20480
 v_mfma_f32_16x16x32_bf16 v[172:175], a[68:71], v[120:123], 0
 ds_read_b64_tr_b16 a[22:23], v238 offset:22528
 s_add_u32 m0, s58, 110592
 s_add_u32 s60, s56, 2654208
 buffer_load_dwordx4 v224, s[44:47], s60 offen offset:0 lds
 v_mfma_f32_16x16x32_bf16 v[172:175], a[64:67], v[116:119], v[172:175]
 ds_read_b64_tr_b16 a[24:25], v238 offset:24576
 v_mfma_f32_16x16x32_bf16 v[172:175], a[60:63], v[112:115], v[172:175]
 ds_read_b64_tr_b16 a[26:27], v238 offset:26624
 buffer_load_dwordx4 v225, s[44:47], s60 offen offset:1024 lds
 v_mfma_f32_16x16x32_bf16 v[172:175], a[56:59], v[108:111], v[172:175]
 ds_read_b64_tr_b16 a[28:29], v238 offset:28672
 v_mfma_f32_16x16x32_bf16 v[172:175], a[52:55], v[104:107], v[172:175]
 ds_read_b64_tr_b16 a[30:31], v238 offset:30720
 v_mfma_f32_16x16x32_bf16 v[172:175], a[48:51], v[100:103], v[172:175]
 ds_read_b64_tr_b16 a[32:33], v238 offset:32768
 buffer_load_dwordx4 v226, s[44:47], s60 offen offset:2048 lds
 v_mfma_f32_16x16x32_bf16 v[172:175], a[44:47], v[96:99], v[172:175]
 ds_read_b64_tr_b16 a[34:35], v238 offset:34816
 v_mfma_f32_16x16x32_bf16 v[172:175], a[40:43], v[92:95], v[172:175]
 v_mfma_f32_16x16x32_bf16 v[172:175], a[36:39], v[88:91], v[172:175]
 s_waitcnt lgkmcnt(10)
 buffer_load_dwordx4 v227, s[44:47], s60 offen offset:3072 lds
 v_mfma_f32_16x16x32_bf16 v[176:179], a[0:3], v[16:19], 0
 ds_read_b64_tr_b16 a[36:37], v239 offset:0
 ds_read_b64_tr_b16 a[38:39], v239 offset:2048
 v_mfma_f32_16x16x32_bf16 v[176:179], a[4:7], v[20:23], v[176:179]
 ds_read_b64_tr_b16 a[40:41], v239 offset:4096
 v_mfma_f32_16x16x32_bf16 v[176:179], a[8:11], v[24:27], v[176:179]
 ds_read_b64_tr_b16 a[42:43], v239 offset:6144
 s_add_u32 m0, s58, 114688
 s_add_u32 s60, s56, 2949120
 buffer_load_dwordx4 v224, s[44:47], s60 offen offset:0 lds
 v_mfma_f32_16x16x32_bf16 v[176:179], a[12:15], v[28:31], v[176:179]
 s_waitcnt lgkmcnt(4)
 ds_read_b64_tr_b16 a[44:45], v239 offset:8192
 v_mfma_f32_16x16x32_bf16 v[176:179], a[16:19], v[32:35], v[176:179]
 ds_read_b64_tr_b16 a[46:47], v239 offset:10240
 v_mfma_f32_16x16x32_bf16 v[176:179], a[20:23], v[36:39], v[176:179]
 ds_read_b64_tr_b16 a[48:49], v239 offset:12288
 buffer_load_dwordx4 v225, s[44:47], s60 offen offset:1024 lds
 v_mfma_f32_16x16x32_bf16 v[176:179], a[24:27], v[40:43], v[176:179]
 ds_read_b64_tr_b16 a[50:51], v239 offset:14336
 v_mfma_f32_16x16x32_bf16 v[176:179], a[28:31], v[44:47], v[176:179]
 ds_read_b64_tr_b16 a[52:53], v239 offset:16384
 v_mfma_f32_16x16x32_bf16 v[176:179], a[32:35], v[48:51], v[176:179]
 ds_read_b64_tr_b16 a[54:55], v239 offset:18432
 ds_read_b64_tr_b16 a[56:57], v239 offset:20480
 buffer_load_dwordx4 v226, s[44:47], s60 offen offset:2048 lds
 v_mfma_f32_16x16x32_bf16 v[180:183], a[32:35], v[120:123], 0
 ds_read_b64_tr_b16 a[58:59], v239 offset:22528
 v_mfma_f32_16x16x32_bf16 v[180:183], a[28:31], v[116:119], v[180:183]
 ds_read_b64_tr_b16 a[60:61], v239 offset:24576
 v_mfma_f32_16x16x32_bf16 v[180:183], a[24:27], v[112:115], v[180:183]
 ds_read_b64_tr_b16 a[62:63], v239 offset:26624
 buffer_load_dwordx4 v227, s[44:47], s60 offen offset:3072 lds
 v_mfma_f32_16x16x32_bf16 v[180:183], a[20:23], v[108:111], v[180:183]
 ds_read_b64_tr_b16 a[64:65], v239 offset:28672
 v_mfma_f32_16x16x32_bf16 v[180:183], a[16:19], v[104:107], v[180:183]
 ds_read_b64_tr_b16 a[66:67], v239 offset:30720
 v_mfma_f32_16x16x32_bf16 v[180:183], a[12:15], v[100:103], v[180:183]
 ds_read_b64_tr_b16 a[68:69], v239 offset:32768
 s_add_u32 m0, s59, 110592
 s_add_u32 s60, s57, 2654208
 buffer_load_dwordx4 v224, s[44:47], s60 offen lds
 v_mfma_f32_16x16x32_bf16 v[180:183], a[8:11], v[96:99], v[180:183]
 ds_read_b64_tr_b16 a[70:71], v239 offset:34816
 v_mfma_f32_16x16x32_bf16 v[180:183], a[4:7], v[92:95], v[180:183]
 v_mfma_f32_16x16x32_bf16 v[180:183], a[0:3], v[88:91], v[180:183]
 s_waitcnt lgkmcnt(0)
 s_barrier
 v_mfma_f32_16x16x32_bf16 v[184:187], a[36:39], v[16:19], 0
 v_add_u32 v236, 36864, v236
 v_add_u32 v237, 36864, v237
 v_add_u32 v238, 36864, v238
 v_add_u32 v239, 36864, v239
 ds_read_b64_tr_b16 a[0:1], v236 offset:0
 ds_read_b64_tr_b16 a[2:3], v236 offset:2048
 v_mfma_f32_16x16x32_bf16 v[184:187], a[40:43], v[20:23], v[184:187]
 ds_read_b64_tr_b16 a[4:5], v236 offset:4096
 v_mfma_f32_16x16x32_bf16 v[184:187], a[44:47], v[24:27], v[184:187]
 ds_read_b64_tr_b16 a[6:7], v236 offset:6144
 s_add_u32 m0, s58, 0
 s_add_u32 s60, s56, 128
 buffer_load_dwordx4 v224, s[40:43], s60 offen offset:0 lds
 v_mfma_f32_16x16x32_bf16 v[184:187], a[48:51], v[28:31], v[184:187]
 ds_read_b64_tr_b16 a[8:9], v236 offset:8192
 v_mfma_f32_16x16x32_bf16 v[184:187], a[52:55], v[32:35], v[184:187]
 ds_read_b64_tr_b16 a[10:11], v236 offset:10240
 v_mfma_f32_16x16x32_bf16 v[184:187], a[56:59], v[36:39], v[184:187]
 ds_read_b64_tr_b16 a[12:13], v236 offset:12288
 v_mfma_f32_16x16x32_bf16 v[184:187], a[60:63], v[40:43], v[184:187]
 ds_read_b64_tr_b16 a[14:15], v236 offset:14336
 v_mfma_f32_16x16x32_bf16 v[184:187], a[64:67], v[44:47], v[184:187]
 ds_read_b64_tr_b16 a[16:17], v236 offset:16384
 buffer_load_dwordx4 v225, s[40:43], s60 offen offset:1024 lds
 v_mfma_f32_16x16x32_bf16 v[184:187], a[68:71], v[48:51], v[184:187]
 ds_read_b64_tr_b16 a[18:19], v236 offset:18432
 ds_read_b64_tr_b16 a[20:21], v236 offset:20480
 v_mfma_f32_16x16x32_bf16 v[188:191], a[68:71], v[120:123], 0
 ds_read_b64_tr_b16 a[22:23], v236 offset:22528
 v_mfma_f32_16x16x32_bf16 v[188:191], a[64:67], v[116:119], v[188:191]
 ds_read_b64_tr_b16 a[24:25], v236 offset:24576
 v_mfma_f32_16x16x32_bf16 v[188:191], a[60:63], v[112:115], v[188:191]
 ds_read_b64_tr_b16 a[26:27], v236 offset:26624
 v_mfma_f32_16x16x32_bf16 v[188:191], a[56:59], v[108:111], v[188:191]
 ds_read_b64_tr_b16 a[28:29], v236 offset:28672
 v_mfma_f32_16x16x32_bf16 v[188:191], a[52:55], v[104:107], v[188:191]
 ds_read_b64_tr_b16 a[30:31], v236 offset:30720
 buffer_load_dwordx4 v226, s[40:43], s60 offen offset:2048 lds
 v_mfma_f32_16x16x32_bf16 v[188:191], a[48:51], v[100:103], v[188:191]
 ds_read_b64_tr_b16 a[32:33], v236 offset:32768
 v_mfma_f32_16x16x32_bf16 v[188:191], a[44:47], v[96:99], v[188:191]
 ds_read_b64_tr_b16 a[34:35], v236 offset:34816
 v_mfma_f32_16x16x32_bf16 v[188:191], a[40:43], v[92:95], v[188:191]
 v_mfma_f32_16x16x32_bf16 v[188:191], a[36:39], v[88:91], v[188:191]
 s_waitcnt lgkmcnt(10)
 v_mfma_f32_16x16x32_bf16 v[160:163], a[0:3], v[52:55], v[160:163]
 ds_read_b64_tr_b16 a[36:37], v237 offset:0
 ds_read_b64_tr_b16 a[38:39], v237 offset:2048
 v_mfma_f32_16x16x32_bf16 v[160:163], a[4:7], v[56:59], v[160:163]
 ds_read_b64_tr_b16 a[40:41], v237 offset:4096
 buffer_load_dwordx4 v227, s[40:43], s60 offen offset:3072 lds
 v_mfma_f32_16x16x32_bf16 v[160:163], a[8:11], v[60:63], v[160:163]
 ds_read_b64_tr_b16 a[42:43], v237 offset:6144
 v_mfma_f32_16x16x32_bf16 v[160:163], a[12:15], v[64:67], v[160:163]
 s_waitcnt lgkmcnt(4)
 ds_read_b64_tr_b16 a[44:45], v237 offset:8192
 v_mfma_f32_16x16x32_bf16 v[160:163], a[16:19], v[68:71], v[160:163]
 ds_read_b64_tr_b16 a[46:47], v237 offset:10240
 v_mfma_f32_16x16x32_bf16 v[160:163], a[20:23], v[72:75], v[160:163]
 ds_read_b64_tr_b16 a[48:49], v237 offset:12288
 v_mfma_f32_16x16x32_bf16 v[160:163], a[24:27], v[76:79], v[160:163]
 ds_read_b64_tr_b16 a[50:51], v237 offset:14336
 s_add_u32 m0, s58, 4096
 s_add_u32 s60, s56, 295040
 buffer_load_dwordx4 v224, s[40:43], s60 offen offset:0 lds
 v_mfma_f32_16x16x32_bf16 v[160:163], a[28:31], v[80:83], v[160:163]
 ds_read_b64_tr_b16 a[52:53], v237 offset:16384
 v_mfma_f32_16x16x32_bf16 v[160:163], a[32:35], v[84:87], v[160:163]
 ds_read_b64_tr_b16 a[54:55], v237 offset:18432
 ds_read_b64_tr_b16 a[56:57], v237 offset:20480
 v_mfma_f32_16x16x32_bf16 v[164:167], a[32:35], v[156:159], v[164:167]
 ds_read_b64_tr_b16 a[58:59], v237 offset:22528
 v_mfma_f32_16x16x32_bf16 v[164:167], a[28:31], v[152:155], v[164:167]
 ds_read_b64_tr_b16 a[60:61], v237 offset:24576
 v_mfma_f32_16x16x32_bf16 v[164:167], a[24:27], v[148:151], v[164:167]
 ds_read_b64_tr_b16 a[62:63], v237 offset:26624
 v_mul_f32 v246, v242, v160
 v_mul_f32 v247, v242, v161
 v_mul_f32 v248, v242, v162
 v_mfma_f32_16x16x32_bf16 v[164:167], a[20:23], v[144:147], v[164:167]
 ds_read_b64_tr_b16 a[64:65], v237 offset:28672
 buffer_load_dwordx4 v225, s[40:43], s60 offen offset:1024 lds
 v_mul_f32 v249, v242, v163
 v_mfma_f32_16x16x32_bf16 v[164:167], a[16:19], v[140:143], v[164:167]
 ds_read_b64_tr_b16 a[66:67], v237 offset:30720
 v_exp_f32 v246, v246
 v_mfma_f32_16x16x32_bf16 v[164:167], a[12:15], v[136:139], v[164:167]
 ds_read_b64_tr_b16 a[68:69], v237 offset:32768
 v_exp_f32 v247, v247
 v_mfma_f32_16x16x32_bf16 v[164:167], a[8:11], v[132:135], v[164:167]
 ds_read_b64_tr_b16 a[70:71], v237 offset:34816
 v_exp_f32 v248, v248
 v_mfma_f32_16x16x32_bf16 v[164:167], a[4:7], v[128:131], v[164:167]
 v_exp_f32 v249, v249
 v_fma_f32 v246, v246, v244, v244
 v_mfma_f32_16x16x32_bf16 v[164:167], a[0:3], v[124:127], v[164:167]
 s_waitcnt lgkmcnt(10)
 v_fma_f32 v247, v247, v244, v244
 v_fma_f32 v248, v248, v244, v244
 v_mfma_f32_16x16x32_bf16 v[168:171], a[36:39], v[52:55], v[168:171]
 ds_read_b64_tr_b16 a[0:1], v238 offset:0
 ds_read_b64_tr_b16 a[2:3], v238 offset:2048
 buffer_load_dwordx4 v226, s[40:43], s60 offen offset:2048 lds
 v_mfma_f32_16x16x32_bf16 v[168:171], a[40:43], v[56:59], v[168:171]
 ds_read_b64_tr_b16 a[4:5], v238 offset:4096
 v_fma_f32 v249, v249, v244, v244
 v_mfma_f32_16x16x32_bf16 v[168:171], a[44:47], v[60:63], v[168:171]
 ds_read_b64_tr_b16 a[6:7], v238 offset:6144
 v_rcp_f32 v246, v246
 v_mfma_f32_16x16x32_bf16 v[168:171], a[48:51], v[64:67], v[168:171]
 s_waitcnt lgkmcnt(4)
 ds_read_b64_tr_b16 a[8:9], v238 offset:8192
 v_rcp_f32 v247, v247
 v_mfma_f32_16x16x32_bf16 v[168:171], a[52:55], v[68:71], v[168:171]
 ds_read_b64_tr_b16 a[10:11], v238 offset:10240
 v_rcp_f32 v248, v248
 v_mfma_f32_16x16x32_bf16 v[168:171], a[56:59], v[72:75], v[168:171]
 ds_read_b64_tr_b16 a[12:13], v238 offset:12288
 buffer_load_dwordx4 v227, s[40:43], s60 offen offset:3072 lds
 v_mfma_f32_16x16x32_bf16 v[168:171], a[60:63], v[76:79], v[168:171]
 ds_read_b64_tr_b16 a[14:15], v238 offset:14336
 v_rcp_f32 v249, v249
 v_mul_f32 v160, v160, v246
 v_mfma_f32_16x16x32_bf16 v[168:171], a[64:67], v[80:83], v[168:171]
 ds_read_b64_tr_b16 a[16:17], v238 offset:16384
 v_mul_f32 v161, v161, v247
 v_mul_f32 v162, v162, v248
 v_mfma_f32_16x16x32_bf16 v[168:171], a[68:71], v[84:87], v[168:171]
 ds_read_b64_tr_b16 a[18:19], v238 offset:18432
 ds_read_b64_tr_b16 a[20:21], v238 offset:20480
 v_mul_f32 v163, v163, v249
 v_mfma_f32_16x16x32_bf16 v[172:175], a[68:71], v[156:159], v[172:175]
 ds_read_b64_tr_b16 a[22:23], v238 offset:22528
 v_mul_f32 v246, v243, v164
 v_mul_f32 v247, v243, v165
 v_mfma_f32_16x16x32_bf16 v[172:175], a[64:67], v[152:155], v[172:175]
 ds_read_b64_tr_b16 a[24:25], v238 offset:24576
 v_mul_f32 v248, v243, v166
 v_mul_f32 v249, v243, v167
 v_mfma_f32_16x16x32_bf16 v[172:175], a[60:63], v[148:151], v[172:175]
 ds_read_b64_tr_b16 a[26:27], v238 offset:26624
 s_add_u32 m0, s59, 0
 s_add_u32 s60, s57, 128
 buffer_load_dwordx4 v224, s[40:43], s60 offen lds
 v_mfma_f32_16x16x32_bf16 v[172:175], a[56:59], v[144:147], v[172:175]
 ds_read_b64_tr_b16 a[28:29], v238 offset:28672
 v_mfma_f32_16x16x32_bf16 v[172:175], a[52:55], v[140:143], v[172:175]
 ds_read_b64_tr_b16 a[30:31], v238 offset:30720
 v_exp_f32 v246, v246
 v_mfma_f32_16x16x32_bf16 v[172:175], a[48:51], v[136:139], v[172:175]
 ds_read_b64_tr_b16 a[32:33], v238 offset:32768
 v_exp_f32 v247, v247
 v_mfma_f32_16x16x32_bf16 v[172:175], a[44:47], v[132:135], v[172:175]
 ds_read_b64_tr_b16 a[34:35], v238 offset:34816
 v_exp_f32 v248, v248
 v_mfma_f32_16x16x32_bf16 v[172:175], a[40:43], v[128:131], v[172:175]
 v_exp_f32 v249, v249
 v_fma_f32 v246, v246, v245, v245
 v_mfma_f32_16x16x32_bf16 v[172:175], a[36:39], v[124:127], v[172:175]
 s_waitcnt lgkmcnt(10)
 v_fma_f32 v247, v247, v245, v245
 v_fma_f32 v248, v248, v245, v245
 v_mfma_f32_16x16x32_bf16 v[176:179], a[0:3], v[52:55], v[176:179]
 ds_read_b64_tr_b16 a[36:37], v239 offset:0
 ds_read_b64_tr_b16 a[38:39], v239 offset:2048
 v_fma_f32 v249, v249, v245, v245
 v_mfma_f32_16x16x32_bf16 v[176:179], a[4:7], v[56:59], v[176:179]
 ds_read_b64_tr_b16 a[40:41], v239 offset:4096
 v_rcp_f32 v246, v246
 v_mfma_f32_16x16x32_bf16 v[176:179], a[8:11], v[60:63], v[176:179]
 ds_read_b64_tr_b16 a[42:43], v239 offset:6144
 v_rcp_f32 v247, v247
 v_mfma_f32_16x16x32_bf16 v[176:179], a[12:15], v[64:67], v[176:179]
 s_waitcnt lgkmcnt(4)
 ds_read_b64_tr_b16 a[44:45], v239 offset:8192
 v_mfma_f32_16x16x32_bf16 v[176:179], a[16:19], v[68:71], v[176:179]
 ds_read_b64_tr_b16 a[46:47], v239 offset:10240
 v_rcp_f32 v248, v248
 v_mfma_f32_16x16x32_bf16 v[176:179], a[20:23], v[72:75], v[176:179]
 ds_read_b64_tr_b16 a[48:49], v239 offset:12288
 v_rcp_f32 v249, v249
 v_mul_f32 v164, v164, v246
 v_mfma_f32_16x16x32_bf16 v[176:179], a[24:27], v[76:79], v[176:179]
 ds_read_b64_tr_b16 a[50:51], v239 offset:14336
 v_mul_f32 v165, v165, v247
 v_mul_f32 v166, v166, v248
 v_mfma_f32_16x16x32_bf16 v[176:179], a[28:31], v[80:83], v[176:179]
 ds_read_b64_tr_b16 a[52:53], v239 offset:16384
 v_mul_f32 v167, v167, v249
 v_mul_f32 v246, v242, v168
 v_mfma_f32_16x16x32_bf16 v[176:179], a[32:35], v[84:87], v[176:179]
 ds_read_b64_tr_b16 a[54:55], v239 offset:18432
 ds_read_b64_tr_b16 a[56:57], v239 offset:20480
 v_mul_f32 v247, v242, v169
 v_mfma_f32_16x16x32_bf16 v[180:183], a[32:35], v[156:159], v[180:183]
 ds_read_b64_tr_b16 a[58:59], v239 offset:22528
 v_mul_f32 v248, v242, v170
 v_mul_f32 v249, v242, v171
 v_mfma_f32_16x16x32_bf16 v[180:183], a[28:31], v[152:155], v[180:183]
 ds_read_b64_tr_b16 a[60:61], v239 offset:24576
 v_exp_f32 v246, v246
 v_mfma_f32_16x16x32_bf16 v[180:183], a[24:27], v[148:151], v[180:183]
 ds_read_b64_tr_b16 a[62:63], v239 offset:26624
 v_exp_f32 v247, v247
 v_mfma_f32_16x16x32_bf16 v[180:183], a[20:23], v[144:147], v[180:183]
 ds_read_b64_tr_b16 a[64:65], v239 offset:28672
 v_exp_f32 v248, v248
 v_mfma_f32_16x16x32_bf16 v[180:183], a[16:19], v[140:143], v[180:183]
 ds_read_b64_tr_b16 a[66:67], v239 offset:30720
 v_exp_f32 v249, v249
 v_mfma_f32_16x16x32_bf16 v[180:183], a[12:15], v[136:139], v[180:183]
 ds_read_b64_tr_b16 a[68:69], v239 offset:32768
 v_fma_f32 v246, v246, v244, v244
 v_fma_f32 v247, v247, v244, v244
 v_mfma_f32_16x16x32_bf16 v[180:183], a[8:11], v[132:135], v[180:183]
 ds_read_b64_tr_b16 a[70:71], v239 offset:34816
 v_fma_f32 v248, v248, v244, v244
 v_fma_f32 v249, v249, v244, v244
 v_mfma_f32_16x16x32_bf16 v[180:183], a[4:7], v[128:131], v[180:183]
 v_rcp_f32 v246, v246
 v_mfma_f32_16x16x32_bf16 v[180:183], a[0:3], v[124:127], v[180:183]
 s_waitcnt vmcnt(18) lgkmcnt(0)
 s_barrier
 v_mfma_f32_16x16x32_bf16 v[184:187], a[36:39], v[52:55], v[184:187]
 v_add_u32 v236, 36864, v236
 v_add_u32 v237, 36864, v237
 v_add_u32 v238, 36864, v238
 v_add_u32 v239, 36864, v239
 ds_read_b64_tr_b16 a[0:1], v236 offset:0
 ds_read_b64_tr_b16 a[2:3], v236 offset:2048
 v_mfma_f32_16x16x32_bf16 v[184:187], a[40:43], v[56:59], v[184:187]
 ds_read_b64_tr_b16 a[4:5], v236 offset:4096
 v_mfma_f32_16x16x32_bf16 v[184:187], a[44:47], v[60:63], v[184:187]
 ds_read_b64_tr_b16 a[6:7], v236 offset:6144
 s_add_u32 m0, s58, 36864
 s_add_u32 s60, s56, 2654336
 buffer_load_dwordx4 v224, s[40:43], s60 offen offset:0 lds
 v_mfma_f32_16x16x32_bf16 v[184:187], a[48:51], v[64:67], v[184:187]
 ds_read_b64_tr_b16 a[8:9], v236 offset:8192
 v_mfma_f32_16x16x32_bf16 v[184:187], a[52:55], v[68:71], v[184:187]
 ds_read_b64_tr_b16 a[10:11], v236 offset:10240
 v_rcp_f32 v247, v247
 v_mfma_f32_16x16x32_bf16 v[184:187], a[56:59], v[72:75], v[184:187]
 ds_read_b64_tr_b16 a[12:13], v236 offset:12288
 v_rcp_f32 v248, v248
 v_mfma_f32_16x16x32_bf16 v[184:187], a[60:63], v[76:79], v[184:187]
 ds_read_b64_tr_b16 a[14:15], v236 offset:14336
 v_rcp_f32 v249, v249
 v_mul_f32 v168, v168, v246
 v_mfma_f32_16x16x32_bf16 v[184:187], a[64:67], v[80:83], v[184:187]
 ds_read_b64_tr_b16 a[16:17], v236 offset:16384
 buffer_load_dwordx4 v225, s[40:43], s60 offen offset:1024 lds
 v_mul_f32 v169, v169, v247
 v_mfma_f32_16x16x32_bf16 v[184:187], a[68:71], v[84:87], v[184:187]
 ds_read_b64_tr_b16 a[18:19], v236 offset:18432
 ds_read_b64_tr_b16 a[20:21], v236 offset:20480
 v_mul_f32 v170, v170, v248
 v_mfma_f32_16x16x32_bf16 v[188:191], a[68:71], v[156:159], v[188:191]
 ds_read_b64_tr_b16 a[22:23], v236 offset:22528
 v_mul_f32 v171, v171, v249
 v_mul_f32 v246, v243, v172
 v_mfma_f32_16x16x32_bf16 v[188:191], a[64:67], v[152:155], v[188:191]
 ds_read_b64_tr_b16 a[24:25], v236 offset:24576
 v_mul_f32 v247, v243, v173
 v_mul_f32 v248, v243, v174
 v_mfma_f32_16x16x32_bf16 v[188:191], a[60:63], v[148:151], v[188:191]
 ds_read_b64_tr_b16 a[26:27], v236 offset:26624
 v_mul_f32 v249, v243, v175
 v_mfma_f32_16x16x32_bf16 v[188:191], a[56:59], v[144:147], v[188:191]
 ds_read_b64_tr_b16 a[28:29], v236 offset:28672
 v_exp_f32 v246, v246
 v_mfma_f32_16x16x32_bf16 v[188:191], a[52:55], v[140:143], v[188:191]
 ds_read_b64_tr_b16 a[30:31], v236 offset:30720
 buffer_load_dwordx4 v226, s[40:43], s60 offen offset:2048 lds
 v_exp_f32 v247, v247
 v_mfma_f32_16x16x32_bf16 v[188:191], a[48:51], v[136:139], v[188:191]
 ds_read_b64_tr_b16 a[32:33], v236 offset:32768
 v_exp_f32 v248, v248
 v_mfma_f32_16x16x32_bf16 v[188:191], a[44:47], v[132:135], v[188:191]
 ds_read_b64_tr_b16 a[34:35], v236 offset:34816
 v_exp_f32 v249, v249
 v_mfma_f32_16x16x32_bf16 v[188:191], a[40:43], v[128:131], v[188:191]
 v_fma_f32 v246, v246, v245, v245
 v_fma_f32 v247, v247, v245, v245
 s_branch L_c3_p3_s
L_c3_p3:
 s_branch L_c3_ret
L_c3_p3_s:
 v_fma_f32 v248, v248, v245, v245
 v_mfma_f32_16x16x32_bf16 v[188:191], a[36:39], v[124:127], v[188:191]
 s_waitcnt lgkmcnt(10)
 v_fma_f32 v249, v249, v245, v245
 v_mfma_f32_16x16x32_bf16 v[192:195], a[0:3], v[16:19], 0
 ds_read_b64_tr_b16 a[36:37], v237 offset:0
 ds_read_b64_tr_b16 a[38:39], v237 offset:2048
 v_rcp_f32 v246, v246
 v_mfma_f32_16x16x32_bf16 v[192:195], a[4:7], v[20:23], v[192:195]
 ds_read_b64_tr_b16 a[40:41], v237 offset:4096
 buffer_load_dwordx4 v227, s[40:43], s60 offen offset:3072 lds
 v_mfma_f32_16x16x32_bf16 v[192:195], a[8:11], v[24:27], v[192:195]
 ds_read_b64_tr_b16 a[42:43], v237 offset:6144
 v_rcp_f32 v247, v247
 v_mfma_f32_16x16x32_bf16 v[192:195], a[12:15], v[28:31], v[192:195]
 s_waitcnt lgkmcnt(4)
 ds_read_b64_tr_b16 a[44:45], v237 offset:8192
 v_rcp_f32 v248, v248
 v_mfma_f32_16x16x32_bf16 v[192:195], a[16:19], v[32:35], v[192:195]
 ds_read_b64_tr_b16 a[46:47], v237 offset:10240
 v_rcp_f32 v249, v249
 v_mfma_f32_16x16x32_bf16 v[192:195], a[20:23], v[36:39], v[192:195]
 ds_read_b64_tr_b16 a[48:49], v237 offset:12288
 v_mul_f32 v172, v172, v246
 v_mul_f32 v173, v173, v247
 v_mfma_f32_16x16x32_bf16 v[192:195], a[24:27], v[40:43], v[192:195]
 ds_read_b64_tr_b16 a[50:51], v237 offset:14336
 s_add_u32 m0, s58, 40960
 s_add_u32 s60, s56, 2949248
 buffer_load_dwordx4 v224, s[40:43], s60 offen offset:0 lds
 v_mfma_f32_16x16x32_bf16 v[192:195], a[28:31], v[44:47], v[192:195]
 ds_read_b64_tr_b16 a[52:53], v237 offset:16384
 v_mul_f32 v174, v174, v248
 v_mfma_f32_16x16x32_bf16 v[192:195], a[32:35], v[48:51], v[192:195]
 ds_read_b64_tr_b16 a[54:55], v237 offset:18432
 ds_read_b64_tr_b16 a[56:57], v237 offset:20480
 v_mul_f32 v175, v175, v249
 v_mfma_f32_16x16x32_bf16 v[196:199], a[32:35], v[120:123], 0
 ds_read_b64_tr_b16 a[58:59], v237 offset:22528
 v_mul_f32 v246, v242, v176
 v_mul_f32 v247, v242, v177
 v_mfma_f32_16x16x32_bf16 v[196:199], a[28:31], v[116:119], v[196:199]
 ds_read_b64_tr_b16 a[60:61], v237 offset:24576
 v_mul_f32 v248, v242, v178
 v_mul_f32 v249, v242, v179
 v_mfma_f32_16x16x32_bf16 v[196:199], a[24:27], v[112:115], v[196:199]
 ds_read_b64_tr_b16 a[62:63], v237 offset:26624
 v_exp_f32 v246, v246
 v_mfma_f32_16x16x32_bf16 v[196:199], a[20:23], v[108:111], v[196:199]
 ds_read_b64_tr_b16 a[64:65], v237 offset:28672
 buffer_load_dwordx4 v225, s[40:43], s60 offen offset:1024 lds
 v_mfma_f32_16x16x32_bf16 v[196:199], a[16:19], v[104:107], v[196:199]
 ds_read_b64_tr_b16 a[66:67], v237 offset:30720
 v_exp_f32 v247, v247
 v_mfma_f32_16x16x32_bf16 v[196:199], a[12:15], v[100:103], v[196:199]
 ds_read_b64_tr_b16 a[68:69], v237 offset:32768
 v_exp_f32 v248, v248
 v_mfma_f32_16x16x32_bf16 v[196:199], a[8:11], v[96:99], v[196:199]
 ds_read_b64_tr_b16 a[70:71], v237 offset:34816
 v_exp_f32 v249, v249
 v_fma_f32 v246, v246, v244, v244
 v_mfma_f32_16x16x32_bf16 v[196:199], a[4:7], v[92:95], v[196:199]
 v_fma_f32 v247, v247, v244, v244
 v_fma_f32 v248, v248, v244, v244
 v_fma_f32 v249, v249, v244, v244
 v_mfma_f32_16x16x32_bf16 v[196:199], a[0:3], v[88:91], v[196:199]
 s_waitcnt lgkmcnt(10)
 v_rcp_f32 v246, v246
 v_mfma_f32_16x16x32_bf16 v[200:203], a[36:39], v[16:19], 0
 ds_read_b64_tr_b16 a[0:1], v238 offset:0
 ds_read_b64_tr_b16 a[2:3], v238 offset:2048
 buffer_load_dwordx4 v226, s[40:43], s60 offen offset:2048 lds
 v_mfma_f32_16x16x32_bf16 v[200:203], a[40:43], v[20:23], v[200:203]
 ds_read_b64_tr_b16 a[4:5], v238 offset:4096
 v_rcp_f32 v247, v247
 v_mfma_f32_16x16x32_bf16 v[200:203], a[44:47], v[24:27], v[200:203]
 ds_read_b64_tr_b16 a[6:7], v238 offset:6144
 v_rcp_f32 v248, v248
 v_mfma_f32_16x16x32_bf16 v[200:203], a[48:51], v[28:31], v[200:203]
 s_waitcnt lgkmcnt(4)
 ds_read_b64_tr_b16 a[8:9], v238 offset:8192
 v_mfma_f32_16x16x32_bf16 v[200:203], a[52:55], v[32:35], v[200:203]
 ds_read_b64_tr_b16 a[10:11], v238 offset:10240
 v_rcp_f32 v249, v249
 v_mul_f32 v176, v176, v246
 v_mfma_f32_16x16x32_bf16 v[200:203], a[56:59], v[36:39], v[200:203]
 ds_read_b64_tr_b16 a[12:13], v238 offset:12288
 buffer_load_dwordx4 v227, s[40:43], s60 offen offset:3072 lds
 v_mul_f32 v177, v177, v247
 v_mfma_f32_16x16x32_bf16 v[200:203], a[60:63], v[40:43], v[200:203]
 ds_read_b64_tr_b16 a[14:15], v238 offset:14336
 v_mul_f32 v178, v178, v248
 v_mul_f32 v179, v179, v249
 v_mfma_f32_16x16x32_bf16 v[200:203], a[64:67], v[44:47], v[200:203]
 ds_read_b64_tr_b16 a[16:17], v238 offset:16384
 v_mul_f32 v246, v243, v180
 v_mul_f32 v247, v243, v181
 v_mfma_f32_16x16x32_bf16 v[200:203], a[68:71], v[48:51], v[200:203]
 ds_read_b64_tr_b16 a[18:19], v238 offset:18432
 ds_read_b64_tr_b16 a[20:21], v238 offset:20480
 v_mul_f32 v248, v243, v182
 v_mfma_f32_16x16x32_bf16 v[204:207], a[68:71], v[120:123], 0
 ds_read_b64_tr_b16 a[22:23], v238 offset:22528
 v_mul_f32 v249, v243, v183
 v_mfma_f32_16x16x32_bf16 v[204:207], a[64:67], v[116:119], v[204:207]
 ds_read_b64_tr_b16 a[24:25], v238 offset:24576
 v_exp_f32 v246, v246
 v_mfma_f32_16x16x32_bf16 v[204:207], a[60:63], v[112:115], v[204:207]
 ds_read_b64_tr_b16 a[26:27], v238 offset:26624
 s_add_u32 m0, s59, 36864
 s_add_u32 s60, s57, 2654336
 buffer_load_dwordx4 v224, s[40:43], s60 offen lds
 v_mfma_f32_16x16x32_bf16 v[204:207], a[56:59], v[108:111], v[204:207]
 ds_read_b64_tr_b16 a[28:29], v238 offset:28672
 v_exp_f32 v247, v247
 v_mfma_f32_16x16x32_bf16 v[204:207], a[52:55], v[104:107], v[204:207]
 ds_read_b64_tr_b16 a[30:31], v238 offset:30720
 v_exp_f32 v248, v248
 v_mfma_f32_16x16x32_bf16 v[204:207], a[48:51], v[100:103], v[204:207]
 ds_read_b64_tr_b16 a[32:33], v238 offset:32768
 v_exp_f32 v249, v249
 v_mfma_f32_16x16x32_bf16 v[204:207], a[44:47], v[96:99], v[204:207]
 ds_read_b64_tr_b16 a[34:35], v238 offset:34816
 v_fma_f32 v246, v246, v245, v245
 v_fma_f32 v247, v247, v245, v245
 v_mfma_f32_16x16x32_bf16 v[204:207], a[40:43], v[92:95], v[204:207]
 v_fma_f32 v248, v248, v245, v245
 v_fma_f32 v249, v249, v245, v245
 v_mfma_f32_16x16x32_bf16 v[204:207], a[36:39], v[88:91], v[204:207]
 s_waitcnt lgkmcnt(10)
 v_rcp_f32 v246, v246
 v_mfma_f32_16x16x32_bf16 v[208:211], a[0:3], v[16:19], 0
 ds_read_b64_tr_b16 a[36:37], v239 offset:0
 ds_read_b64_tr_b16 a[38:39], v239 offset:2048
 v_rcp_f32 v247, v247
 v_mfma_f32_16x16x32_bf16 v[208:211], a[4:7], v[20:23], v[208:211]
 ds_read_b64_tr_b16 a[40:41], v239 offset:4096
 v_rcp_f32 v248, v248
 v_mfma_f32_16x16x32_bf16 v[208:211], a[8:11], v[24:27], v[208:211]
 ds_read_b64_tr_b16 a[42:43], v239 offset:6144
 v_rcp_f32 v249, v249
 v_mfma_f32_16x16x32_bf16 v[208:211], a[12:15], v[28:31], v[208:211]
 s_waitcnt lgkmcnt(4)
 ds_read_b64_tr_b16 a[44:45], v239 offset:8192
 v_mul_f32 v180, v180, v246
 v_mfma_f32_16x16x32_bf16 v[208:211], a[16:19], v[32:35], v[208:211]
 ds_read_b64_tr_b16 a[46:47], v239 offset:10240
 v_mul_f32 v181, v181, v247
 v_mul_f32 v182, v182, v248
 v_mfma_f32_16x16x32_bf16 v[208:211], a[20:23], v[36:39], v[208:211]
 ds_read_b64_tr_b16 a[48:49], v239 offset:12288
 v_mul_f32 v183, v183, v249
 v_mul_f32 v246, v242, v184
 v_mfma_f32_16x16x32_bf16 v[208:211], a[24:27], v[40:43], v[208:211]
 ds_read_b64_tr_b16 a[50:51], v239 offset:14336
 v_mul_f32 v247, v242, v185
 v_mul_f32 v248, v242, v186
 v_mfma_f32_16x16x32_bf16 v[208:211], a[28:31], v[44:47], v[208:211]
 ds_read_b64_tr_b16 a[52:53], v239 offset:16384
 v_mul_f32 v249, v242, v187
 v_mfma_f32_16x16x32_bf16 v[208:211], a[32:35], v[48:51], v[208:211]
 ds_read_b64_tr_b16 a[54:55], v239 offset:18432
 ds_read_b64_tr_b16 a[56:57], v239 offset:20480
 v_exp_f32 v246, v246
 v_mfma_f32_16x16x32_bf16 v[212:215], a[32:35], v[120:123], 0
 ds_read_b64_tr_b16 a[58:59], v239 offset:22528
 v_exp_f32 v247, v247
 v_mfma_f32_16x16x32_bf16 v[212:215], a[28:31], v[116:119], v[212:215]
 ds_read_b64_tr_b16 a[60:61], v239 offset:24576
 v_exp_f32 v248, v248
 v_mfma_f32_16x16x32_bf16 v[212:215], a[24:27], v[112:115], v[212:215]
 ds_read_b64_tr_b16 a[62:63], v239 offset:26624
 v_exp_f32 v249, v249
 v_mfma_f32_16x16x32_bf16 v[212:215], a[20:23], v[108:111], v[212:215]
 ds_read_b64_tr_b16 a[64:65], v239 offset:28672
 v_fma_f32 v246, v246, v244, v244
 v_fma_f32 v247, v247, v244, v244
 v_mfma_f32_16x16x32_bf16 v[212:215], a[16:19], v[104:107], v[212:215]
 ds_read_b64_tr_b16 a[66:67], v239 offset:30720
 v_fma_f32 v248, v248, v244, v244
 v_fma_f32 v249, v249, v244, v244
 v_mfma_f32_16x16x32_bf16 v[212:215], a[12:15], v[100:103], v[212:215]
 ds_read_b64_tr_b16 a[68:69], v239 offset:32768
 v_rcp_f32 v246, v246
 v_mfma_f32_16x16x32_bf16 v[212:215], a[8:11], v[96:99], v[212:215]
 ds_read_b64_tr_b16 a[70:71], v239 offset:34816
 v_rcp_f32 v247, v247
 v_mfma_f32_16x16x32_bf16 v[212:215], a[4:7], v[92:95], v[212:215]
 v_rcp_f32 v248, v248
 v_mfma_f32_16x16x32_bf16 v[212:215], a[0:3], v[88:91], v[212:215]
 s_waitcnt vmcnt(18) lgkmcnt(0)
 s_barrier
 v_mfma_f32_16x16x32_bf16 v[216:219], a[36:39], v[16:19], 0
 v_add_u32 v236, 36864, v236
 v_add_u32 v237, 36864, v237
 v_add_u32 v238, 36864, v238
 v_add_u32 v239, 36864, v239
 ds_read_b64_tr_b16 a[0:1], v236 offset:0
 ds_read_b64_tr_b16 a[2:3], v236 offset:2048
 v_mfma_f32_16x16x32_bf16 v[216:219], a[40:43], v[20:23], v[216:219]
 ds_read_b64_tr_b16 a[4:5], v236 offset:4096
 v_mfma_f32_16x16x32_bf16 v[216:219], a[44:47], v[24:27], v[216:219]
 ds_read_b64_tr_b16 a[6:7], v236 offset:6144
 s_add_u32 m0, s58, 73728
 s_add_u32 s60, s56, 128
 buffer_load_dwordx4 v224, s[44:47], s60 offen offset:0 lds
 v_mfma_f32_16x16x32_bf16 v[216:219], a[48:51], v[28:31], v[216:219]
 ds_read_b64_tr_b16 a[8:9], v236 offset:8192
 v_mfma_f32_16x16x32_bf16 v[216:219], a[52:55], v[32:35], v[216:219]
 ds_read_b64_tr_b16 a[10:11], v236 offset:10240
 v_rcp_f32 v249, v249
 v_mul_f32 v184, v184, v246
 v_mfma_f32_16x16x32_bf16 v[216:219], a[56:59], v[36:39], v[216:219]
 ds_read_b64_tr_b16 a[12:13], v236 offset:12288
 v_mul_f32 v185, v185, v247
 v_mul_f32 v186, v186, v248
 v_mfma_f32_16x16x32_bf16 v[216:219], a[60:63], v[40:43], v[216:219]
 ds_read_b64_tr_b16 a[14:15], v236 offset:14336
 v_mul_f32 v187, v187, v249
 v_mul_f32 v246, v243, v188
 v_mfma_f32_16x16x32_bf16 v[216:219], a[64:67], v[44:47], v[216:219]
 ds_read_b64_tr_b16 a[16:17], v236 offset:16384
 buffer_load_dwordx4 v225, s[44:47], s60 offen offset:1024 lds
 v_mul_f32 v247, v243, v189
 v_mfma_f32_16x16x32_bf16 v[216:219], a[68:71], v[48:51], v[216:219]
 ds_read_b64_tr_b16 a[18:19], v236 offset:18432
 ds_read_b64_tr_b16 a[20:21], v236 offset:20480
 v_mul_f32 v248, v243, v190
 v_mfma_f32_16x16x32_bf16 v[220:223], a[68:71], v[120:123], 0
 ds_read_b64_tr_b16 a[22:23], v236 offset:22528
 v_mul_f32 v249, v243, v191
 v_mfma_f32_16x16x32_bf16 v[220:223], a[64:67], v[116:119], v[220:223]
 ds_read_b64_tr_b16 a[24:25], v236 offset:24576
 v_exp_f32 v246, v246
 v_mfma_f32_16x16x32_bf16 v[220:223], a[60:63], v[112:115], v[220:223]
 ds_read_b64_tr_b16 a[26:27], v236 offset:26624
 v_exp_f32 v247, v247
 v_mfma_f32_16x16x32_bf16 v[220:223], a[56:59], v[108:111], v[220:223]
 ds_read_b64_tr_b16 a[28:29], v236 offset:28672
 v_exp_f32 v248, v248
 v_mfma_f32_16x16x32_bf16 v[220:223], a[52:55], v[104:107], v[220:223]
 ds_read_b64_tr_b16 a[30:31], v236 offset:30720
 buffer_load_dwordx4 v226, s[44:47], s60 offen offset:2048 lds
 v_exp_f32 v249, v249
 v_mfma_f32_16x16x32_bf16 v[220:223], a[48:51], v[100:103], v[220:223]
 ds_read_b64_tr_b16 a[32:33], v236 offset:32768
 v_fma_f32 v246, v246, v245, v245
 v_fma_f32 v247, v247, v245, v245
 v_mfma_f32_16x16x32_bf16 v[220:223], a[44:47], v[96:99], v[220:223]
 ds_read_b64_tr_b16 a[34:35], v236 offset:34816
 v_fma_f32 v248, v248, v245, v245
 v_fma_f32 v249, v249, v245, v245
 v_mfma_f32_16x16x32_bf16 v[220:223], a[40:43], v[92:95], v[220:223]
 v_rcp_f32 v246, v246
 v_mfma_f32_16x16x32_bf16 v[220:223], a[36:39], v[88:91], v[220:223]
 s_waitcnt lgkmcnt(10)
 v_rcp_f32 v247, v247
 v_mfma_f32_16x16x32_bf16 v[192:195], a[0:3], v[52:55], v[192:195]
 ds_read_b64_tr_b16 a[36:37], v237 offset:0
 ds_read_b64_tr_b16 a[38:39], v237 offset:2048
 v_rcp_f32 v248, v248
 v_mfma_f32_16x16x32_bf16 v[192:195], a[4:7], v[56:59], v[192:195]
 ds_read_b64_tr_b16 a[40:41], v237 offset:4096
 buffer_load_dwordx4 v227, s[44:47], s60 offen offset:3072 lds
 v_mfma_f32_16x16x32_bf16 v[192:195], a[8:11], v[60:63], v[192:195]
 ds_read_b64_tr_b16 a[42:43], v237 offset:6144
 v_rcp_f32 v249, v249
 v_mul_f32 v188, v188, v246
 v_mfma_f32_16x16x32_bf16 v[192:195], a[12:15], v[64:67], v[192:195]
 s_waitcnt lgkmcnt(4)
 ds_read_b64_tr_b16 a[44:45], v237 offset:8192
 v_mul_f32 v189, v189, v247
 v_mfma_f32_16x16x32_bf16 v[192:195], a[16:19], v[68:71], v[192:195]
 ds_read_b64_tr_b16 a[46:47], v237 offset:10240
 v_mul_f32 v190, v190, v248
 v_mul_f32 v191, v191, v249
 v_mfma_f32_16x16x32_bf16 v[192:195], a[20:23], v[72:75], v[192:195]
 ds_read_b64_tr_b16 a[48:49], v237 offset:12288
 v_mfma_f32_16x16x32_bf16 v[192:195], a[24:27], v[76:79], v[192:195]
 ds_read_b64_tr_b16 a[50:51], v237 offset:14336
 s_add_u32 m0, s58, 77824
 s_add_u32 s60, s56, 295040
 buffer_load_dwordx4 v224, s[44:47], s60 offen offset:0 lds
 v_mfma_f32_16x16x32_bf16 v[192:195], a[28:31], v[80:83], v[192:195]
 ds_read_b64_tr_b16 a[52:53], v237 offset:16384
 v_mfma_f32_16x16x32_bf16 v[192:195], a[32:35], v[84:87], v[192:195]
 ds_read_b64_tr_b16 a[54:55], v237 offset:18432
 ds_read_b64_tr_b16 a[56:57], v237 offset:20480
 v_mfma_f32_16x16x32_bf16 v[196:199], a[32:35], v[156:159], v[196:199]
 ds_read_b64_tr_b16 a[58:59], v237 offset:22528
 v_mfma_f32_16x16x32_bf16 v[196:199], a[28:31], v[152:155], v[196:199]
 ds_read_b64_tr_b16 a[60:61], v237 offset:24576
 s_add_u32 s67, s25, 1
 s_and_b32 s67, s67, 3
 s_lshl_b32 s67, s67, 1
 s_add_u32 s67, s67, s35
 s_lshl_b32 s67, s67, 10
 v_add_u32 v232, s67, v9
 s_add_u32 s80, s63, s67
 s_add_u32 s4, s64, s67
 s_sub_u32 s4, s4, 4096
 v_mfma_f32_16x16x32_bf16 v[196:199], a[24:27], v[148:151], v[196:199]
 ds_read_b64_tr_b16 a[62:63], v237 offset:26624
 v_mfma_f32_16x16x32_bf16 v[196:199], a[20:23], v[144:147], v[196:199]
 ds_read_b64_tr_b16 a[64:65], v237 offset:28672
 buffer_load_dwordx4 v225, s[44:47], s60 offen offset:1024 lds
 v_mfma_f32_16x16x32_bf16 v[196:199], a[16:19], v[140:143], v[196:199]
 ds_read_b64_tr_b16 a[66:67], v237 offset:30720
 v_mul_f32 v192, v192, v160
 v_mfma_f32_16x16x32_bf16 v[196:199], a[12:15], v[136:139], v[196:199]
 ds_read_b64_tr_b16 a[68:69], v237 offset:32768
 v_mul_f32 v193, v193, v161
 v_mul_f32 v194, v194, v162
 v_mfma_f32_16x16x32_bf16 v[196:199], a[8:11], v[132:135], v[196:199]
 ds_read_b64_tr_b16 a[70:71], v237 offset:34816
 v_mul_f32 v195, v195, v163
 v_cvt_pk_bf16_f32 v192, v192, v193
 v_mfma_f32_16x16x32_bf16 v[196:199], a[4:7], v[128:131], v[196:199]
 v_cvt_pk_bf16_f32 v193, v194, v195
 v_accvgpr_write_b32 a144, v192
 v_accvgpr_write_b32 a145, v193
 v_mfma_f32_16x16x32_bf16 v[196:199], a[0:3], v[124:127], v[196:199]
 s_waitcnt lgkmcnt(10)
 v_mfma_f32_16x16x32_bf16 v[200:203], a[36:39], v[52:55], v[200:203]
 ds_read_b64_tr_b16 a[0:1], v238 offset:0
 ds_read_b64_tr_b16 a[2:3], v238 offset:2048
 buffer_load_dwordx4 v226, s[44:47], s60 offen offset:2048 lds
 v_mfma_f32_16x16x32_bf16 v[200:203], a[40:43], v[56:59], v[200:203]
 ds_read_b64_tr_b16 a[4:5], v238 offset:4096
 v_mfma_f32_16x16x32_bf16 v[200:203], a[44:47], v[60:63], v[200:203]
 ds_read_b64_tr_b16 a[6:7], v238 offset:6144
 s_add_u32 s67, s25, 2
 s_and_b32 s67, s67, 3
 s_lshl_b32 s67, s67, 1
 s_add_u32 s67, s67, s35
 s_lshl_b32 s67, s67, 10
 v_add_u32 v233, s67, v9
 s_add_u32 s81, s63, s67
 s_add_u32 s5, s64, s67
 s_sub_u32 s5, s5, 4096
 v_mfma_f32_16x16x32_bf16 v[200:203], a[48:51], v[64:67], v[200:203]
 s_waitcnt lgkmcnt(4)
 ds_read_b64_tr_b16 a[8:9], v238 offset:8192
 v_mfma_f32_16x16x32_bf16 v[200:203], a[52:55], v[68:71], v[200:203]
 ds_read_b64_tr_b16 a[10:11], v238 offset:10240
 v_mfma_f32_16x16x32_bf16 v[200:203], a[56:59], v[72:75], v[200:203]
 ds_read_b64_tr_b16 a[12:13], v238 offset:12288
 buffer_load_dwordx4 v227, s[44:47], s60 offen offset:3072 lds
 v_mfma_f32_16x16x32_bf16 v[200:203], a[60:63], v[76:79], v[200:203]
 ds_read_b64_tr_b16 a[14:15], v238 offset:14336
 v_mul_f32 v196, v196, v164
 v_mul_f32 v197, v197, v165
 v_mfma_f32_16x16x32_bf16 v[200:203], a[64:67], v[80:83], v[200:203]
 ds_read_b64_tr_b16 a[16:17], v238 offset:16384
 v_mul_f32 v198, v198, v166
 v_mul_f32 v199, v199, v167
 v_mfma_f32_16x16x32_bf16 v[200:203], a[68:71], v[84:87], v[200:203]
 ds_read_b64_tr_b16 a[18:19], v238 offset:18432
 ds_read_b64_tr_b16 a[20:21], v238 offset:20480
 v_cvt_pk_bf16_f32 v196, v196, v197
 v_mfma_f32_16x16x32_bf16 v[204:207], a[68:71], v[156:159], v[204:207]
 ds_read_b64_tr_b16 a[22:23], v238 offset:22528
 v_cvt_pk_bf16_f32 v197, v198, v199
 v_accvgpr_write_b32 a148, v196
 v_mfma_f32_16x16x32_bf16 v[204:207], a[64:67], v[152:155], v[204:207]
 ds_read_b64_tr_b16 a[24:25], v238 offset:24576
 v_accvgpr_write_b32 a149, v197
 v_mfma_f32_16x16x32_bf16 v[204:207], a[60:63], v[148:151], v[204:207]
 ds_read_b64_tr_b16 a[26:27], v238 offset:26624
 s_add_u32 m0, s59, 73728
 s_add_u32 s60, s57, 128
 buffer_load_dwordx4 v224, s[44:47], s60 offen lds
 v_mfma_f32_16x16x32_bf16 v[204:207], a[56:59], v[144:147], v[204:207]
 ds_read_b64_tr_b16 a[28:29], v238 offset:28672
 s_add_u32 s67, s25, 3
 s_and_b32 s67, s67, 3
 s_lshl_b32 s67, s67, 1
 s_add_u32 s67, s67, s35
 s_lshl_b32 s67, s67, 10
 v_add_u32 v234, s67, v9
 s_add_u32 s82, s63, s67
 s_add_u32 s6, s64, s67
 s_sub_u32 s6, s6, 4096
 v_mfma_f32_16x16x32_bf16 v[204:207], a[52:55], v[140:143], v[204:207]
 ds_read_b64_tr_b16 a[30:31], v238 offset:30720
 v_mfma_f32_16x16x32_bf16 v[204:207], a[48:51], v[136:139], v[204:207]
 ds_read_b64_tr_b16 a[32:33], v238 offset:32768
 v_mfma_f32_16x16x32_bf16 v[204:207], a[44:47], v[132:135], v[204:207]
 ds_read_b64_tr_b16 a[34:35], v238 offset:34816
 v_mfma_f32_16x16x32_bf16 v[204:207], a[40:43], v[128:131], v[204:207]
 v_mul_f32 v200, v200, v168
 v_mul_f32 v201, v201, v169
 v_mfma_f32_16x16x32_bf16 v[204:207], a[36:39], v[124:127], v[204:207]
 s_waitcnt lgkmcnt(10)
 v_mul_f32 v202, v202, v170
 v_mul_f32 v203, v203, v171
 v_mfma_f32_16x16x32_bf16 v[208:211], a[0:3], v[52:55], v[208:211]
 ds_read_b64_tr_b16 a[36:37], v239 offset:0
 ds_read_b64_tr_b16 a[38:39], v239 offset:2048
 v_cvt_pk_bf16_f32 v194, v200, v201
 v_mfma_f32_16x16x32_bf16 v[208:211], a[4:7], v[56:59], v[208:211]
 ds_read_b64_tr_b16 a[40:41], v239 offset:4096
 v_cvt_pk_bf16_f32 v195, v202, v203
 v_accvgpr_write_b32 a146, v194
 v_mfma_f32_16x16x32_bf16 v[208:211], a[8:11], v[60:63], v[208:211]
 ds_read_b64_tr_b16 a[42:43], v239 offset:6144
 v_accvgpr_write_b32 a147, v195
 v_mfma_f32_16x16x32_bf16 v[208:211], a[12:15], v[64:67], v[208:211]
 s_waitcnt lgkmcnt(4)
 ds_read_b64_tr_b16 a[44:45], v239 offset:8192
 s_add_u32 s67, s66, 0
 buffer_store_dwordx4 v[192:195], v9, s[8:11], s67 offen sc1
 v_mfma_f32_16x16x32_bf16 v[208:211], a[16:19], v[68:71], v[208:211]
 ds_read_b64_tr_b16 a[46:47], v239 offset:10240
 s_add_u32 s67, s25, 4
 s_and_b32 s67, s67, 3
 s_lshl_b32 s67, s67, 1
 s_add_u32 s67, s67, s35
 s_lshl_b32 s67, s67, 10
 v_add_u32 v235, s67, v9
 s_add_u32 s83, s63, s67
 s_add_u32 s7, s64, s67
 s_sub_u32 s7, s7, 4096
 v_mfma_f32_16x16x32_bf16 v[208:211], a[20:23], v[72:75], v[208:211]
 ds_read_b64_tr_b16 a[48:49], v239 offset:12288
 v_mfma_f32_16x16x32_bf16 v[208:211], a[24:27], v[76:79], v[208:211]
 ds_read_b64_tr_b16 a[50:51], v239 offset:14336
 v_mfma_f32_16x16x32_bf16 v[208:211], a[28:31], v[80:83], v[208:211]
 ds_read_b64_tr_b16 a[52:53], v239 offset:16384
 v_mfma_f32_16x16x32_bf16 v[208:211], a[32:35], v[84:87], v[208:211]
 ds_read_b64_tr_b16 a[54:55], v239 offset:18432
 ds_read_b64_tr_b16 a[56:57], v239 offset:20480
 v_mfma_f32_16x16x32_bf16 v[212:215], a[32:35], v[156:159], v[212:215]
 ds_read_b64_tr_b16 a[58:59], v239 offset:22528
 v_mul_f32 v204, v204, v172
 v_mul_f32 v205, v205, v173
 v_mfma_f32_16x16x32_bf16 v[212:215], a[28:31], v[152:155], v[212:215]
 ds_read_b64_tr_b16 a[60:61], v239 offset:24576
 v_mul_f32 v206, v206, v174
 v_mul_f32 v207, v207, v175
 v_mfma_f32_16x16x32_bf16 v[212:215], a[24:27], v[148:151], v[212:215]
 ds_read_b64_tr_b16 a[62:63], v239 offset:26624
 v_cvt_pk_bf16_f32 v198, v204, v205
 v_cvt_pk_bf16_f32 v199, v206, v207
 v_mfma_f32_16x16x32_bf16 v[212:215], a[20:23], v[144:147], v[212:215]
 ds_read_b64_tr_b16 a[64:65], v239 offset:28672
 v_accvgpr_write_b32 a150, v198
 v_accvgpr_write_b32 a151, v199
 v_mfma_f32_16x16x32_bf16 v[212:215], a[16:19], v[140:143], v[212:215]
 ds_read_b64_tr_b16 a[66:67], v239 offset:30720
 s_add_u32 s67, s66, 1024
 buffer_store_dwordx4 v[196:199], v9, s[8:11], s67 offen sc1
 v_mfma_f32_16x16x32_bf16 v[212:215], a[12:15], v[136:139], v[212:215]
 ds_read_b64_tr_b16 a[68:69], v239 offset:32768
 s_xor_b32 s67, s35, 1
 s_lshl_b32 s67, s67, 13
 v_add_u32 v254, s67, v9
 s_add_u32 s84, s63, s67
 s_add_u32 s36, s64, s67
 s_sub_u32 s36, s36, 4096
 v_mfma_f32_16x16x32_bf16 v[212:215], a[8:11], v[132:135], v[212:215]
 ds_read_b64_tr_b16 a[70:71], v239 offset:34816
 v_mfma_f32_16x16x32_bf16 v[212:215], a[4:7], v[128:131], v[212:215]
 v_mul_f32 v208, v208, v176
 v_mfma_f32_16x16x32_bf16 v[212:215], a[0:3], v[124:127], v[212:215]
 s_waitcnt vmcnt(20) lgkmcnt(0)
 s_barrier
 v_mfma_f32_16x16x32_bf16 v[216:219], a[36:39], v[52:55], v[216:219]
 v_subrev_u32 v236, 110592, v236
 v_subrev_u32 v237, 110592, v237
 v_subrev_u32 v238, 110592, v238
 v_subrev_u32 v239, 110592, v239
 ds_read_b64_tr_b16 a[0:1], v236 offset:0
 ds_read_b64_tr_b16 a[2:3], v236 offset:2048
 v_mfma_f32_16x16x32_bf16 v[216:219], a[40:43], v[56:59], v[216:219]
 ds_read_b64_tr_b16 a[4:5], v236 offset:4096
 v_mfma_f32_16x16x32_bf16 v[216:219], a[44:47], v[60:63], v[216:219]
 ds_read_b64_tr_b16 a[6:7], v236 offset:6144
 s_add_u32 m0, s58, 110592
 s_add_u32 s60, s56, 2654336
 buffer_load_dwordx4 v224, s[44:47], s60 offen offset:0 lds
 v_mfma_f32_16x16x32_bf16 v[216:219], a[48:51], v[64:67], v[216:219]
 ds_read_b64_tr_b16 a[8:9], v236 offset:8192
 v_mfma_f32_16x16x32_bf16 v[216:219], a[52:55], v[68:71], v[216:219]
 ds_read_b64_tr_b16 a[10:11], v236 offset:10240
 v_mul_f32 v209, v209, v177
 v_mul_f32 v210, v210, v178
 v_mfma_f32_16x16x32_bf16 v[216:219], a[56:59], v[72:75], v[216:219]
 ds_read_b64_tr_b16 a[12:13], v236 offset:12288
 v_mul_f32 v211, v211, v179
 v_mul_f32 v212, v212, v180
 v_mfma_f32_16x16x32_bf16 v[216:219], a[60:63], v[76:79], v[216:219]
 ds_read_b64_tr_b16 a[14:15], v236 offset:14336
 v_mul_f32 v213, v213, v181
 v_mul_f32 v214, v214, v182
 v_mfma_f32_16x16x32_bf16 v[216:219], a[64:67], v[80:83], v[216:219]
 ds_read_b64_tr_b16 a[16:17], v236 offset:16384
 buffer_load_dwordx4 v225, s[44:47], s60 offen offset:1024 lds
 v_mul_f32 v215, v215, v183
 v_mfma_f32_16x16x32_bf16 v[216:219], a[68:71], v[84:87], v[216:219]
 ds_read_b64_tr_b16 a[18:19], v236 offset:18432
 ds_read_b64_tr_b16 a[20:21], v236 offset:20480
 v_cvt_pk_bf16_f32 v208, v208, v209
 v_mfma_f32_16x16x32_bf16 v[220:223], a[68:71], v[156:159], v[220:223]
 ds_read_b64_tr_b16 a[22:23], v236 offset:22528
 v_cvt_pk_bf16_f32 v209, v210, v211
 v_accvgpr_write_b32 a152, v208
 v_mfma_f32_16x16x32_bf16 v[220:223], a[64:67], v[152:155], v[220:223]
 ds_read_b64_tr_b16 a[24:25], v236 offset:24576
 v_accvgpr_write_b32 a153, v209
 v_cvt_pk_bf16_f32 v212, v212, v213
 v_mfma_f32_16x16x32_bf16 v[220:223], a[60:63], v[148:151], v[220:223]
 ds_read_b64_tr_b16 a[26:27], v236 offset:26624
 v_cvt_pk_bf16_f32 v213, v214, v215
 v_accvgpr_write_b32 a156, v212
 v_mfma_f32_16x16x32_bf16 v[220:223], a[56:59], v[144:147], v[220:223]
 ds_read_b64_tr_b16 a[28:29], v236 offset:28672
 v_accvgpr_write_b32 a157, v213
 v_mul_f32 v216, v216, v184
 v_mfma_f32_16x16x32_bf16 v[220:223], a[52:55], v[140:143], v[220:223]
 ds_read_b64_tr_b16 a[30:31], v236 offset:30720
 buffer_load_dwordx4 v226, s[44:47], s60 offen offset:2048 lds
 v_mul_f32 v217, v217, v185
 v_mfma_f32_16x16x32_bf16 v[220:223], a[48:51], v[136:139], v[220:223]
 ds_read_b64_tr_b16 a[32:33], v236 offset:32768
 v_mul_f32 v218, v218, v186
 v_mul_f32 v219, v219, v187
 v_mfma_f32_16x16x32_bf16 v[220:223], a[44:47], v[132:135], v[220:223]
 ds_read_b64_tr_b16 a[34:35], v236 offset:34816
 v_cvt_pk_bf16_f32 v210, v216, v217
 v_cvt_pk_bf16_f32 v211, v218, v219
 v_mfma_f32_16x16x32_bf16 v[220:223], a[40:43], v[128:131], v[220:223]
 v_accvgpr_write_b32 a154, v210
 v_accvgpr_write_b32 a155, v211
 v_mfma_f32_16x16x32_bf16 v[220:223], a[36:39], v[124:127], v[220:223]
 s_waitcnt lgkmcnt(10)
 s_add_u32 s67, s66, 2048
 buffer_store_dwordx4 v[208:211], v9, s[8:11], s67 offen sc1
 v_mfma_f32_16x16x32_bf16 v[160:163], a[0:3], v[16:19], 0
 ds_read_b64_tr_b16 a[36:37], v237 offset:0
 ds_read_b64_tr_b16 a[38:39], v237 offset:2048
 v_mfma_f32_16x16x32_bf16 v[160:163], a[4:7], v[20:23], v[160:163]
 ds_read_b64_tr_b16 a[40:41], v237 offset:4096
 buffer_load_dwordx4 v227, s[44:47], s60 offen offset:3072 lds
 v_mfma_f32_16x16x32_bf16 v[160:163], a[8:11], v[24:27], v[160:163]
 ds_read_b64_tr_b16 a[42:43], v237 offset:6144
 v_mul_f32 v220, v220, v188
 v_mul_f32 v221, v221, v189
 v_mul_f32 v222, v222, v190
 v_mfma_f32_16x16x32_bf16 v[160:163], a[12:15], v[28:31], v[160:163]
 s_waitcnt lgkmcnt(4)
 ds_read_b64_tr_b16 a[44:45], v237 offset:8192
 v_mul_f32 v223, v223, v191
 v_mfma_f32_16x16x32_bf16 v[160:163], a[16:19], v[32:35], v[160:163]
 ds_read_b64_tr_b16 a[46:47], v237 offset:10240
 v_cvt_pk_bf16_f32 v214, v220, v221
 v_cvt_pk_bf16_f32 v215, v222, v223
 v_mfma_f32_16x16x32_bf16 v[160:163], a[20:23], v[36:39], v[160:163]
 ds_read_b64_tr_b16 a[48:49], v237 offset:12288
 v_accvgpr_write_b32 a158, v214
 v_accvgpr_write_b32 a159, v215
 v_mfma_f32_16x16x32_bf16 v[160:163], a[24:27], v[40:43], v[160:163]
 ds_read_b64_tr_b16 a[50:51], v237 offset:14336
 s_add_u32 m0, s58, 114688
 s_add_u32 s60, s56, 2949248
 buffer_load_dwordx4 v224, s[44:47], s60 offen offset:0 lds
 v_mfma_f32_16x16x32_bf16 v[160:163], a[28:31], v[44:47], v[160:163]
 ds_read_b64_tr_b16 a[52:53], v237 offset:16384
 v_mfma_f32_16x16x32_bf16 v[160:163], a[32:35], v[48:51], v[160:163]
 ds_read_b64_tr_b16 a[54:55], v237 offset:18432
 ds_read_b64_tr_b16 a[56:57], v237 offset:20480
 s_add_u32 s67, s66, 3072
 buffer_store_dwordx4 v[212:215], v9, s[8:11], s67 offen sc1
 v_mfma_f32_16x16x32_bf16 v[164:167], a[32:35], v[120:123], 0
 ds_read_b64_tr_b16 a[58:59], v237 offset:22528
 v_mfma_f32_16x16x32_bf16 v[164:167], a[28:31], v[116:119], v[164:167]
 ds_read_b64_tr_b16 a[60:61], v237 offset:24576
 v_mov_b32 v255, v9
 v_mfma_f32_16x16x32_bf16 v[164:167], a[24:27], v[112:115], v[164:167]
 ds_read_b64_tr_b16 a[62:63], v237 offset:26624
 v_mfma_f32_16x16x32_bf16 v[164:167], a[20:23], v[108:111], v[164:167]
 ds_read_b64_tr_b16 a[64:65], v237 offset:28672
 buffer_load_dwordx4 v225, s[44:47], s60 offen offset:1024 lds
 v_mfma_f32_16x16x32_bf16 v[164:167], a[16:19], v[104:107], v[164:167]
 ds_read_b64_tr_b16 a[66:67], v237 offset:30720
 v_mfma_f32_16x16x32_bf16 v[164:167], a[12:15], v[100:103], v[164:167]
 ds_read_b64_tr_b16 a[68:69], v237 offset:32768
 v_mfma_f32_16x16x32_bf16 v[164:167], a[8:11], v[96:99], v[164:167]
 ds_read_b64_tr_b16 a[70:71], v237 offset:34816
 v_mfma_f32_16x16x32_bf16 v[164:167], a[4:7], v[92:95], v[164:167]
 v_mfma_f32_16x16x32_bf16 v[164:167], a[0:3], v[88:91], v[164:167]
 s_branch L_c3_p4_s
L_c3_p4:
 s_branch L_c3_ret
L_c3_p4_s:
 s_waitcnt lgkmcnt(10)
 v_mfma_f32_16x16x32_bf16 v[168:171], a[36:39], v[16:19], 0
 ds_read_b64_tr_b16 a[0:1], v238 offset:0
 ds_read_b64_tr_b16 a[2:3], v238 offset:2048
 buffer_load_dwordx4 v226, s[44:47], s60 offen offset:2048 lds
 v_mfma_f32_16x16x32_bf16 v[168:171], a[40:43], v[20:23], v[168:171]
 ds_read_b64_tr_b16 a[4:5], v238 offset:4096
 v_mfma_f32_16x16x32_bf16 v[168:171], a[44:47], v[24:27], v[168:171]
 ds_read_b64_tr_b16 a[6:7], v238 offset:6144
 v_mfma_f32_16x16x32_bf16 v[168:171], a[48:51], v[28:31], v[168:171]
 s_waitcnt lgkmcnt(4)
 ds_read_b64_tr_b16 a[8:9], v238 offset:8192
 v_mfma_f32_16x16x32_bf16 v[168:171], a[52:55], v[32:35], v[168:171]
 ds_read_b64_tr_b16 a[10:11], v238 offset:10240
 v_mfma_f32_16x16x32_bf16 v[168:171], a[56:59], v[36:39], v[168:171]
 ds_read_b64_tr_b16 a[12:13], v238 offset:12288
 buffer_load_dwordx4 v227, s[44:47], s60 offen offset:3072 lds
 v_mfma_f32_16x16x32_bf16 v[168:171], a[60:63], v[40:43], v[168:171]
 ds_read_b64_tr_b16 a[14:15], v238 offset:14336
 v_mfma_f32_16x16x32_bf16 v[168:171], a[64:67], v[44:47], v[168:171]
 ds_read_b64_tr_b16 a[16:17], v238 offset:16384
 v_mfma_f32_16x16x32_bf16 v[168:171], a[68:71], v[48:51], v[168:171]
 ds_read_b64_tr_b16 a[18:19], v238 offset:18432
 ds_read_b64_tr_b16 a[20:21], v238 offset:20480
 v_mfma_f32_16x16x32_bf16 v[172:175], a[68:71], v[120:123], 0
 ds_read_b64_tr_b16 a[22:23], v238 offset:22528
 v_mfma_f32_16x16x32_bf16 v[172:175], a[64:67], v[116:119], v[172:175]
 ds_read_b64_tr_b16 a[24:25], v238 offset:24576
 v_mfma_f32_16x16x32_bf16 v[172:175], a[60:63], v[112:115], v[172:175]
 ds_read_b64_tr_b16 a[26:27], v238 offset:26624
 s_add_u32 m0, s59, 110592
 s_add_u32 s60, s57, 2654336
 buffer_load_dwordx4 v224, s[44:47], s60 offen lds
 v_mfma_f32_16x16x32_bf16 v[172:175], a[56:59], v[108:111], v[172:175]
 ds_read_b64_tr_b16 a[28:29], v238 offset:28672
 v_mfma_f32_16x16x32_bf16 v[172:175], a[52:55], v[104:107], v[172:175]
 ds_read_b64_tr_b16 a[30:31], v238 offset:30720
 v_mfma_f32_16x16x32_bf16 v[172:175], a[48:51], v[100:103], v[172:175]
 ds_read_b64_tr_b16 a[32:33], v238 offset:32768
 v_mfma_f32_16x16x32_bf16 v[172:175], a[44:47], v[96:99], v[172:175]
 ds_read_b64_tr_b16 a[34:35], v238 offset:34816
 v_mfma_f32_16x16x32_bf16 v[172:175], a[40:43], v[92:95], v[172:175]
 v_mfma_f32_16x16x32_bf16 v[172:175], a[36:39], v[88:91], v[172:175]
 s_waitcnt lgkmcnt(10)
 v_mfma_f32_16x16x32_bf16 v[176:179], a[0:3], v[16:19], 0
 ds_read_b64_tr_b16 a[36:37], v239 offset:0
 ds_read_b64_tr_b16 a[38:39], v239 offset:2048
 v_mfma_f32_16x16x32_bf16 v[176:179], a[4:7], v[20:23], v[176:179]
 ds_read_b64_tr_b16 a[40:41], v239 offset:4096
 v_mfma_f32_16x16x32_bf16 v[176:179], a[8:11], v[24:27], v[176:179]
 ds_read_b64_tr_b16 a[42:43], v239 offset:6144
 v_mfma_f32_16x16x32_bf16 v[176:179], a[12:15], v[28:31], v[176:179]
 s_waitcnt lgkmcnt(4)
 ds_read_b64_tr_b16 a[44:45], v239 offset:8192
 v_mfma_f32_16x16x32_bf16 v[176:179], a[16:19], v[32:35], v[176:179]
 ds_read_b64_tr_b16 a[46:47], v239 offset:10240
 v_mfma_f32_16x16x32_bf16 v[176:179], a[20:23], v[36:39], v[176:179]
 ds_read_b64_tr_b16 a[48:49], v239 offset:12288
 v_mfma_f32_16x16x32_bf16 v[176:179], a[24:27], v[40:43], v[176:179]
 ds_read_b64_tr_b16 a[50:51], v239 offset:14336
 v_mfma_f32_16x16x32_bf16 v[176:179], a[28:31], v[44:47], v[176:179]
 ds_read_b64_tr_b16 a[52:53], v239 offset:16384
 v_mfma_f32_16x16x32_bf16 v[176:179], a[32:35], v[48:51], v[176:179]
 ds_read_b64_tr_b16 a[54:55], v239 offset:18432
 ds_read_b64_tr_b16 a[56:57], v239 offset:20480
 v_mfma_f32_16x16x32_bf16 v[180:183], a[32:35], v[120:123], 0
 ds_read_b64_tr_b16 a[58:59], v239 offset:22528
 v_mfma_f32_16x16x32_bf16 v[180:183], a[28:31], v[116:119], v[180:183]
 ds_read_b64_tr_b16 a[60:61], v239 offset:24576
 v_mfma_f32_16x16x32_bf16 v[180:183], a[24:27], v[112:115], v[180:183]
 ds_read_b64_tr_b16 a[62:63], v239 offset:26624
 v_mfma_f32_16x16x32_bf16 v[180:183], a[20:23], v[108:111], v[180:183]
 ds_read_b64_tr_b16 a[64:65], v239 offset:28672
 v_mfma_f32_16x16x32_bf16 v[180:183], a[16:19], v[104:107], v[180:183]
 ds_read_b64_tr_b16 a[66:67], v239 offset:30720
 v_mfma_f32_16x16x32_bf16 v[180:183], a[12:15], v[100:103], v[180:183]
 ds_read_b64_tr_b16 a[68:69], v239 offset:32768
 v_mfma_f32_16x16x32_bf16 v[180:183], a[8:11], v[96:99], v[180:183]
 ds_read_b64_tr_b16 a[70:71], v239 offset:34816
 v_mfma_f32_16x16x32_bf16 v[180:183], a[4:7], v[92:95], v[180:183]
 v_mfma_f32_16x16x32_bf16 v[180:183], a[0:3], v[88:91], v[180:183]
 s_waitcnt vmcnt(22) lgkmcnt(0)
 s_barrier
 v_mfma_f32_16x16x32_bf16 v[184:187], a[36:39], v[16:19], 0
 v_add_u32 v236, 36864, v236
 v_add_u32 v237, 36864, v237
 v_add_u32 v238, 36864, v238
 v_add_u32 v239, 36864, v239
 ds_read_b64_tr_b16 a[0:1], v236 offset:0
 ds_read_b64_tr_b16 a[2:3], v236 offset:2048
 v_mfma_f32_16x16x32_bf16 v[184:187], a[40:43], v[20:23], v[184:187]
 ds_read_b64_tr_b16 a[4:5], v236 offset:4096
 v_mfma_f32_16x16x32_bf16 v[184:187], a[44:47], v[24:27], v[184:187]
 ds_read_b64_tr_b16 a[6:7], v236 offset:6144
 s_add_u32 m0, s58, 0
 s_add_u32 s60, s56, 256
 buffer_load_dwordx4 v224, s[40:43], s60 offen offset:0 lds
 v_mfma_f32_16x16x32_bf16 v[184:187], a[48:51], v[28:31], v[184:187]
 ds_read_b64_tr_b16 a[8:9], v236 offset:8192
 v_mfma_f32_16x16x32_bf16 v[184:187], a[52:55], v[32:35], v[184:187]
 ds_read_b64_tr_b16 a[10:11], v236 offset:10240
 v_mfma_f32_16x16x32_bf16 v[184:187], a[56:59], v[36:39], v[184:187]
 ds_read_b64_tr_b16 a[12:13], v236 offset:12288
 v_mfma_f32_16x16x32_bf16 v[184:187], a[60:63], v[40:43], v[184:187]
 ds_read_b64_tr_b16 a[14:15], v236 offset:14336
 v_mfma_f32_16x16x32_bf16 v[184:187], a[64:67], v[44:47], v[184:187]
 ds_read_b64_tr_b16 a[16:17], v236 offset:16384
 buffer_load_dwordx4 v225, s[40:43], s60 offen offset:1024 lds
 v_mfma_f32_16x16x32_bf16 v[184:187], a[68:71], v[48:51], v[184:187]
 ds_read_b64_tr_b16 a[18:19], v236 offset:18432
 ds_read_b64_tr_b16 a[20:21], v236 offset:20480
 v_mfma_f32_16x16x32_bf16 v[188:191], a[68:71], v[120:123], 0
 ds_read_b64_tr_b16 a[22:23], v236 offset:22528
 v_mfma_f32_16x16x32_bf16 v[188:191], a[64:67], v[116:119], v[188:191]
 ds_read_b64_tr_b16 a[24:25], v236 offset:24576
 v_mfma_f32_16x16x32_bf16 v[188:191], a[60:63], v[112:115], v[188:191]
 ds_read_b64_tr_b16 a[26:27], v236 offset:26624
 v_mfma_f32_16x16x32_bf16 v[188:191], a[56:59], v[108:111], v[188:191]
 ds_read_b64_tr_b16 a[28:29], v236 offset:28672
 v_mfma_f32_16x16x32_bf16 v[188:191], a[52:55], v[104:107], v[188:191]
 ds_read_b64_tr_b16 a[30:31], v236 offset:30720
 buffer_load_dwordx4 v226, s[40:43], s60 offen offset:2048 lds
 v_mfma_f32_16x16x32_bf16 v[188:191], a[48:51], v[100:103], v[188:191]
 ds_read_b64_tr_b16 a[32:33], v236 offset:32768
 v_mfma_f32_16x16x32_bf16 v[188:191], a[44:47], v[96:99], v[188:191]
 ds_read_b64_tr_b16 a[34:35], v236 offset:34816
 v_mfma_f32_16x16x32_bf16 v[188:191], a[40:43], v[92:95], v[188:191]
 v_mfma_f32_16x16x32_bf16 v[188:191], a[36:39], v[88:91], v[188:191]
 s_waitcnt lgkmcnt(10)
 v_mfma_f32_16x16x32_bf16 v[160:163], a[0:3], v[52:55], v[160:163]
 ds_read_b64_tr_b16 a[36:37], v237 offset:0
 ds_read_b64_tr_b16 a[38:39], v237 offset:2048
 v_mfma_f32_16x16x32_bf16 v[160:163], a[4:7], v[56:59], v[160:163]
 ds_read_b64_tr_b16 a[40:41], v237 offset:4096
 buffer_load_dwordx4 v227, s[40:43], s60 offen offset:3072 lds
 v_mfma_f32_16x16x32_bf16 v[160:163], a[8:11], v[60:63], v[160:163]
 ds_read_b64_tr_b16 a[42:43], v237 offset:6144
 v_mfma_f32_16x16x32_bf16 v[160:163], a[12:15], v[64:67], v[160:163]
 s_waitcnt lgkmcnt(4)
 ds_read_b64_tr_b16 a[44:45], v237 offset:8192
 v_mfma_f32_16x16x32_bf16 v[160:163], a[16:19], v[68:71], v[160:163]
 ds_read_b64_tr_b16 a[46:47], v237 offset:10240
 v_mfma_f32_16x16x32_bf16 v[160:163], a[20:23], v[72:75], v[160:163]
 ds_read_b64_tr_b16 a[48:49], v237 offset:12288
 v_mfma_f32_16x16x32_bf16 v[160:163], a[24:27], v[76:79], v[160:163]
 ds_read_b64_tr_b16 a[50:51], v237 offset:14336
 s_add_u32 m0, s58, 4096
 s_add_u32 s60, s56, 295168
 buffer_load_dwordx4 v224, s[40:43], s60 offen offset:0 lds
 v_mfma_f32_16x16x32_bf16 v[160:163], a[28:31], v[80:83], v[160:163]
 ds_read_b64_tr_b16 a[52:53], v237 offset:16384
 v_mfma_f32_16x16x32_bf16 v[160:163], a[32:35], v[84:87], v[160:163]
 ds_read_b64_tr_b16 a[54:55], v237 offset:18432
 ds_read_b64_tr_b16 a[56:57], v237 offset:20480
 v_mfma_f32_16x16x32_bf16 v[164:167], a[32:35], v[156:159], v[164:167]
 ds_read_b64_tr_b16 a[58:59], v237 offset:22528
 v_mfma_f32_16x16x32_bf16 v[164:167], a[28:31], v[152:155], v[164:167]
 ds_read_b64_tr_b16 a[60:61], v237 offset:24576
 v_mfma_f32_16x16x32_bf16 v[164:167], a[24:27], v[148:151], v[164:167]
 ds_read_b64_tr_b16 a[62:63], v237 offset:26624
 v_mul_f32 v246, v242, v160
 v_mul_f32 v247, v242, v161
 v_mul_f32 v248, v242, v162
 v_mfma_f32_16x16x32_bf16 v[164:167], a[20:23], v[144:147], v[164:167]
 ds_read_b64_tr_b16 a[64:65], v237 offset:28672
 buffer_load_dwordx4 v225, s[40:43], s60 offen offset:1024 lds
 v_mul_f32 v249, v242, v163
 v_mfma_f32_16x16x32_bf16 v[164:167], a[16:19], v[140:143], v[164:167]
 ds_read_b64_tr_b16 a[66:67], v237 offset:30720
 v_exp_f32 v246, v246
 v_mfma_f32_16x16x32_bf16 v[164:167], a[12:15], v[136:139], v[164:167]
 ds_read_b64_tr_b16 a[68:69], v237 offset:32768
 v_exp_f32 v247, v247
 v_mfma_f32_16x16x32_bf16 v[164:167], a[8:11], v[132:135], v[164:167]
 ds_read_b64_tr_b16 a[70:71], v237 offset:34816
 v_exp_f32 v248, v248
 v_mfma_f32_16x16x32_bf16 v[164:167], a[4:7], v[128:131], v[164:167]
 v_exp_f32 v249, v249
 v_fma_f32 v246, v246, v244, v244
 v_mfma_f32_16x16x32_bf16 v[164:167], a[0:3], v[124:127], v[164:167]
 s_waitcnt lgkmcnt(10)
 v_fma_f32 v247, v247, v244, v244
 v_fma_f32 v248, v248, v244, v244
 v_mfma_f32_16x16x32_bf16 v[168:171], a[36:39], v[52:55], v[168:171]
 ds_read_b64_tr_b16 a[0:1], v238 offset:0
 ds_read_b64_tr_b16 a[2:3], v238 offset:2048
 buffer_load_dwordx4 v226, s[40:43], s60 offen offset:2048 lds
 v_mfma_f32_16x16x32_bf16 v[168:171], a[40:43], v[56:59], v[168:171]
 ds_read_b64_tr_b16 a[4:5], v238 offset:4096
 v_fma_f32 v249, v249, v244, v244
 v_mfma_f32_16x16x32_bf16 v[168:171], a[44:47], v[60:63], v[168:171]
 ds_read_b64_tr_b16 a[6:7], v238 offset:6144
 v_min_u32 v14, 26, v1
 v_mul_u32_u24 v15, 22, v14
 v_lshrrev_b32 v15, 6, v15
 v_mul_u32_u24 v5, 6, v15
 v_add_u32 v14, v14, v5
 v_mfma_f32_16x16x32_bf16 v[168:171], a[48:51], v[64:67], v[168:171]
 s_waitcnt lgkmcnt(4)
 ds_read_b64_tr_b16 a[8:9], v238 offset:8192
 v_mfma_f32_16x16x32_bf16 v[168:171], a[52:55], v[68:71], v[168:171]
 ds_read_b64_tr_b16 a[10:11], v238 offset:10240
 v_mfma_f32_16x16x32_bf16 v[168:171], a[56:59], v[72:75], v[168:171]
 ds_read_b64_tr_b16 a[12:13], v238 offset:12288
 buffer_load_dwordx4 v227, s[40:43], s60 offen offset:3072 lds
 v_rcp_f32 v246, v246
 v_mfma_f32_16x16x32_bf16 v[168:171], a[60:63], v[76:79], v[168:171]
 ds_read_b64_tr_b16 a[14:15], v238 offset:14336
 v_rcp_f32 v247, v247
 v_mfma_f32_16x16x32_bf16 v[168:171], a[64:67], v[80:83], v[168:171]
 ds_read_b64_tr_b16 a[16:17], v238 offset:16384
 v_rcp_f32 v248, v248
 v_mfma_f32_16x16x32_bf16 v[168:171], a[68:71], v[84:87], v[168:171]
 ds_read_b64_tr_b16 a[18:19], v238 offset:18432
 ds_read_b64_tr_b16 a[20:21], v238 offset:20480
 v_mfma_f32_16x16x32_bf16 v[172:175], a[68:71], v[156:159], v[172:175]
 ds_read_b64_tr_b16 a[22:23], v238 offset:22528
 v_rcp_f32 v249, v249
 v_mul_f32 v160, v160, v246
 v_mfma_f32_16x16x32_bf16 v[172:175], a[64:67], v[152:155], v[172:175]
 ds_read_b64_tr_b16 a[24:25], v238 offset:24576
 v_mul_f32 v161, v161, v247
 v_mul_f32 v162, v162, v248
 v_mfma_f32_16x16x32_bf16 v[172:175], a[60:63], v[148:151], v[172:175]
 ds_read_b64_tr_b16 a[26:27], v238 offset:26624
 s_add_u32 m0, s59, 0
 s_add_u32 s60, s57, 256
 buffer_load_dwordx4 v224, s[40:43], s60 offen lds
 v_mfma_f32_16x16x32_bf16 v[172:175], a[56:59], v[144:147], v[172:175]
 ds_read_b64_tr_b16 a[28:29], v238 offset:28672
 s_add_u32 s67, s26, s22
 s_and_b32 s67, s67, 3
 s_and_b32 s32, s24, 12
 s_add_u32 s67, s67, s32
 s_mul_i32 s67, s67, 81
 s_mul_i32 s32, s26, 9
 s_lshr_b32 s32, s32, 2
 s_add_u32 s67, s67, s32
 v_add_u32 v14, s67, v14
 v_and_b32 v14, 255, v14
 v_lshlrev_b32 v14, 7, v14
 s_mov_b32 s32, 950272
 v_mfma_f32_16x16x32_bf16 v[172:175], a[52:55], v[140:143], v[172:175]
 ds_read_b64_tr_b16 a[30:31], v238 offset:30720
 v_mfma_f32_16x16x32_bf16 v[172:175], a[48:51], v[136:139], v[172:175]
 ds_read_b64_tr_b16 a[32:33], v238 offset:32768
 v_mfma_f32_16x16x32_bf16 v[172:175], a[44:47], v[132:135], v[172:175]
 ds_read_b64_tr_b16 a[34:35], v238 offset:34816
 v_mfma_f32_16x16x32_bf16 v[172:175], a[40:43], v[128:131], v[172:175]
 v_mfma_f32_16x16x32_bf16 v[172:175], a[36:39], v[124:127], v[172:175]
 s_waitcnt lgkmcnt(10)
 v_mfma_f32_16x16x32_bf16 v[176:179], a[0:3], v[52:55], v[176:179]
 ds_read_b64_tr_b16 a[36:37], v239 offset:0
 ds_read_b64_tr_b16 a[38:39], v239 offset:2048
 v_mul_f32 v163, v163, v249
 v_mfma_f32_16x16x32_bf16 v[176:179], a[4:7], v[56:59], v[176:179]
 ds_read_b64_tr_b16 a[40:41], v239 offset:4096
 v_mul_f32 v246, v243, v164
 v_mul_f32 v247, v243, v165
 v_mfma_f32_16x16x32_bf16 v[176:179], a[8:11], v[60:63], v[176:179]
 ds_read_b64_tr_b16 a[42:43], v239 offset:6144
 v_mul_f32 v248, v243, v166
 v_mul_f32 v249, v243, v167
 v_mfma_f32_16x16x32_bf16 v[176:179], a[12:15], v[64:67], v[176:179]
 s_waitcnt lgkmcnt(4)
 ds_read_b64_tr_b16 a[44:45], v239 offset:8192
 v_mfma_f32_16x16x32_bf16 v[176:179], a[16:19], v[68:71], v[176:179]
 ds_read_b64_tr_b16 a[46:47], v239 offset:10240
 v_exp_f32 v246, v246
 v_mfma_f32_16x16x32_bf16 v[176:179], a[20:23], v[72:75], v[176:179]
 ds_read_b64_tr_b16 a[48:49], v239 offset:12288
 v_exp_f32 v247, v247
 v_mfma_f32_16x16x32_bf16 v[176:179], a[24:27], v[76:79], v[176:179]
 ds_read_b64_tr_b16 a[50:51], v239 offset:14336
 v_exp_f32 v248, v248
 v_mfma_f32_16x16x32_bf16 v[176:179], a[28:31], v[80:83], v[176:179]
 ds_read_b64_tr_b16 a[52:53], v239 offset:16384
 v_exp_f32 v249, v249
 v_fma_f32 v246, v246, v245, v245
 v_mfma_f32_16x16x32_bf16 v[176:179], a[32:35], v[84:87], v[176:179]
 ds_read_b64_tr_b16 a[54:55], v239 offset:18432
 ds_read_b64_tr_b16 a[56:57], v239 offset:20480
 v_fma_f32 v247, v247, v245, v245
 v_mfma_f32_16x16x32_bf16 v[180:183], a[32:35], v[156:159], v[180:183]
 ds_read_b64_tr_b16 a[58:59], v239 offset:22528
 v_fma_f32 v248, v248, v245, v245
 v_fma_f32 v249, v249, v245, v245
 v_mfma_f32_16x16x32_bf16 v[180:183], a[28:31], v[152:155], v[180:183]
 ds_read_b64_tr_b16 a[60:61], v239 offset:24576
 v_rcp_f32 v246, v246
 v_mfma_f32_16x16x32_bf16 v[180:183], a[24:27], v[148:151], v[180:183]
 ds_read_b64_tr_b16 a[62:63], v239 offset:26624
 v_rcp_f32 v247, v247
 v_mfma_f32_16x16x32_bf16 v[180:183], a[20:23], v[144:147], v[180:183]
 ds_read_b64_tr_b16 a[64:65], v239 offset:28672
 v_rcp_f32 v248, v248
 v_mfma_f32_16x16x32_bf16 v[180:183], a[16:19], v[140:143], v[180:183]
 ds_read_b64_tr_b16 a[66:67], v239 offset:30720
 v_rcp_f32 v249, v249
 v_mfma_f32_16x16x32_bf16 v[180:183], a[12:15], v[136:139], v[180:183]
 ds_read_b64_tr_b16 a[68:69], v239 offset:32768
 v_mul_f32 v164, v164, v246
 v_mul_f32 v165, v165, v247
 v_mfma_f32_16x16x32_bf16 v[180:183], a[8:11], v[132:135], v[180:183]
 ds_read_b64_tr_b16 a[70:71], v239 offset:34816
 v_mul_f32 v166, v166, v248
 v_mul_f32 v167, v167, v249
 v_mfma_f32_16x16x32_bf16 v[180:183], a[4:7], v[128:131], v[180:183]
 v_mul_f32 v246, v242, v168
 v_mul_f32 v247, v242, v169
 v_mul_f32 v248, v242, v170
 v_mfma_f32_16x16x32_bf16 v[180:183], a[0:3], v[124:127], v[180:183]
 s_waitcnt vmcnt(22) lgkmcnt(0)
 s_barrier
 v_mfma_f32_16x16x32_bf16 v[184:187], a[36:39], v[52:55], v[184:187]
 v_add_u32 v236, 36864, v236
 v_add_u32 v237, 36864, v237
 v_add_u32 v238, 36864, v238
 v_add_u32 v239, 36864, v239
 ds_read_b64_tr_b16 a[0:1], v236 offset:0
 ds_read_b64_tr_b16 a[2:3], v236 offset:2048
 v_mfma_f32_16x16x32_bf16 v[184:187], a[40:43], v[56:59], v[184:187]
 ds_read_b64_tr_b16 a[4:5], v236 offset:4096
 v_mfma_f32_16x16x32_bf16 v[184:187], a[44:47], v[60:63], v[184:187]
 ds_read_b64_tr_b16 a[6:7], v236 offset:6144
 s_add_u32 m0, s58, 36864
 s_add_u32 s60, s56, 2654464
 buffer_load_dwordx4 v224, s[40:43], s60 offen offset:0 lds
 v_mfma_f32_16x16x32_bf16 v[184:187], a[48:51], v[64:67], v[184:187]
 ds_read_b64_tr_b16 a[8:9], v236 offset:8192
 v_mfma_f32_16x16x32_bf16 v[184:187], a[52:55], v[68:71], v[184:187]
 ds_read_b64_tr_b16 a[10:11], v236 offset:10240
 v_mul_f32 v249, v242, v171
 v_mfma_f32_16x16x32_bf16 v[184:187], a[56:59], v[72:75], v[184:187]
 ds_read_b64_tr_b16 a[12:13], v236 offset:12288
 v_exp_f32 v246, v246
 v_mfma_f32_16x16x32_bf16 v[184:187], a[60:63], v[76:79], v[184:187]
 ds_read_b64_tr_b16 a[14:15], v236 offset:14336
 v_exp_f32 v247, v247
 v_mfma_f32_16x16x32_bf16 v[184:187], a[64:67], v[80:83], v[184:187]
 ds_read_b64_tr_b16 a[16:17], v236 offset:16384
 buffer_load_dwordx4 v225, s[40:43], s60 offen offset:1024 lds
 v_exp_f32 v248, v248
 v_mfma_f32_16x16x32_bf16 v[184:187], a[68:71], v[84:87], v[184:187]
 ds_read_b64_tr_b16 a[18:19], v236 offset:18432
 ds_read_b64_tr_b16 a[20:21], v236 offset:20480
 v_mfma_f32_16x16x32_bf16 v[188:191], a[68:71], v[156:159], v[188:191]
 ds_read_b64_tr_b16 a[22:23], v236 offset:22528
 v_exp_f32 v249, v249
 v_fma_f32 v246, v246, v244, v244
 v_mfma_f32_16x16x32_bf16 v[188:191], a[64:67], v[152:155], v[188:191]
 ds_read_b64_tr_b16 a[24:25], v236 offset:24576
 v_fma_f32 v247, v247, v244, v244
 v_fma_f32 v248, v248, v244, v244
 v_mfma_f32_16x16x32_bf16 v[188:191], a[60:63], v[148:151], v[188:191]
 ds_read_b64_tr_b16 a[26:27], v236 offset:26624
 v_fma_f32 v249, v249, v244, v244
 v_mfma_f32_16x16x32_bf16 v[188:191], a[56:59], v[144:147], v[188:191]
 ds_read_b64_tr_b16 a[28:29], v236 offset:28672
 v_rcp_f32 v246, v246
 v_mfma_f32_16x16x32_bf16 v[188:191], a[52:55], v[140:143], v[188:191]
 ds_read_b64_tr_b16 a[30:31], v236 offset:30720
 buffer_load_dwordx4 v226, s[40:43], s60 offen offset:2048 lds
 v_rcp_f32 v247, v247
 v_mfma_f32_16x16x32_bf16 v[188:191], a[48:51], v[136:139], v[188:191]
 ds_read_b64_tr_b16 a[32:33], v236 offset:32768
 v_rcp_f32 v248, v248
 v_mfma_f32_16x16x32_bf16 v[188:191], a[44:47], v[132:135], v[188:191]
 ds_read_b64_tr_b16 a[34:35], v236 offset:34816
 v_rcp_f32 v249, v249
 v_mfma_f32_16x16x32_bf16 v[188:191], a[40:43], v[128:131], v[188:191]
 v_mul_f32 v168, v168, v246
 v_mul_f32 v169, v169, v247
 v_mul_f32 v170, v170, v248
 v_mfma_f32_16x16x32_bf16 v[188:191], a[36:39], v[124:127], v[188:191]
 s_waitcnt lgkmcnt(10)
 v_mul_f32 v171, v171, v249
 v_mul_f32 v246, v243, v172
 v_mfma_f32_16x16x32_bf16 v[192:195], a[0:3], v[16:19], 0
 ds_read_b64_tr_b16 a[36:37], v237 offset:0
 ds_read_b64_tr_b16 a[38:39], v237 offset:2048
 v_mul_f32 v247, v243, v173
 v_mfma_f32_16x16x32_bf16 v[192:195], a[4:7], v[20:23], v[192:195]
 ds_read_b64_tr_b16 a[40:41], v237 offset:4096
 buffer_load_dwordx4 v227, s[40:43], s60 offen offset:3072 lds
 v_mul_f32 v248, v243, v174
 v_mfma_f32_16x16x32_bf16 v[192:195], a[8:11], v[24:27], v[192:195]
 ds_read_b64_tr_b16 a[42:43], v237 offset:6144
 v_mul_f32 v249, v243, v175
 v_mfma_f32_16x16x32_bf16 v[192:195], a[12:15], v[28:31], v[192:195]
 s_waitcnt lgkmcnt(4)
 ds_read_b64_tr_b16 a[44:45], v237 offset:8192
 v_exp_f32 v246, v246
 v_mfma_f32_16x16x32_bf16 v[192:195], a[16:19], v[32:35], v[192:195]
 ds_read_b64_tr_b16 a[46:47], v237 offset:10240
 v_exp_f32 v247, v247
 v_mfma_f32_16x16x32_bf16 v[192:195], a[20:23], v[36:39], v[192:195]
 ds_read_b64_tr_b16 a[48:49], v237 offset:12288
 v_exp_f32 v248, v248
 v_mfma_f32_16x16x32_bf16 v[192:195], a[24:27], v[40:43], v[192:195]
 ds_read_b64_tr_b16 a[50:51], v237 offset:14336
 s_add_u32 m0, s58, 40960
 s_add_u32 s60, s56, 2949376
 buffer_load_dwordx4 v224, s[40:43], s60 offen offset:0 lds
 v_mfma_f32_16x16x32_bf16 v[192:195], a[28:31], v[44:47], v[192:195]
 ds_read_b64_tr_b16 a[52:53], v237 offset:16384
 v_mfma_f32_16x16x32_bf16 v[192:195], a[32:35], v[48:51], v[192:195]
 ds_read_b64_tr_b16 a[54:55], v237 offset:18432
 ds_read_b64_tr_b16 a[56:57], v237 offset:20480
 v_exp_f32 v249, v249
 v_mfma_f32_16x16x32_bf16 v[196:199], a[32:35], v[120:123], 0
 ds_read_b64_tr_b16 a[58:59], v237 offset:22528
 v_fma_f32 v246, v246, v245, v245
 v_fma_f32 v247, v247, v245, v245
 v_mfma_f32_16x16x32_bf16 v[196:199], a[28:31], v[116:119], v[196:199]
 ds_read_b64_tr_b16 a[60:61], v237 offset:24576
 v_fma_f32 v248, v248, v245, v245
 v_fma_f32 v249, v249, v245, v245
 v_mfma_f32_16x16x32_bf16 v[196:199], a[24:27], v[112:115], v[196:199]
 ds_read_b64_tr_b16 a[62:63], v237 offset:26624
 v_rcp_f32 v246, v246
 v_mfma_f32_16x16x32_bf16 v[196:199], a[20:23], v[108:111], v[196:199]
 ds_read_b64_tr_b16 a[64:65], v237 offset:28672
 buffer_load_dwordx4 v225, s[40:43], s60 offen offset:1024 lds
 v_mfma_f32_16x16x32_bf16 v[196:199], a[16:19], v[104:107], v[196:199]
 ds_read_b64_tr_b16 a[66:67], v237 offset:30720
 v_rcp_f32 v247, v247
 v_mfma_f32_16x16x32_bf16 v[196:199], a[12:15], v[100:103], v[196:199]
 ds_read_b64_tr_b16 a[68:69], v237 offset:32768
 v_rcp_f32 v248, v248
 v_mfma_f32_16x16x32_bf16 v[196:199], a[8:11], v[96:99], v[196:199]
 ds_read_b64_tr_b16 a[70:71], v237 offset:34816
 v_rcp_f32 v249, v249
 v_mul_f32 v172, v172, v246
 v_mfma_f32_16x16x32_bf16 v[196:199], a[4:7], v[92:95], v[196:199]
 v_mul_f32 v173, v173, v247
 v_mul_f32 v174, v174, v248
 v_mul_f32 v175, v175, v249
 v_mfma_f32_16x16x32_bf16 v[196:199], a[0:3], v[88:91], v[196:199]
 s_waitcnt lgkmcnt(10)
 v_mul_f32 v246, v242, v176
 v_mul_f32 v247, v242, v177
 v_mfma_f32_16x16x32_bf16 v[200:203], a[36:39], v[16:19], 0
 ds_read_b64_tr_b16 a[0:1], v238 offset:0
 ds_read_b64_tr_b16 a[2:3], v238 offset:2048
 buffer_load_dwordx4 v226, s[40:43], s60 offen offset:2048 lds
 v_mfma_f32_16x16x32_bf16 v[200:203], a[40:43], v[20:23], v[200:203]
 ds_read_b64_tr_b16 a[4:5], v238 offset:4096
 v_mul_f32 v248, v242, v178
 v_mul_f32 v249, v242, v179
 v_mfma_f32_16x16x32_bf16 v[200:203], a[44:47], v[24:27], v[200:203]
 ds_read_b64_tr_b16 a[6:7], v238 offset:6144
 v_exp_f32 v246, v246
 v_mfma_f32_16x16x32_bf16 v[200:203], a[48:51], v[28:31], v[200:203]
 s_waitcnt lgkmcnt(4)
 ds_read_b64_tr_b16 a[8:9], v238 offset:8192
 v_mfma_f32_16x16x32_bf16 v[200:203], a[52:55], v[32:35], v[200:203]
 ds_read_b64_tr_b16 a[10:11], v238 offset:10240
 v_exp_f32 v247, v247
 v_mfma_f32_16x16x32_bf16 v[200:203], a[56:59], v[36:39], v[200:203]
 ds_read_b64_tr_b16 a[12:13], v238 offset:12288
 buffer_load_dwordx4 v227, s[40:43], s60 offen offset:3072 lds
 v_exp_f32 v248, v248
 v_mfma_f32_16x16x32_bf16 v[200:203], a[60:63], v[40:43], v[200:203]
 ds_read_b64_tr_b16 a[14:15], v238 offset:14336
 v_exp_f32 v249, v249
 v_mfma_f32_16x16x32_bf16 v[200:203], a[64:67], v[44:47], v[200:203]
 ds_read_b64_tr_b16 a[16:17], v238 offset:16384
 v_fma_f32 v246, v246, v244, v244
 v_fma_f32 v247, v247, v244, v244
 v_mfma_f32_16x16x32_bf16 v[200:203], a[68:71], v[48:51], v[200:203]
 ds_read_b64_tr_b16 a[18:19], v238 offset:18432
 ds_read_b64_tr_b16 a[20:21], v238 offset:20480
 v_fma_f32 v248, v248, v244, v244
 v_mfma_f32_16x16x32_bf16 v[204:207], a[68:71], v[120:123], 0
 ds_read_b64_tr_b16 a[22:23], v238 offset:22528
 v_fma_f32 v249, v249, v244, v244
 v_mfma_f32_16x16x32_bf16 v[204:207], a[64:67], v[116:119], v[204:207]
 ds_read_b64_tr_b16 a[24:25], v238 offset:24576
 v_rcp_f32 v246, v246
 v_mfma_f32_16x16x32_bf16 v[204:207], a[60:63], v[112:115], v[204:207]
 ds_read_b64_tr_b16 a[26:27], v238 offset:26624
 s_add_u32 m0, s59, 36864
 s_add_u32 s60, s57, 2654464
 buffer_load_dwordx4 v224, s[40:43], s60 offen lds
 v_mfma_f32_16x16x32_bf16 v[204:207], a[56:59], v[108:111], v[204:207]
 ds_read_b64_tr_b16 a[28:29], v238 offset:28672
 v_rcp_f32 v247, v247
 v_mfma_f32_16x16x32_bf16 v[204:207], a[52:55], v[104:107], v[204:207]
 ds_read_b64_tr_b16 a[30:31], v238 offset:30720
 v_rcp_f32 v248, v248
 v_mfma_f32_16x16x32_bf16 v[204:207], a[48:51], v[100:103], v[204:207]
 ds_read_b64_tr_b16 a[32:33], v238 offset:32768
 v_rcp_f32 v249, v249
 v_mfma_f32_16x16x32_bf16 v[204:207], a[44:47], v[96:99], v[204:207]
 ds_read_b64_tr_b16 a[34:35], v238 offset:34816
 v_mul_f32 v176, v176, v246
 v_mul_f32 v177, v177, v247
 v_mfma_f32_16x16x32_bf16 v[204:207], a[40:43], v[92:95], v[204:207]
 v_mul_f32 v178, v178, v248
 v_mul_f32 v179, v179, v249
 v_mul_f32 v246, v243, v180
 v_mfma_f32_16x16x32_bf16 v[204:207], a[36:39], v[88:91], v[204:207]
 s_waitcnt lgkmcnt(10)
 v_mul_f32 v247, v243, v181
 v_mul_f32 v248, v243, v182
 v_mfma_f32_16x16x32_bf16 v[208:211], a[0:3], v[16:19], 0
 ds_read_b64_tr_b16 a[36:37], v239 offset:0
 ds_read_b64_tr_b16 a[38:39], v239 offset:2048
 v_mul_f32 v249, v243, v183
 v_mfma_f32_16x16x32_bf16 v[208:211], a[4:7], v[20:23], v[208:211]
 ds_read_b64_tr_b16 a[40:41], v239 offset:4096
 v_exp_f32 v246, v246
 v_mfma_f32_16x16x32_bf16 v[208:211], a[8:11], v[24:27], v[208:211]
 ds_read_b64_tr_b16 a[42:43], v239 offset:6144
 v_exp_f32 v247, v247
 v_mfma_f32_16x16x32_bf16 v[208:211], a[12:15], v[28:31], v[208:211]
 s_waitcnt lgkmcnt(4)
 ds_read_b64_tr_b16 a[44:45], v239 offset:8192
 v_mfma_f32_16x16x32_bf16 v[208:211], a[16:19], v[32:35], v[208:211]
 ds_read_b64_tr_b16 a[46:47], v239 offset:10240
 v_exp_f32 v248, v248
 v_mfma_f32_16x16x32_bf16 v[208:211], a[20:23], v[36:39], v[208:211]
 ds_read_b64_tr_b16 a[48:49], v239 offset:12288
 v_exp_f32 v249, v249
 v_fma_f32 v246, v246, v245, v245
 v_mfma_f32_16x16x32_bf16 v[208:211], a[24:27], v[40:43], v[208:211]
 ds_read_b64_tr_b16 a[50:51], v239 offset:14336
 v_fma_f32 v247, v247, v245, v245
 v_fma_f32 v248, v248, v245, v245
 v_mfma_f32_16x16x32_bf16 v[208:211], a[28:31], v[44:47], v[208:211]
 ds_read_b64_tr_b16 a[52:53], v239 offset:16384
 v_fma_f32 v249, v249, v245, v245
 v_mfma_f32_16x16x32_bf16 v[208:211], a[32:35], v[48:51], v[208:211]
 ds_read_b64_tr_b16 a[54:55], v239 offset:18432
 ds_read_b64_tr_b16 a[56:57], v239 offset:20480
 v_rcp_f32 v246, v246
 v_mfma_f32_16x16x32_bf16 v[212:215], a[32:35], v[120:123], 0
 ds_read_b64_tr_b16 a[58:59], v239 offset:22528
 v_rcp_f32 v247, v247
 v_mfma_f32_16x16x32_bf16 v[212:215], a[28:31], v[116:119], v[212:215]
 ds_read_b64_tr_b16 a[60:61], v239 offset:24576
 v_rcp_f32 v248, v248
 v_mfma_f32_16x16x32_bf16 v[212:215], a[24:27], v[112:115], v[212:215]
 ds_read_b64_tr_b16 a[62:63], v239 offset:26624
 v_rcp_f32 v249, v249
 v_mfma_f32_16x16x32_bf16 v[212:215], a[20:23], v[108:111], v[212:215]
 ds_read_b64_tr_b16 a[64:65], v239 offset:28672
 v_mul_f32 v180, v180, v246
 v_mul_f32 v181, v181, v247
 v_mfma_f32_16x16x32_bf16 v[212:215], a[16:19], v[104:107], v[212:215]
 ds_read_b64_tr_b16 a[66:67], v239 offset:30720
 v_mul_f32 v182, v182, v248
 v_mul_f32 v183, v183, v249
 v_mfma_f32_16x16x32_bf16 v[212:215], a[12:15], v[100:103], v[212:215]
 ds_read_b64_tr_b16 a[68:69], v239 offset:32768
 v_mul_f32 v246, v242, v184
 v_mul_f32 v247, v242, v185
 v_mfma_f32_16x16x32_bf16 v[212:215], a[8:11], v[96:99], v[212:215]
 ds_read_b64_tr_b16 a[70:71], v239 offset:34816
 v_mul_f32 v248, v242, v186
 v_mul_f32 v249, v242, v187
 v_mfma_f32_16x16x32_bf16 v[212:215], a[4:7], v[92:95], v[212:215]
 v_exp_f32 v246, v246
 v_mfma_f32_16x16x32_bf16 v[212:215], a[0:3], v[88:91], v[212:215]
 s_waitcnt vmcnt(18) lgkmcnt(0)
 s_barrier
 v_mfma_f32_16x16x32_bf16 v[216:219], a[36:39], v[16:19], 0
 v_add_u32 v236, 36864, v236
 v_add_u32 v237, 36864, v237
 v_add_u32 v238, 36864, v238
 v_add_u32 v239, 36864, v239
 ds_read_b64_tr_b16 a[0:1], v236 offset:0
 ds_read_b64_tr_b16 a[2:3], v236 offset:2048
 v_mfma_f32_16x16x32_bf16 v[216:219], a[40:43], v[20:23], v[216:219]
 ds_read_b64_tr_b16 a[4:5], v236 offset:4096
 v_mfma_f32_16x16x32_bf16 v[216:219], a[44:47], v[24:27], v[216:219]
 ds_read_b64_tr_b16 a[6:7], v236 offset:6144
 s_add_u32 m0, s58, 73728
 s_add_u32 s60, s56, 256
 buffer_load_dwordx4 v224, s[44:47], s60 offen offset:0 lds
 s_branch L_c3_p5_s
L_c3_p5:
 s_branch L_c3_ret
L_c3_p5_s:
 v_mfma_f32_16x16x32_bf16 v[216:219], a[48:51], v[28:31], v[216:219]
 ds_read_b64_tr_b16 a[8:9], v236 offset:8192
 v_mfma_f32_16x16x32_bf16 v[216:219], a[52:55], v[32:35], v[216:219]
 ds_read_b64_tr_b16 a[10:11], v236 offset:10240
 v_exp_f32 v247, v247
 v_mfma_f32_16x16x32_bf16 v[216:219], a[56:59], v[36:39], v[216:219]
 ds_read_b64_tr_b16 a[12:13], v236 offset:12288
 v_exp_f32 v248, v248
 v_mfma_f32_16x16x32_bf16 v[216:219], a[60:63], v[40:43], v[216:219]
 ds_read_b64_tr_b16 a[14:15], v236 offset:14336
 v_exp_f32 v249, v249
 v_fma_f32 v246, v246, v244, v244
 v_mfma_f32_16x16x32_bf16 v[216:219], a[64:67], v[44:47], v[216:219]
 ds_read_b64_tr_b16 a[16:17], v236 offset:16384
 buffer_load_dwordx4 v225, s[44:47], s60 offen offset:1024 lds
 v_fma_f32 v247, v247, v244, v244
 v_mfma_f32_16x16x32_bf16 v[216:219], a[68:71], v[48:51], v[216:219]
 ds_read_b64_tr_b16 a[18:19], v236 offset:18432
 ds_read_b64_tr_b16 a[20:21], v236 offset:20480
 v_fma_f32 v248, v248, v244, v244
 v_mfma_f32_16x16x32_bf16 v[220:223], a[68:71], v[120:123], 0
 ds_read_b64_tr_b16 a[22:23], v236 offset:22528
 v_fma_f32 v249, v249, v244, v244
 v_mfma_f32_16x16x32_bf16 v[220:223], a[64:67], v[116:119], v[220:223]
 ds_read_b64_tr_b16 a[24:25], v236 offset:24576
 v_rcp_f32 v246, v246
 v_mfma_f32_16x16x32_bf16 v[220:223], a[60:63], v[112:115], v[220:223]
 ds_read_b64_tr_b16 a[26:27], v236 offset:26624
 v_rcp_f32 v247, v247
 v_mfma_f32_16x16x32_bf16 v[220:223], a[56:59], v[108:111], v[220:223]
 ds_read_b64_tr_b16 a[28:29], v236 offset:28672
 v_rcp_f32 v248, v248
 v_mfma_f32_16x16x32_bf16 v[220:223], a[52:55], v[104:107], v[220:223]
 ds_read_b64_tr_b16 a[30:31], v236 offset:30720
 buffer_load_dwordx4 v226, s[44:47], s60 offen offset:2048 lds
 v_rcp_f32 v249, v249
 v_mfma_f32_16x16x32_bf16 v[220:223], a[48:51], v[100:103], v[220:223]
 ds_read_b64_tr_b16 a[32:33], v236 offset:32768
 v_mul_f32 v184, v184, v246
 v_mul_f32 v185, v185, v247
 v_mfma_f32_16x16x32_bf16 v[220:223], a[44:47], v[96:99], v[220:223]
 ds_read_b64_tr_b16 a[34:35], v236 offset:34816
 v_mul_f32 v186, v186, v248
 v_mul_f32 v187, v187, v249
 v_mfma_f32_16x16x32_bf16 v[220:223], a[40:43], v[92:95], v[220:223]
 v_mul_f32 v246, v243, v188
 v_mul_f32 v247, v243, v189
 v_mul_f32 v248, v243, v190
 v_mfma_f32_16x16x32_bf16 v[220:223], a[36:39], v[88:91], v[220:223]
 s_waitcnt lgkmcnt(10)
 v_mul_f32 v249, v243, v191
 v_mfma_f32_16x16x32_bf16 v[192:195], a[0:3], v[52:55], v[192:195]
 ds_read_b64_tr_b16 a[36:37], v237 offset:0
 ds_read_b64_tr_b16 a[38:39], v237 offset:2048
 v_exp_f32 v246, v246
 v_mfma_f32_16x16x32_bf16 v[192:195], a[4:7], v[56:59], v[192:195]
 ds_read_b64_tr_b16 a[40:41], v237 offset:4096
 buffer_load_dwordx4 v227, s[44:47], s60 offen offset:3072 lds
 v_mfma_f32_16x16x32_bf16 v[192:195], a[8:11], v[60:63], v[192:195]
 ds_read_b64_tr_b16 a[42:43], v237 offset:6144
 v_exp_f32 v247, v247
 v_mfma_f32_16x16x32_bf16 v[192:195], a[12:15], v[64:67], v[192:195]
 s_waitcnt lgkmcnt(4)
 ds_read_b64_tr_b16 a[44:45], v237 offset:8192
 v_exp_f32 v248, v248
 v_mfma_f32_16x16x32_bf16 v[192:195], a[16:19], v[68:71], v[192:195]
 ds_read_b64_tr_b16 a[46:47], v237 offset:10240
 v_exp_f32 v249, v249
 v_mfma_f32_16x16x32_bf16 v[192:195], a[20:23], v[72:75], v[192:195]
 ds_read_b64_tr_b16 a[48:49], v237 offset:12288
 v_fma_f32 v246, v246, v245, v245
 v_fma_f32 v247, v247, v245, v245
 v_mfma_f32_16x16x32_bf16 v[192:195], a[24:27], v[76:79], v[192:195]
 ds_read_b64_tr_b16 a[50:51], v237 offset:14336
 s_add_u32 m0, s58, 77824
 s_add_u32 s60, s56, 295168
 buffer_load_dwordx4 v224, s[44:47], s60 offen offset:0 lds
 v_mfma_f32_16x16x32_bf16 v[192:195], a[28:31], v[80:83], v[192:195]
 ds_read_b64_tr_b16 a[52:53], v237 offset:16384
 v_fma_f32 v248, v248, v245, v245
 v_mfma_f32_16x16x32_bf16 v[192:195], a[32:35], v[84:87], v[192:195]
 ds_read_b64_tr_b16 a[54:55], v237 offset:18432
 ds_read_b64_tr_b16 a[56:57], v237 offset:20480
 v_fma_f32 v249, v249, v245, v245
 v_mfma_f32_16x16x32_bf16 v[196:199], a[32:35], v[156:159], v[196:199]
 ds_read_b64_tr_b16 a[58:59], v237 offset:22528
 v_rcp_f32 v246, v246
 v_mfma_f32_16x16x32_bf16 v[196:199], a[28:31], v[152:155], v[196:199]
 ds_read_b64_tr_b16 a[60:61], v237 offset:24576
 v_rcp_f32 v247, v247
 v_mfma_f32_16x16x32_bf16 v[196:199], a[24:27], v[148:151], v[196:199]
 ds_read_b64_tr_b16 a[62:63], v237 offset:26624
 v_rcp_f32 v248, v248
 v_mfma_f32_16x16x32_bf16 v[196:199], a[20:23], v[144:147], v[196:199]
 ds_read_b64_tr_b16 a[64:65], v237 offset:28672
 buffer_load_dwordx4 v225, s[44:47], s60 offen offset:1024 lds
 v_mfma_f32_16x16x32_bf16 v[196:199], a[16:19], v[140:143], v[196:199]
 ds_read_b64_tr_b16 a[66:67], v237 offset:30720
 v_rcp_f32 v249, v249
 v_mul_f32 v188, v188, v246
 v_mfma_f32_16x16x32_bf16 v[196:199], a[12:15], v[136:139], v[196:199]
 ds_read_b64_tr_b16 a[68:69], v237 offset:32768
 v_mul_f32 v189, v189, v247
 v_mul_f32 v190, v190, v248
 v_mfma_f32_16x16x32_bf16 v[196:199], a[8:11], v[132:135], v[196:199]
 ds_read_b64_tr_b16 a[70:71], v237 offset:34816
 v_mul_f32 v191, v191, v249
 v_mul_f32 v192, v192, v160
 v_mfma_f32_16x16x32_bf16 v[196:199], a[4:7], v[128:131], v[196:199]
 v_mul_f32 v193, v193, v161
 v_mul_f32 v194, v194, v162
 v_mul_f32 v195, v195, v163
 v_mfma_f32_16x16x32_bf16 v[196:199], a[0:3], v[124:127], v[196:199]
 s_waitcnt lgkmcnt(10)
 v_cvt_pk_bf16_f32 v192, v192, v193
 v_cvt_pk_bf16_f32 v193, v194, v195
 v_mfma_f32_16x16x32_bf16 v[200:203], a[36:39], v[52:55], v[200:203]
 ds_read_b64_tr_b16 a[0:1], v238 offset:0
 ds_read_b64_tr_b16 a[2:3], v238 offset:2048
 buffer_load_dwordx4 v226, s[44:47], s60 offen offset:2048 lds
 v_mfma_f32_16x16x32_bf16 v[200:203], a[40:43], v[56:59], v[200:203]
 ds_read_b64_tr_b16 a[4:5], v238 offset:4096
 v_accvgpr_write_b32 a160, v192
 v_accvgpr_write_b32 a161, v193
 v_mfma_f32_16x16x32_bf16 v[200:203], a[44:47], v[60:63], v[200:203]
 ds_read_b64_tr_b16 a[6:7], v238 offset:6144
 v_mul_f32 v196, v196, v164
 v_mul_f32 v197, v197, v165
 v_mfma_f32_16x16x32_bf16 v[200:203], a[48:51], v[64:67], v[200:203]
 s_waitcnt lgkmcnt(4)
 ds_read_b64_tr_b16 a[8:9], v238 offset:8192
 v_mul_f32 v198, v198, v166
 v_mfma_f32_16x16x32_bf16 v[200:203], a[52:55], v[68:71], v[200:203]
 ds_read_b64_tr_b16 a[10:11], v238 offset:10240
 v_mul_f32 v199, v199, v167
 v_cvt_pk_bf16_f32 v196, v196, v197
 v_mfma_f32_16x16x32_bf16 v[200:203], a[56:59], v[72:75], v[200:203]
 ds_read_b64_tr_b16 a[12:13], v238 offset:12288
 buffer_load_dwordx4 v227, s[44:47], s60 offen offset:3072 lds
 v_cvt_pk_bf16_f32 v197, v198, v199
 v_mfma_f32_16x16x32_bf16 v[200:203], a[60:63], v[76:79], v[200:203]
 ds_read_b64_tr_b16 a[14:15], v238 offset:14336
 v_accvgpr_write_b32 a164, v196
 v_accvgpr_write_b32 a165, v197
 v_mfma_f32_16x16x32_bf16 v[200:203], a[64:67], v[80:83], v[200:203]
 ds_read_b64_tr_b16 a[16:17], v238 offset:16384
 v_mfma_f32_16x16x32_bf16 v[200:203], a[68:71], v[84:87], v[200:203]
 ds_read_b64_tr_b16 a[18:19], v238 offset:18432
 ds_read_b64_tr_b16 a[20:21], v238 offset:20480
 v_mfma_f32_16x16x32_bf16 v[204:207], a[68:71], v[156:159], v[204:207]
 ds_read_b64_tr_b16 a[22:23], v238 offset:22528
 v_mfma_f32_16x16x32_bf16 v[204:207], a[64:67], v[152:155], v[204:207]
 ds_read_b64_tr_b16 a[24:25], v238 offset:24576
 v_mfma_f32_16x16x32_bf16 v[204:207], a[60:63], v[148:151], v[204:207]
 ds_read_b64_tr_b16 a[26:27], v238 offset:26624
 s_add_u32 m0, s59, 73728
 s_add_u32 s60, s57, 256
 buffer_load_dwordx4 v224, s[44:47], s60 offen lds
 v_mul_f32 v200, v200, v168
 v_mul_f32 v201, v201, v169
 v_mfma_f32_16x16x32_bf16 v[204:207], a[56:59], v[144:147], v[204:207]
 ds_read_b64_tr_b16 a[28:29], v238 offset:28672
 v_mul_f32 v202, v202, v170
 v_mul_f32 v203, v203, v171
 v_mfma_f32_16x16x32_bf16 v[204:207], a[52:55], v[140:143], v[204:207]
 ds_read_b64_tr_b16 a[30:31], v238 offset:30720
 v_cvt_pk_bf16_f32 v194, v200, v201
 v_cvt_pk_bf16_f32 v195, v202, v203
 v_mfma_f32_16x16x32_bf16 v[204:207], a[48:51], v[136:139], v[204:207]
 ds_read_b64_tr_b16 a[32:33], v238 offset:32768
 v_accvgpr_write_b32 a162, v194
 v_accvgpr_write_b32 a163, v195
 v_mfma_f32_16x16x32_bf16 v[204:207], a[44:47], v[132:135], v[204:207]
 ds_read_b64_tr_b16 a[34:35], v238 offset:34816
 s_add_u32 s67, s66, 4096
 buffer_store_dwordx4 v[192:195], v9, s[8:11], s67 offen sc1
 v_mfma_f32_16x16x32_bf16 v[204:207], a[40:43], v[128:131], v[204:207]
 v_mfma_f32_16x16x32_bf16 v[204:207], a[36:39], v[124:127], v[204:207]
 s_waitcnt lgkmcnt(10)
 v_mfma_f32_16x16x32_bf16 v[208:211], a[0:3], v[52:55], v[208:211]
 ds_read_b64_tr_b16 a[36:37], v239 offset:0
 ds_read_b64_tr_b16 a[38:39], v239 offset:2048
 v_mfma_f32_16x16x32_bf16 v[208:211], a[4:7], v[56:59], v[208:211]
 ds_read_b64_tr_b16 a[40:41], v239 offset:4096
 v_mfma_f32_16x16x32_bf16 v[208:211], a[8:11], v[60:63], v[208:211]
 ds_read_b64_tr_b16 a[42:43], v239 offset:6144
 v_mul_f32 v204, v204, v172
 v_mul_f32 v205, v205, v173
 v_mul_f32 v206, v206, v174
 v_mfma_f32_16x16x32_bf16 v[208:211], a[12:15], v[64:67], v[208:211]
 s_waitcnt lgkmcnt(4)
 ds_read_b64_tr_b16 a[44:45], v239 offset:8192
 v_mul_f32 v207, v207, v175
 v_mfma_f32_16x16x32_bf16 v[208:211], a[16:19], v[68:71], v[208:211]
 ds_read_b64_tr_b16 a[46:47], v239 offset:10240
 v_cvt_pk_bf16_f32 v198, v204, v205
 v_cvt_pk_bf16_f32 v199, v206, v207
 v_mfma_f32_16x16x32_bf16 v[208:211], a[20:23], v[72:75], v[208:211]
 ds_read_b64_tr_b16 a[48:49], v239 offset:12288
 v_accvgpr_write_b32 a166, v198
 v_accvgpr_write_b32 a167, v199
 v_mfma_f32_16x16x32_bf16 v[208:211], a[24:27], v[76:79], v[208:211]
 ds_read_b64_tr_b16 a[50:51], v239 offset:14336
 s_add_u32 s67, s66, 5120
 buffer_store_dwordx4 v[196:199], v9, s[8:11], s67 offen sc1
 v_mfma_f32_16x16x32_bf16 v[208:211], a[28:31], v[80:83], v[208:211]
 ds_read_b64_tr_b16 a[52:53], v239 offset:16384
 v_mfma_f32_16x16x32_bf16 v[208:211], a[32:35], v[84:87], v[208:211]
 ds_read_b64_tr_b16 a[54:55], v239 offset:18432
 ds_read_b64_tr_b16 a[56:57], v239 offset:20480
 v_mfma_f32_16x16x32_bf16 v[212:215], a[32:35], v[156:159], v[212:215]
 ds_read_b64_tr_b16 a[58:59], v239 offset:22528
 v_mfma_f32_16x16x32_bf16 v[212:215], a[28:31], v[152:155], v[212:215]
 ds_read_b64_tr_b16 a[60:61], v239 offset:24576
 v_mfma_f32_16x16x32_bf16 v[212:215], a[24:27], v[148:151], v[212:215]
 ds_read_b64_tr_b16 a[62:63], v239 offset:26624
 v_mul_f32 v208, v208, v176
 v_mul_f32 v209, v209, v177
 v_mul_f32 v210, v210, v178
 v_mfma_f32_16x16x32_bf16 v[212:215], a[20:23], v[144:147], v[212:215]
 ds_read_b64_tr_b16 a[64:65], v239 offset:28672
 v_mul_f32 v211, v211, v179
 v_cvt_pk_bf16_f32 v208, v208, v209
 v_mfma_f32_16x16x32_bf16 v[212:215], a[16:19], v[140:143], v[212:215]
 ds_read_b64_tr_b16 a[66:67], v239 offset:30720
 v_cvt_pk_bf16_f32 v209, v210, v211
 v_accvgpr_write_b32 a168, v208
 v_mfma_f32_16x16x32_bf16 v[212:215], a[12:15], v[136:139], v[212:215]
 ds_read_b64_tr_b16 a[68:69], v239 offset:32768
 v_accvgpr_write_b32 a169, v209
 v_mfma_f32_16x16x32_bf16 v[212:215], a[8:11], v[132:135], v[212:215]
 ds_read_b64_tr_b16 a[70:71], v239 offset:34816
 v_mfma_f32_16x16x32_bf16 v[212:215], a[4:7], v[128:131], v[212:215]
 v_mfma_f32_16x16x32_bf16 v[212:215], a[0:3], v[124:127], v[212:215]
 s_waitcnt vmcnt(20) lgkmcnt(0)
 s_barrier
 v_mfma_f32_16x16x32_bf16 v[216:219], a[36:39], v[52:55], v[216:219]
 v_subrev_u32 v236, 110592, v236
 v_subrev_u32 v237, 110592, v237
 v_subrev_u32 v238, 110592, v238
 v_subrev_u32 v239, 110592, v239
 ds_read_b64_tr_b16 a[0:1], v236 offset:0
 ds_read_b64_tr_b16 a[2:3], v236 offset:2048
 v_mfma_f32_16x16x32_bf16 v[216:219], a[40:43], v[56:59], v[216:219]
 ds_read_b64_tr_b16 a[4:5], v236 offset:4096
 v_mfma_f32_16x16x32_bf16 v[216:219], a[44:47], v[60:63], v[216:219]
 ds_read_b64_tr_b16 a[6:7], v236 offset:6144
 s_add_u32 m0, s58, 110592
 s_add_u32 s60, s56, 2654464
 buffer_load_dwordx4 v224, s[44:47], s60 offen offset:0 lds
 v_mul_f32 v212, v212, v180
 v_mfma_f32_16x16x32_bf16 v[216:219], a[48:51], v[64:67], v[216:219]
 ds_read_b64_tr_b16 a[8:9], v236 offset:8192
 v_mul_f32 v213, v213, v181
 v_mul_f32 v214, v214, v182
 v_mfma_f32_16x16x32_bf16 v[216:219], a[52:55], v[68:71], v[216:219]
 ds_read_b64_tr_b16 a[10:11], v236 offset:10240
 v_mul_f32 v215, v215, v183
 v_cvt_pk_bf16_f32 v212, v212, v213
 v_mfma_f32_16x16x32_bf16 v[216:219], a[56:59], v[72:75], v[216:219]
 ds_read_b64_tr_b16 a[12:13], v236 offset:12288
 v_cvt_pk_bf16_f32 v213, v214, v215
 v_accvgpr_write_b32 a172, v212
 v_mfma_f32_16x16x32_bf16 v[216:219], a[60:63], v[76:79], v[216:219]
 ds_read_b64_tr_b16 a[14:15], v236 offset:14336
 v_accvgpr_write_b32 a173, v213
 v_mfma_f32_16x16x32_bf16 v[216:219], a[64:67], v[80:83], v[216:219]
 ds_read_b64_tr_b16 a[16:17], v236 offset:16384
 buffer_load_dwordx4 v225, s[44:47], s60 offen offset:1024 lds
 v_mfma_f32_16x16x32_bf16 v[216:219], a[68:71], v[84:87], v[216:219]
 ds_read_b64_tr_b16 a[18:19], v236 offset:18432
 ds_read_b64_tr_b16 a[20:21], v236 offset:20480
 v_mfma_f32_16x16x32_bf16 v[220:223], a[68:71], v[156:159], v[220:223]
 ds_read_b64_tr_b16 a[22:23], v236 offset:22528
 v_mfma_f32_16x16x32_bf16 v[220:223], a[64:67], v[152:155], v[220:223]
 ds_read_b64_tr_b16 a[24:25], v236 offset:24576
 v_mfma_f32_16x16x32_bf16 v[220:223], a[60:63], v[148:151], v[220:223]
 ds_read_b64_tr_b16 a[26:27], v236 offset:26624
 v_mul_f32 v216, v216, v184
 v_mul_f32 v217, v217, v185
 v_mul_f32 v218, v218, v186
 v_mfma_f32_16x16x32_bf16 v[220:223], a[56:59], v[144:147], v[220:223]
 ds_read_b64_tr_b16 a[28:29], v236 offset:28672
 v_mul_f32 v219, v219, v187
 v_cvt_pk_bf16_f32 v210, v216, v217
 v_mfma_f32_16x16x32_bf16 v[220:223], a[52:55], v[140:143], v[220:223]
 ds_read_b64_tr_b16 a[30:31], v236 offset:30720
 buffer_load_dwordx4 v226, s[44:47], s60 offen offset:2048 lds
 v_cvt_pk_bf16_f32 v211, v218, v219
 v_mfma_f32_16x16x32_bf16 v[220:223], a[48:51], v[136:139], v[220:223]
 ds_read_b64_tr_b16 a[32:33], v236 offset:32768
 v_accvgpr_write_b32 a170, v210
 v_accvgpr_write_b32 a171, v211
 v_mfma_f32_16x16x32_bf16 v[220:223], a[44:47], v[132:135], v[220:223]
 ds_read_b64_tr_b16 a[34:35], v236 offset:34816
 s_add_u32 s67, s66, 6144
 buffer_store_dwordx4 v[208:211], v9, s[8:11], s67 offen sc1
 v_mfma_f32_16x16x32_bf16 v[220:223], a[40:43], v[128:131], v[220:223]
 v_mfma_f32_16x16x32_bf16 v[220:223], a[36:39], v[124:127], v[220:223]
 s_waitcnt lgkmcnt(10)
 v_mfma_f32_16x16x32_bf16 v[160:163], a[0:3], v[16:19], 0
 ds_read_b64_tr_b16 a[36:37], v237 offset:0
 ds_read_b64_tr_b16 a[38:39], v237 offset:2048
 v_mfma_f32_16x16x32_bf16 v[160:163], a[4:7], v[20:23], v[160:163]
 ds_read_b64_tr_b16 a[40:41], v237 offset:4096
 buffer_load_dwordx4 v227, s[44:47], s60 offen offset:3072 lds
 v_mfma_f32_16x16x32_bf16 v[160:163], a[8:11], v[24:27], v[160:163]
 ds_read_b64_tr_b16 a[42:43], v237 offset:6144
 v_mul_f32 v220, v220, v188
 v_mul_f32 v221, v221, v189
 v_mul_f32 v222, v222, v190
 v_mfma_f32_16x16x32_bf16 v[160:163], a[12:15], v[28:31], v[160:163]
 s_waitcnt lgkmcnt(4)
 ds_read_b64_tr_b16 a[44:45], v237 offset:8192
 v_mul_f32 v223, v223, v191
 v_mfma_f32_16x16x32_bf16 v[160:163], a[16:19], v[32:35], v[160:163]
 ds_read_b64_tr_b16 a[46:47], v237 offset:10240
 v_cvt_pk_bf16_f32 v214, v220, v221
 v_cvt_pk_bf16_f32 v215, v222, v223
 v_mfma_f32_16x16x32_bf16 v[160:163], a[20:23], v[36:39], v[160:163]
 ds_read_b64_tr_b16 a[48:49], v237 offset:12288
 v_accvgpr_write_b32 a174, v214
 v_accvgpr_write_b32 a175, v215
 v_mfma_f32_16x16x32_bf16 v[160:163], a[24:27], v[40:43], v[160:163]
 ds_read_b64_tr_b16 a[50:51], v237 offset:14336
 s_add_u32 m0, s58, 114688
 s_add_u32 s60, s56, 2949376
 buffer_load_dwordx4 v224, s[44:47], s60 offen offset:0 lds
 v_mfma_f32_16x16x32_bf16 v[160:163], a[28:31], v[44:47], v[160:163]
 ds_read_b64_tr_b16 a[52:53], v237 offset:16384
 v_mfma_f32_16x16x32_bf16 v[160:163], a[32:35], v[48:51], v[160:163]
 ds_read_b64_tr_b16 a[54:55], v237 offset:18432
 ds_read_b64_tr_b16 a[56:57], v237 offset:20480
 s_add_u32 s67, s66, 7168
 buffer_store_dwordx4 v[212:215], v9, s[8:11], s67 offen sc1
 v_mfma_f32_16x16x32_bf16 v[164:167], a[32:35], v[120:123], 0
 ds_read_b64_tr_b16 a[58:59], v237 offset:22528
 v_mfma_f32_16x16x32_bf16 v[164:167], a[28:31], v[116:119], v[164:167]
 ds_read_b64_tr_b16 a[60:61], v237 offset:24576
 v_mfma_f32_16x16x32_bf16 v[164:167], a[24:27], v[112:115], v[164:167]
 ds_read_b64_tr_b16 a[62:63], v237 offset:26624
 v_mfma_f32_16x16x32_bf16 v[164:167], a[20:23], v[108:111], v[164:167]
 ds_read_b64_tr_b16 a[64:65], v237 offset:28672
 buffer_load_dwordx4 v225, s[44:47], s60 offen offset:1024 lds
 v_mfma_f32_16x16x32_bf16 v[164:167], a[16:19], v[104:107], v[164:167]
 ds_read_b64_tr_b16 a[66:67], v237 offset:30720
 v_mfma_f32_16x16x32_bf16 v[164:167], a[12:15], v[100:103], v[164:167]
 ds_read_b64_tr_b16 a[68:69], v237 offset:32768
 v_mfma_f32_16x16x32_bf16 v[164:167], a[8:11], v[96:99], v[164:167]
 ds_read_b64_tr_b16 a[70:71], v237 offset:34816
 v_mfma_f32_16x16x32_bf16 v[164:167], a[4:7], v[92:95], v[164:167]
 v_mfma_f32_16x16x32_bf16 v[164:167], a[0:3], v[88:91], v[164:167]
 s_waitcnt lgkmcnt(10)
 v_mfma_f32_16x16x32_bf16 v[168:171], a[36:39], v[16:19], 0
 ds_read_b64_tr_b16 a[0:1], v238 offset:0
 ds_read_b64_tr_b16 a[2:3], v238 offset:2048
 buffer_load_dwordx4 v226, s[44:47], s60 offen offset:2048 lds
 v_mfma_f32_16x16x32_bf16 v[168:171], a[40:43], v[20:23], v[168:171]
 ds_read_b64_tr_b16 a[4:5], v238 offset:4096
 v_mfma_f32_16x16x32_bf16 v[168:171], a[44:47], v[24:27], v[168:171]
 ds_read_b64_tr_b16 a[6:7], v238 offset:6144
 v_mfma_f32_16x16x32_bf16 v[168:171], a[48:51], v[28:31], v[168:171]
 s_waitcnt lgkmcnt(4)
 ds_read_b64_tr_b16 a[8:9], v238 offset:8192
 v_mfma_f32_16x16x32_bf16 v[168:171], a[52:55], v[32:35], v[168:171]
 ds_read_b64_tr_b16 a[10:11], v238 offset:10240
 v_mfma_f32_16x16x32_bf16 v[168:171], a[56:59], v[36:39], v[168:171]
 ds_read_b64_tr_b16 a[12:13], v238 offset:12288
 buffer_load_dwordx4 v227, s[44:47], s60 offen offset:3072 lds
 v_mfma_f32_16x16x32_bf16 v[168:171], a[60:63], v[40:43], v[168:171]
 ds_read_b64_tr_b16 a[14:15], v238 offset:14336
 v_mfma_f32_16x16x32_bf16 v[168:171], a[64:67], v[44:47], v[168:171]
 ds_read_b64_tr_b16 a[16:17], v238 offset:16384
 v_mfma_f32_16x16x32_bf16 v[168:171], a[68:71], v[48:51], v[168:171]
 ds_read_b64_tr_b16 a[18:19], v238 offset:18432
 ds_read_b64_tr_b16 a[20:21], v238 offset:20480
 v_mfma_f32_16x16x32_bf16 v[172:175], a[68:71], v[120:123], 0
 ds_read_b64_tr_b16 a[22:23], v238 offset:22528
 v_mfma_f32_16x16x32_bf16 v[172:175], a[64:67], v[116:119], v[172:175]
 ds_read_b64_tr_b16 a[24:25], v238 offset:24576
 v_mfma_f32_16x16x32_bf16 v[172:175], a[60:63], v[112:115], v[172:175]
 ds_read_b64_tr_b16 a[26:27], v238 offset:26624
 s_add_u32 m0, s59, 110592
 s_add_u32 s60, s57, 2654464
 buffer_load_dwordx4 v224, s[44:47], s60 offen lds
 v_mfma_f32_16x16x32_bf16 v[172:175], a[56:59], v[108:111], v[172:175]
 ds_read_b64_tr_b16 a[28:29], v238 offset:28672
 v_mfma_f32_16x16x32_bf16 v[172:175], a[52:55], v[104:107], v[172:175]
 ds_read_b64_tr_b16 a[30:31], v238 offset:30720
 v_mfma_f32_16x16x32_bf16 v[172:175], a[48:51], v[100:103], v[172:175]
 ds_read_b64_tr_b16 a[32:33], v238 offset:32768
 v_mfma_f32_16x16x32_bf16 v[172:175], a[44:47], v[96:99], v[172:175]
 ds_read_b64_tr_b16 a[34:35], v238 offset:34816
 v_mfma_f32_16x16x32_bf16 v[172:175], a[40:43], v[92:95], v[172:175]
 v_mfma_f32_16x16x32_bf16 v[172:175], a[36:39], v[88:91], v[172:175]
 s_waitcnt lgkmcnt(10)
 v_mfma_f32_16x16x32_bf16 v[176:179], a[0:3], v[16:19], 0
 ds_read_b64_tr_b16 a[36:37], v239 offset:0
 ds_read_b64_tr_b16 a[38:39], v239 offset:2048
 v_mfma_f32_16x16x32_bf16 v[176:179], a[4:7], v[20:23], v[176:179]
 ds_read_b64_tr_b16 a[40:41], v239 offset:4096
 v_mfma_f32_16x16x32_bf16 v[176:179], a[8:11], v[24:27], v[176:179]
 ds_read_b64_tr_b16 a[42:43], v239 offset:6144
 v_mfma_f32_16x16x32_bf16 v[176:179], a[12:15], v[28:31], v[176:179]
 s_waitcnt lgkmcnt(4)
 ds_read_b64_tr_b16 a[44:45], v239 offset:8192
 v_mfma_f32_16x16x32_bf16 v[176:179], a[16:19], v[32:35], v[176:179]
 ds_read_b64_tr_b16 a[46:47], v239 offset:10240
 v_mfma_f32_16x16x32_bf16 v[176:179], a[20:23], v[36:39], v[176:179]
 ds_read_b64_tr_b16 a[48:49], v239 offset:12288
 v_mfma_f32_16x16x32_bf16 v[176:179], a[24:27], v[40:43], v[176:179]
 ds_read_b64_tr_b16 a[50:51], v239 offset:14336
 v_mfma_f32_16x16x32_bf16 v[176:179], a[28:31], v[44:47], v[176:179]
 ds_read_b64_tr_b16 a[52:53], v239 offset:16384
 v_mfma_f32_16x16x32_bf16 v[176:179], a[32:35], v[48:51], v[176:179]
 ds_read_b64_tr_b16 a[54:55], v239 offset:18432
 ds_read_b64_tr_b16 a[56:57], v239 offset:20480
 v_mfma_f32_16x16x32_bf16 v[180:183], a[32:35], v[120:123], 0
 ds_read_b64_tr_b16 a[58:59], v239 offset:22528
 v_mfma_f32_16x16x32_bf16 v[180:183], a[28:31], v[116:119], v[180:183]
 ds_read_b64_tr_b16 a[60:61], v239 offset:24576
 v_mfma_f32_16x16x32_bf16 v[180:183], a[24:27], v[112:115], v[180:183]
 ds_read_b64_tr_b16 a[62:63], v239 offset:26624
 v_mfma_f32_16x16x32_bf16 v[180:183], a[20:23], v[108:111], v[180:183]
 ds_read_b64_tr_b16 a[64:65], v239 offset:28672
 v_mfma_f32_16x16x32_bf16 v[180:183], a[16:19], v[104:107], v[180:183]
 ds_read_b64_tr_b16 a[66:67], v239 offset:30720
 v_mfma_f32_16x16x32_bf16 v[180:183], a[12:15], v[100:103], v[180:183]
 ds_read_b64_tr_b16 a[68:69], v239 offset:32768
 v_mfma_f32_16x16x32_bf16 v[180:183], a[8:11], v[96:99], v[180:183]
 ds_read_b64_tr_b16 a[70:71], v239 offset:34816
 v_mfma_f32_16x16x32_bf16 v[180:183], a[4:7], v[92:95], v[180:183]
 v_mfma_f32_16x16x32_bf16 v[180:183], a[0:3], v[88:91], v[180:183]
 s_waitcnt vmcnt(22) lgkmcnt(0)
 s_barrier
 v_mfma_f32_16x16x32_bf16 v[184:187], a[36:39], v[16:19], 0
 v_add_u32 v236, 36864, v236
 v_add_u32 v237, 36864, v237
 v_add_u32 v238, 36864, v238
 v_add_u32 v239, 36864, v239
 ds_read_b64_tr_b16 a[0:1], v236 offset:0
 ds_read_b64_tr_b16 a[2:3], v236 offset:2048
 v_mfma_f32_16x16x32_bf16 v[184:187], a[40:43], v[20:23], v[184:187]
 ds_read_b64_tr_b16 a[4:5], v236 offset:4096
 v_mfma_f32_16x16x32_bf16 v[184:187], a[44:47], v[24:27], v[184:187]
 ds_read_b64_tr_b16 a[6:7], v236 offset:6144
 s_add_u32 m0, s58, 0
 s_add_u32 s60, s56, 384
 buffer_load_dwordx4 v224, s[40:43], s60 offen offset:0 lds
 v_mfma_f32_16x16x32_bf16 v[184:187], a[48:51], v[28:31], v[184:187]
 ds_read_b64_tr_b16 a[8:9], v236 offset:8192
 v_mfma_f32_16x16x32_bf16 v[184:187], a[52:55], v[32:35], v[184:187]
 ds_read_b64_tr_b16 a[10:11], v236 offset:10240
 v_mfma_f32_16x16x32_bf16 v[184:187], a[56:59], v[36:39], v[184:187]
 ds_read_b64_tr_b16 a[12:13], v236 offset:12288
 v_mfma_f32_16x16x32_bf16 v[184:187], a[60:63], v[40:43], v[184:187]
 ds_read_b64_tr_b16 a[14:15], v236 offset:14336
 v_mfma_f32_16x16x32_bf16 v[184:187], a[64:67], v[44:47], v[184:187]
 ds_read_b64_tr_b16 a[16:17], v236 offset:16384
 buffer_load_dwordx4 v225, s[40:43], s60 offen offset:1024 lds
 v_mfma_f32_16x16x32_bf16 v[184:187], a[68:71], v[48:51], v[184:187]
 ds_read_b64_tr_b16 a[18:19], v236 offset:18432
 ds_read_b64_tr_b16 a[20:21], v236 offset:20480
 v_mfma_f32_16x16x32_bf16 v[188:191], a[68:71], v[120:123], 0
 ds_read_b64_tr_b16 a[22:23], v236 offset:22528
 v_mfma_f32_16x16x32_bf16 v[188:191], a[64:67], v[116:119], v[188:191]
 ds_read_b64_tr_b16 a[24:25], v236 offset:24576
 v_mfma_f32_16x16x32_bf16 v[188:191], a[60:63], v[112:115], v[188:191]
 ds_read_b64_tr_b16 a[26:27], v236 offset:26624
 v_mfma_f32_16x16x32_bf16 v[188:191], a[56:59], v[108:111], v[188:191]
 ds_read_b64_tr_b16 a[28:29], v236 offset:28672
 v_mfma_f32_16x16x32_bf16 v[188:191], a[52:55], v[104:107], v[188:191]
 ds_read_b64_tr_b16 a[30:31], v236 offset:30720
 buffer_load_dwordx4 v226, s[40:43], s60 offen offset:2048 lds
 v_mfma_f32_16x16x32_bf16 v[188:191], a[48:51], v[100:103], v[188:191]
 ds_read_b64_tr_b16 a[32:33], v236 offset:32768
 v_mfma_f32_16x16x32_bf16 v[188:191], a[44:47], v[96:99], v[188:191]
 ds_read_b64_tr_b16 a[34:35], v236 offset:34816
 v_mfma_f32_16x16x32_bf16 v[188:191], a[40:43], v[92:95], v[188:191]
 v_mfma_f32_16x16x32_bf16 v[188:191], a[36:39], v[88:91], v[188:191]
 s_waitcnt lgkmcnt(10)
 v_mfma_f32_16x16x32_bf16 v[160:163], a[0:3], v[52:55], v[160:163]
 ds_read_b64_tr_b16 a[36:37], v237 offset:0
 ds_read_b64_tr_b16 a[38:39], v237 offset:2048
 v_mfma_f32_16x16x32_bf16 v[160:163], a[4:7], v[56:59], v[160:163]
 ds_read_b64_tr_b16 a[40:41], v237 offset:4096
 buffer_load_dwordx4 v227, s[40:43], s60 offen offset:3072 lds
 v_mfma_f32_16x16x32_bf16 v[160:163], a[8:11], v[60:63], v[160:163]
 ds_read_b64_tr_b16 a[42:43], v237 offset:6144
 v_mfma_f32_16x16x32_bf16 v[160:163], a[12:15], v[64:67], v[160:163]
 s_waitcnt lgkmcnt(4)
 ds_read_b64_tr_b16 a[44:45], v237 offset:8192
 v_mfma_f32_16x16x32_bf16 v[160:163], a[16:19], v[68:71], v[160:163]
 ds_read_b64_tr_b16 a[46:47], v237 offset:10240
 v_mfma_f32_16x16x32_bf16 v[160:163], a[20:23], v[72:75], v[160:163]
 ds_read_b64_tr_b16 a[48:49], v237 offset:12288
 v_mfma_f32_16x16x32_bf16 v[160:163], a[24:27], v[76:79], v[160:163]
 ds_read_b64_tr_b16 a[50:51], v237 offset:14336
 s_add_u32 m0, s58, 4096
 s_add_u32 s60, s56, 295296
 buffer_load_dwordx4 v224, s[40:43], s60 offen offset:0 lds
 v_mfma_f32_16x16x32_bf16 v[160:163], a[28:31], v[80:83], v[160:163]
 ds_read_b64_tr_b16 a[52:53], v237 offset:16384
 v_mfma_f32_16x16x32_bf16 v[160:163], a[32:35], v[84:87], v[160:163]
 ds_read_b64_tr_b16 a[54:55], v237 offset:18432
 ds_read_b64_tr_b16 a[56:57], v237 offset:20480
 v_mfma_f32_16x16x32_bf16 v[164:167], a[32:35], v[156:159], v[164:167]
 ds_read_b64_tr_b16 a[58:59], v237 offset:22528
 v_mfma_f32_16x16x32_bf16 v[164:167], a[28:31], v[152:155], v[164:167]
 ds_read_b64_tr_b16 a[60:61], v237 offset:24576
 v_mfma_f32_16x16x32_bf16 v[164:167], a[24:27], v[148:151], v[164:167]
 ds_read_b64_tr_b16 a[62:63], v237 offset:26624
 v_mul_f32 v246, v242, v160
 v_mul_f32 v247, v242, v161
 v_mul_f32 v248, v242, v162
 v_mfma_f32_16x16x32_bf16 v[164:167], a[20:23], v[144:147], v[164:167]
 ds_read_b64_tr_b16 a[64:65], v237 offset:28672
 buffer_load_dwordx4 v225, s[40:43], s60 offen offset:1024 lds
 v_mul_f32 v249, v242, v163
 v_mfma_f32_16x16x32_bf16 v[164:167], a[16:19], v[140:143], v[164:167]
 ds_read_b64_tr_b16 a[66:67], v237 offset:30720
 v_exp_f32 v246, v246
 v_mfma_f32_16x16x32_bf16 v[164:167], a[12:15], v[136:139], v[164:167]
 ds_read_b64_tr_b16 a[68:69], v237 offset:32768
 v_exp_f32 v247, v247
 v_mfma_f32_16x16x32_bf16 v[164:167], a[8:11], v[132:135], v[164:167]
 ds_read_b64_tr_b16 a[70:71], v237 offset:34816
 v_exp_f32 v248, v248
 v_mfma_f32_16x16x32_bf16 v[164:167], a[4:7], v[128:131], v[164:167]
 v_exp_f32 v249, v249
 v_fma_f32 v246, v246, v244, v244
 v_mfma_f32_16x16x32_bf16 v[164:167], a[0:3], v[124:127], v[164:167]
 s_waitcnt lgkmcnt(10)
 v_fma_f32 v247, v247, v244, v244
 v_fma_f32 v248, v248, v244, v244
 v_mfma_f32_16x16x32_bf16 v[168:171], a[36:39], v[52:55], v[168:171]
 ds_read_b64_tr_b16 a[0:1], v238 offset:0
 ds_read_b64_tr_b16 a[2:3], v238 offset:2048
 buffer_load_dwordx4 v226, s[40:43], s60 offen offset:2048 lds
 v_mfma_f32_16x16x32_bf16 v[168:171], a[40:43], v[56:59], v[168:171]
 ds_read_b64_tr_b16 a[4:5], v238 offset:4096
 v_fma_f32 v249, v249, v244, v244
 v_mfma_f32_16x16x32_bf16 v[168:171], a[44:47], v[60:63], v[168:171]
 ds_read_b64_tr_b16 a[6:7], v238 offset:6144
 v_rcp_f32 v246, v246
 v_mfma_f32_16x16x32_bf16 v[168:171], a[48:51], v[64:67], v[168:171]
 s_waitcnt lgkmcnt(4)
 ds_read_b64_tr_b16 a[8:9], v238 offset:8192
 v_rcp_f32 v247, v247
 v_mfma_f32_16x16x32_bf16 v[168:171], a[52:55], v[68:71], v[168:171]
 ds_read_b64_tr_b16 a[10:11], v238 offset:10240
 v_rcp_f32 v248, v248
 v_mfma_f32_16x16x32_bf16 v[168:171], a[56:59], v[72:75], v[168:171]
 ds_read_b64_tr_b16 a[12:13], v238 offset:12288
 buffer_load_dwordx4 v227, s[40:43], s60 offen offset:3072 lds
 v_mfma_f32_16x16x32_bf16 v[168:171], a[60:63], v[76:79], v[168:171]
 s_branch L_c3_p6_s
L_c3_p6:
 s_branch L_c3_ret
L_c3_p6_s:
 ds_read_b64_tr_b16 a[14:15], v238 offset:14336
 v_rcp_f32 v249, v249
 v_mul_f32 v160, v160, v246
 v_mfma_f32_16x16x32_bf16 v[168:171], a[64:67], v[80:83], v[168:171]
 ds_read_b64_tr_b16 a[16:17], v238 offset:16384
 v_mul_f32 v161, v161, v247
 v_mul_f32 v162, v162, v248
 v_mfma_f32_16x16x32_bf16 v[168:171], a[68:71], v[84:87], v[168:171]
 ds_read_b64_tr_b16 a[18:19], v238 offset:18432
 ds_read_b64_tr_b16 a[20:21], v238 offset:20480
 v_mul_f32 v163, v163, v249
 v_mfma_f32_16x16x32_bf16 v[172:175], a[68:71], v[156:159], v[172:175]
 ds_read_b64_tr_b16 a[22:23], v238 offset:22528
 v_mul_f32 v246, v243, v164
 v_mul_f32 v247, v243, v165
 v_mfma_f32_16x16x32_bf16 v[172:175], a[64:67], v[152:155], v[172:175]
 ds_read_b64_tr_b16 a[24:25], v238 offset:24576
 v_mul_f32 v248, v243, v166
 v_mul_f32 v249, v243, v167
 v_mfma_f32_16x16x32_bf16 v[172:175], a[60:63], v[148:151], v[172:175]
 ds_read_b64_tr_b16 a[26:27], v238 offset:26624
 s_add_u32 m0, s59, 0
 s_add_u32 s60, s57, 384
 buffer_load_dwordx4 v224, s[40:43], s60 offen lds
 v_mfma_f32_16x16x32_bf16 v[172:175], a[56:59], v[144:147], v[172:175]
 ds_read_b64_tr_b16 a[28:29], v238 offset:28672
 v_mfma_f32_16x16x32_bf16 v[172:175], a[52:55], v[140:143], v[172:175]
 ds_read_b64_tr_b16 a[30:31], v238 offset:30720
 v_exp_f32 v246, v246
 v_mfma_f32_16x16x32_bf16 v[172:175], a[48:51], v[136:139], v[172:175]
 ds_read_b64_tr_b16 a[32:33], v238 offset:32768
 v_exp_f32 v247, v247
 v_mfma_f32_16x16x32_bf16 v[172:175], a[44:47], v[132:135], v[172:175]
 ds_read_b64_tr_b16 a[34:35], v238 offset:34816
 v_exp_f32 v248, v248
 v_mfma_f32_16x16x32_bf16 v[172:175], a[40:43], v[128:131], v[172:175]
 v_exp_f32 v249, v249
 v_fma_f32 v246, v246, v245, v245
 v_mfma_f32_16x16x32_bf16 v[172:175], a[36:39], v[124:127], v[172:175]
 s_waitcnt lgkmcnt(10)
 v_fma_f32 v247, v247, v245, v245
 v_fma_f32 v248, v248, v245, v245
 v_mfma_f32_16x16x32_bf16 v[176:179], a[0:3], v[52:55], v[176:179]
 ds_read_b64_tr_b16 a[36:37], v239 offset:0
 ds_read_b64_tr_b16 a[38:39], v239 offset:2048
 v_fma_f32 v249, v249, v245, v245
 v_mfma_f32_16x16x32_bf16 v[176:179], a[4:7], v[56:59], v[176:179]
 ds_read_b64_tr_b16 a[40:41], v239 offset:4096
 v_rcp_f32 v246, v246
 v_mfma_f32_16x16x32_bf16 v[176:179], a[8:11], v[60:63], v[176:179]
 ds_read_b64_tr_b16 a[42:43], v239 offset:6144
 v_rcp_f32 v247, v247
 v_mfma_f32_16x16x32_bf16 v[176:179], a[12:15], v[64:67], v[176:179]
 s_waitcnt lgkmcnt(4)
 ds_read_b64_tr_b16 a[44:45], v239 offset:8192
 v_mfma_f32_16x16x32_bf16 v[176:179], a[16:19], v[68:71], v[176:179]
 ds_read_b64_tr_b16 a[46:47], v239 offset:10240
 v_rcp_f32 v248, v248
 v_mfma_f32_16x16x32_bf16 v[176:179], a[20:23], v[72:75], v[176:179]
 ds_read_b64_tr_b16 a[48:49], v239 offset:12288
 v_rcp_f32 v249, v249
 v_mul_f32 v164, v164, v246
 v_mfma_f32_16x16x32_bf16 v[176:179], a[24:27], v[76:79], v[176:179]
 ds_read_b64_tr_b16 a[50:51], v239 offset:14336
 v_mul_f32 v165, v165, v247
 v_mul_f32 v166, v166, v248
 v_mfma_f32_16x16x32_bf16 v[176:179], a[28:31], v[80:83], v[176:179]
 ds_read_b64_tr_b16 a[52:53], v239 offset:16384
 v_mul_f32 v167, v167, v249
 v_mul_f32 v246, v242, v168
 v_mfma_f32_16x16x32_bf16 v[176:179], a[32:35], v[84:87], v[176:179]
 ds_read_b64_tr_b16 a[54:55], v239 offset:18432
 ds_read_b64_tr_b16 a[56:57], v239 offset:20480
 v_mul_f32 v247, v242, v169
 v_mfma_f32_16x16x32_bf16 v[180:183], a[32:35], v[156:159], v[180:183]
 ds_read_b64_tr_b16 a[58:59], v239 offset:22528
 v_mul_f32 v248, v242, v170
 v_mul_f32 v249, v242, v171
 v_mfma_f32_16x16x32_bf16 v[180:183], a[28:31], v[152:155], v[180:183]
 ds_read_b64_tr_b16 a[60:61], v239 offset:24576
 v_exp_f32 v246, v246
 v_mfma_f32_16x16x32_bf16 v[180:183], a[24:27], v[148:151], v[180:183]
 ds_read_b64_tr_b16 a[62:63], v239 offset:26624
 v_exp_f32 v247, v247
 v_mfma_f32_16x16x32_bf16 v[180:183], a[20:23], v[144:147], v[180:183]
 ds_read_b64_tr_b16 a[64:65], v239 offset:28672
 v_exp_f32 v248, v248
 v_mfma_f32_16x16x32_bf16 v[180:183], a[16:19], v[140:143], v[180:183]
 ds_read_b64_tr_b16 a[66:67], v239 offset:30720
 v_exp_f32 v249, v249
 v_mfma_f32_16x16x32_bf16 v[180:183], a[12:15], v[136:139], v[180:183]
 ds_read_b64_tr_b16 a[68:69], v239 offset:32768
 v_fma_f32 v246, v246, v244, v244
 v_fma_f32 v247, v247, v244, v244
 v_mfma_f32_16x16x32_bf16 v[180:183], a[8:11], v[132:135], v[180:183]
 ds_read_b64_tr_b16 a[70:71], v239 offset:34816
 v_fma_f32 v248, v248, v244, v244
 v_fma_f32 v249, v249, v244, v244
 v_mfma_f32_16x16x32_bf16 v[180:183], a[4:7], v[128:131], v[180:183]
 v_rcp_f32 v246, v246
 v_mfma_f32_16x16x32_bf16 v[180:183], a[0:3], v[124:127], v[180:183]
 s_waitcnt vmcnt(22) lgkmcnt(0)
 s_barrier
 v_mfma_f32_16x16x32_bf16 v[184:187], a[36:39], v[52:55], v[184:187]
 v_add_u32 v236, 36864, v236
 v_add_u32 v237, 36864, v237
 v_add_u32 v238, 36864, v238
 v_add_u32 v239, 36864, v239
 ds_read_b64_tr_b16 a[0:1], v236 offset:0
 ds_read_b64_tr_b16 a[2:3], v236 offset:2048
 v_mfma_f32_16x16x32_bf16 v[184:187], a[40:43], v[56:59], v[184:187]
 ds_read_b64_tr_b16 a[4:5], v236 offset:4096
 v_mfma_f32_16x16x32_bf16 v[184:187], a[44:47], v[60:63], v[184:187]
 ds_read_b64_tr_b16 a[6:7], v236 offset:6144
 s_add_u32 m0, s58, 36864
 s_add_u32 s60, s56, 2654592
 buffer_load_dwordx4 v224, s[40:43], s60 offen offset:0 lds
 v_mfma_f32_16x16x32_bf16 v[184:187], a[48:51], v[64:67], v[184:187]
 ds_read_b64_tr_b16 a[8:9], v236 offset:8192
 v_mfma_f32_16x16x32_bf16 v[184:187], a[52:55], v[68:71], v[184:187]
 ds_read_b64_tr_b16 a[10:11], v236 offset:10240
 v_rcp_f32 v247, v247
 v_mfma_f32_16x16x32_bf16 v[184:187], a[56:59], v[72:75], v[184:187]
 ds_read_b64_tr_b16 a[12:13], v236 offset:12288
 v_rcp_f32 v248, v248
 v_mfma_f32_16x16x32_bf16 v[184:187], a[60:63], v[76:79], v[184:187]
 ds_read_b64_tr_b16 a[14:15], v236 offset:14336
 v_rcp_f32 v249, v249
 v_mul_f32 v168, v168, v246
 v_mfma_f32_16x16x32_bf16 v[184:187], a[64:67], v[80:83], v[184:187]
 ds_read_b64_tr_b16 a[16:17], v236 offset:16384
 buffer_load_dwordx4 v225, s[40:43], s60 offen offset:1024 lds
 v_mul_f32 v169, v169, v247
 v_mfma_f32_16x16x32_bf16 v[184:187], a[68:71], v[84:87], v[184:187]
 ds_read_b64_tr_b16 a[18:19], v236 offset:18432
 ds_read_b64_tr_b16 a[20:21], v236 offset:20480
 v_mul_f32 v170, v170, v248
 v_mfma_f32_16x16x32_bf16 v[188:191], a[68:71], v[156:159], v[188:191]
 ds_read_b64_tr_b16 a[22:23], v236 offset:22528
 v_mul_f32 v171, v171, v249
 v_mul_f32 v246, v243, v172
 v_mfma_f32_16x16x32_bf16 v[188:191], a[64:67], v[152:155], v[188:191]
 ds_read_b64_tr_b16 a[24:25], v236 offset:24576
 v_mul_f32 v247, v243, v173
 v_mul_f32 v248, v243, v174
 v_mfma_f32_16x16x32_bf16 v[188:191], a[60:63], v[148:151], v[188:191]
 ds_read_b64_tr_b16 a[26:27], v236 offset:26624
 v_mul_f32 v249, v243, v175
 v_mfma_f32_16x16x32_bf16 v[188:191], a[56:59], v[144:147], v[188:191]
 ds_read_b64_tr_b16 a[28:29], v236 offset:28672
 v_exp_f32 v246, v246
 v_mfma_f32_16x16x32_bf16 v[188:191], a[52:55], v[140:143], v[188:191]
 ds_read_b64_tr_b16 a[30:31], v236 offset:30720
 buffer_load_dwordx4 v226, s[40:43], s60 offen offset:2048 lds
 v_exp_f32 v247, v247
 v_mfma_f32_16x16x32_bf16 v[188:191], a[48:51], v[136:139], v[188:191]
 ds_read_b64_tr_b16 a[32:33], v236 offset:32768
 v_exp_f32 v248, v248
 v_mfma_f32_16x16x32_bf16 v[188:191], a[44:47], v[132:135], v[188:191]
 ds_read_b64_tr_b16 a[34:35], v236 offset:34816
 v_exp_f32 v249, v249
 v_mfma_f32_16x16x32_bf16 v[188:191], a[40:43], v[128:131], v[188:191]
 v_fma_f32 v246, v246, v245, v245
 v_fma_f32 v247, v247, v245, v245
 v_fma_f32 v248, v248, v245, v245
 v_mfma_f32_16x16x32_bf16 v[188:191], a[36:39], v[124:127], v[188:191]
 s_waitcnt lgkmcnt(10)
 v_fma_f32 v249, v249, v245, v245
 v_mfma_f32_16x16x32_bf16 v[192:195], a[0:3], v[16:19], 0
 ds_read_b64_tr_b16 a[36:37], v237 offset:0
 ds_read_b64_tr_b16 a[38:39], v237 offset:2048
 v_rcp_f32 v246, v246
 v_mfma_f32_16x16x32_bf16 v[192:195], a[4:7], v[20:23], v[192:195]
 ds_read_b64_tr_b16 a[40:41], v237 offset:4096
 buffer_load_dwordx4 v227, s[40:43], s60 offen offset:3072 lds
 v_mfma_f32_16x16x32_bf16 v[192:195], a[8:11], v[24:27], v[192:195]
 ds_read_b64_tr_b16 a[42:43], v237 offset:6144
 v_rcp_f32 v247, v247
 v_mfma_f32_16x16x32_bf16 v[192:195], a[12:15], v[28:31], v[192:195]
 s_waitcnt lgkmcnt(4)
 ds_read_b64_tr_b16 a[44:45], v237 offset:8192
 v_rcp_f32 v248, v248
 v_mfma_f32_16x16x32_bf16 v[192:195], a[16:19], v[32:35], v[192:195]
 ds_read_b64_tr_b16 a[46:47], v237 offset:10240
 v_rcp_f32 v249, v249
 v_mfma_f32_16x16x32_bf16 v[192:195], a[20:23], v[36:39], v[192:195]
 ds_read_b64_tr_b16 a[48:49], v237 offset:12288
 v_mul_f32 v172, v172, v246
 v_mul_f32 v173, v173, v247
 v_mfma_f32_16x16x32_bf16 v[192:195], a[24:27], v[40:43], v[192:195]
 ds_read_b64_tr_b16 a[50:51], v237 offset:14336
 s_add_u32 m0, s58, 40960
 s_add_u32 s60, s56, 2949504
 buffer_load_dwordx4 v224, s[40:43], s60 offen offset:0 lds
 v_mfma_f32_16x16x32_bf16 v[192:195], a[28:31], v[44:47], v[192:195]
 ds_read_b64_tr_b16 a[52:53], v237 offset:16384
 v_mul_f32 v174, v174, v248
 v_mfma_f32_16x16x32_bf16 v[192:195], a[32:35], v[48:51], v[192:195]
 ds_read_b64_tr_b16 a[54:55], v237 offset:18432
 ds_read_b64_tr_b16 a[56:57], v237 offset:20480
 v_mul_f32 v175, v175, v249
 v_mfma_f32_16x16x32_bf16 v[196:199], a[32:35], v[120:123], 0
 ds_read_b64_tr_b16 a[58:59], v237 offset:22528
 v_mul_f32 v246, v242, v176
 v_mul_f32 v247, v242, v177
 v_mfma_f32_16x16x32_bf16 v[196:199], a[28:31], v[116:119], v[196:199]
 ds_read_b64_tr_b16 a[60:61], v237 offset:24576
 v_mul_f32 v248, v242, v178
 v_mul_f32 v249, v242, v179
 v_mfma_f32_16x16x32_bf16 v[196:199], a[24:27], v[112:115], v[196:199]
 ds_read_b64_tr_b16 a[62:63], v237 offset:26624
 v_exp_f32 v246, v246
 v_mfma_f32_16x16x32_bf16 v[196:199], a[20:23], v[108:111], v[196:199]
 ds_read_b64_tr_b16 a[64:65], v237 offset:28672
 buffer_load_dwordx4 v225, s[40:43], s60 offen offset:1024 lds
 v_mfma_f32_16x16x32_bf16 v[196:199], a[16:19], v[104:107], v[196:199]
 ds_read_b64_tr_b16 a[66:67], v237 offset:30720
 v_exp_f32 v247, v247
 v_mfma_f32_16x16x32_bf16 v[196:199], a[12:15], v[100:103], v[196:199]
 ds_read_b64_tr_b16 a[68:69], v237 offset:32768
 v_exp_f32 v248, v248
 v_mfma_f32_16x16x32_bf16 v[196:199], a[8:11], v[96:99], v[196:199]
 ds_read_b64_tr_b16 a[70:71], v237 offset:34816
 v_exp_f32 v249, v249
 v_fma_f32 v246, v246, v244, v244
 v_mfma_f32_16x16x32_bf16 v[196:199], a[4:7], v[92:95], v[196:199]
 v_fma_f32 v247, v247, v244, v244
 v_fma_f32 v248, v248, v244, v244
 v_fma_f32 v249, v249, v244, v244
 v_mfma_f32_16x16x32_bf16 v[196:199], a[0:3], v[88:91], v[196:199]
 s_waitcnt lgkmcnt(10)
 v_rcp_f32 v246, v246
 v_mfma_f32_16x16x32_bf16 v[200:203], a[36:39], v[16:19], 0
 ds_read_b64_tr_b16 a[0:1], v238 offset:0
 ds_read_b64_tr_b16 a[2:3], v238 offset:2048
 buffer_load_dwordx4 v226, s[40:43], s60 offen offset:2048 lds
 v_mfma_f32_16x16x32_bf16 v[200:203], a[40:43], v[20:23], v[200:203]
 ds_read_b64_tr_b16 a[4:5], v238 offset:4096
 v_rcp_f32 v247, v247
 v_mfma_f32_16x16x32_bf16 v[200:203], a[44:47], v[24:27], v[200:203]
 ds_read_b64_tr_b16 a[6:7], v238 offset:6144
 v_rcp_f32 v248, v248
 v_mfma_f32_16x16x32_bf16 v[200:203], a[48:51], v[28:31], v[200:203]
 s_waitcnt lgkmcnt(4)
 ds_read_b64_tr_b16 a[8:9], v238 offset:8192
 v_mfma_f32_16x16x32_bf16 v[200:203], a[52:55], v[32:35], v[200:203]
 ds_read_b64_tr_b16 a[10:11], v238 offset:10240
 v_rcp_f32 v249, v249
 v_mul_f32 v176, v176, v246
 v_mfma_f32_16x16x32_bf16 v[200:203], a[56:59], v[36:39], v[200:203]
 ds_read_b64_tr_b16 a[12:13], v238 offset:12288
 buffer_load_dwordx4 v227, s[40:43], s60 offen offset:3072 lds
 v_mul_f32 v177, v177, v247
 v_mfma_f32_16x16x32_bf16 v[200:203], a[60:63], v[40:43], v[200:203]
 ds_read_b64_tr_b16 a[14:15], v238 offset:14336
 v_mul_f32 v178, v178, v248
 v_mul_f32 v179, v179, v249
 v_mfma_f32_16x16x32_bf16 v[200:203], a[64:67], v[44:47], v[200:203]
 ds_read_b64_tr_b16 a[16:17], v238 offset:16384
 v_mul_f32 v246, v243, v180
 v_mul_f32 v247, v243, v181
 v_mfma_f32_16x16x32_bf16 v[200:203], a[68:71], v[48:51], v[200:203]
 ds_read_b64_tr_b16 a[18:19], v238 offset:18432
 ds_read_b64_tr_b16 a[20:21], v238 offset:20480
 v_mul_f32 v248, v243, v182
 v_mfma_f32_16x16x32_bf16 v[204:207], a[68:71], v[120:123], 0
 ds_read_b64_tr_b16 a[22:23], v238 offset:22528
 v_mul_f32 v249, v243, v183
 v_mfma_f32_16x16x32_bf16 v[204:207], a[64:67], v[116:119], v[204:207]
 ds_read_b64_tr_b16 a[24:25], v238 offset:24576
 v_exp_f32 v246, v246
 v_mfma_f32_16x16x32_bf16 v[204:207], a[60:63], v[112:115], v[204:207]
 ds_read_b64_tr_b16 a[26:27], v238 offset:26624
 s_add_u32 m0, s59, 36864
 s_add_u32 s60, s57, 2654592
 buffer_load_dwordx4 v224, s[40:43], s60 offen lds
 v_mfma_f32_16x16x32_bf16 v[204:207], a[56:59], v[108:111], v[204:207]
 ds_read_b64_tr_b16 a[28:29], v238 offset:28672
 v_exp_f32 v247, v247
 v_mfma_f32_16x16x32_bf16 v[204:207], a[52:55], v[104:107], v[204:207]
 ds_read_b64_tr_b16 a[30:31], v238 offset:30720
 v_exp_f32 v248, v248
 v_mfma_f32_16x16x32_bf16 v[204:207], a[48:51], v[100:103], v[204:207]
 ds_read_b64_tr_b16 a[32:33], v238 offset:32768
 v_exp_f32 v249, v249
 v_mfma_f32_16x16x32_bf16 v[204:207], a[44:47], v[96:99], v[204:207]
 ds_read_b64_tr_b16 a[34:35], v238 offset:34816
 v_fma_f32 v246, v246, v245, v245
 v_fma_f32 v247, v247, v245, v245
 v_mfma_f32_16x16x32_bf16 v[204:207], a[40:43], v[92:95], v[204:207]
 v_fma_f32 v248, v248, v245, v245
 v_fma_f32 v249, v249, v245, v245
 v_mfma_f32_16x16x32_bf16 v[204:207], a[36:39], v[88:91], v[204:207]
 s_waitcnt lgkmcnt(10)
 v_rcp_f32 v246, v246
 v_mfma_f32_16x16x32_bf16 v[208:211], a[0:3], v[16:19], 0
 ds_read_b64_tr_b16 a[36:37], v239 offset:0
 ds_read_b64_tr_b16 a[38:39], v239 offset:2048
 v_rcp_f32 v247, v247
 v_mfma_f32_16x16x32_bf16 v[208:211], a[4:7], v[20:23], v[208:211]
 ds_read_b64_tr_b16 a[40:41], v239 offset:4096
 v_rcp_f32 v248, v248
 v_mfma_f32_16x16x32_bf16 v[208:211], a[8:11], v[24:27], v[208:211]
 ds_read_b64_tr_b16 a[42:43], v239 offset:6144
 v_rcp_f32 v249, v249
 v_mfma_f32_16x16x32_bf16 v[208:211], a[12:15], v[28:31], v[208:211]
 s_waitcnt lgkmcnt(4)
 ds_read_b64_tr_b16 a[44:45], v239 offset:8192
 v_mul_f32 v180, v180, v246
 v_mfma_f32_16x16x32_bf16 v[208:211], a[16:19], v[32:35], v[208:211]
 ds_read_b64_tr_b16 a[46:47], v239 offset:10240
 v_mul_f32 v181, v181, v247
 v_mul_f32 v182, v182, v248
 v_mfma_f32_16x16x32_bf16 v[208:211], a[20:23], v[36:39], v[208:211]
 ds_read_b64_tr_b16 a[48:49], v239 offset:12288
 v_mul_f32 v183, v183, v249
 v_mul_f32 v246, v242, v184
 v_mfma_f32_16x16x32_bf16 v[208:211], a[24:27], v[40:43], v[208:211]
 ds_read_b64_tr_b16 a[50:51], v239 offset:14336
 v_mul_f32 v247, v242, v185
 v_mul_f32 v248, v242, v186
 v_mfma_f32_16x16x32_bf16 v[208:211], a[28:31], v[44:47], v[208:211]
 ds_read_b64_tr_b16 a[52:53], v239 offset:16384
 v_mul_f32 v249, v242, v187
 v_mfma_f32_16x16x32_bf16 v[208:211], a[32:35], v[48:51], v[208:211]
 ds_read_b64_tr_b16 a[54:55], v239 offset:18432
 ds_read_b64_tr_b16 a[56:57], v239 offset:20480
 v_exp_f32 v246, v246
 v_mfma_f32_16x16x32_bf16 v[212:215], a[32:35], v[120:123], 0
 ds_read_b64_tr_b16 a[58:59], v239 offset:22528
 v_exp_f32 v247, v247
 v_mfma_f32_16x16x32_bf16 v[212:215], a[28:31], v[116:119], v[212:215]
 ds_read_b64_tr_b16 a[60:61], v239 offset:24576
 v_exp_f32 v248, v248
 v_mfma_f32_16x16x32_bf16 v[212:215], a[24:27], v[112:115], v[212:215]
 ds_read_b64_tr_b16 a[62:63], v239 offset:26624
 v_exp_f32 v249, v249
 v_mfma_f32_16x16x32_bf16 v[212:215], a[20:23], v[108:111], v[212:215]
 ds_read_b64_tr_b16 a[64:65], v239 offset:28672
 v_fma_f32 v246, v246, v244, v244
 v_fma_f32 v247, v247, v244, v244
 v_mfma_f32_16x16x32_bf16 v[212:215], a[16:19], v[104:107], v[212:215]
 ds_read_b64_tr_b16 a[66:67], v239 offset:30720
 v_fma_f32 v248, v248, v244, v244
 v_fma_f32 v249, v249, v244, v244
 v_mfma_f32_16x16x32_bf16 v[212:215], a[12:15], v[100:103], v[212:215]
 ds_read_b64_tr_b16 a[68:69], v239 offset:32768
 v_rcp_f32 v246, v246
 v_mfma_f32_16x16x32_bf16 v[212:215], a[8:11], v[96:99], v[212:215]
 ds_read_b64_tr_b16 a[70:71], v239 offset:34816
 v_rcp_f32 v247, v247
 v_mfma_f32_16x16x32_bf16 v[212:215], a[4:7], v[92:95], v[212:215]
 v_rcp_f32 v248, v248
 v_mfma_f32_16x16x32_bf16 v[212:215], a[0:3], v[88:91], v[212:215]
 s_waitcnt vmcnt(18) lgkmcnt(0)
 s_barrier
 v_mfma_f32_16x16x32_bf16 v[216:219], a[36:39], v[16:19], 0
 v_add_u32 v236, 36864, v236
 v_add_u32 v237, 36864, v237
 v_add_u32 v238, 36864, v238
 v_add_u32 v239, 36864, v239
 ds_read_b64_tr_b16 a[0:1], v236 offset:0
 ds_read_b64_tr_b16 a[2:3], v236 offset:2048
 v_mfma_f32_16x16x32_bf16 v[216:219], a[40:43], v[20:23], v[216:219]
 ds_read_b64_tr_b16 a[4:5], v236 offset:4096
 v_mfma_f32_16x16x32_bf16 v[216:219], a[44:47], v[24:27], v[216:219]
 ds_read_b64_tr_b16 a[6:7], v236 offset:6144
 s_add_u32 m0, s58, 73728
 s_add_u32 s60, s56, 384
 buffer_load_dwordx4 v224, s[44:47], s60 offen offset:0 lds
 v_mfma_f32_16x16x32_bf16 v[216:219], a[48:51], v[28:31], v[216:219]
 ds_read_b64_tr_b16 a[8:9], v236 offset:8192
 v_mfma_f32_16x16x32_bf16 v[216:219], a[52:55], v[32:35], v[216:219]
 ds_read_b64_tr_b16 a[10:11], v236 offset:10240
 v_rcp_f32 v249, v249
 v_mul_f32 v184, v184, v246
 v_mfma_f32_16x16x32_bf16 v[216:219], a[56:59], v[36:39], v[216:219]
 ds_read_b64_tr_b16 a[12:13], v236 offset:12288
 v_mul_f32 v185, v185, v247
 v_mul_f32 v186, v186, v248
 v_mfma_f32_16x16x32_bf16 v[216:219], a[60:63], v[40:43], v[216:219]
 ds_read_b64_tr_b16 a[14:15], v236 offset:14336
 v_mul_f32 v187, v187, v249
 v_mul_f32 v246, v243, v188
 v_mfma_f32_16x16x32_bf16 v[216:219], a[64:67], v[44:47], v[216:219]
 ds_read_b64_tr_b16 a[16:17], v236 offset:16384
 buffer_load_dwordx4 v225, s[44:47], s60 offen offset:1024 lds
 v_mul_f32 v247, v243, v189
 v_mfma_f32_16x16x32_bf16 v[216:219], a[68:71], v[48:51], v[216:219]
 ds_read_b64_tr_b16 a[18:19], v236 offset:18432
 ds_read_b64_tr_b16 a[20:21], v236 offset:20480
 v_mul_f32 v248, v243, v190
 v_mfma_f32_16x16x32_bf16 v[220:223], a[68:71], v[120:123], 0
 ds_read_b64_tr_b16 a[22:23], v236 offset:22528
 v_mul_f32 v249, v243, v191
 v_mfma_f32_16x16x32_bf16 v[220:223], a[64:67], v[116:119], v[220:223]
 ds_read_b64_tr_b16 a[24:25], v236 offset:24576
 v_exp_f32 v246, v246
 v_mfma_f32_16x16x32_bf16 v[220:223], a[60:63], v[112:115], v[220:223]
 ds_read_b64_tr_b16 a[26:27], v236 offset:26624
 v_exp_f32 v247, v247
 v_mfma_f32_16x16x32_bf16 v[220:223], a[56:59], v[108:111], v[220:223]
 ds_read_b64_tr_b16 a[28:29], v236 offset:28672
 v_exp_f32 v248, v248
 v_mfma_f32_16x16x32_bf16 v[220:223], a[52:55], v[104:107], v[220:223]
 ds_read_b64_tr_b16 a[30:31], v236 offset:30720
 buffer_load_dwordx4 v226, s[44:47], s60 offen offset:2048 lds
 v_exp_f32 v249, v249
 v_mfma_f32_16x16x32_bf16 v[220:223], a[48:51], v[100:103], v[220:223]
 ds_read_b64_tr_b16 a[32:33], v236 offset:32768
 v_fma_f32 v246, v246, v245, v245
 v_fma_f32 v247, v247, v245, v245
 v_mfma_f32_16x16x32_bf16 v[220:223], a[44:47], v[96:99], v[220:223]
 ds_read_b64_tr_b16 a[34:35], v236 offset:34816
 v_fma_f32 v248, v248, v245, v245
 v_fma_f32 v249, v249, v245, v245
 v_mfma_f32_16x16x32_bf16 v[220:223], a[40:43], v[92:95], v[220:223]
 v_rcp_f32 v246, v246
 v_mfma_f32_16x16x32_bf16 v[220:223], a[36:39], v[88:91], v[220:223]
 s_waitcnt lgkmcnt(10)
 v_rcp_f32 v247, v247
 v_mfma_f32_16x16x32_bf16 v[192:195], a[0:3], v[52:55], v[192:195]
 ds_read_b64_tr_b16 a[36:37], v237 offset:0
 ds_read_b64_tr_b16 a[38:39], v237 offset:2048
L_s4:
 v_rcp_f32 v248, v248
 v_mfma_f32_16x16x32_bf16 v[192:195], a[4:7], v[56:59], v[192:195]
 ds_read_b64_tr_b16 a[40:41], v237 offset:4096
 buffer_load_dwordx4 v227, s[44:47], s60 offen offset:3072 lds
 v_mfma_f32_16x16x32_bf16 v[192:195], a[8:11], v[60:63], v[192:195]
 ds_read_b64_tr_b16 a[42:43], v237 offset:6144
 v_rcp_f32 v249, v249
 v_mul_f32 v188, v188, v246
 v_mfma_f32_16x16x32_bf16 v[192:195], a[12:15], v[64:67], v[192:195]
 s_waitcnt lgkmcnt(4)
 ds_read_b64_tr_b16 a[44:45], v237 offset:8192
 v_mul_f32 v189, v189, v247
 v_mfma_f32_16x16x32_bf16 v[192:195], a[16:19], v[68:71], v[192:195]
 ds_read_b64_tr_b16 a[46:47], v237 offset:10240
 v_mul_f32 v190, v190, v248
 v_mul_f32 v191, v191, v249
 v_mfma_f32_16x16x32_bf16 v[192:195], a[20:23], v[72:75], v[192:195]
 ds_read_b64_tr_b16 a[48:49], v237 offset:12288
 v_mfma_f32_16x16x32_bf16 v[192:195], a[24:27], v[76:79], v[192:195]
 ds_read_b64_tr_b16 a[50:51], v237 offset:14336
 s_add_u32 m0, s58, 77824
 s_add_u32 s60, s56, 295296
 buffer_load_dwordx4 v224, s[44:47], s60 offen offset:0 lds
 v_mfma_f32_16x16x32_bf16 v[192:195], a[28:31], v[80:83], v[192:195]
 ds_read_b64_tr_b16 a[52:53], v237 offset:16384
 v_mfma_f32_16x16x32_bf16 v[192:195], a[32:35], v[84:87], v[192:195]
 ds_read_b64_tr_b16 a[54:55], v237 offset:18432
 ds_read_b64_tr_b16 a[56:57], v237 offset:20480
 v_mfma_f32_16x16x32_bf16 v[196:199], a[32:35], v[156:159], v[196:199]
 ds_read_b64_tr_b16 a[58:59], v237 offset:22528
 v_mfma_f32_16x16x32_bf16 v[196:199], a[28:31], v[152:155], v[196:199]
 ds_read_b64_tr_b16 a[60:61], v237 offset:24576
 v_mfma_f32_16x16x32_bf16 v[196:199], a[24:27], v[148:151], v[196:199]
 ds_read_b64_tr_b16 a[62:63], v237 offset:26624
 v_mul_f32 v192, v192, v160
 v_mul_f32 v193, v193, v161
 v_mul_f32 v194, v194, v162
 v_mfma_f32_16x16x32_bf16 v[196:199], a[20:23], v[144:147], v[196:199]
 ds_read_b64_tr_b16 a[64:65], v237 offset:28672
 buffer_load_dwordx4 v225, s[44:47], s60 offen offset:1024 lds
 v_mul_f32 v195, v195, v163
 v_mfma_f32_16x16x32_bf16 v[196:199], a[16:19], v[140:143], v[196:199]
 ds_read_b64_tr_b16 a[66:67], v237 offset:30720
 v_cvt_pk_bf16_f32 v192, v192, v193
 v_cvt_pk_bf16_f32 v193, v194, v195
 v_mfma_f32_16x16x32_bf16 v[196:199], a[12:15], v[136:139], v[196:199]
 ds_read_b64_tr_b16 a[68:69], v237 offset:32768
 v_accvgpr_write_b32 a176, v192
 v_accvgpr_write_b32 a177, v193
 v_mfma_f32_16x16x32_bf16 v[196:199], a[8:11], v[132:135], v[196:199]
 ds_read_b64_tr_b16 a[70:71], v237 offset:34816
 v_mfma_f32_16x16x32_bf16 v[196:199], a[4:7], v[128:131], v[196:199]
 v_mfma_f32_16x16x32_bf16 v[196:199], a[0:3], v[124:127], v[196:199]
 s_waitcnt lgkmcnt(10)
 v_mfma_f32_16x16x32_bf16 v[200:203], a[36:39], v[52:55], v[200:203]
 ds_read_b64_tr_b16 a[0:1], v238 offset:0
 ds_read_b64_tr_b16 a[2:3], v238 offset:2048
 buffer_load_dwordx4 v226, s[44:47], s60 offen offset:2048 lds
 v_mfma_f32_16x16x32_bf16 v[200:203], a[40:43], v[56:59], v[200:203]
 ds_read_b64_tr_b16 a[4:5], v238 offset:4096
 v_mfma_f32_16x16x32_bf16 v[200:203], a[44:47], v[60:63], v[200:203]
 ds_read_b64_tr_b16 a[6:7], v238 offset:6144
 v_mul_f32 v196, v196, v164
 v_mul_f32 v197, v197, v165
 v_mul_f32 v198, v198, v166
 v_mfma_f32_16x16x32_bf16 v[200:203], a[48:51], v[64:67], v[200:203]
 s_waitcnt lgkmcnt(4)
 ds_read_b64_tr_b16 a[8:9], v238 offset:8192
 v_mul_f32 v199, v199, v167
 v_mfma_f32_16x16x32_bf16 v[200:203], a[52:55], v[68:71], v[200:203]
 ds_read_b64_tr_b16 a[10:11], v238 offset:10240
 v_cvt_pk_bf16_f32 v196, v196, v197
 v_cvt_pk_bf16_f32 v197, v198, v199
 v_mfma_f32_16x16x32_bf16 v[200:203], a[56:59], v[72:75], v[200:203]
 ds_read_b64_tr_b16 a[12:13], v238 offset:12288
 buffer_load_dwordx4 v227, s[44:47], s60 offen offset:3072 lds
 v_accvgpr_write_b32 a180, v196
 v_mfma_f32_16x16x32_bf16 v[200:203], a[60:63], v[76:79], v[200:203]
 ds_read_b64_tr_b16 a[14:15], v238 offset:14336
 v_accvgpr_write_b32 a181, v197
 v_mfma_f32_16x16x32_bf16 v[200:203], a[64:67], v[80:83], v[200:203]
 ds_read_b64_tr_b16 a[16:17], v238 offset:16384
 v_mfma_f32_16x16x32_bf16 v[200:203], a[68:71], v[84:87], v[200:203]
 ds_read_b64_tr_b16 a[18:19], v238 offset:18432
 ds_read_b64_tr_b16 a[20:21], v238 offset:20480
 v_mfma_f32_16x16x32_bf16 v[204:207], a[68:71], v[156:159], v[204:207]
 ds_read_b64_tr_b16 a[22:23], v238 offset:22528
 v_mfma_f32_16x16x32_bf16 v[204:207], a[64:67], v[152:155], v[204:207]
 ds_read_b64_tr_b16 a[24:25], v238 offset:24576
 v_mfma_f32_16x16x32_bf16 v[204:207], a[60:63], v[148:151], v[204:207]
 ds_read_b64_tr_b16 a[26:27], v238 offset:26624
 s_add_u32 m0, s59, 73728
 s_add_u32 s60, s57, 384
 buffer_load_dwordx4 v224, s[44:47], s60 offen lds
 v_mul_f32 v200, v200, v168
 v_mul_f32 v201, v201, v169
 v_mfma_f32_16x16x32_bf16 v[204:207], a[56:59], v[144:147], v[204:207]
 ds_read_b64_tr_b16 a[28:29], v238 offset:28672
 buffer_load_dword v13, v14, s[96:99], s32 offen sc1
 v_mul_f32 v202, v202, v170
 v_mfma_f32_16x16x32_bf16 v[204:207], a[52:55], v[140:143], v[204:207]
 ds_read_b64_tr_b16 a[30:31], v238 offset:30720
 v_mul_f32 v203, v203, v171
 v_cvt_pk_bf16_f32 v194, v200, v201
 v_mfma_f32_16x16x32_bf16 v[204:207], a[48:51], v[136:139], v[204:207]
 ds_read_b64_tr_b16 a[32:33], v238 offset:32768
 v_cvt_pk_bf16_f32 v195, v202, v203
 v_accvgpr_write_b32 a178, v194
 v_mfma_f32_16x16x32_bf16 v[204:207], a[44:47], v[132:135], v[204:207]
 ds_read_b64_tr_b16 a[34:35], v238 offset:34816
 v_accvgpr_write_b32 a179, v195
 v_mfma_f32_16x16x32_bf16 v[204:207], a[40:43], v[128:131], v[204:207]
 s_add_u32 s67, s66, 8192
 buffer_store_dwordx4 v[192:195], v9, s[8:11], s67 offen sc1
 v_mfma_f32_16x16x32_bf16 v[204:207], a[36:39], v[124:127], v[204:207]
 s_waitcnt lgkmcnt(10)
 v_mfma_f32_16x16x32_bf16 v[208:211], a[0:3], v[52:55], v[208:211]
 ds_read_b64_tr_b16 a[36:37], v239 offset:0
 ds_read_b64_tr_b16 a[38:39], v239 offset:2048
 v_mfma_f32_16x16x32_bf16 v[208:211], a[4:7], v[56:59], v[208:211]
 ds_read_b64_tr_b16 a[40:41], v239 offset:4096
 v_mfma_f32_16x16x32_bf16 v[208:211], a[8:11], v[60:63], v[208:211]
 ds_read_b64_tr_b16 a[42:43], v239 offset:6144
 v_mul_f32 v204, v204, v172
 v_mul_f32 v205, v205, v173
 v_mul_f32 v206, v206, v174
 v_mfma_f32_16x16x32_bf16 v[208:211], a[12:15], v[64:67], v[208:211]
 s_waitcnt lgkmcnt(4)
 ds_read_b64_tr_b16 a[44:45], v239 offset:8192
 v_mul_f32 v207, v207, v175
 v_mfma_f32_16x16x32_bf16 v[208:211], a[16:19], v[68:71], v[208:211]
 ds_read_b64_tr_b16 a[46:47], v239 offset:10240
 v_cvt_pk_bf16_f32 v198, v204, v205
 v_cvt_pk_bf16_f32 v199, v206, v207
 v_mfma_f32_16x16x32_bf16 v[208:211], a[20:23], v[72:75], v[208:211]
 ds_read_b64_tr_b16 a[48:49], v239 offset:12288
 v_accvgpr_write_b32 a182, v198
 v_accvgpr_write_b32 a183, v199
 v_mfma_f32_16x16x32_bf16 v[208:211], a[24:27], v[76:79], v[208:211]
 ds_read_b64_tr_b16 a[50:51], v239 offset:14336
 s_add_u32 s67, s66, 9216
 buffer_store_dwordx4 v[196:199], v9, s[8:11], s67 offen sc1
 v_mfma_f32_16x16x32_bf16 v[208:211], a[28:31], v[80:83], v[208:211]
 ds_read_b64_tr_b16 a[52:53], v239 offset:16384
 v_mfma_f32_16x16x32_bf16 v[208:211], a[32:35], v[84:87], v[208:211]
 ds_read_b64_tr_b16 a[54:55], v239 offset:18432
 ds_read_b64_tr_b16 a[56:57], v239 offset:20480
 v_mfma_f32_16x16x32_bf16 v[212:215], a[32:35], v[156:159], v[212:215]
 ds_read_b64_tr_b16 a[58:59], v239 offset:22528
 v_mfma_f32_16x16x32_bf16 v[212:215], a[28:31], v[152:155], v[212:215]
 ds_read_b64_tr_b16 a[60:61], v239 offset:24576
 v_mfma_f32_16x16x32_bf16 v[212:215], a[24:27], v[148:151], v[212:215]
 ds_read_b64_tr_b16 a[62:63], v239 offset:26624
 v_mul_f32 v208, v208, v176
 v_mul_f32 v209, v209, v177
 v_mul_f32 v210, v210, v178
 v_mfma_f32_16x16x32_bf16 v[212:215], a[20:23], v[144:147], v[212:215]
 ds_read_b64_tr_b16 a[64:65], v239 offset:28672
 v_mul_f32 v211, v211, v179
 v_cvt_pk_bf16_f32 v208, v208, v209
 v_mfma_f32_16x16x32_bf16 v[212:215], a[16:19], v[140:143], v[212:215]
 ds_read_b64_tr_b16 a[66:67], v239 offset:30720
 v_cvt_pk_bf16_f32 v209, v210, v211
 v_accvgpr_write_b32 a184, v208
 v_mfma_f32_16x16x32_bf16 v[212:215], a[12:15], v[136:139], v[212:215]
 s_branch L_c4_p0_s
L_c4_p0:
 s_branch L_c4_p4
L_c4_p0_s:
 ds_read_b64_tr_b16 a[68:69], v239 offset:32768
 v_accvgpr_write_b32 a185, v209
 v_mfma_f32_16x16x32_bf16 v[212:215], a[8:11], v[132:135], v[212:215]
 ds_read_b64_tr_b16 a[70:71], v239 offset:34816
 v_mfma_f32_16x16x32_bf16 v[212:215], a[4:7], v[128:131], v[212:215]
 v_mfma_f32_16x16x32_bf16 v[212:215], a[0:3], v[124:127], v[212:215]
 s_waitcnt vmcnt(21) lgkmcnt(0)
 s_barrier
 v_mfma_f32_16x16x32_bf16 v[216:219], a[36:39], v[52:55], v[216:219]
 v_subrev_u32 v236, 110592, v236
 v_subrev_u32 v237, 110592, v237
 v_subrev_u32 v238, 110592, v238
 v_subrev_u32 v239, 110592, v239
 ds_read_b64_tr_b16 a[0:1], v236 offset:0
 ds_read_b64_tr_b16 a[2:3], v236 offset:2048
 v_mfma_f32_16x16x32_bf16 v[216:219], a[40:43], v[56:59], v[216:219]
 ds_read_b64_tr_b16 a[4:5], v236 offset:4096
 v_mfma_f32_16x16x32_bf16 v[216:219], a[44:47], v[60:63], v[216:219]
 ds_read_b64_tr_b16 a[6:7], v236 offset:6144
 s_add_u32 m0, s58, 110592
 s_add_u32 s60, s56, 2654592
 buffer_load_dwordx4 v224, s[44:47], s60 offen offset:0 lds
 v_mul_f32 v212, v212, v180
 v_mfma_f32_16x16x32_bf16 v[216:219], a[48:51], v[64:67], v[216:219]
 ds_read_b64_tr_b16 a[8:9], v236 offset:8192
 v_mul_f32 v213, v213, v181
 v_mul_f32 v214, v214, v182
 v_mfma_f32_16x16x32_bf16 v[216:219], a[52:55], v[68:71], v[216:219]
 ds_read_b64_tr_b16 a[10:11], v236 offset:10240
 v_mul_f32 v215, v215, v183
 v_cvt_pk_bf16_f32 v212, v212, v213
 v_mfma_f32_16x16x32_bf16 v[216:219], a[56:59], v[72:75], v[216:219]
 ds_read_b64_tr_b16 a[12:13], v236 offset:12288
 v_cvt_pk_bf16_f32 v213, v214, v215
 v_accvgpr_write_b32 a188, v212
 v_mfma_f32_16x16x32_bf16 v[216:219], a[60:63], v[76:79], v[216:219]
 ds_read_b64_tr_b16 a[14:15], v236 offset:14336
 v_accvgpr_write_b32 a189, v213
 v_mfma_f32_16x16x32_bf16 v[216:219], a[64:67], v[80:83], v[216:219]
 ds_read_b64_tr_b16 a[16:17], v236 offset:16384
 buffer_load_dwordx4 v225, s[44:47], s60 offen offset:1024 lds
 v_mfma_f32_16x16x32_bf16 v[216:219], a[68:71], v[84:87], v[216:219]
 ds_read_b64_tr_b16 a[18:19], v236 offset:18432
 ds_read_b64_tr_b16 a[20:21], v236 offset:20480
 v_mfma_f32_16x16x32_bf16 v[220:223], a[68:71], v[156:159], v[220:223]
 ds_read_b64_tr_b16 a[22:23], v236 offset:22528
 v_mfma_f32_16x16x32_bf16 v[220:223], a[64:67], v[152:155], v[220:223]
 ds_read_b64_tr_b16 a[24:25], v236 offset:24576
 v_mfma_f32_16x16x32_bf16 v[220:223], a[60:63], v[148:151], v[220:223]
 ds_read_b64_tr_b16 a[26:27], v236 offset:26624
 v_mul_f32 v216, v216, v184
 v_mul_f32 v217, v217, v185
 v_mul_f32 v218, v218, v186
 v_mfma_f32_16x16x32_bf16 v[220:223], a[56:59], v[144:147], v[220:223]
 ds_read_b64_tr_b16 a[28:29], v236 offset:28672
 v_mul_f32 v219, v219, v187
 v_cvt_pk_bf16_f32 v210, v216, v217
 v_mfma_f32_16x16x32_bf16 v[220:223], a[52:55], v[140:143], v[220:223]
 ds_read_b64_tr_b16 a[30:31], v236 offset:30720
 buffer_load_dwordx4 v226, s[44:47], s60 offen offset:2048 lds
 v_cvt_pk_bf16_f32 v211, v218, v219
 v_mfma_f32_16x16x32_bf16 v[220:223], a[48:51], v[136:139], v[220:223]
 ds_read_b64_tr_b16 a[32:33], v236 offset:32768
 v_accvgpr_write_b32 a186, v210
 v_accvgpr_write_b32 a187, v211
 v_mfma_f32_16x16x32_bf16 v[220:223], a[44:47], v[132:135], v[220:223]
 ds_read_b64_tr_b16 a[34:35], v236 offset:34816
 s_add_u32 s67, s66, 10240
 buffer_store_dwordx4 v[208:211], v9, s[8:11], s67 offen sc1
 v_mfma_f32_16x16x32_bf16 v[220:223], a[40:43], v[128:131], v[220:223]
 v_mfma_f32_16x16x32_bf16 v[220:223], a[36:39], v[124:127], v[220:223]
 s_waitcnt lgkmcnt(10)
 v_mfma_f32_16x16x32_bf16 v[160:163], a[0:3], v[16:19], 0
 ds_read_b64_tr_b16 a[36:37], v237 offset:0
 ds_read_b64_tr_b16 a[38:39], v237 offset:2048
 v_mfma_f32_16x16x32_bf16 v[160:163], a[4:7], v[20:23], v[160:163]
 ds_read_b64_tr_b16 a[40:41], v237 offset:4096
 buffer_load_dwordx4 v227, s[44:47], s60 offen offset:3072 lds
 v_mfma_f32_16x16x32_bf16 v[160:163], a[8:11], v[24:27], v[160:163]
 ds_read_b64_tr_b16 a[42:43], v237 offset:6144
 v_mul_f32 v220, v220, v188
 v_mul_f32 v221, v221, v189
 v_mul_f32 v222, v222, v190
 v_mfma_f32_16x16x32_bf16 v[160:163], a[12:15], v[28:31], v[160:163]
 s_waitcnt lgkmcnt(4)
 ds_read_b64_tr_b16 a[44:45], v237 offset:8192
 v_mul_f32 v223, v223, v191
 v_mfma_f32_16x16x32_bf16 v[160:163], a[16:19], v[32:35], v[160:163]
 ds_read_b64_tr_b16 a[46:47], v237 offset:10240
 v_cvt_pk_bf16_f32 v214, v220, v221
 v_cvt_pk_bf16_f32 v215, v222, v223
 v_mfma_f32_16x16x32_bf16 v[160:163], a[20:23], v[36:39], v[160:163]
 ds_read_b64_tr_b16 a[48:49], v237 offset:12288
 v_accvgpr_write_b32 a190, v214
 v_accvgpr_write_b32 a191, v215
 v_mfma_f32_16x16x32_bf16 v[160:163], a[24:27], v[40:43], v[160:163]
 ds_read_b64_tr_b16 a[50:51], v237 offset:14336
 s_add_u32 m0, s58, 114688
 s_add_u32 s60, s56, 2949504
 buffer_load_dwordx4 v224, s[44:47], s60 offen offset:0 lds
 v_mfma_f32_16x16x32_bf16 v[160:163], a[28:31], v[44:47], v[160:163]
 ds_read_b64_tr_b16 a[52:53], v237 offset:16384
 v_mfma_f32_16x16x32_bf16 v[160:163], a[32:35], v[48:51], v[160:163]
 ds_read_b64_tr_b16 a[54:55], v237 offset:18432
 ds_read_b64_tr_b16 a[56:57], v237 offset:20480
 s_add_u32 s67, s66, 11264
 buffer_store_dwordx4 v[212:215], v9, s[8:11], s67 offen sc1
 v_mfma_f32_16x16x32_bf16 v[164:167], a[32:35], v[120:123], 0
 ds_read_b64_tr_b16 a[58:59], v237 offset:22528
 v_mfma_f32_16x16x32_bf16 v[164:167], a[28:31], v[116:119], v[164:167]
 ds_read_b64_tr_b16 a[60:61], v237 offset:24576
 v_mfma_f32_16x16x32_bf16 v[164:167], a[24:27], v[112:115], v[164:167]
 ds_read_b64_tr_b16 a[62:63], v237 offset:26624
 v_mfma_f32_16x16x32_bf16 v[164:167], a[20:23], v[108:111], v[164:167]
 ds_read_b64_tr_b16 a[64:65], v237 offset:28672
 buffer_load_dwordx4 v225, s[44:47], s60 offen offset:1024 lds
 v_mfma_f32_16x16x32_bf16 v[164:167], a[16:19], v[104:107], v[164:167]
 ds_read_b64_tr_b16 a[66:67], v237 offset:30720
 v_mfma_f32_16x16x32_bf16 v[164:167], a[12:15], v[100:103], v[164:167]
 ds_read_b64_tr_b16 a[68:69], v237 offset:32768
 v_mfma_f32_16x16x32_bf16 v[164:167], a[8:11], v[96:99], v[164:167]
 ds_read_b64_tr_b16 a[70:71], v237 offset:34816
 v_mfma_f32_16x16x32_bf16 v[164:167], a[4:7], v[92:95], v[164:167]
 v_mfma_f32_16x16x32_bf16 v[164:167], a[0:3], v[88:91], v[164:167]
 s_waitcnt lgkmcnt(10)
 v_mfma_f32_16x16x32_bf16 v[168:171], a[36:39], v[16:19], 0
 ds_read_b64_tr_b16 a[0:1], v238 offset:0
 ds_read_b64_tr_b16 a[2:3], v238 offset:2048
 buffer_load_dwordx4 v226, s[44:47], s60 offen offset:2048 lds
 v_mfma_f32_16x16x32_bf16 v[168:171], a[40:43], v[20:23], v[168:171]
 ds_read_b64_tr_b16 a[4:5], v238 offset:4096
 v_mfma_f32_16x16x32_bf16 v[168:171], a[44:47], v[24:27], v[168:171]
 ds_read_b64_tr_b16 a[6:7], v238 offset:6144
 v_mfma_f32_16x16x32_bf16 v[168:171], a[48:51], v[28:31], v[168:171]
 s_waitcnt lgkmcnt(4)
 ds_read_b64_tr_b16 a[8:9], v238 offset:8192
 v_mfma_f32_16x16x32_bf16 v[168:171], a[52:55], v[32:35], v[168:171]
 ds_read_b64_tr_b16 a[10:11], v238 offset:10240
 v_mfma_f32_16x16x32_bf16 v[168:171], a[56:59], v[36:39], v[168:171]
 ds_read_b64_tr_b16 a[12:13], v238 offset:12288
 buffer_load_dwordx4 v227, s[44:47], s60 offen offset:3072 lds
 v_mfma_f32_16x16x32_bf16 v[168:171], a[60:63], v[40:43], v[168:171]
 ds_read_b64_tr_b16 a[14:15], v238 offset:14336
 v_mfma_f32_16x16x32_bf16 v[168:171], a[64:67], v[44:47], v[168:171]
 ds_read_b64_tr_b16 a[16:17], v238 offset:16384
 v_mfma_f32_16x16x32_bf16 v[168:171], a[68:71], v[48:51], v[168:171]
 ds_read_b64_tr_b16 a[18:19], v238 offset:18432
 ds_read_b64_tr_b16 a[20:21], v238 offset:20480
 v_mfma_f32_16x16x32_bf16 v[172:175], a[68:71], v[120:123], 0
 ds_read_b64_tr_b16 a[22:23], v238 offset:22528
 v_mfma_f32_16x16x32_bf16 v[172:175], a[64:67], v[116:119], v[172:175]
 ds_read_b64_tr_b16 a[24:25], v238 offset:24576
 v_mfma_f32_16x16x32_bf16 v[172:175], a[60:63], v[112:115], v[172:175]
 ds_read_b64_tr_b16 a[26:27], v238 offset:26624
 s_add_u32 m0, s59, 110592
 s_add_u32 s60, s57, 2654592
 buffer_load_dwordx4 v224, s[44:47], s60 offen lds
 v_mfma_f32_16x16x32_bf16 v[172:175], a[56:59], v[108:111], v[172:175]
 ds_read_b64_tr_b16 a[28:29], v238 offset:28672
 v_mfma_f32_16x16x32_bf16 v[172:175], a[52:55], v[104:107], v[172:175]
 ds_read_b64_tr_b16 a[30:31], v238 offset:30720
 v_mfma_f32_16x16x32_bf16 v[172:175], a[48:51], v[100:103], v[172:175]
 ds_read_b64_tr_b16 a[32:33], v238 offset:32768
 v_mfma_f32_16x16x32_bf16 v[172:175], a[44:47], v[96:99], v[172:175]
 ds_read_b64_tr_b16 a[34:35], v238 offset:34816
 v_mfma_f32_16x16x32_bf16 v[172:175], a[40:43], v[92:95], v[172:175]
 v_mfma_f32_16x16x32_bf16 v[172:175], a[36:39], v[88:91], v[172:175]
 s_waitcnt lgkmcnt(10)
 v_mfma_f32_16x16x32_bf16 v[176:179], a[0:3], v[16:19], 0
 ds_read_b64_tr_b16 a[36:37], v239 offset:0
 ds_read_b64_tr_b16 a[38:39], v239 offset:2048
 v_mfma_f32_16x16x32_bf16 v[176:179], a[4:7], v[20:23], v[176:179]
 ds_read_b64_tr_b16 a[40:41], v239 offset:4096
 v_mfma_f32_16x16x32_bf16 v[176:179], a[8:11], v[24:27], v[176:179]
 ds_read_b64_tr_b16 a[42:43], v239 offset:6144
 v_mfma_f32_16x16x32_bf16 v[176:179], a[12:15], v[28:31], v[176:179]
 s_waitcnt lgkmcnt(4)
 ds_read_b64_tr_b16 a[44:45], v239 offset:8192
 v_mfma_f32_16x16x32_bf16 v[176:179], a[16:19], v[32:35], v[176:179]
 ds_read_b64_tr_b16 a[46:47], v239 offset:10240
 s_waitcnt vmcnt(13)
 v_cmp_ne_u32 vcc, s3, v13
 s_nop 4
 s_cbranch_vccnz L_slow_w
L_back_w:
 v_mfma_f32_16x16x32_bf16 v[176:179], a[20:23], v[36:39], v[176:179]
 ds_read_b64_tr_b16 a[48:49], v239 offset:12288
 v_mfma_f32_16x16x32_bf16 v[176:179], a[24:27], v[40:43], v[176:179]
 ds_read_b64_tr_b16 a[50:51], v239 offset:14336
 v_mfma_f32_16x16x32_bf16 v[176:179], a[28:31], v[44:47], v[176:179]
 ds_read_b64_tr_b16 a[52:53], v239 offset:16384
 v_mfma_f32_16x16x32_bf16 v[176:179], a[32:35], v[48:51], v[176:179]
 ds_read_b64_tr_b16 a[54:55], v239 offset:18432
 ds_read_b64_tr_b16 a[56:57], v239 offset:20480
 v_mfma_f32_16x16x32_bf16 v[180:183], a[32:35], v[120:123], 0
 ds_read_b64_tr_b16 a[58:59], v239 offset:22528
 v_mfma_f32_16x16x32_bf16 v[180:183], a[28:31], v[116:119], v[180:183]
 ds_read_b64_tr_b16 a[60:61], v239 offset:24576
 v_mfma_f32_16x16x32_bf16 v[180:183], a[24:27], v[112:115], v[180:183]
 ds_read_b64_tr_b16 a[62:63], v239 offset:26624
 v_mfma_f32_16x16x32_bf16 v[180:183], a[20:23], v[108:111], v[180:183]
 ds_read_b64_tr_b16 a[64:65], v239 offset:28672
 v_mfma_f32_16x16x32_bf16 v[180:183], a[16:19], v[104:107], v[180:183]
 ds_read_b64_tr_b16 a[66:67], v239 offset:30720
 v_mfma_f32_16x16x32_bf16 v[180:183], a[12:15], v[100:103], v[180:183]
 ds_read_b64_tr_b16 a[68:69], v239 offset:32768
 v_mfma_f32_16x16x32_bf16 v[180:183], a[8:11], v[96:99], v[180:183]
 ds_read_b64_tr_b16 a[70:71], v239 offset:34816
 v_mfma_f32_16x16x32_bf16 v[180:183], a[4:7], v[92:95], v[180:183]
 v_mfma_f32_16x16x32_bf16 v[180:183], a[0:3], v[88:91], v[180:183]
 s_waitcnt lgkmcnt(0)
 s_barrier
 v_mfma_f32_16x16x32_bf16 v[184:187], a[36:39], v[16:19], 0
 v_add_u32 v236, 36864, v236
 v_add_u32 v237, 36864, v237
 v_add_u32 v238, 36864, v238
 v_add_u32 v239, 36864, v239
 ds_read_b64_tr_b16 a[0:1], v236 offset:0
 ds_read_b64_tr_b16 a[2:3], v236 offset:2048
 v_mfma_f32_16x16x32_bf16 v[184:187], a[40:43], v[20:23], v[184:187]
 ds_read_b64_tr_b16 a[4:5], v236 offset:4096
 v_mfma_f32_16x16x32_bf16 v[184:187], a[44:47], v[24:27], v[184:187]
 ds_read_b64_tr_b16 a[6:7], v236 offset:6144
 s_add_u32 m0, s61, 0
 s_add_u32 s60, s62, 0
 buffer_load_dwordx4 v228, s[52:55], s60 offen offset:0 lds
 v_mfma_f32_16x16x32_bf16 v[184:187], a[48:51], v[28:31], v[184:187]
 ds_read_b64_tr_b16 a[8:9], v236 offset:8192
 v_mfma_f32_16x16x32_bf16 v[184:187], a[52:55], v[32:35], v[184:187]
 ds_read_b64_tr_b16 a[10:11], v236 offset:10240
 v_mfma_f32_16x16x32_bf16 v[184:187], a[56:59], v[36:39], v[184:187]
 ds_read_b64_tr_b16 a[12:13], v236 offset:12288
 v_mfma_f32_16x16x32_bf16 v[184:187], a[60:63], v[40:43], v[184:187]
 ds_read_b64_tr_b16 a[14:15], v236 offset:14336
 v_mfma_f32_16x16x32_bf16 v[184:187], a[64:67], v[44:47], v[184:187]
 ds_read_b64_tr_b16 a[16:17], v236 offset:16384
 buffer_load_dwordx4 v229, s[52:55], s60 offen offset:1024 lds
 v_mfma_f32_16x16x32_bf16 v[184:187], a[68:71], v[48:51], v[184:187]
 ds_read_b64_tr_b16 a[18:19], v236 offset:18432
 ds_read_b64_tr_b16 a[20:21], v236 offset:20480
 v_mfma_f32_16x16x32_bf16 v[188:191], a[68:71], v[120:123], 0
 ds_read_b64_tr_b16 a[22:23], v236 offset:22528
 v_mfma_f32_16x16x32_bf16 v[188:191], a[64:67], v[116:119], v[188:191]
 ds_read_b64_tr_b16 a[24:25], v236 offset:24576
 v_mfma_f32_16x16x32_bf16 v[188:191], a[60:63], v[112:115], v[188:191]
 ds_read_b64_tr_b16 a[26:27], v236 offset:26624
 v_mfma_f32_16x16x32_bf16 v[188:191], a[56:59], v[108:111], v[188:191]
 ds_read_b64_tr_b16 a[28:29], v236 offset:28672
 v_mfma_f32_16x16x32_bf16 v[188:191], a[52:55], v[104:107], v[188:191]
 ds_read_b64_tr_b16 a[30:31], v236 offset:30720
 buffer_load_dwordx4 v230, s[52:55], s60 offen offset:2048 lds
 v_mfma_f32_16x16x32_bf16 v[188:191], a[48:51], v[100:103], v[188:191]
 ds_read_b64_tr_b16 a[32:33], v236 offset:32768
 v_mfma_f32_16x16x32_bf16 v[188:191], a[44:47], v[96:99], v[188:191]
 ds_read_b64_tr_b16 a[34:35], v236 offset:34816
 v_mfma_f32_16x16x32_bf16 v[188:191], a[40:43], v[92:95], v[188:191]
 v_mfma_f32_16x16x32_bf16 v[188:191], a[36:39], v[88:91], v[188:191]
 s_waitcnt lgkmcnt(10)
 v_mfma_f32_16x16x32_bf16 v[160:163], a[0:3], v[52:55], v[160:163]
 ds_read_b64_tr_b16 a[36:37], v237 offset:0
 ds_read_b64_tr_b16 a[38:39], v237 offset:2048
 v_mfma_f32_16x16x32_bf16 v[160:163], a[4:7], v[56:59], v[160:163]
 ds_read_b64_tr_b16 a[40:41], v237 offset:4096
 buffer_load_dwordx4 v231, s[52:55], s60 offen offset:3072 lds
 v_mfma_f32_16x16x32_bf16 v[160:163], a[8:11], v[60:63], v[160:163]
 ds_read_b64_tr_b16 a[42:43], v237 offset:6144
 v_mfma_f32_16x16x32_bf16 v[160:163], a[12:15], v[64:67], v[160:163]
 s_waitcnt lgkmcnt(4)
 ds_read_b64_tr_b16 a[44:45], v237 offset:8192
 v_mfma_f32_16x16x32_bf16 v[160:163], a[16:19], v[68:71], v[160:163]
 ds_read_b64_tr_b16 a[46:47], v237 offset:10240
 v_mfma_f32_16x16x32_bf16 v[160:163], a[20:23], v[72:75], v[160:163]
 ds_read_b64_tr_b16 a[48:49], v237 offset:12288
 v_mfma_f32_16x16x32_bf16 v[160:163], a[24:27], v[76:79], v[160:163]
 ds_read_b64_tr_b16 a[50:51], v237 offset:14336
 s_add_u32 m0, s61, 4096
 s_add_u32 s60, s62, 589824
 buffer_load_dwordx4 v228, s[52:55], s60 offen offset:0 lds
 v_mfma_f32_16x16x32_bf16 v[160:163], a[28:31], v[80:83], v[160:163]
 ds_read_b64_tr_b16 a[52:53], v237 offset:16384
 v_mfma_f32_16x16x32_bf16 v[160:163], a[32:35], v[84:87], v[160:163]
 ds_read_b64_tr_b16 a[54:55], v237 offset:18432
 ds_read_b64_tr_b16 a[56:57], v237 offset:20480
 v_mfma_f32_16x16x32_bf16 v[164:167], a[32:35], v[156:159], v[164:167]
 ds_read_b64_tr_b16 a[58:59], v237 offset:22528
 v_mfma_f32_16x16x32_bf16 v[164:167], a[28:31], v[152:155], v[164:167]
 ds_read_b64_tr_b16 a[60:61], v237 offset:24576
 v_mfma_f32_16x16x32_bf16 v[164:167], a[24:27], v[148:151], v[164:167]
 ds_read_b64_tr_b16 a[62:63], v237 offset:26624
 v_mul_f32 v246, v242, v160
 v_mul_f32 v247, v242, v161
 v_mul_f32 v248, v242, v162
 v_mfma_f32_16x16x32_bf16 v[164:167], a[20:23], v[144:147], v[164:167]
 ds_read_b64_tr_b16 a[64:65], v237 offset:28672
 buffer_load_dwordx4 v229, s[52:55], s60 offen offset:1024 lds
 v_mul_f32 v249, v242, v163
 v_mfma_f32_16x16x32_bf16 v[164:167], a[16:19], v[140:143], v[164:167]
 ds_read_b64_tr_b16 a[66:67], v237 offset:30720
 v_exp_f32 v246, v246
 v_mfma_f32_16x16x32_bf16 v[164:167], a[12:15], v[136:139], v[164:167]
 ds_read_b64_tr_b16 a[68:69], v237 offset:32768
 v_exp_f32 v247, v247
 v_mfma_f32_16x16x32_bf16 v[164:167], a[8:11], v[132:135], v[164:167]
 ds_read_b64_tr_b16 a[70:71], v237 offset:34816
 v_exp_f32 v248, v248
 v_mfma_f32_16x16x32_bf16 v[164:167], a[4:7], v[128:131], v[164:167]
 v_exp_f32 v249, v249
 v_fma_f32 v246, v246, v244, v244
 v_mfma_f32_16x16x32_bf16 v[164:167], a[0:3], v[124:127], v[164:167]
 s_waitcnt lgkmcnt(10)
 v_fma_f32 v247, v247, v244, v244
 v_fma_f32 v248, v248, v244, v244
 v_mfma_f32_16x16x32_bf16 v[168:171], a[36:39], v[52:55], v[168:171]
 ds_read_b64_tr_b16 a[0:1], v238 offset:0
 ds_read_b64_tr_b16 a[2:3], v238 offset:2048
 buffer_load_dwordx4 v230, s[52:55], s60 offen offset:2048 lds
 v_mfma_f32_16x16x32_bf16 v[168:171], a[40:43], v[56:59], v[168:171]
 ds_read_b64_tr_b16 a[4:5], v238 offset:4096
 v_fma_f32 v249, v249, v244, v244
 v_mfma_f32_16x16x32_bf16 v[168:171], a[44:47], v[60:63], v[168:171]
 ds_read_b64_tr_b16 a[6:7], v238 offset:6144
 v_rcp_f32 v246, v246
 v_mfma_f32_16x16x32_bf16 v[168:171], a[48:51], v[64:67], v[168:171]
 s_waitcnt lgkmcnt(4)
 ds_read_b64_tr_b16 a[8:9], v238 offset:8192
 v_rcp_f32 v247, v247
 v_mfma_f32_16x16x32_bf16 v[168:171], a[52:55], v[68:71], v[168:171]
 ds_read_b64_tr_b16 a[10:11], v238 offset:10240
 v_rcp_f32 v248, v248
 v_mfma_f32_16x16x32_bf16 v[168:171], a[56:59], v[72:75], v[168:171]
 ds_read_b64_tr_b16 a[12:13], v238 offset:12288
 buffer_load_dwordx4 v231, s[52:55], s60 offen offset:3072 lds
 v_mfma_f32_16x16x32_bf16 v[168:171], a[60:63], v[76:79], v[168:171]
 ds_read_b64_tr_b16 a[14:15], v238 offset:14336
 v_rcp_f32 v249, v249
 v_mul_f32 v160, v160, v246
 v_mfma_f32_16x16x32_bf16 v[168:171], a[64:67], v[80:83], v[168:171]
 ds_read_b64_tr_b16 a[16:17], v238 offset:16384
 v_mul_f32 v161, v161, v247
 v_mul_f32 v162, v162, v248
 v_mfma_f32_16x16x32_bf16 v[168:171], a[68:71], v[84:87], v[168:171]
 ds_read_b64_tr_b16 a[18:19], v238 offset:18432
 ds_read_b64_tr_b16 a[20:21], v238 offset:20480
 v_mul_f32 v163, v163, v249
 v_mfma_f32_16x16x32_bf16 v[172:175], a[68:71], v[156:159], v[172:175]
 ds_read_b64_tr_b16 a[22:23], v238 offset:22528
 v_mul_f32 v246, v243, v164
 v_mul_f32 v247, v243, v165
 v_mfma_f32_16x16x32_bf16 v[172:175], a[64:67], v[152:155], v[172:175]
 ds_read_b64_tr_b16 a[24:25], v238 offset:24576
 v_mul_f32 v248, v243, v166
 v_mul_f32 v249, v243, v167
 v_mfma_f32_16x16x32_bf16 v[172:175], a[60:63], v[148:151], v[172:175]
 ds_read_b64_tr_b16 a[26:27], v238 offset:26624
 s_add_u32 m0, s61, 8192
 s_add_u32 s60, s62, 1179648
 buffer_load_dwordx4 v228, s[52:55], s60 offen offset:0 lds
 v_mfma_f32_16x16x32_bf16 v[172:175], a[56:59], v[144:147], v[172:175]
 ds_read_b64_tr_b16 a[28:29], v238 offset:28672
 v_mfma_f32_16x16x32_bf16 v[172:175], a[52:55], v[140:143], v[172:175]
 ds_read_b64_tr_b16 a[30:31], v238 offset:30720
 v_exp_f32 v246, v246
 v_mfma_f32_16x16x32_bf16 v[172:175], a[48:51], v[136:139], v[172:175]
 ds_read_b64_tr_b16 a[32:33], v238 offset:32768
 v_exp_f32 v247, v247
 v_mfma_f32_16x16x32_bf16 v[172:175], a[44:47], v[132:135], v[172:175]
 ds_read_b64_tr_b16 a[34:35], v238 offset:34816
 v_exp_f32 v248, v248
 v_mfma_f32_16x16x32_bf16 v[172:175], a[40:43], v[128:131], v[172:175]
 v_exp_f32 v249, v249
 v_fma_f32 v246, v246, v245, v245
 v_mfma_f32_16x16x32_bf16 v[172:175], a[36:39], v[124:127], v[172:175]
 s_waitcnt lgkmcnt(10)
 v_fma_f32 v247, v247, v245, v245
 v_fma_f32 v248, v248, v245, v245
 v_mfma_f32_16x16x32_bf16 v[176:179], a[0:3], v[52:55], v[176:179]
 ds_read_b64_tr_b16 a[36:37], v239 offset:0
 ds_read_b64_tr_b16 a[38:39], v239 offset:2048
 v_fma_f32 v249, v249, v245, v245
 v_mfma_f32_16x16x32_bf16 v[176:179], a[4:7], v[56:59], v[176:179]
 ds_read_b64_tr_b16 a[40:41], v239 offset:4096
 v_rcp_f32 v246, v246
 v_mfma_f32_16x16x32_bf16 v[176:179], a[8:11], v[60:63], v[176:179]
 ds_read_b64_tr_b16 a[42:43], v239 offset:6144
 v_rcp_f32 v247, v247
 v_mfma_f32_16x16x32_bf16 v[176:179], a[12:15], v[64:67], v[176:179]
 s_waitcnt lgkmcnt(4)
 ds_read_b64_tr_b16 a[44:45], v239 offset:8192
 v_mfma_f32_16x16x32_bf16 v[176:179], a[16:19], v[68:71], v[176:179]
 ds_read_b64_tr_b16 a[46:47], v239 offset:10240
 v_rcp_f32 v248, v248
 v_mfma_f32_16x16x32_bf16 v[176:179], a[20:23], v[72:75], v[176:179]
 ds_read_b64_tr_b16 a[48:49], v239 offset:12288
 v_rcp_f32 v249, v249
 v_mul_f32 v164, v164, v246
 v_mfma_f32_16x16x32_bf16 v[176:179], a[24:27], v[76:79], v[176:179]
 ds_read_b64_tr_b16 a[50:51], v239 offset:14336
 v_mul_f32 v165, v165, v247
 v_mul_f32 v166, v166, v248
 v_mfma_f32_16x16x32_bf16 v[176:179], a[28:31], v[80:83], v[176:179]
 ds_read_b64_tr_b16 a[52:53], v239 offset:16384
 v_mul_f32 v167, v167, v249
 v_mul_f32 v246, v242, v168
 v_mfma_f32_16x16x32_bf16 v[176:179], a[32:35], v[84:87], v[176:179]
 ds_read_b64_tr_b16 a[54:55], v239 offset:18432
 ds_read_b64_tr_b16 a[56:57], v239 offset:20480
 v_mul_f32 v247, v242, v169
 v_mfma_f32_16x16x32_bf16 v[180:183], a[32:35], v[156:159], v[180:183]
 ds_read_b64_tr_b16 a[58:59], v239 offset:22528
 v_mul_f32 v248, v242, v170
 v_mul_f32 v249, v242, v171
 v_mfma_f32_16x16x32_bf16 v[180:183], a[28:31], v[152:155], v[180:183]
 ds_read_b64_tr_b16 a[60:61], v239 offset:24576
 v_exp_f32 v246, v246
 v_mfma_f32_16x16x32_bf16 v[180:183], a[24:27], v[148:151], v[180:183]
 ds_read_b64_tr_b16 a[62:63], v239 offset:26624
 v_exp_f32 v247, v247
 v_mfma_f32_16x16x32_bf16 v[180:183], a[20:23], v[144:147], v[180:183]
 ds_read_b64_tr_b16 a[64:65], v239 offset:28672
 v_exp_f32 v248, v248
 v_mfma_f32_16x16x32_bf16 v[180:183], a[16:19], v[140:143], v[180:183]
 ds_read_b64_tr_b16 a[66:67], v239 offset:30720
 v_exp_f32 v249, v249
 v_mfma_f32_16x16x32_bf16 v[180:183], a[12:15], v[136:139], v[180:183]
 ds_read_b64_tr_b16 a[68:69], v239 offset:32768
 v_fma_f32 v246, v246, v244, v244
 v_fma_f32 v247, v247, v244, v244
 v_mfma_f32_16x16x32_bf16 v[180:183], a[8:11], v[132:135], v[180:183]
 ds_read_b64_tr_b16 a[70:71], v239 offset:34816
 v_fma_f32 v248, v248, v244, v244
 v_fma_f32 v249, v249, v244, v244
 v_mfma_f32_16x16x32_bf16 v[180:183], a[4:7], v[128:131], v[180:183]
 v_rcp_f32 v246, v246
 v_mfma_f32_16x16x32_bf16 v[180:183], a[0:3], v[124:127], v[180:183]
 s_waitcnt lgkmcnt(0)
 s_barrier
 v_mfma_f32_16x16x32_bf16 v[184:187], a[36:39], v[52:55], v[184:187]
 v_add_u32 v236, 36864, v236
 v_add_u32 v237, 36864, v237
 v_add_u32 v238, 36864, v238
 v_add_u32 v239, 36864, v239
 ds_read_b64_tr_b16 a[0:1], v236 offset:0
 ds_read_b64_tr_b16 a[2:3], v236 offset:2048
 v_mfma_f32_16x16x32_bf16 v[184:187], a[40:43], v[56:59], v[184:187]
 ds_read_b64_tr_b16 a[4:5], v236 offset:4096
 v_mfma_f32_16x16x32_bf16 v[184:187], a[44:47], v[60:63], v[184:187]
 ds_read_b64_tr_b16 a[6:7], v236 offset:6144
 s_add_u32 m0, s61, 36864
 s_add_u32 s60, s62, 2654208
 buffer_load_dwordx4 v228, s[52:55], s60 offen offset:0 lds
 v_mfma_f32_16x16x32_bf16 v[184:187], a[48:51], v[64:67], v[184:187]
 ds_read_b64_tr_b16 a[8:9], v236 offset:8192
 v_mfma_f32_16x16x32_bf16 v[184:187], a[52:55], v[68:71], v[184:187]
 ds_read_b64_tr_b16 a[10:11], v236 offset:10240
 v_rcp_f32 v247, v247
 v_mfma_f32_16x16x32_bf16 v[184:187], a[56:59], v[72:75], v[184:187]
 ds_read_b64_tr_b16 a[12:13], v236 offset:12288
 v_rcp_f32 v248, v248
 v_mfma_f32_16x16x32_bf16 v[184:187], a[60:63], v[76:79], v[184:187]
 ds_read_b64_tr_b16 a[14:15], v236 offset:14336
 v_rcp_f32 v249, v249
 v_mul_f32 v168, v168, v246
 v_mfma_f32_16x16x32_bf16 v[184:187], a[64:67], v[80:83], v[184:187]
 ds_read_b64_tr_b16 a[16:17], v236 offset:16384
 buffer_load_dwordx4 v229, s[52:55], s60 offen offset:1024 lds
 v_mul_f32 v169, v169, v247
 v_mfma_f32_16x16x32_bf16 v[184:187], a[68:71], v[84:87], v[184:187]
 ds_read_b64_tr_b16 a[18:19], v236 offset:18432
 ds_read_b64_tr_b16 a[20:21], v236 offset:20480
 v_mul_f32 v170, v170, v248
 v_mfma_f32_16x16x32_bf16 v[188:191], a[68:71], v[156:159], v[188:191]
 ds_read_b64_tr_b16 a[22:23], v236 offset:22528
 v_mul_f32 v171, v171, v249
 v_mul_f32 v246, v243, v172
 v_mfma_f32_16x16x32_bf16 v[188:191], a[64:67], v[152:155], v[188:191]
 ds_read_b64_tr_b16 a[24:25], v236 offset:24576
 v_mul_f32 v247, v243, v173
 v_mul_f32 v248, v243, v174
 v_mfma_f32_16x16x32_bf16 v[188:191], a[60:63], v[148:151], v[188:191]
 ds_read_b64_tr_b16 a[26:27], v236 offset:26624
 v_mul_f32 v249, v243, v175
 v_mfma_f32_16x16x32_bf16 v[188:191], a[56:59], v[144:147], v[188:191]
 ds_read_b64_tr_b16 a[28:29], v236 offset:28672
 v_exp_f32 v246, v246
 v_mfma_f32_16x16x32_bf16 v[188:191], a[52:55], v[140:143], v[188:191]
 ds_read_b64_tr_b16 a[30:31], v236 offset:30720
 buffer_load_dwordx4 v230, s[52:55], s60 offen offset:2048 lds
 v_exp_f32 v247, v247
 v_mfma_f32_16x16x32_bf16 v[188:191], a[48:51], v[136:139], v[188:191]
 ds_read_b64_tr_b16 a[32:33], v236 offset:32768
 v_exp_f32 v248, v248
 v_mfma_f32_16x16x32_bf16 v[188:191], a[44:47], v[132:135], v[188:191]
 ds_read_b64_tr_b16 a[34:35], v236 offset:34816
 v_exp_f32 v249, v249
 v_mfma_f32_16x16x32_bf16 v[188:191], a[40:43], v[128:131], v[188:191]
 v_fma_f32 v246, v246, v245, v245
 v_fma_f32 v247, v247, v245, v245
 v_fma_f32 v248, v248, v245, v245
 v_mfma_f32_16x16x32_bf16 v[188:191], a[36:39], v[124:127], v[188:191]
 s_waitcnt lgkmcnt(10)
 v_fma_f32 v249, v249, v245, v245
 v_mfma_f32_16x16x32_bf16 v[192:195], a[0:3], v[16:19], 0
 ds_read_b64_tr_b16 a[36:37], v237 offset:0
 ds_read_b64_tr_b16 a[38:39], v237 offset:2048
 v_rcp_f32 v246, v246
 v_mfma_f32_16x16x32_bf16 v[192:195], a[4:7], v[20:23], v[192:195]
 ds_read_b64_tr_b16 a[40:41], v237 offset:4096
 buffer_load_dwordx4 v231, s[52:55], s60 offen offset:3072 lds
 v_mfma_f32_16x16x32_bf16 v[192:195], a[8:11], v[24:27], v[192:195]
 ds_read_b64_tr_b16 a[42:43], v237 offset:6144
 v_rcp_f32 v247, v247
 v_mfma_f32_16x16x32_bf16 v[192:195], a[12:15], v[28:31], v[192:195]
 s_waitcnt lgkmcnt(4)
 ds_read_b64_tr_b16 a[44:45], v237 offset:8192
 v_rcp_f32 v248, v248
 v_mfma_f32_16x16x32_bf16 v[192:195], a[16:19], v[32:35], v[192:195]
 ds_read_b64_tr_b16 a[46:47], v237 offset:10240
 v_rcp_f32 v249, v249
 v_mfma_f32_16x16x32_bf16 v[192:195], a[20:23], v[36:39], v[192:195]
 ds_read_b64_tr_b16 a[48:49], v237 offset:12288
 v_mul_f32 v172, v172, v246
 v_mul_f32 v173, v173, v247
 v_mfma_f32_16x16x32_bf16 v[192:195], a[24:27], v[40:43], v[192:195]
 ds_read_b64_tr_b16 a[50:51], v237 offset:14336
 s_add_u32 m0, s61, 40960
 s_add_u32 s60, s62, 3244032
 buffer_load_dwordx4 v228, s[52:55], s60 offen offset:0 lds
 v_mfma_f32_16x16x32_bf16 v[192:195], a[28:31], v[44:47], v[192:195]
 ds_read_b64_tr_b16 a[52:53], v237 offset:16384
 v_mul_f32 v174, v174, v248
 v_mfma_f32_16x16x32_bf16 v[192:195], a[32:35], v[48:51], v[192:195]
 ds_read_b64_tr_b16 a[54:55], v237 offset:18432
 ds_read_b64_tr_b16 a[56:57], v237 offset:20480
 v_mul_f32 v175, v175, v249
 v_mfma_f32_16x16x32_bf16 v[196:199], a[32:35], v[120:123], 0
 ds_read_b64_tr_b16 a[58:59], v237 offset:22528
 v_mul_f32 v246, v242, v176
 v_mul_f32 v247, v242, v177
 v_mfma_f32_16x16x32_bf16 v[196:199], a[28:31], v[116:119], v[196:199]
 ds_read_b64_tr_b16 a[60:61], v237 offset:24576
 v_mul_f32 v248, v242, v178
 v_mul_f32 v249, v242, v179
 v_mfma_f32_16x16x32_bf16 v[196:199], a[24:27], v[112:115], v[196:199]
 ds_read_b64_tr_b16 a[62:63], v237 offset:26624
 v_exp_f32 v246, v246
 v_mfma_f32_16x16x32_bf16 v[196:199], a[20:23], v[108:111], v[196:199]
 ds_read_b64_tr_b16 a[64:65], v237 offset:28672
 buffer_load_dwordx4 v229, s[52:55], s60 offen offset:1024 lds
 v_mfma_f32_16x16x32_bf16 v[196:199], a[16:19], v[104:107], v[196:199]
 ds_read_b64_tr_b16 a[66:67], v237 offset:30720
 v_exp_f32 v247, v247
 v_mfma_f32_16x16x32_bf16 v[196:199], a[12:15], v[100:103], v[196:199]
 ds_read_b64_tr_b16 a[68:69], v237 offset:32768
 v_exp_f32 v248, v248
 v_mfma_f32_16x16x32_bf16 v[196:199], a[8:11], v[96:99], v[196:199]
 ds_read_b64_tr_b16 a[70:71], v237 offset:34816
 v_exp_f32 v249, v249
 v_fma_f32 v246, v246, v244, v244
 v_mfma_f32_16x16x32_bf16 v[196:199], a[4:7], v[92:95], v[196:199]
 v_fma_f32 v247, v247, v244, v244
 v_fma_f32 v248, v248, v244, v244
 v_fma_f32 v249, v249, v244, v244
 v_mfma_f32_16x16x32_bf16 v[196:199], a[0:3], v[88:91], v[196:199]
 s_waitcnt lgkmcnt(10)
 v_rcp_f32 v246, v246
 v_mfma_f32_16x16x32_bf16 v[200:203], a[36:39], v[16:19], 0
 ds_read_b64_tr_b16 a[0:1], v238 offset:0
 ds_read_b64_tr_b16 a[2:3], v238 offset:2048
 s_branch L_c4_p1_s
L_c4_p1:
 s_branch L_c4_p5
L_c4_p1_s:
 buffer_load_dwordx4 v230, s[52:55], s60 offen offset:2048 lds
 v_mfma_f32_16x16x32_bf16 v[200:203], a[40:43], v[20:23], v[200:203]
 ds_read_b64_tr_b16 a[4:5], v238 offset:4096
 v_rcp_f32 v247, v247
 v_mfma_f32_16x16x32_bf16 v[200:203], a[44:47], v[24:27], v[200:203]
 ds_read_b64_tr_b16 a[6:7], v238 offset:6144
 v_rcp_f32 v248, v248
 v_mfma_f32_16x16x32_bf16 v[200:203], a[48:51], v[28:31], v[200:203]
 s_waitcnt lgkmcnt(4)
 ds_read_b64_tr_b16 a[8:9], v238 offset:8192
 v_mfma_f32_16x16x32_bf16 v[200:203], a[52:55], v[32:35], v[200:203]
 ds_read_b64_tr_b16 a[10:11], v238 offset:10240
 v_rcp_f32 v249, v249
 v_mul_f32 v176, v176, v246
 v_mfma_f32_16x16x32_bf16 v[200:203], a[56:59], v[36:39], v[200:203]
 ds_read_b64_tr_b16 a[12:13], v238 offset:12288
 buffer_load_dwordx4 v231, s[52:55], s60 offen offset:3072 lds
 v_mul_f32 v177, v177, v247
 v_mfma_f32_16x16x32_bf16 v[200:203], a[60:63], v[40:43], v[200:203]
 ds_read_b64_tr_b16 a[14:15], v238 offset:14336
 v_mul_f32 v178, v178, v248
 v_mul_f32 v179, v179, v249
 v_mfma_f32_16x16x32_bf16 v[200:203], a[64:67], v[44:47], v[200:203]
 ds_read_b64_tr_b16 a[16:17], v238 offset:16384
 v_mul_f32 v246, v243, v180
 v_mul_f32 v247, v243, v181
 v_mfma_f32_16x16x32_bf16 v[200:203], a[68:71], v[48:51], v[200:203]
 ds_read_b64_tr_b16 a[18:19], v238 offset:18432
 ds_read_b64_tr_b16 a[20:21], v238 offset:20480
 v_mul_f32 v248, v243, v182
 v_mfma_f32_16x16x32_bf16 v[204:207], a[68:71], v[120:123], 0
 ds_read_b64_tr_b16 a[22:23], v238 offset:22528
 v_mul_f32 v249, v243, v183
 v_mfma_f32_16x16x32_bf16 v[204:207], a[64:67], v[116:119], v[204:207]
 ds_read_b64_tr_b16 a[24:25], v238 offset:24576
 v_exp_f32 v246, v246
 v_mfma_f32_16x16x32_bf16 v[204:207], a[60:63], v[112:115], v[204:207]
 ds_read_b64_tr_b16 a[26:27], v238 offset:26624
 s_add_u32 m0, s61, 45056
 s_add_u32 s60, s62, 3833856
 buffer_load_dwordx4 v228, s[52:55], s60 offen offset:0 lds
 v_mfma_f32_16x16x32_bf16 v[204:207], a[56:59], v[108:111], v[204:207]
 ds_read_b64_tr_b16 a[28:29], v238 offset:28672
 s_waitcnt vmcnt(22)
 v_mov_b32 v4, s3
 buffer_store_dword v4, v3, s[96:99], s69 offen sc1
 s_add_u32 s69, s69, 0x20000
 v_mfma_f32_16x16x32_bf16 v[204:207], a[52:55], v[104:107], v[204:207]
 ds_read_b64_tr_b16 a[30:31], v238 offset:30720
 v_mfma_f32_16x16x32_bf16 v[204:207], a[48:51], v[100:103], v[204:207]
 ds_read_b64_tr_b16 a[32:33], v238 offset:32768
 v_exp_f32 v247, v247
 v_mfma_f32_16x16x32_bf16 v[204:207], a[44:47], v[96:99], v[204:207]
 ds_read_b64_tr_b16 a[34:35], v238 offset:34816
 v_exp_f32 v248, v248
 v_mfma_f32_16x16x32_bf16 v[204:207], a[40:43], v[92:95], v[204:207]
 v_exp_f32 v249, v249
 v_fma_f32 v246, v246, v245, v245
 v_mfma_f32_16x16x32_bf16 v[204:207], a[36:39], v[88:91], v[204:207]
 s_waitcnt lgkmcnt(10)
 v_fma_f32 v247, v247, v245, v245
 v_fma_f32 v248, v248, v245, v245
 v_mfma_f32_16x16x32_bf16 v[208:211], a[0:3], v[16:19], 0
 ds_read_b64_tr_b16 a[36:37], v239 offset:0
 ds_read_b64_tr_b16 a[38:39], v239 offset:2048
 v_fma_f32 v249, v249, v245, v245
 v_mfma_f32_16x16x32_bf16 v[208:211], a[4:7], v[20:23], v[208:211]
 ds_read_b64_tr_b16 a[40:41], v239 offset:4096
 v_rcp_f32 v246, v246
 v_mfma_f32_16x16x32_bf16 v[208:211], a[8:11], v[24:27], v[208:211]
 ds_read_b64_tr_b16 a[42:43], v239 offset:6144
 v_rcp_f32 v247, v247
 v_mfma_f32_16x16x32_bf16 v[208:211], a[12:15], v[28:31], v[208:211]
 s_waitcnt lgkmcnt(4)
 ds_read_b64_tr_b16 a[44:45], v239 offset:8192
 v_mfma_f32_16x16x32_bf16 v[208:211], a[16:19], v[32:35], v[208:211]
 ds_read_b64_tr_b16 a[46:47], v239 offset:10240
 v_rcp_f32 v248, v248
 v_mfma_f32_16x16x32_bf16 v[208:211], a[20:23], v[36:39], v[208:211]
 ds_read_b64_tr_b16 a[48:49], v239 offset:12288
 v_rcp_f32 v249, v249
 v_mul_f32 v180, v180, v246
 v_mfma_f32_16x16x32_bf16 v[208:211], a[24:27], v[40:43], v[208:211]
 ds_read_b64_tr_b16 a[50:51], v239 offset:14336
 v_mul_f32 v181, v181, v247
 v_mul_f32 v182, v182, v248
 v_mfma_f32_16x16x32_bf16 v[208:211], a[28:31], v[44:47], v[208:211]
 ds_read_b64_tr_b16 a[52:53], v239 offset:16384
 v_mul_f32 v183, v183, v249
 v_mul_f32 v246, v242, v184
 v_mfma_f32_16x16x32_bf16 v[208:211], a[32:35], v[48:51], v[208:211]
 ds_read_b64_tr_b16 a[54:55], v239 offset:18432
 ds_read_b64_tr_b16 a[56:57], v239 offset:20480
 v_mul_f32 v247, v242, v185
 v_mfma_f32_16x16x32_bf16 v[212:215], a[32:35], v[120:123], 0
 ds_read_b64_tr_b16 a[58:59], v239 offset:22528
 v_mul_f32 v248, v242, v186
 v_mul_f32 v249, v242, v187
 v_mfma_f32_16x16x32_bf16 v[212:215], a[28:31], v[116:119], v[212:215]
 ds_read_b64_tr_b16 a[60:61], v239 offset:24576
 v_exp_f32 v246, v246
 v_mfma_f32_16x16x32_bf16 v[212:215], a[24:27], v[112:115], v[212:215]
 ds_read_b64_tr_b16 a[62:63], v239 offset:26624
 v_exp_f32 v247, v247
 v_mfma_f32_16x16x32_bf16 v[212:215], a[20:23], v[108:111], v[212:215]
 ds_read_b64_tr_b16 a[64:65], v239 offset:28672
 v_exp_f32 v248, v248
 v_mfma_f32_16x16x32_bf16 v[212:215], a[16:19], v[104:107], v[212:215]
 ds_read_b64_tr_b16 a[66:67], v239 offset:30720
 v_exp_f32 v249, v249
 v_mfma_f32_16x16x32_bf16 v[212:215], a[12:15], v[100:103], v[212:215]
 ds_read_b64_tr_b16 a[68:69], v239 offset:32768
 v_fma_f32 v246, v246, v244, v244
 v_fma_f32 v247, v247, v244, v244
 v_mfma_f32_16x16x32_bf16 v[212:215], a[8:11], v[96:99], v[212:215]
 ds_read_b64_tr_b16 a[70:71], v239 offset:34816
 v_fma_f32 v248, v248, v244, v244
 v_fma_f32 v249, v249, v244, v244
 v_mfma_f32_16x16x32_bf16 v[212:215], a[4:7], v[92:95], v[212:215]
 v_rcp_f32 v246, v246
 v_mfma_f32_16x16x32_bf16 v[212:215], a[0:3], v[88:91], v[212:215]
 s_waitcnt vmcnt(19) lgkmcnt(0)
 s_barrier
 v_mfma_f32_16x16x32_bf16 v[216:219], a[36:39], v[16:19], 0
 v_add_u32 v236, 36864, v236
 v_add_u32 v237, 36864, v237
 v_add_u32 v238, 36864, v238
 v_add_u32 v239, 36864, v239
 ds_read_b64_tr_b16 a[0:1], v236 offset:0
 ds_read_b64_tr_b16 a[2:3], v236 offset:2048
 v_mfma_f32_16x16x32_bf16 v[216:219], a[40:43], v[20:23], v[216:219]
 ds_read_b64_tr_b16 a[4:5], v236 offset:4096
 v_mfma_f32_16x16x32_bf16 v[216:219], a[44:47], v[24:27], v[216:219]
 ds_read_b64_tr_b16 a[6:7], v236 offset:6144
 s_add_u32 m0, s61, 73728
 s_add_u32 s60, s63, 0
 buffer_load_dwordx4 v9, s[48:51], s60 offen offset:0 sc1 lds
 v_mfma_f32_16x16x32_bf16 v[216:219], a[48:51], v[28:31], v[216:219]
 ds_read_b64_tr_b16 a[8:9], v236 offset:8192
 v_mfma_f32_16x16x32_bf16 v[216:219], a[52:55], v[32:35], v[216:219]
 ds_read_b64_tr_b16 a[10:11], v236 offset:10240
 v_rcp_f32 v247, v247
 v_mfma_f32_16x16x32_bf16 v[216:219], a[56:59], v[36:39], v[216:219]
 ds_read_b64_tr_b16 a[12:13], v236 offset:12288
 v_rcp_f32 v248, v248
 v_mfma_f32_16x16x32_bf16 v[216:219], a[60:63], v[40:43], v[216:219]
 ds_read_b64_tr_b16 a[14:15], v236 offset:14336
 v_rcp_f32 v249, v249
 v_mul_f32 v184, v184, v246
 v_mfma_f32_16x16x32_bf16 v[216:219], a[64:67], v[44:47], v[216:219]
 ds_read_b64_tr_b16 a[16:17], v236 offset:16384
 buffer_load_dwordx4 v9, s[48:51], s60 offen offset:1024 sc1 lds
 v_mul_f32 v185, v185, v247
 v_mfma_f32_16x16x32_bf16 v[216:219], a[68:71], v[48:51], v[216:219]
 ds_read_b64_tr_b16 a[18:19], v236 offset:18432
 ds_read_b64_tr_b16 a[20:21], v236 offset:20480
 v_mul_f32 v186, v186, v248
 v_mfma_f32_16x16x32_bf16 v[220:223], a[68:71], v[120:123], 0
 ds_read_b64_tr_b16 a[22:23], v236 offset:22528
 v_mul_f32 v187, v187, v249
 v_mul_f32 v246, v243, v188
 v_mfma_f32_16x16x32_bf16 v[220:223], a[64:67], v[116:119], v[220:223]
 ds_read_b64_tr_b16 a[24:25], v236 offset:24576
 v_mul_f32 v247, v243, v189
 v_mul_f32 v248, v243, v190
 v_mfma_f32_16x16x32_bf16 v[220:223], a[60:63], v[112:115], v[220:223]
 ds_read_b64_tr_b16 a[26:27], v236 offset:26624
 v_mul_f32 v249, v243, v191
 v_mfma_f32_16x16x32_bf16 v[220:223], a[56:59], v[108:111], v[220:223]
 ds_read_b64_tr_b16 a[28:29], v236 offset:28672
 v_exp_f32 v246, v246
 v_mfma_f32_16x16x32_bf16 v[220:223], a[52:55], v[104:107], v[220:223]
 ds_read_b64_tr_b16 a[30:31], v236 offset:30720
 buffer_load_dwordx4 v9, s[48:51], s60 offen offset:2048 sc1 lds
 v_exp_f32 v247, v247
 v_mfma_f32_16x16x32_bf16 v[220:223], a[48:51], v[100:103], v[220:223]
 ds_read_b64_tr_b16 a[32:33], v236 offset:32768
 v_exp_f32 v248, v248
 v_mfma_f32_16x16x32_bf16 v[220:223], a[44:47], v[96:99], v[220:223]
 ds_read_b64_tr_b16 a[34:35], v236 offset:34816
 v_exp_f32 v249, v249
 v_mfma_f32_16x16x32_bf16 v[220:223], a[40:43], v[92:95], v[220:223]
 v_fma_f32 v246, v246, v245, v245
 v_fma_f32 v247, v247, v245, v245
 v_fma_f32 v248, v248, v245, v245
 v_mfma_f32_16x16x32_bf16 v[220:223], a[36:39], v[88:91], v[220:223]
 s_waitcnt lgkmcnt(10)
 v_fma_f32 v249, v249, v245, v245
 v_mfma_f32_16x16x32_bf16 v[192:195], a[0:3], v[52:55], v[192:195]
 ds_read_b64_tr_b16 a[36:37], v237 offset:0
 ds_read_b64_tr_b16 a[38:39], v237 offset:2048
 v_rcp_f32 v246, v246
 v_mfma_f32_16x16x32_bf16 v[192:195], a[4:7], v[56:59], v[192:195]
 ds_read_b64_tr_b16 a[40:41], v237 offset:4096
 buffer_load_dwordx4 v9, s[48:51], s60 offen offset:3072 sc1 lds
 v_mfma_f32_16x16x32_bf16 v[192:195], a[8:11], v[60:63], v[192:195]
 ds_read_b64_tr_b16 a[42:43], v237 offset:6144
 v_rcp_f32 v247, v247
 v_mfma_f32_16x16x32_bf16 v[192:195], a[12:15], v[64:67], v[192:195]
 s_waitcnt lgkmcnt(4)
 ds_read_b64_tr_b16 a[44:45], v237 offset:8192
 v_rcp_f32 v248, v248
 v_mfma_f32_16x16x32_bf16 v[192:195], a[16:19], v[68:71], v[192:195]
 ds_read_b64_tr_b16 a[46:47], v237 offset:10240
 v_rcp_f32 v249, v249
 v_mfma_f32_16x16x32_bf16 v[192:195], a[20:23], v[72:75], v[192:195]
 ds_read_b64_tr_b16 a[48:49], v237 offset:12288
 v_mul_f32 v188, v188, v246
 v_mul_f32 v189, v189, v247
 v_mfma_f32_16x16x32_bf16 v[192:195], a[24:27], v[76:79], v[192:195]
 ds_read_b64_tr_b16 a[50:51], v237 offset:14336
 s_add_u32 m0, s61, 77824
 s_add_u32 s60, s63, 4096
 buffer_load_dwordx4 v9, s[48:51], s60 offen offset:0 sc1 lds
 v_mfma_f32_16x16x32_bf16 v[192:195], a[28:31], v[80:83], v[192:195]
 ds_read_b64_tr_b16 a[52:53], v237 offset:16384
 v_mul_f32 v190, v190, v248
 v_mfma_f32_16x16x32_bf16 v[192:195], a[32:35], v[84:87], v[192:195]
 ds_read_b64_tr_b16 a[54:55], v237 offset:18432
 ds_read_b64_tr_b16 a[56:57], v237 offset:20480
 v_mul_f32 v191, v191, v249
 v_mfma_f32_16x16x32_bf16 v[196:199], a[32:35], v[156:159], v[196:199]
 ds_read_b64_tr_b16 a[58:59], v237 offset:22528
 v_mfma_f32_16x16x32_bf16 v[196:199], a[28:31], v[152:155], v[196:199]
 ds_read_b64_tr_b16 a[60:61], v237 offset:24576
 v_mfma_f32_16x16x32_bf16 v[196:199], a[24:27], v[148:151], v[196:199]
 ds_read_b64_tr_b16 a[62:63], v237 offset:26624
 v_mul_f32 v192, v192, v160
 v_mul_f32 v193, v193, v161
 v_mul_f32 v194, v194, v162
 v_mfma_f32_16x16x32_bf16 v[196:199], a[20:23], v[144:147], v[196:199]
 ds_read_b64_tr_b16 a[64:65], v237 offset:28672
 buffer_load_dwordx4 v9, s[48:51], s60 offen offset:1024 sc1 lds
 v_mul_f32 v195, v195, v163
 v_mfma_f32_16x16x32_bf16 v[196:199], a[16:19], v[140:143], v[196:199]
 ds_read_b64_tr_b16 a[66:67], v237 offset:30720
 v_cvt_pk_bf16_f32 v192, v192, v193
 v_cvt_pk_bf16_f32 v193, v194, v195
 v_mfma_f32_16x16x32_bf16 v[196:199], a[12:15], v[136:139], v[196:199]
 ds_read_b64_tr_b16 a[68:69], v237 offset:32768
 s_add_u32 s77, s26, 1
 s_and_b32 s77, s77, 3
 s_mul_i32 s77, s77, 73728
 s_add_u32 s77, s77, s68
 v_mfma_f32_16x16x32_bf16 v[196:199], a[8:11], v[132:135], v[196:199]
 ds_read_b64_tr_b16 a[70:71], v237 offset:34816
 v_mfma_f32_16x16x32_bf16 v[196:199], a[4:7], v[128:131], v[196:199]
 v_accvgpr_write_b32 a192, v192
 v_accvgpr_write_b32 a193, v193
 v_mfma_f32_16x16x32_bf16 v[196:199], a[0:3], v[124:127], v[196:199]
 s_waitcnt lgkmcnt(10)
 v_mfma_f32_16x16x32_bf16 v[200:203], a[36:39], v[52:55], v[200:203]
 ds_read_b64_tr_b16 a[0:1], v238 offset:0
 ds_read_b64_tr_b16 a[2:3], v238 offset:2048
 buffer_load_dwordx4 v9, s[48:51], s60 offen offset:2048 sc1 lds
 s_add_u32 s78, s26, 2
 s_and_b32 s78, s78, 3
 s_mul_i32 s78, s78, 73728
 s_add_u32 s78, s78, s68
 v_mfma_f32_16x16x32_bf16 v[200:203], a[40:43], v[56:59], v[200:203]
 ds_read_b64_tr_b16 a[4:5], v238 offset:4096
 v_mfma_f32_16x16x32_bf16 v[200:203], a[44:47], v[60:63], v[200:203]
 ds_read_b64_tr_b16 a[6:7], v238 offset:6144
 v_mul_f32 v196, v196, v164
 v_mul_f32 v197, v197, v165
 v_mul_f32 v198, v198, v166
 v_mfma_f32_16x16x32_bf16 v[200:203], a[48:51], v[64:67], v[200:203]
 s_waitcnt lgkmcnt(4)
 ds_read_b64_tr_b16 a[8:9], v238 offset:8192
 v_mul_f32 v199, v199, v167
 v_mfma_f32_16x16x32_bf16 v[200:203], a[52:55], v[68:71], v[200:203]
 ds_read_b64_tr_b16 a[10:11], v238 offset:10240
 s_add_u32 s79, s26, 3
 s_and_b32 s79, s79, 3
 s_mul_i32 s79, s79, 73728
 s_add_u32 s79, s79, s68
 v_mfma_f32_16x16x32_bf16 v[200:203], a[56:59], v[72:75], v[200:203]
 ds_read_b64_tr_b16 a[12:13], v238 offset:12288
 buffer_load_dwordx4 v9, s[48:51], s60 offen offset:3072 sc1 lds
 v_mfma_f32_16x16x32_bf16 v[200:203], a[60:63], v[76:79], v[200:203]
 ds_read_b64_tr_b16 a[14:15], v238 offset:14336
 v_cvt_pk_bf16_f32 v196, v196, v197
 v_mfma_f32_16x16x32_bf16 v[200:203], a[64:67], v[80:83], v[200:203]
 ds_read_b64_tr_b16 a[16:17], v238 offset:16384
 v_cvt_pk_bf16_f32 v197, v198, v199
 v_accvgpr_write_b32 a196, v196
 v_mfma_f32_16x16x32_bf16 v[200:203], a[68:71], v[84:87], v[200:203]
 ds_read_b64_tr_b16 a[18:19], v238 offset:18432
 ds_read_b64_tr_b16 a[20:21], v238 offset:20480
 v_accvgpr_write_b32 a197, v197
 v_mfma_f32_16x16x32_bf16 v[204:207], a[68:71], v[156:159], v[204:207]
 ds_read_b64_tr_b16 a[22:23], v238 offset:22528
 v_mfma_f32_16x16x32_bf16 v[204:207], a[64:67], v[152:155], v[204:207]
 ds_read_b64_tr_b16 a[24:25], v238 offset:24576
 v_mfma_f32_16x16x32_bf16 v[204:207], a[60:63], v[148:151], v[204:207]
 ds_read_b64_tr_b16 a[26:27], v238 offset:26624
 s_add_u32 m0, s61, 81920
 s_add_u32 s60, s63, 8192
 buffer_load_dwordx4 v9, s[48:51], s60 offen offset:0 sc1 lds
 v_mul_f32 v200, v200, v168
 v_mul_f32 v201, v201, v169
 v_mfma_f32_16x16x32_bf16 v[204:207], a[56:59], v[144:147], v[204:207]
 ds_read_b64_tr_b16 a[28:29], v238 offset:28672
 v_mul_f32 v202, v202, v170
 v_mul_f32 v203, v203, v171
 v_mfma_f32_16x16x32_bf16 v[204:207], a[52:55], v[140:143], v[204:207]
 ds_read_b64_tr_b16 a[30:31], v238 offset:30720
 v_cvt_pk_bf16_f32 v194, v200, v201
 v_cvt_pk_bf16_f32 v195, v202, v203
 v_mfma_f32_16x16x32_bf16 v[204:207], a[48:51], v[136:139], v[204:207]
 ds_read_b64_tr_b16 a[32:33], v238 offset:32768
 v_accvgpr_write_b32 a194, v194
 v_accvgpr_write_b32 a195, v195
 v_mfma_f32_16x16x32_bf16 v[204:207], a[44:47], v[132:135], v[204:207]
 ds_read_b64_tr_b16 a[34:35], v238 offset:34816
 s_add_u32 s67, s66, 12288
 buffer_store_dwordx4 v[192:195], v9, s[8:11], s67 offen sc1
 v_mfma_f32_16x16x32_bf16 v[204:207], a[40:43], v[128:131], v[204:207]
 v_mfma_f32_16x16x32_bf16 v[204:207], a[36:39], v[124:127], v[204:207]
 s_waitcnt lgkmcnt(10)
 v_mfma_f32_16x16x32_bf16 v[208:211], a[0:3], v[52:55], v[208:211]
 ds_read_b64_tr_b16 a[36:37], v239 offset:0
 ds_read_b64_tr_b16 a[38:39], v239 offset:2048
 v_mfma_f32_16x16x32_bf16 v[208:211], a[4:7], v[56:59], v[208:211]
 ds_read_b64_tr_b16 a[40:41], v239 offset:4096
 v_mfma_f32_16x16x32_bf16 v[208:211], a[8:11], v[60:63], v[208:211]
 ds_read_b64_tr_b16 a[42:43], v239 offset:6144
 v_mul_f32 v204, v204, v172
 v_mul_f32 v205, v205, v173
 v_mul_f32 v206, v206, v174
 v_mfma_f32_16x16x32_bf16 v[208:211], a[12:15], v[64:67], v[208:211]
 s_waitcnt lgkmcnt(4)
 ds_read_b64_tr_b16 a[44:45], v239 offset:8192
 v_mul_f32 v207, v207, v175
 v_mfma_f32_16x16x32_bf16 v[208:211], a[16:19], v[68:71], v[208:211]
 ds_read_b64_tr_b16 a[46:47], v239 offset:10240
 buffer_load_dword v13, v12, s[96:99], s70 offen sc1
 v_cvt_pk_bf16_f32 v198, v204, v205
 v_mfma_f32_16x16x32_bf16 v[208:211], a[20:23], v[72:75], v[208:211]
 ds_read_b64_tr_b16 a[48:49], v239 offset:12288
 v_cvt_pk_bf16_f32 v199, v206, v207
 v_accvgpr_write_b32 a198, v198
 v_mfma_f32_16x16x32_bf16 v[208:211], a[24:27], v[76:79], v[208:211]
 ds_read_b64_tr_b16 a[50:51], v239 offset:14336
 v_accvgpr_write_b32 a199, v199
 v_mfma_f32_16x16x32_bf16 v[208:211], a[28:31], v[80:83], v[208:211]
 ds_read_b64_tr_b16 a[52:53], v239 offset:16384
 s_add_u32 s67, s66, 13312
 buffer_store_dwordx4 v[196:199], v9, s[8:11], s67 offen sc1
 v_mfma_f32_16x16x32_bf16 v[208:211], a[32:35], v[84:87], v[208:211]
 ds_read_b64_tr_b16 a[54:55], v239 offset:18432
 ds_read_b64_tr_b16 a[56:57], v239 offset:20480
 v_mfma_f32_16x16x32_bf16 v[212:215], a[32:35], v[156:159], v[212:215]
 ds_read_b64_tr_b16 a[58:59], v239 offset:22528
 v_mfma_f32_16x16x32_bf16 v[212:215], a[28:31], v[152:155], v[212:215]
 ds_read_b64_tr_b16 a[60:61], v239 offset:24576
 v_mfma_f32_16x16x32_bf16 v[212:215], a[24:27], v[148:151], v[212:215]
 ds_read_b64_tr_b16 a[62:63], v239 offset:26624
 v_mul_f32 v208, v208, v176
 v_mul_f32 v209, v209, v177
 v_mul_f32 v210, v210, v178
 v_mfma_f32_16x16x32_bf16 v[212:215], a[20:23], v[144:147], v[212:215]
 ds_read_b64_tr_b16 a[64:65], v239 offset:28672
 v_mul_f32 v211, v211, v179
 v_cvt_pk_bf16_f32 v208, v208, v209
 v_mfma_f32_16x16x32_bf16 v[212:215], a[16:19], v[140:143], v[212:215]
 ds_read_b64_tr_b16 a[66:67], v239 offset:30720
 v_cvt_pk_bf16_f32 v209, v210, v211
 v_accvgpr_write_b32 a200, v208
 v_mfma_f32_16x16x32_bf16 v[212:215], a[12:15], v[136:139], v[212:215]
 ds_read_b64_tr_b16 a[68:69], v239 offset:32768
 v_accvgpr_write_b32 a201, v209
 v_mfma_f32_16x16x32_bf16 v[212:215], a[8:11], v[132:135], v[212:215]
 ds_read_b64_tr_b16 a[70:71], v239 offset:34816
 v_mfma_f32_16x16x32_bf16 v[212:215], a[4:7], v[128:131], v[212:215]
 v_mfma_f32_16x16x32_bf16 v[212:215], a[0:3], v[124:127], v[212:215]
 s_waitcnt vmcnt(22) lgkmcnt(0)
 s_barrier
 v_mfma_f32_16x16x32_bf16 v[216:219], a[36:39], v[52:55], v[216:219]
 ds_read_b64_tr_b16 a[0:1], v240 offset:0
 ds_read_b64_tr_b16 a[2:3], v240 offset:1024
 v_mfma_f32_16x16x32_bf16 v[216:219], a[40:43], v[56:59], v[216:219]
 ds_read_b64_tr_b16 a[4:5], v240 offset:2048
 v_mfma_f32_16x16x32_bf16 v[216:219], a[44:47], v[60:63], v[216:219]
 ds_read_b64_tr_b16 a[6:7], v240 offset:3072
 s_add_u32 m0, s61, 110592
 s_add_u32 s60, s63, 36864
 buffer_load_dwordx4 v9, s[48:51], s60 offen offset:0 sc1 lds
 v_mul_f32 v212, v212, v180
 v_mul_f32 v213, v213, v181
 v_mfma_f32_16x16x32_bf16 v[216:219], a[48:51], v[64:67], v[216:219]
 ds_read_b64_tr_b16 a[8:9], v240 offset:4096
 v_mul_f32 v214, v214, v182
 v_mul_f32 v215, v215, v183
 v_mfma_f32_16x16x32_bf16 v[216:219], a[52:55], v[68:71], v[216:219]
 ds_read_b64_tr_b16 a[10:11], v240 offset:5120
 v_cvt_pk_bf16_f32 v212, v212, v213
 v_cvt_pk_bf16_f32 v213, v214, v215
 v_mfma_f32_16x16x32_bf16 v[216:219], a[56:59], v[72:75], v[216:219]
 ds_read_b64_tr_b16 a[12:13], v240 offset:6144
 v_accvgpr_write_b32 a204, v212
 v_accvgpr_write_b32 a205, v213
 v_mfma_f32_16x16x32_bf16 v[216:219], a[60:63], v[76:79], v[216:219]
 ds_read_b64_tr_b16 a[14:15], v240 offset:7168
 v_mfma_f32_16x16x32_bf16 v[216:219], a[64:67], v[80:83], v[216:219]
 ds_read_b64_tr_b16 a[16:17], v240 offset:8192
 buffer_load_dwordx4 v9, s[48:51], s60 offen offset:1024 sc1 lds
 v_mfma_f32_16x16x32_bf16 v[216:219], a[68:71], v[84:87], v[216:219]
 ds_read_b64_tr_b16 a[18:19], v240 offset:9216
 ds_read_b64_tr_b16 a[20:21], v240 offset:10240
 v_mfma_f32_16x16x32_bf16 v[220:223], a[68:71], v[156:159], v[220:223]
 ds_read_b64_tr_b16 a[22:23], v240 offset:11264
 v_mfma_f32_16x16x32_bf16 v[220:223], a[64:67], v[152:155], v[220:223]
 ds_read_b64_tr_b16 a[24:25], v240 offset:12288
 v_mfma_f32_16x16x32_bf16 v[220:223], a[60:63], v[148:151], v[220:223]
 ds_read_b64_tr_b16 a[26:27], v240 offset:13312
 v_mul_f32 v216, v216, v184
 v_mul_f32 v217, v217, v185
 v_mul_f32 v218, v218, v186
 v_mfma_f32_16x16x32_bf16 v[220:223], a[56:59], v[144:147], v[220:223]
 ds_read_b64_tr_b16 a[28:29], v240 offset:14336
 v_mul_f32 v219, v219, v187
 v_cvt_pk_bf16_f32 v210, v216, v217
 v_mfma_f32_16x16x32_bf16 v[220:223], a[52:55], v[140:143], v[220:223]
 ds_read_b64_tr_b16 a[30:31], v240 offset:15360
 buffer_load_dwordx4 v9, s[48:51], s60 offen offset:2048 sc1 lds
 v_cvt_pk_bf16_f32 v211, v218, v219
 v_mfma_f32_16x16x32_bf16 v[220:223], a[48:51], v[136:139], v[220:223]
 ds_read_b64_tr_b16 a[32:33], v240 offset:16384
 v_accvgpr_write_b32 a202, v210
 v_accvgpr_write_b32 a203, v211
 v_mfma_f32_16x16x32_bf16 v[220:223], a[44:47], v[132:135], v[220:223]
 ds_read_b64_tr_b16 a[34:35], v240 offset:17408
 s_add_u32 s67, s66, 14336
 buffer_store_dwordx4 v[208:211], v9, s[8:11], s67 offen sc1
 v_mfma_f32_16x16x32_bf16 v[220:223], a[40:43], v[128:131], v[220:223]
 v_mfma_f32_16x16x32_bf16 v[220:223], a[36:39], v[124:127], v[220:223]
 s_waitcnt lgkmcnt(10)
 v_mfma_f32_16x16x32_bf16 v[160:163], a[0:3], v[16:19], 0
 ds_read_b64_tr_b16 a[36:37], v241 offset:0
 ds_read_b64_tr_b16 a[38:39], v241 offset:1024
 v_mfma_f32_16x16x32_bf16 v[160:163], a[4:7], v[20:23], v[160:163]
 ds_read_b64_tr_b16 a[40:41], v241 offset:2048
 buffer_load_dwordx4 v9, s[48:51], s60 offen offset:3072 sc1 lds
 v_mfma_f32_16x16x32_bf16 v[160:163], a[8:11], v[24:27], v[160:163]
 ds_read_b64_tr_b16 a[42:43], v241 offset:3072
 v_mul_f32 v220, v220, v188
 v_mul_f32 v221, v221, v189
 v_mul_f32 v222, v222, v190
 v_mfma_f32_16x16x32_bf16 v[160:163], a[12:15], v[28:31], v[160:163]
 s_waitcnt lgkmcnt(4)
 ds_read_b64_tr_b16 a[44:45], v241 offset:4096
 v_mul_f32 v223, v223, v191
 v_mfma_f32_16x16x32_bf16 v[160:163], a[16:19], v[32:35], v[160:163]
 ds_read_b64_tr_b16 a[46:47], v241 offset:5120
 s_waitcnt vmcnt(6)
 v_cmp_ne_u32 vcc, s3, v13
 s_nop 4
 s_cbranch_vccnz L_slow_a
L_back_a:
 s_add_u32 s70, s70, 0x20000
 v_mfma_f32_16x16x32_bf16 v[160:163], a[20:23], v[36:39], v[160:163]
 ds_read_b64_tr_b16 a[48:49], v241 offset:6144
 v_mfma_f32_16x16x32_bf16 v[160:163], a[24:27], v[40:43], v[160:163]
 ds_read_b64_tr_b16 a[50:51], v241 offset:7168
 s_add_u32 m0, s61, 114688
 s_add_u32 s60, s63, 40960
 buffer_load_dwordx4 v9, s[48:51], s60 offen offset:0 sc1 lds
 v_mfma_f32_16x16x32_bf16 v[160:163], a[28:31], v[44:47], v[160:163]
 ds_read_b64_tr_b16 a[52:53], v241 offset:8192
 v_cvt_pk_bf16_f32 v214, v220, v221
 v_mfma_f32_16x16x32_bf16 v[160:163], a[32:35], v[48:51], v[160:163]
 ds_read_b64_tr_b16 a[54:55], v241 offset:9216
 ds_read_b64_tr_b16 a[56:57], v241 offset:10240
 s_add_u32 s27, s77, 0
 buffer_load_dwordx4 a[72:75], v9, s[8:11], s27 offen sc1
 v_mfma_f32_16x16x32_bf16 v[164:167], a[32:35], v[120:123], 0
 ds_read_b64_tr_b16 a[58:59], v241 offset:11264
 v_cvt_pk_bf16_f32 v215, v222, v223
 v_mfma_f32_16x16x32_bf16 v[164:167], a[28:31], v[116:119], v[164:167]
 ds_read_b64_tr_b16 a[60:61], v241 offset:12288
 v_accvgpr_write_b32 a206, v214
 v_accvgpr_write_b32 a207, v215
 v_mfma_f32_16x16x32_bf16 v[164:167], a[24:27], v[112:115], v[164:167]
 ds_read_b64_tr_b16 a[62:63], v241 offset:13312
 s_add_u32 s67, s66, 15360
 buffer_store_dwordx4 v[212:215], v9, s[8:11], s67 offen sc1
 v_mfma_f32_16x16x32_bf16 v[164:167], a[20:23], v[108:111], v[164:167]
 ds_read_b64_tr_b16 a[64:65], v241 offset:14336
 buffer_load_dwordx4 v9, s[48:51], s60 offen offset:1024 sc1 lds
 v_mfma_f32_16x16x32_bf16 v[164:167], a[16:19], v[104:107], v[164:167]
 ds_read_b64_tr_b16 a[66:67], v241 offset:15360
 v_mfma_f32_16x16x32_bf16 v[164:167], a[12:15], v[100:103], v[164:167]
 ds_read_b64_tr_b16 a[68:69], v241 offset:16384
 v_mfma_f32_16x16x32_bf16 v[164:167], a[8:11], v[96:99], v[164:167]
 ds_read_b64_tr_b16 a[70:71], v241 offset:17408
 v_mfma_f32_16x16x32_bf16 v[164:167], a[4:7], v[92:95], v[164:167]
 buffer_load_dwordx4 a[76:79], v9, s[8:11], s27 offen offset:1024 sc1
 v_mfma_f32_16x16x32_bf16 v[164:167], a[0:3], v[88:91], v[164:167]
 s_waitcnt lgkmcnt(10)
 v_mfma_f32_16x16x32_bf16 v[168:171], a[36:39], v[16:19], 0
 ds_read_b64_tr_b16 a[0:1], v240 offset:18432
 ds_read_b64_tr_b16 a[2:3], v240 offset:19456
 buffer_load_dwordx4 v9, s[48:51], s60 offen offset:2048 sc1 lds
 v_mfma_f32_16x16x32_bf16 v[168:171], a[40:43], v[20:23], v[168:171]
 ds_read_b64_tr_b16 a[4:5], v240 offset:20480
 v_mfma_f32_16x16x32_bf16 v[168:171], a[44:47], v[24:27], v[168:171]
 ds_read_b64_tr_b16 a[6:7], v240 offset:21504
 v_mfma_f32_16x16x32_bf16 v[168:171], a[48:51], v[28:31], v[168:171]
 s_waitcnt lgkmcnt(4)
 ds_read_b64_tr_b16 a[8:9], v240 offset:22528
 v_mfma_f32_16x16x32_bf16 v[168:171], a[52:55], v[32:35], v[168:171]
 ds_read_b64_tr_b16 a[10:11], v240 offset:23552
 v_mfma_f32_16x16x32_bf16 v[168:171], a[56:59], v[36:39], v[168:171]
 ds_read_b64_tr_b16 a[12:13], v240 offset:24576
 buffer_load_dwordx4 v9, s[48:51], s60 offen offset:3072 sc1 lds
 v_mfma_f32_16x16x32_bf16 v[168:171], a[60:63], v[40:43], v[168:171]
 ds_read_b64_tr_b16 a[14:15], v240 offset:25600
 v_mfma_f32_16x16x32_bf16 v[168:171], a[64:67], v[44:47], v[168:171]
 ds_read_b64_tr_b16 a[16:17], v240 offset:26624
 s_add_u32 s27, s78, 0
 buffer_load_dwordx4 a[80:83], v9, s[8:11], s27 offen sc1
 v_mfma_f32_16x16x32_bf16 v[168:171], a[68:71], v[48:51], v[168:171]
 ds_read_b64_tr_b16 a[18:19], v240 offset:27648
 ds_read_b64_tr_b16 a[20:21], v240 offset:28672
 v_mfma_f32_16x16x32_bf16 v[172:175], a[68:71], v[120:123], 0
 ds_read_b64_tr_b16 a[22:23], v240 offset:29696
 v_mfma_f32_16x16x32_bf16 v[172:175], a[64:67], v[116:119], v[172:175]
 ds_read_b64_tr_b16 a[24:25], v240 offset:30720
 v_mfma_f32_16x16x32_bf16 v[172:175], a[60:63], v[112:115], v[172:175]
 ds_read_b64_tr_b16 a[26:27], v240 offset:31744
 s_add_u32 m0, s61, 118784
 s_add_u32 s60, s63, 45056
 buffer_load_dwordx4 v9, s[48:51], s60 offen offset:0 sc1 lds
 v_mfma_f32_16x16x32_bf16 v[172:175], a[56:59], v[108:111], v[172:175]
 ds_read_b64_tr_b16 a[28:29], v240 offset:32768
 v_mfma_f32_16x16x32_bf16 v[172:175], a[52:55], v[104:107], v[172:175]
 ds_read_b64_tr_b16 a[30:31], v240 offset:33792
 v_mfma_f32_16x16x32_bf16 v[172:175], a[48:51], v[100:103], v[172:175]
 ds_read_b64_tr_b16 a[32:33], v240 offset:34816
 v_mfma_f32_16x16x32_bf16 v[172:175], a[44:47], v[96:99], v[172:175]
 ds_read_b64_tr_b16 a[34:35], v240 offset:35840
 v_mfma_f32_16x16x32_bf16 v[172:175], a[40:43], v[92:95], v[172:175]
 buffer_load_dwordx4 a[84:87], v9, s[8:11], s27 offen offset:1024 sc1
 v_mfma_f32_16x16x32_bf16 v[172:175], a[36:39], v[88:91], v[172:175]
 s_waitcnt lgkmcnt(10)
 v_mfma_f32_16x16x32_bf16 v[192:195], a[0:3], v[16:19], 0
 ds_read_b64_tr_b16 a[36:37], v241 offset:18432
 ds_read_b64_tr_b16 a[38:39], v241 offset:19456
 v_mfma_f32_16x16x32_bf16 v[192:195], a[4:7], v[20:23], v[192:195]
 ds_read_b64_tr_b16 a[40:41], v241 offset:20480
 v_mfma_f32_16x16x32_bf16 v[192:195], a[8:11], v[24:27], v[192:195]
 ds_read_b64_tr_b16 a[42:43], v241 offset:21504
 v_mfma_f32_16x16x32_bf16 v[192:195], a[12:15], v[28:31], v[192:195]
 s_waitcnt lgkmcnt(4)
 ds_read_b64_tr_b16 a[44:45], v241 offset:22528
 v_mfma_f32_16x16x32_bf16 v[192:195], a[16:19], v[32:35], v[192:195]
 ds_read_b64_tr_b16 a[46:47], v241 offset:23552
 v_mfma_f32_16x16x32_bf16 v[192:195], a[20:23], v[36:39], v[192:195]
 ds_read_b64_tr_b16 a[48:49], v241 offset:24576
 v_mfma_f32_16x16x32_bf16 v[192:195], a[24:27], v[40:43], v[192:195]
 ds_read_b64_tr_b16 a[50:51], v241 offset:25600
 v_mfma_f32_16x16x32_bf16 v[192:195], a[28:31], v[44:47], v[192:195]
 ds_read_b64_tr_b16 a[52:53], v241 offset:26624
 s_add_u32 s27, s79, 0
 buffer_load_dwordx4 a[88:91], v9, s[8:11], s27 offen sc1
 v_mfma_f32_16x16x32_bf16 v[192:195], a[32:35], v[48:51], v[192:195]
 ds_read_b64_tr_b16 a[54:55], v241 offset:27648
 ds_read_b64_tr_b16 a[56:57], v241 offset:28672
 v_mfma_f32_16x16x32_bf16 v[196:199], a[32:35], v[120:123], 0
 ds_read_b64_tr_b16 a[58:59], v241 offset:29696
 v_mfma_f32_16x16x32_bf16 v[196:199], a[28:31], v[116:119], v[196:199]
 ds_read_b64_tr_b16 a[60:61], v241 offset:30720
 v_mfma_f32_16x16x32_bf16 v[196:199], a[24:27], v[112:115], v[196:199]
 ds_read_b64_tr_b16 a[62:63], v241 offset:31744
 s_branch L_c4_p2_s
L_c4_p2:
 s_branch L_c4_p6
L_c4_p2_s:
 v_mfma_f32_16x16x32_bf16 v[196:199], a[20:23], v[108:111], v[196:199]
 ds_read_b64_tr_b16 a[64:65], v241 offset:32768
 v_mfma_f32_16x16x32_bf16 v[196:199], a[16:19], v[104:107], v[196:199]
 ds_read_b64_tr_b16 a[66:67], v241 offset:33792
 v_mfma_f32_16x16x32_bf16 v[196:199], a[12:15], v[100:103], v[196:199]
 ds_read_b64_tr_b16 a[68:69], v241 offset:34816
 v_mfma_f32_16x16x32_bf16 v[196:199], a[8:11], v[96:99], v[196:199]
 ds_read_b64_tr_b16 a[70:71], v241 offset:35840
 v_mfma_f32_16x16x32_bf16 v[196:199], a[4:7], v[92:95], v[196:199]
 buffer_load_dwordx4 a[92:95], v9, s[8:11], s27 offen offset:1024 sc1
 v_mfma_f32_16x16x32_bf16 v[196:199], a[0:3], v[88:91], v[196:199]
 s_waitcnt lgkmcnt(0)
 s_barrier
 v_mfma_f32_16x16x32_bf16 v[200:203], a[36:39], v[16:19], 0
 v_add_u32 v240, 36864, v240
 v_add_u32 v241, 36864, v241
 ds_read_b64_tr_b16 a[0:1], v240 offset:0
 ds_read_b64_tr_b16 a[2:3], v240 offset:1024
 v_mfma_f32_16x16x32_bf16 v[200:203], a[40:43], v[20:23], v[200:203]
 ds_read_b64_tr_b16 a[4:5], v240 offset:2048
 v_mfma_f32_16x16x32_bf16 v[200:203], a[44:47], v[24:27], v[200:203]
 ds_read_b64_tr_b16 a[6:7], v240 offset:3072
 s_add_u32 m0, s61, 0
 s_add_u32 s60, s80, 73728
 buffer_load_dwordx4 v9, s[48:51], s60 offen offset:0 sc1 lds
 v_mfma_f32_16x16x32_bf16 v[200:203], a[48:51], v[28:31], v[200:203]
 ds_read_b64_tr_b16 a[8:9], v240 offset:4096
 v_mfma_f32_16x16x32_bf16 v[200:203], a[52:55], v[32:35], v[200:203]
 ds_read_b64_tr_b16 a[10:11], v240 offset:5120
 v_mfma_f32_16x16x32_bf16 v[200:203], a[56:59], v[36:39], v[200:203]
 ds_read_b64_tr_b16 a[12:13], v240 offset:6144
 v_mfma_f32_16x16x32_bf16 v[200:203], a[60:63], v[40:43], v[200:203]
 ds_read_b64_tr_b16 a[14:15], v240 offset:7168
 v_mfma_f32_16x16x32_bf16 v[200:203], a[64:67], v[44:47], v[200:203]
 ds_read_b64_tr_b16 a[16:17], v240 offset:8192
 s_add_u32 s60, s80, 73728
 buffer_load_dwordx4 v9, s[48:51], s60 offen offset:1024 sc1 lds
 v_mfma_f32_16x16x32_bf16 v[200:203], a[68:71], v[48:51], v[200:203]
 ds_read_b64_tr_b16 a[18:19], v240 offset:9216
 ds_read_b64_tr_b16 a[20:21], v240 offset:10240
 v_mfma_f32_16x16x32_bf16 v[204:207], a[68:71], v[120:123], 0
 ds_read_b64_tr_b16 a[22:23], v240 offset:11264
 v_mfma_f32_16x16x32_bf16 v[204:207], a[64:67], v[116:119], v[204:207]
 ds_read_b64_tr_b16 a[24:25], v240 offset:12288
 v_mfma_f32_16x16x32_bf16 v[204:207], a[60:63], v[112:115], v[204:207]
 ds_read_b64_tr_b16 a[26:27], v240 offset:13312
 v_mfma_f32_16x16x32_bf16 v[204:207], a[56:59], v[108:111], v[204:207]
 ds_read_b64_tr_b16 a[28:29], v240 offset:14336
 v_mfma_f32_16x16x32_bf16 v[204:207], a[52:55], v[104:107], v[204:207]
 ds_read_b64_tr_b16 a[30:31], v240 offset:15360
 s_add_u32 s60, s81, 71680
 buffer_load_dwordx4 v9, s[48:51], s60 offen offset:2048 sc1 lds
 v_mfma_f32_16x16x32_bf16 v[204:207], a[48:51], v[100:103], v[204:207]
 ds_read_b64_tr_b16 a[32:33], v240 offset:16384
 v_mfma_f32_16x16x32_bf16 v[204:207], a[44:47], v[96:99], v[204:207]
 ds_read_b64_tr_b16 a[34:35], v240 offset:17408
 v_mfma_f32_16x16x32_bf16 v[204:207], a[40:43], v[92:95], v[204:207]
 v_mfma_f32_16x16x32_bf16 v[204:207], a[36:39], v[88:91], v[204:207]
 s_waitcnt lgkmcnt(10)
 v_mfma_f32_16x16x32_bf16 v[160:163], a[0:3], v[52:55], v[160:163]
 ds_read_b64_tr_b16 a[36:37], v241 offset:0
 ds_read_b64_tr_b16 a[38:39], v241 offset:1024
 v_mfma_f32_16x16x32_bf16 v[160:163], a[4:7], v[56:59], v[160:163]
 ds_read_b64_tr_b16 a[40:41], v241 offset:2048
 s_add_u32 s60, s81, 71680
 buffer_load_dwordx4 v9, s[48:51], s60 offen offset:3072 sc1 lds
 v_mfma_f32_16x16x32_bf16 v[160:163], a[8:11], v[60:63], v[160:163]
 ds_read_b64_tr_b16 a[42:43], v241 offset:3072
 v_mfma_f32_16x16x32_bf16 v[160:163], a[12:15], v[64:67], v[160:163]
 s_waitcnt lgkmcnt(4)
 ds_read_b64_tr_b16 a[44:45], v241 offset:4096
 v_mfma_f32_16x16x32_bf16 v[160:163], a[16:19], v[68:71], v[160:163]
 ds_read_b64_tr_b16 a[46:47], v241 offset:5120
 v_mfma_f32_16x16x32_bf16 v[160:163], a[20:23], v[72:75], v[160:163]
 ds_read_b64_tr_b16 a[48:49], v241 offset:6144
 v_mfma_f32_16x16x32_bf16 v[160:163], a[24:27], v[76:79], v[160:163]
 ds_read_b64_tr_b16 a[50:51], v241 offset:7168
 s_add_u32 m0, s61, 4096
 s_add_u32 s60, s82, 73728
 buffer_load_dwordx4 v9, s[48:51], s60 offen offset:0 sc1 lds
 v_mfma_f32_16x16x32_bf16 v[160:163], a[28:31], v[80:83], v[160:163]
 ds_read_b64_tr_b16 a[52:53], v241 offset:8192
 v_mfma_f32_16x16x32_bf16 v[160:163], a[32:35], v[84:87], v[160:163]
 ds_read_b64_tr_b16 a[54:55], v241 offset:9216
 ds_read_b64_tr_b16 a[56:57], v241 offset:10240
 s_add_u32 s27, s77, 2048
 buffer_load_dwordx4 a[96:99], v9, s[8:11], s27 offen sc1
 v_mfma_f32_16x16x32_bf16 v[164:167], a[32:35], v[156:159], v[164:167]
 ds_read_b64_tr_b16 a[58:59], v241 offset:11264
 v_mfma_f32_16x16x32_bf16 v[164:167], a[28:31], v[152:155], v[164:167]
 ds_read_b64_tr_b16 a[60:61], v241 offset:12288
 v_mfma_f32_16x16x32_bf16 v[164:167], a[24:27], v[148:151], v[164:167]
 ds_read_b64_tr_b16 a[62:63], v241 offset:13312
 v_mul_f32 v246, v242, v160
 v_mul_f32 v247, v242, v161
 v_mul_f32 v248, v242, v162
 v_mfma_f32_16x16x32_bf16 v[164:167], a[20:23], v[144:147], v[164:167]
 ds_read_b64_tr_b16 a[64:65], v241 offset:14336
 s_add_u32 s60, s82, 73728
 buffer_load_dwordx4 v9, s[48:51], s60 offen offset:1024 sc1 lds
 v_mfma_f32_16x16x32_bf16 v[164:167], a[16:19], v[140:143], v[164:167]
 ds_read_b64_tr_b16 a[66:67], v241 offset:15360
 v_mul_f32 v249, v242, v163
 v_mfma_f32_16x16x32_bf16 v[164:167], a[12:15], v[136:139], v[164:167]
 ds_read_b64_tr_b16 a[68:69], v241 offset:16384
 v_exp_f32 v246, v246
 v_mfma_f32_16x16x32_bf16 v[164:167], a[8:11], v[132:135], v[164:167]
 ds_read_b64_tr_b16 a[70:71], v241 offset:17408
 v_exp_f32 v247, v247
 v_mfma_f32_16x16x32_bf16 v[164:167], a[4:7], v[128:131], v[164:167]
 buffer_load_dwordx4 a[100:103], v9, s[8:11], s27 offen offset:1024 sc1
 v_exp_f32 v248, v248
 v_mfma_f32_16x16x32_bf16 v[164:167], a[0:3], v[124:127], v[164:167]
 s_waitcnt lgkmcnt(10)
 v_exp_f32 v249, v249
 v_fma_f32 v246, v246, v244, v244
 v_mfma_f32_16x16x32_bf16 v[168:171], a[36:39], v[52:55], v[168:171]
 ds_read_b64_tr_b16 a[0:1], v240 offset:18432
 ds_read_b64_tr_b16 a[2:3], v240 offset:19456
 s_add_u32 s60, s84, 71680
 buffer_load_dwordx4 v9, s[48:51], s60 offen offset:2048 sc1 lds
 v_mfma_f32_16x16x32_bf16 v[168:171], a[40:43], v[56:59], v[168:171]
 ds_read_b64_tr_b16 a[4:5], v240 offset:20480
 v_fma_f32 v247, v247, v244, v244
 v_mfma_f32_16x16x32_bf16 v[168:171], a[44:47], v[60:63], v[168:171]
 ds_read_b64_tr_b16 a[6:7], v240 offset:21504
 v_fma_f32 v248, v248, v244, v244
 v_fma_f32 v249, v249, v244, v244
 v_mfma_f32_16x16x32_bf16 v[168:171], a[48:51], v[64:67], v[168:171]
 s_waitcnt lgkmcnt(4)
 ds_read_b64_tr_b16 a[8:9], v240 offset:22528
 v_mfma_f32_16x16x32_bf16 v[168:171], a[52:55], v[68:71], v[168:171]
 ds_read_b64_tr_b16 a[10:11], v240 offset:23552
 v_rcp_f32 v246, v246
 v_mfma_f32_16x16x32_bf16 v[168:171], a[56:59], v[72:75], v[168:171]
 ds_read_b64_tr_b16 a[12:13], v240 offset:24576
 s_add_u32 s60, s80, 107520
 buffer_load_dwordx4 v9, s[48:51], s60 offen offset:3072 sc1 lds
 v_mfma_f32_16x16x32_bf16 v[168:171], a[60:63], v[76:79], v[168:171]
 ds_read_b64_tr_b16 a[14:15], v240 offset:25600
 v_rcp_f32 v247, v247
 v_mfma_f32_16x16x32_bf16 v[168:171], a[64:67], v[80:83], v[168:171]
 ds_read_b64_tr_b16 a[16:17], v240 offset:26624
 s_add_u32 s27, s78, 2048
 buffer_load_dwordx4 a[104:107], v9, s[8:11], s27 offen sc1
 v_mfma_f32_16x16x32_bf16 v[168:171], a[68:71], v[84:87], v[168:171]
 ds_read_b64_tr_b16 a[18:19], v240 offset:27648
 ds_read_b64_tr_b16 a[20:21], v240 offset:28672
 v_rcp_f32 v248, v248
 v_mfma_f32_16x16x32_bf16 v[172:175], a[68:71], v[156:159], v[172:175]
 ds_read_b64_tr_b16 a[22:23], v240 offset:29696
 v_rcp_f32 v249, v249
 v_mfma_f32_16x16x32_bf16 v[172:175], a[64:67], v[152:155], v[172:175]
 ds_read_b64_tr_b16 a[24:25], v240 offset:30720
 v_mul_f32 v160, v160, v246
 v_mul_f32 v161, v161, v247
 v_mfma_f32_16x16x32_bf16 v[172:175], a[60:63], v[148:151], v[172:175]
 ds_read_b64_tr_b16 a[26:27], v240 offset:31744
 s_add_u32 m0, s61, 8192
 s_add_u32 s60, s80, 111616
 buffer_load_dwordx4 v9, s[48:51], s60 offen offset:0 sc1 lds
 v_mfma_f32_16x16x32_bf16 v[172:175], a[56:59], v[144:147], v[172:175]
 ds_read_b64_tr_b16 a[28:29], v240 offset:32768
 v_mul_f32 v162, v162, v248
 v_mfma_f32_16x16x32_bf16 v[172:175], a[52:55], v[140:143], v[172:175]
 ds_read_b64_tr_b16 a[30:31], v240 offset:33792
 v_mul_f32 v163, v163, v249
 v_mul_f32 v246, v243, v164
 v_mfma_f32_16x16x32_bf16 v[172:175], a[48:51], v[136:139], v[172:175]
 ds_read_b64_tr_b16 a[32:33], v240 offset:34816
 v_mul_f32 v247, v243, v165
 v_mul_f32 v248, v243, v166
 v_mfma_f32_16x16x32_bf16 v[172:175], a[44:47], v[132:135], v[172:175]
 ds_read_b64_tr_b16 a[34:35], v240 offset:35840
 v_mul_f32 v249, v243, v167
 v_mfma_f32_16x16x32_bf16 v[172:175], a[40:43], v[128:131], v[172:175]
 buffer_load_dwordx4 a[108:111], v9, s[8:11], s27 offen offset:1024 sc1
 v_exp_f32 v246, v246
 v_mfma_f32_16x16x32_bf16 v[172:175], a[36:39], v[124:127], v[172:175]
 s_waitcnt lgkmcnt(10)
 v_exp_f32 v247, v247
 v_mfma_f32_16x16x32_bf16 v[192:195], a[0:3], v[52:55], v[192:195]
 ds_read_b64_tr_b16 a[36:37], v241 offset:18432
 ds_read_b64_tr_b16 a[38:39], v241 offset:19456
 v_exp_f32 v248, v248
 v_mfma_f32_16x16x32_bf16 v[192:195], a[4:7], v[56:59], v[192:195]
 ds_read_b64_tr_b16 a[40:41], v241 offset:20480
 v_exp_f32 v249, v249
 v_mfma_f32_16x16x32_bf16 v[192:195], a[8:11], v[60:63], v[192:195]
 ds_read_b64_tr_b16 a[42:43], v241 offset:21504
 v_fma_f32 v246, v246, v245, v245
 v_fma_f32 v247, v247, v245, v245
 v_mfma_f32_16x16x32_bf16 v[192:195], a[12:15], v[64:67], v[192:195]
 s_waitcnt lgkmcnt(4)
 ds_read_b64_tr_b16 a[44:45], v241 offset:22528
 v_fma_f32 v248, v248, v245, v245
 v_mfma_f32_16x16x32_bf16 v[192:195], a[16:19], v[68:71], v[192:195]
 ds_read_b64_tr_b16 a[46:47], v241 offset:23552
 s_waitcnt vmcnt(22)
 v_mov_b32 v4, s3
 buffer_store_dword v4, v3, s[96:99], s69 offen sc1
 s_add_u32 s69, s69, 0x20000
 v_mfma_f32_16x16x32_bf16 v[192:195], a[20:23], v[72:75], v[192:195]
 ds_read_b64_tr_b16 a[48:49], v241 offset:24576
 v_fma_f32 v249, v249, v245, v245
 v_mfma_f32_16x16x32_bf16 v[192:195], a[24:27], v[76:79], v[192:195]
 ds_read_b64_tr_b16 a[50:51], v241 offset:25600
 v_rcp_f32 v246, v246
 v_mfma_f32_16x16x32_bf16 v[192:195], a[28:31], v[80:83], v[192:195]
 ds_read_b64_tr_b16 a[52:53], v241 offset:26624
 s_add_u32 s27, s79, 2048
 buffer_load_dwordx4 a[112:115], v9, s[8:11], s27 offen sc1
 v_mfma_f32_16x16x32_bf16 v[192:195], a[32:35], v[84:87], v[192:195]
 ds_read_b64_tr_b16 a[54:55], v241 offset:27648
 ds_read_b64_tr_b16 a[56:57], v241 offset:28672
 v_mfma_f32_16x16x32_bf16 v[196:199], a[32:35], v[156:159], v[196:199]
 ds_read_b64_tr_b16 a[58:59], v241 offset:29696
 v_rcp_f32 v247, v247
 v_mfma_f32_16x16x32_bf16 v[196:199], a[28:31], v[152:155], v[196:199]
 ds_read_b64_tr_b16 a[60:61], v241 offset:30720
 v_rcp_f32 v248, v248
 v_mfma_f32_16x16x32_bf16 v[196:199], a[24:27], v[148:151], v[196:199]
 ds_read_b64_tr_b16 a[62:63], v241 offset:31744
 v_rcp_f32 v249, v249
 v_mul_f32 v164, v164, v246
 v_mfma_f32_16x16x32_bf16 v[196:199], a[20:23], v[144:147], v[196:199]
 ds_read_b64_tr_b16 a[64:65], v241 offset:32768
 v_mul_f32 v165, v165, v247
 v_mul_f32 v166, v166, v248
 v_mfma_f32_16x16x32_bf16 v[196:199], a[16:19], v[140:143], v[196:199]
 ds_read_b64_tr_b16 a[66:67], v241 offset:33792
 v_mul_f32 v167, v167, v249
 v_mul_f32 v192, v192, v160
 v_mfma_f32_16x16x32_bf16 v[196:199], a[12:15], v[136:139], v[196:199]
 ds_read_b64_tr_b16 a[68:69], v241 offset:34816
 v_mul_f32 v193, v193, v161
 v_mul_f32 v194, v194, v162
 v_mfma_f32_16x16x32_bf16 v[196:199], a[8:11], v[132:135], v[196:199]
 ds_read_b64_tr_b16 a[70:71], v241 offset:35840
 v_mul_f32 v195, v195, v163
 v_cvt_pk_bf16_f32 v192, v192, v193
 v_mfma_f32_16x16x32_bf16 v[196:199], a[4:7], v[128:131], v[196:199]
 buffer_load_dwordx4 a[116:119], v9, s[8:11], s27 offen offset:1024 sc1
 v_cvt_pk_bf16_f32 v193, v194, v195
 v_accvgpr_write_b32 a208, v192
 v_mfma_f32_16x16x32_bf16 v[196:199], a[0:3], v[124:127], v[196:199]
 s_waitcnt lgkmcnt(0)
 s_barrier
 v_mfma_f32_16x16x32_bf16 v[200:203], a[36:39], v[52:55], v[200:203]
 v_add_u32 v232, 73728, v232
 v_add_u32 v233, 73728, v233
 v_add_u32 v234, 73728, v234
 v_add_u32 v235, 73728, v235
 v_add_u32 v254, 73728, v254
 ds_read_b128 a[0:3], v232 offset:0
 v_mfma_f32_16x16x32_bf16 v[200:203], a[40:43], v[56:59], v[200:203]
 v_mfma_f32_16x16x32_bf16 v[200:203], a[44:47], v[60:63], v[200:203]
 ds_read_b128 a[4:7], v232 offset:9216
 s_add_u32 m0, s61, 36864
 s_add_u32 s60, s81, 110592
 buffer_load_dwordx4 v9, s[48:51], s60 offen offset:0 sc1 lds
 v_mfma_f32_16x16x32_bf16 v[200:203], a[48:51], v[64:67], v[200:203]
 v_accvgpr_write_b32 a209, v193
 v_mul_f32 v196, v196, v164
 v_mfma_f32_16x16x32_bf16 v[200:203], a[52:55], v[68:71], v[200:203]
 ds_read_b128 a[8:11], v232 offset:18432
 v_mul_f32 v197, v197, v165
 v_mul_f32 v198, v198, v166
 v_mfma_f32_16x16x32_bf16 v[200:203], a[56:59], v[72:75], v[200:203]
 v_mul_f32 v199, v199, v167
 v_mul_f32 v246, v242, v168
 v_mul_f32 v247, v242, v169
 v_mul_f32 v248, v242, v170
 v_mfma_f32_16x16x32_bf16 v[200:203], a[60:63], v[76:79], v[200:203]
 ds_read_b128 a[12:15], v232 offset:27648
 v_mul_f32 v249, v242, v171
 v_exp_f32 v246, v246
 v_exp_f32 v247, v247
 v_mfma_f32_16x16x32_bf16 v[200:203], a[64:67], v[80:83], v[200:203]
 s_add_u32 s60, s81, 110592
 buffer_load_dwordx4 v9, s[48:51], s60 offen offset:1024 sc1 lds
 v_exp_f32 v248, v248
 v_exp_f32 v249, v249
 v_fma_f32 v246, v246, v244, v244
 v_mfma_f32_16x16x32_bf16 v[200:203], a[68:71], v[84:87], v[200:203]
 ds_read_b128 a[16:19], v232 offset:1024
 v_fma_f32 v247, v247, v244, v244
 v_fma_f32 v248, v248, v244, v244
 v_fma_f32 v249, v249, v244, v244
 v_mfma_f32_16x16x32_bf16 v[204:207], a[68:71], v[156:159], v[204:207]
 v_rcp_f32 v246, v246
 v_rcp_f32 v247, v247
 v_rcp_f32 v248, v248
 v_mfma_f32_16x16x32_bf16 v[204:207], a[64:67], v[152:155], v[204:207]
 ds_read_b128 a[20:23], v232 offset:10240
 v_rcp_f32 v249, v249
 v_mul_f32 v168, v168, v246
 v_mul_f32 v169, v169, v247
 v_mul_f32 v170, v170, v248
 v_mul_f32 v171, v171, v249
 v_mfma_f32_16x16x32_bf16 v[204:207], a[60:63], v[148:151], v[204:207]
 v_cvt_pk_bf16_f32 v196, v196, v197
 v_cvt_pk_bf16_f32 v197, v198, v199
 v_mfma_f32_16x16x32_bf16 v[204:207], a[56:59], v[144:147], v[204:207]
 ds_read_b128 a[24:27], v232 offset:19456
 v_accvgpr_write_b32 a212, v196
 v_accvgpr_write_b32 a213, v197
 v_mfma_f32_16x16x32_bf16 v[204:207], a[52:55], v[140:143], v[204:207]
 s_add_u32 s60, s82, 108544
 buffer_load_dwordx4 v9, s[48:51], s60 offen offset:2048 sc1 lds
 v_mfma_f32_16x16x32_bf16 v[204:207], a[48:51], v[136:139], v[204:207]
 ds_read_b128 a[28:31], v232 offset:28672
 v_mfma_f32_16x16x32_bf16 v[204:207], a[44:47], v[132:135], v[204:207]
 v_mfma_f32_16x16x32_bf16 v[204:207], a[40:43], v[128:131], v[204:207]
 v_mul_f32 v200, v200, v168
 v_mul_f32 v201, v201, v169
 v_mfma_f32_16x16x32_bf16 v[204:207], a[36:39], v[124:127], v[204:207]
 s_waitcnt lgkmcnt(4)
 v_mul_f32 v202, v202, v170
 v_mul_f32 v203, v203, v171
 v_mul_f32 v246, v243, v172
 v_mul_f32 v247, v243, v173
 v_mul_f32 v248, v243, v174
 v_mul_f32 v249, v243, v175
 v_exp_f32 v246, v246
 v_exp_f32 v247, v247
 v_exp_f32 v248, v248
 v_exp_f32 v249, v249
 v_fma_f32 v246, v246, v245, v245
 v_fma_f32 v247, v247, v245, v245
 v_fma_f32 v248, v248, v245, v245
 v_fma_f32 v249, v249, v245, v245
 v_mfma_f32_16x16x32_bf16 v[16:19], a[0:3], a[144:147], 0
 ds_read_b128 a[32:35], v233 offset:0
 v_rcp_f32 v246, v246
 v_rcp_f32 v247, v247
 v_rcp_f32 v248, v248
 v_mfma_f32_16x16x32_bf16 v[16:19], a[4:7], a[72:75], v[16:19]
 ds_read_b128 a[36:39], v233 offset:9216
 s_add_u32 s60, s82, 108544
 buffer_load_dwordx4 v9, s[48:51], s60 offen offset:3072 sc1 lds
 v_rcp_f32 v249, v249
 v_mul_f32 v172, v172, v246
 v_mul_f32 v173, v173, v247
 v_mul_f32 v174, v174, v248
 v_mul_f32 v175, v175, v249
 s_waitcnt vmcnt(24)
 v_mfma_f32_16x16x32_bf16 v[16:19], a[8:11], a[80:83], v[16:19]
 v_cvt_pk_bf16_f32 v194, v200, v201
 v_cvt_pk_bf16_f32 v195, v202, v203
 v_accvgpr_write_b32 a210, v194
 s_waitcnt vmcnt(21)
 v_mfma_f32_16x16x32_bf16 v[16:19], a[12:15], a[88:91], v[16:19]
 ds_read_b128 a[40:43], v233 offset:18432
 v_accvgpr_write_b32 a211, v195
 s_add_u32 s67, s66, 16384
 buffer_store_dwordx4 v[192:195], v9, s[8:11], s67 offen sc1
 s_waitcnt vmcnt(21)
 v_mfma_f32_16x16x32_bf16 v[20:23], a[12:15], a[92:95], 0
 ds_read_b128 a[44:47], v233 offset:27648
 v_mfma_f32_16x16x32_bf16 v[20:23], a[8:11], a[84:87], v[20:23]
 v_mfma_f32_16x16x32_bf16 v[20:23], a[4:7], a[76:79], v[20:23]
 s_add_u32 m0, s61, 40960
 s_add_u32 s60, s84, 110592
 buffer_load_dwordx4 v9, s[48:51], s60 offen offset:0 sc1 lds
 v_mfma_f32_16x16x32_bf16 v[20:23], a[0:3], a[148:151], v[20:23]
 s_waitcnt lgkmcnt(4)
 v_mul_f32 v204, v204, v172
 v_mul_f32 v205, v205, v173
 v_mfma_f32_16x16x32_bf16 v[24:27], a[16:19], a[144:147], 0
 ds_read_b128 a[48:51], v233 offset:1024
 s_add_u32 s27, s77, 4096
 buffer_load_dwordx4 a[120:123], v9, s[8:11], s27 offen sc1
 v_mul_f32 v206, v206, v174
 v_mul_f32 v207, v207, v175
 v_mfma_f32_16x16x32_bf16 v[24:27], a[20:23], a[72:75], v[24:27]
 ds_read_b128 a[52:55], v233 offset:10240
 v_mfma_f32_16x16x32_bf16 v[24:27], a[24:27], a[80:83], v[24:27]
 v_mfma_f32_16x16x32_bf16 v[24:27], a[28:31], a[88:91], v[24:27]
 ds_read_b128 a[56:59], v233 offset:19456
 v_cvt_pk_bf16_f32 v198, v204, v205
 v_cvt_pk_bf16_f32 v199, v206, v207
 v_accvgpr_write_b32 a214, v198
 v_mfma_f32_16x16x32_bf16 v[28:31], a[28:31], a[92:95], 0
 ds_read_b128 a[60:63], v233 offset:28672
 s_add_u32 s60, s80, 146432
 buffer_load_dwordx4 v9, s[48:51], s60 offen offset:1024 sc1 lds
 v_accvgpr_write_b32 a215, v199
 s_add_u32 s67, s66, 17408
 buffer_store_dwordx4 v[196:199], v9, s[8:11], s67 offen sc1
 v_mfma_f32_16x16x32_bf16 v[28:31], a[24:27], a[84:87], v[28:31]
 v_mfma_f32_16x16x32_bf16 v[28:31], a[20:23], a[76:79], v[28:31]
 v_mfma_f32_16x16x32_bf16 v[28:31], a[16:19], a[148:151], v[28:31]
 s_waitcnt lgkmcnt(4)
 v_mfma_f32_16x16x32_bf16 v[32:35], a[32:35], a[144:147], 0
 ds_read_b128 a[0:3], v234 offset:0
 buffer_load_dwordx4 a[124:127], v9, s[8:11], s27 offen offset:1024 sc1
 v_mfma_f32_16x16x32_bf16 v[32:35], a[36:39], a[72:75], v[32:35]
 ds_read_b128 a[4:7], v234 offset:9216
 v_mfma_f32_16x16x32_bf16 v[32:35], a[40:43], a[80:83], v[32:35]
 s_add_u32 s60, s80, 146432
 buffer_load_dwordx4 v9, s[48:51], s60 offen offset:2048 sc1 lds
 v_mfma_f32_16x16x32_bf16 v[32:35], a[44:47], a[88:91], v[32:35]
 ds_read_b128 a[8:11], v234 offset:18432
 v_mfma_f32_16x16x32_bf16 v[36:39], a[44:47], a[92:95], 0
 ds_read_b128 a[12:15], v234 offset:27648
 v_mfma_f32_16x16x32_bf16 v[36:39], a[40:43], a[84:87], v[36:39]
 v_mfma_f32_16x16x32_bf16 v[36:39], a[36:39], a[76:79], v[36:39]
 v_mfma_f32_16x16x32_bf16 v[36:39], a[32:35], a[148:151], v[36:39]
 s_waitcnt lgkmcnt(4)
 s_add_u32 s60, s81, 144384
 buffer_load_dwordx4 v9, s[48:51], s60 offen offset:3072 sc1 lds
 v_mfma_f32_16x16x32_bf16 v[40:43], a[48:51], a[144:147], 0
 ds_read_b128 a[16:19], v234 offset:1024
 v_mfma_f32_16x16x32_bf16 v[40:43], a[52:55], a[72:75], v[40:43]
 ds_read_b128 a[20:23], v234 offset:10240
 s_add_u32 s27, s78, 4096
 buffer_load_dwordx4 a[128:131], v9, s[8:11], s27 offen sc1
 v_mfma_f32_16x16x32_bf16 v[40:43], a[56:59], a[80:83], v[40:43]
 v_mfma_f32_16x16x32_bf16 v[40:43], a[60:63], a[88:91], v[40:43]
 ds_read_b128 a[24:27], v234 offset:19456
 v_mfma_f32_16x16x32_bf16 v[44:47], a[60:63], a[92:95], 0
 ds_read_b128 a[28:31], v234 offset:28672
 v_mfma_f32_16x16x32_bf16 v[44:47], a[56:59], a[84:87], v[44:47]
 s_add_u32 m0, s61, 45056
 s_add_u32 s60, s81, 148480
 buffer_load_dwordx4 v9, s[48:51], s60 offen offset:0 sc1 lds
 v_mfma_f32_16x16x32_bf16 v[44:47], a[52:55], a[76:79], v[44:47]
 v_mfma_f32_16x16x32_bf16 v[44:47], a[48:51], a[148:151], v[44:47]
 s_waitcnt lgkmcnt(4)
 v_mfma_f32_16x16x32_bf16 v[48:51], a[0:3], a[144:147], 0
 ds_read_b128 a[32:35], v235 offset:0
 v_mfma_f32_16x16x32_bf16 v[48:51], a[4:7], a[72:75], v[48:51]
 ds_read_b128 a[36:39], v235 offset:9216
 v_mfma_f32_16x16x32_bf16 v[48:51], a[8:11], a[80:83], v[48:51]
 buffer_load_dwordx4 a[132:135], v9, s[8:11], s27 offen offset:1024 sc1
 v_mfma_f32_16x16x32_bf16 v[48:51], a[12:15], a[88:91], v[48:51]
 ds_read_b128 a[40:43], v235 offset:18432
 v_mfma_f32_16x16x32_bf16 v[52:55], a[12:15], a[92:95], 0
 ds_read_b128 a[44:47], v235 offset:27648
 v_mfma_f32_16x16x32_bf16 v[52:55], a[8:11], a[84:87], v[52:55]
 v_mfma_f32_16x16x32_bf16 v[52:55], a[4:7], a[76:79], v[52:55]
 v_mfma_f32_16x16x32_bf16 v[52:55], a[0:3], a[148:151], v[52:55]
 s_waitcnt lgkmcnt(4)
 v_mfma_f32_16x16x32_bf16 v[56:59], a[16:19], a[144:147], 0
 ds_read_b128 a[48:51], v235 offset:1024
 v_lshrrev_b32 v2, 1, v6
 v_mfma_f32_16x16x32_bf16 v[56:59], a[20:23], a[72:75], v[56:59]
 ds_read_b128 a[52:55], v235 offset:10240
 v_and_b32 v5, 1, v6
 v_mfma_f32_16x16x32_bf16 v[56:59], a[24:27], a[80:83], v[56:59]
 v_lshlrev_b32 v5, 4, v5
 v_mfma_f32_16x16x32_bf16 v[56:59], a[28:31], a[88:91], v[56:59]
 ds_read_b128 a[56:59], v235 offset:19456
 s_add_u32 s27, s79, 4096
 buffer_load_dwordx4 a[136:139], v9, s[8:11], s27 offen sc1
 v_mov_b32 v8, 0x3f80
 v_mfma_f32_16x16x32_bf16 v[60:63], a[28:31], a[92:95], 0
 ds_read_b128 a[60:63], v235 offset:28672
 v_lshlrev_b32 v5, v5, v8
 v_mfma_f32_16x16x32_bf16 v[60:63], a[24:27], a[84:87], v[60:63]
 v_mfma_f32_16x16x32_bf16 v[60:63], a[20:23], a[76:79], v[60:63]
 v_cmp_eq_u32 vcc, 0, v2
 v_mfma_f32_16x16x32_bf16 v[60:63], a[16:19], a[148:151], v[60:63]
 s_waitcnt lgkmcnt(4)
 v_cndmask_b32 v96, 0, v5, vcc
 v_mfma_f32_16x16x32_bf16 v[64:67], a[32:35], a[144:147], 0
 ds_read_b128 a[0:3], v254 offset:0
 v_cmp_eq_u32 vcc, 1, v2
 v_mfma_f32_16x16x32_bf16 v[64:67], a[36:39], a[72:75], v[64:67]
 ds_read_b128 a[4:7], v254 offset:9216
 v_cndmask_b32 v97, 0, v5, vcc
 v_mfma_f32_16x16x32_bf16 v[64:67], a[40:43], a[80:83], v[64:67]
 v_cmp_eq_u32 vcc, 2, v2
 v_mfma_f32_16x16x32_bf16 v[64:67], a[44:47], a[88:91], v[64:67]
 ds_read_b128 a[8:11], v254 offset:18432
 v_mfma_f32_16x16x32_bf16 v[68:71], a[44:47], a[92:95], 0
 ds_read_b128 a[12:15], v254 offset:27648
 buffer_load_dwordx4 a[140:143], v9, s[8:11], s27 offen offset:1024 sc1
 v_cndmask_b32 v98, 0, v5, vcc
 v_mfma_f32_16x16x32_bf16 v[68:71], a[40:43], a[84:87], v[68:71]
 v_cmp_eq_u32 vcc, 3, v2
 v_mfma_f32_16x16x32_bf16 v[68:71], a[36:39], a[76:79], v[68:71]
 s_nop 0
 v_cndmask_b32 v99, 0, v5, vcc
 v_mfma_f32_16x16x32_bf16 v[68:71], a[32:35], a[148:151], v[68:71]
 s_waitcnt lgkmcnt(0)
 s_barrier
 v_lshrrev_b32 v8, 2, v6
 v_mfma_f32_16x16x32_bf16 v[72:75], a[48:51], a[144:147], 0
 v_add_u32 v232, 36864, v232
 v_add_u32 v233, 36864, v233
 v_add_u32 v234, 36864, v234
 v_add_u32 v235, 36864, v235
 v_add_u32 v254, 36864, v254
 ds_read_b128 a[16:19], v232 offset:0
 v_mfma_f32_16x16x32_bf16 v[72:75], a[52:55], a[72:75], v[72:75]
 ds_read_b128 a[20:23], v232 offset:9216
 v_cmp_eq_u32 vcc, v8, v7
 v_mfma_f32_16x16x32_bf16 v[72:75], a[56:59], a[80:83], v[72:75]
 s_add_u32 m0, s61, 73728
 s_add_u32 s60, s82, 147456
 buffer_load_dwordx4 v9, s[48:51], s60 offen offset:0 sc1 lds
 v_cndmask_b32 v5, 0, v5, vcc
 v_mfma_f32_16x16x32_bf16 v[72:75], a[60:63], a[88:91], v[72:75]
 ds_read_b128 a[24:27], v232 offset:18432
 v_and_b32 v2, 1, v2
 v_mfma_f32_16x16x32_bf16 v[76:79], a[60:63], a[92:95], 0
 ds_read_b128 a[28:31], v232 offset:27648
 v_cmp_eq_u32 vcc, 0, v2
 v_mfma_f32_16x16x32_bf16 v[76:79], a[56:59], a[84:87], v[76:79]
 s_nop 0
 v_cndmask_b32 v102, 0, v5, vcc
 v_mfma_f32_16x16x32_bf16 v[76:79], a[52:55], a[76:79], v[76:79]
 v_mfma_f32_16x16x32_bf16 v[76:79], a[48:51], a[148:151], v[76:79]
 s_add_u32 s60, s82, 147456
 buffer_load_dwordx4 v9, s[48:51], s60 offen offset:1024 sc1 lds
 v_cmp_eq_u32 vcc, 1, v2
 v_mfma_f32_16x16x32_bf16 v[80:83], a[0:3], a[144:147], 0
 ds_read_b128 a[32:35], v232 offset:1024
 s_add_u32 s27, s77, 6144
 buffer_load_dwordx4 a[216:219], v9, s[8:11], s27 offen sc1
 v_cndmask_b32 v103, 0, v5, vcc
 v_mfma_f32_16x16x32_bf16 v[80:83], a[4:7], a[72:75], v[80:83]
 ds_read_b128 a[36:39], v232 offset:10240
 v_mov_b32 v100, 0
 v_mfma_f32_16x16x32_bf16 v[80:83], a[8:11], a[80:83], v[80:83]
 v_mov_b32 v101, 0
 v_mfma_f32_16x16x32_bf16 v[80:83], a[12:15], a[88:91], v[80:83]
 ds_read_b128 a[40:43], v232 offset:19456
 v_mov_b32 v104, 0
 v_mfma_f32_16x16x32_bf16 v[84:87], a[12:15], a[92:95], 0
 ds_read_b128 a[44:47], v232 offset:28672
 v_mfma_f32_16x16x32_bf16 v[84:87], a[8:11], a[84:87], v[84:87]
 s_add_u32 s60, s84, 145408
 buffer_load_dwordx4 v9, s[48:51], s60 offen offset:2048 sc1 lds
 v_mov_b32 v105, 0
 v_mfma_f32_16x16x32_bf16 v[84:87], a[4:7], a[76:79], v[84:87]
 s_lshl_b32 s29, s23, 2
 v_mfma_f32_16x16x32_bf16 v[84:87], a[0:3], a[148:151], v[84:87]
 s_waitcnt lgkmcnt(4)
 s_add_u32 s29, s29, s26
 v_mfma_f32_16x16x32_bf16 v[16:19], a[16:19], a[152:155], v[16:19]
 ds_read_b128 a[48:51], v233 offset:0
 buffer_load_dwordx4 a[220:223], v9, s[8:11], s27 offen offset:1024 sc1
 s_lshl_b32 s29, s29, 2
 s_waitcnt vmcnt(32)
 v_mfma_f32_16x16x32_bf16 v[16:19], a[20:23], a[96:99], v[16:19]
 ds_read_b128 a[52:55], v233 offset:9216
 s_waitcnt vmcnt(27)
 v_mfma_f32_16x16x32_bf16 v[16:19], a[24:27], a[104:107], v[16:19]
 s_add_u32 s85, s25, 1
 s_waitcnt vmcnt(23)
 v_mfma_f32_16x16x32_bf16 v[16:19], a[28:31], a[112:115], v[16:19]
 ds_read_b128 a[56:59], v233 offset:18432
 s_add_u32 s60, s80, 181248
 buffer_load_dwordx4 v9, s[48:51], s60 offen offset:3072 sc1 lds
 s_and_b32 s85, s85, 3
 s_waitcnt vmcnt(23)
 v_mfma_f32_16x16x32_bf16 v[20:23], a[28:31], a[116:119], v[20:23]
 ds_read_b128 a[60:63], v233 offset:27648
 s_add_u32 s85, s85, s29
 v_mfma_f32_16x16x32_bf16 v[20:23], a[24:27], a[108:111], v[20:23]
 s_lshl_b32 s85, s85, 2
 v_mfma_f32_16x16x32_bf16 v[20:23], a[20:23], a[100:103], v[20:23]
 s_add_u32 s85, s85, s22
 v_mfma_f32_16x16x32_bf16 v[20:23], a[16:19], a[156:159], v[20:23]
 s_waitcnt lgkmcnt(4)
 v_mfma_f32_16x16x32_bf16 v[24:27], a[32:35], a[152:155], v[24:27]
 ds_read_b128 a[0:3], v233 offset:1024
 s_add_u32 m0, s61, 77824
 s_add_u32 s60, s80, 185344
 buffer_load_dwordx4 v9, s[48:51], s60 offen offset:0 sc1 lds
 s_mul_i32 s85, s85, 6144
 v_mfma_f32_16x16x32_bf16 v[24:27], a[36:39], a[96:99], v[24:27]
 ds_read_b128 a[4:7], v233 offset:10240
 s_add_u32 s27, s78, 6144
 buffer_load_dwordx4 a[224:227], v9, s[8:11], s27 offen sc1
 s_add_u32 s86, s25, 2
 v_mfma_f32_16x16x32_bf16 v[24:27], a[40:43], a[104:107], v[24:27]
 s_and_b32 s86, s86, 3
 v_mfma_f32_16x16x32_bf16 v[24:27], a[44:47], a[112:115], v[24:27]
 ds_read_b128 a[8:11], v233 offset:19456
 s_add_u32 s86, s86, s29
 v_mfma_f32_16x16x32_bf16 v[28:31], a[44:47], a[116:119], v[28:31]
 s_branch L_c4_p3_s
L_c4_p3:
 s_branch L_c4_ret
L_c4_p3_s:
 ds_read_b128 a[12:15], v233 offset:28672
 v_mfma_f32_16x16x32_bf16 v[28:31], a[40:43], a[108:111], v[28:31]
 s_lshl_b32 s86, s86, 2
 v_mfma_f32_16x16x32_bf16 v[28:31], a[36:39], a[100:103], v[28:31]
 s_add_u32 s60, s81, 183296
 buffer_load_dwordx4 v9, s[48:51], s60 offen offset:1024 sc1 lds
 s_add_u32 s86, s86, s22
 v_mfma_f32_16x16x32_bf16 v[28:31], a[32:35], a[156:159], v[28:31]
 s_waitcnt lgkmcnt(4)
 s_mul_i32 s86, s86, 6144
 v_mfma_f32_16x16x32_bf16 v[32:35], a[48:51], a[152:155], v[32:35]
 ds_read_b128 a[16:19], v234 offset:0
 s_add_u32 s87, s25, 3
 v_mfma_f32_16x16x32_bf16 v[32:35], a[52:55], a[96:99], v[32:35]
 ds_read_b128 a[20:23], v234 offset:9216
 s_and_b32 s87, s87, 3
 v_mfma_f32_16x16x32_bf16 v[32:35], a[56:59], a[104:107], v[32:35]
 buffer_load_dwordx4 a[228:231], v9, s[8:11], s27 offen offset:1024 sc1
 v_mfma_f32_16x16x32_bf16 v[32:35], a[60:63], a[112:115], v[32:35]
 ds_read_b128 a[24:27], v234 offset:18432
 s_add_u32 s87, s87, s29
 v_mfma_f32_16x16x32_bf16 v[36:39], a[60:63], a[116:119], v[36:39]
 ds_read_b128 a[28:31], v234 offset:27648
 s_add_u32 s60, s81, 183296
 buffer_load_dwordx4 v9, s[48:51], s60 offen offset:2048 sc1 lds
 s_waitcnt vmcnt(19)
 v_mov_b32 v4, s3
 buffer_store_dword v4, v3, s[96:99], s69 offen sc1
 s_lshl_b32 s87, s87, 2
 v_mfma_f32_16x16x32_bf16 v[36:39], a[56:59], a[108:111], v[36:39]
 s_add_u32 s87, s87, s22
 v_mfma_f32_16x16x32_bf16 v[36:39], a[52:55], a[100:103], v[36:39]
 s_mul_i32 s87, s87, 6144
 v_mfma_f32_16x16x32_bf16 v[36:39], a[48:51], a[156:159], v[36:39]
 s_waitcnt lgkmcnt(4)
 s_add_u32 s72, s29, s25
 v_mfma_f32_16x16x32_bf16 v[40:43], a[0:3], a[152:155], v[40:43]
 ds_read_b128 a[32:35], v234 offset:1024
 v_mfma_f32_16x16x32_bf16 v[40:43], a[4:7], a[96:99], v[40:43]
 ds_read_b128 a[36:39], v234 offset:10240
 s_add_u32 s60, s82, 181248
 buffer_load_dwordx4 v9, s[48:51], s60 offen offset:3072 sc1 lds
 s_lshl_b32 s74, s72, 2
 v_mfma_f32_16x16x32_bf16 v[40:43], a[8:11], a[104:107], v[40:43]
 s_add_u32 s74, s74, s22
 v_mfma_f32_16x16x32_bf16 v[40:43], a[12:15], a[112:115], v[40:43]
 ds_read_b128 a[40:43], v234 offset:19456
 s_add_u32 s27, s79, 6144
 buffer_load_dwordx4 a[232:235], v9, s[8:11], s27 offen sc1
 s_mul_i32 s74, s74, 6144
 v_mfma_f32_16x16x32_bf16 v[44:47], a[12:15], a[116:119], v[44:47]
 ds_read_b128 a[44:47], v234 offset:28672
 s_add_u32 s71, s29, s22
 v_mfma_f32_16x16x32_bf16 v[44:47], a[8:11], a[108:111], v[44:47]
 v_mfma_f32_16x16x32_bf16 v[44:47], a[4:7], a[100:103], v[44:47]
 s_lshl_b32 s73, s71, 9
 v_mfma_f32_16x16x32_bf16 v[44:47], a[0:3], a[156:159], v[44:47]
 s_waitcnt lgkmcnt(4)
 s_add_u32 m0, s61, 81920
 s_add_u32 s60, s82, 185344
 buffer_load_dwordx4 v9, s[48:51], s60 offen offset:0 sc1 lds
 s_lshl_b32 s75, s29, 9
 v_mfma_f32_16x16x32_bf16 v[48:51], a[16:19], a[152:155], v[48:51]
 ds_read_b128 a[48:51], v235 offset:0
 s_lshl_b32 s71, s71, 2
 v_mfma_f32_16x16x32_bf16 v[48:51], a[20:23], a[96:99], v[48:51]
 ds_read_b128 a[52:55], v235 offset:9216
 s_add_u32 s71, s71, s25
 v_mfma_f32_16x16x32_bf16 v[48:51], a[24:27], a[104:107], v[48:51]
 s_lshl_b32 s71, s71, 10
 v_mfma_f32_16x16x32_bf16 v[48:51], a[28:31], a[112:115], v[48:51]
 ds_read_b128 a[56:59], v235 offset:18432
 v_mfma_f32_16x16x32_bf16 v[52:55], a[28:31], a[116:119], v[52:55]
 ds_read_b128 a[60:63], v235 offset:27648
 buffer_load_dwordx4 a[236:239], v9, s[8:11], s27 offen offset:1024 sc1
 s_add_u32 s71, s71, 0x600000
 v_mfma_f32_16x16x32_bf16 v[52:55], a[24:27], a[108:111], v[52:55]
 s_lshl_b32 s72, s72, 12
 v_mfma_f32_16x16x32_bf16 v[52:55], a[20:23], a[100:103], v[52:55]
 s_lshl_b32 s29, s22, 8
 v_mfma_f32_16x16x32_bf16 v[52:55], a[16:19], a[156:159], v[52:55]
 s_waitcnt lgkmcnt(4)
 s_add_u32 s72, s72, s29
 v_mfma_f32_16x16x32_bf16 v[56:59], a[32:35], a[152:155], v[56:59]
 ds_read_b128 a[0:3], v235 offset:1024
 s_add_u32 s72, s72, 0x600000
 v_mfma_f32_16x16x32_bf16 v[56:59], a[36:39], a[96:99], v[56:59]
 ds_read_b128 a[4:7], v235 offset:10240
 v_mfma_f32_16x16x32_bf16 v[56:59], a[40:43], a[104:107], v[56:59]
 s_lshl_b32 s29, s25, 7
 v_mfma_f32_16x16x32_bf16 v[56:59], a[44:47], a[112:115], v[56:59]
 ds_read_b128 a[8:11], v235 offset:19456
 s_add_u32 s73, s73, s29
 v_mfma_f32_16x16x32_bf16 v[60:63], a[44:47], a[116:119], v[60:63]
 ds_read_b128 a[12:15], v235 offset:28672
 s_add_u32 s73, s73, 786432
 v_mfma_f32_16x16x32_bf16 v[60:63], a[40:43], a[108:111], v[60:63]
 s_add_u32 s75, s75, 786432
 v_mfma_f32_16x16x32_bf16 v[60:63], a[36:39], a[100:103], v[60:63]
 v_mfma_f32_16x16x32_bf16 v[60:63], a[32:35], a[156:159], v[60:63]
 s_waitcnt lgkmcnt(4)
 s_lshl_b32 s29, s23, 2
 v_mfma_f32_16x16x32_bf16 v[64:67], a[48:51], a[152:155], v[64:67]
 ds_read_b128 a[16:19], v254 offset:0
 s_add_u32 s27, s77, 8192
 buffer_load_dwordx4 v[148:151], v9, s[8:11], s27 offen sc1
 s_add_u32 s32, s29, s22
 v_mfma_f32_16x16x32_bf16 v[64:67], a[52:55], a[96:99], v[64:67]
 ds_read_b128 a[20:23], v254 offset:9216
 s_mul_i32 s90, s32, 36864
 v_mfma_f32_16x16x32_bf16 v[64:67], a[56:59], a[104:107], v[64:67]
 s_mov_b32 s31, s90
 v_mfma_f32_16x16x32_bf16 v[64:67], a[60:63], a[112:115], v[64:67]
 ds_read_b128 a[24:27], v254 offset:18432
 s_lshl_b32 s32, s33, 4
 v_mfma_f32_16x16x32_bf16 v[68:71], a[60:63], a[116:119], v[68:71]
 ds_read_b128 a[28:31], v254 offset:27648
 v_mfma_f32_16x16x32_bf16 v[68:71], a[56:59], a[108:111], v[68:71]
 s_add_u32 s90, s90, s32
 v_mfma_f32_16x16x32_bf16 v[68:71], a[52:55], a[100:103], v[68:71]
 s_lshl_b32 s32, s25, 10
 v_mfma_f32_16x16x32_bf16 v[68:71], a[48:51], a[156:159], v[68:71]
 s_waitcnt lgkmcnt(0)
 s_barrier
 s_add_u32 s90, s90, s32
 v_mfma_f32_16x16x32_bf16 v[72:75], a[0:3], a[152:155], v[72:75]
 ds_read_b128 a[32:35], v255 offset:0
 buffer_load_dwordx4 v[152:155], v9, s[8:11], s27 offen offset:1024 sc1
 s_add_u32 s29, s29, s25
 v_mfma_f32_16x16x32_bf16 v[72:75], a[4:7], a[96:99], v[72:75]
 ds_read_b128 a[36:39], v255 offset:9216
 v_mfma_f32_16x16x32_bf16 v[72:75], a[8:11], a[104:107], v[72:75]
 s_add_u32 m0, s61, 110592
 s_add_u32 s60, s84, 184320
 buffer_load_dwordx4 v9, s[48:51], s60 offen offset:0 sc1 lds
 s_mul_i32 s91, s29, 36864
 v_mfma_f32_16x16x32_bf16 v[72:75], a[12:15], a[112:115], v[72:75]
 ds_read_b128 a[40:43], v255 offset:18432
 s_mov_b32 s30, s91
 v_mfma_f32_16x16x32_bf16 v[76:79], a[12:15], a[116:119], v[76:79]
 ds_read_b128 a[44:47], v255 offset:27648
 s_lshl_b32 s29, s22, 8
 v_mfma_f32_16x16x32_bf16 v[76:79], a[8:11], a[108:111], v[76:79]
 s_add_u32 s91, s91, s29
 v_mfma_f32_16x16x32_bf16 v[76:79], a[4:7], a[100:103], v[76:79]
 s_lshr_b32 s29, s34, 6
 v_mfma_f32_16x16x32_bf16 v[76:79], a[0:3], a[156:159], v[76:79]
 s_add_u32 s60, s80, 220160
 buffer_load_dwordx4 v9, s[48:51], s60 offen offset:1024 sc1 lds
 v_mfma_f32_16x16x32_bf16 v[80:83], a[16:19], a[152:155], v[80:83]
 ds_read_b128 a[48:51], v255 offset:1024
 s_lshl_b32 s29, s29, 10
 v_mfma_f32_16x16x32_bf16 v[80:83], a[20:23], a[96:99], v[80:83]
 ds_read_b128 a[52:55], v255 offset:10240
 s_add_u32 s27, s78, 8192
 buffer_load_dwordx4 v[156:159], v9, s[8:11], s27 offen sc1
 s_add_u32 s91, s91, s29
 v_mfma_f32_16x16x32_bf16 v[80:83], a[24:27], a[104:107], v[80:83]
 s_lshl_b32 s29, s35, 3
 v_mfma_f32_16x16x32_bf16 v[80:83], a[28:31], a[112:115], v[80:83]
 ds_read_b128 a[56:59], v255 offset:19456
 s_add_u32 s91, s91, s29
 v_mfma_f32_16x16x32_bf16 v[84:87], a[28:31], a[116:119], v[84:87]
 ds_read_b128 a[60:63], v255 offset:28672
 s_add_u32 s31, s31, s33
 v_mfma_f32_16x16x32_bf16 v[84:87], a[24:27], a[108:111], v[84:87]
 s_add_u32 s60, s80, 220160
 buffer_load_dwordx4 v9, s[48:51], s60 offen offset:2048 sc1 lds
 v_mfma_f32_16x16x32_bf16 v[84:87], a[20:23], a[100:103], v[84:87]
 s_lshl_b32 s29, s25, 6
 v_mfma_f32_16x16x32_bf16 v[84:87], a[16:19], a[156:159], v[84:87]
 s_waitcnt lgkmcnt(4)
 s_add_u32 s31, s31, s29
 v_mfma_f32_16x16x32_bf16 v[16:19], a[32:35], a[160:163], v[16:19]
 ds_read_b128 a[0:3], v255 offset:2048
 s_add_u32 s30, s30, s34
 v_mfma_f32_16x16x32_bf16 v[16:19], a[36:39], a[120:123], v[16:19]
 ds_read_b128 a[4:7], v255 offset:11264
 s_lshl_b32 s29, s22, 3
 s_waitcnt vmcnt(26)
 v_mfma_f32_16x16x32_bf16 v[16:19], a[40:43], a[128:131], v[16:19]
 buffer_load_dwordx4 v[160:163], v9, s[8:11], s27 offen offset:1024 sc1
 s_waitcnt vmcnt(24)
 v_mfma_f32_16x16x32_bf16 v[16:19], a[44:47], a[136:139], v[16:19]
 ds_read_b128 a[8:11], v255 offset:20480
 s_add_u32 s60, s81, 218112
 buffer_load_dwordx4 v9, s[48:51], s60 offen offset:3072 sc1 lds
 s_add_u32 s30, s30, s29
 s_waitcnt vmcnt(24)
 v_mfma_f32_16x16x32_bf16 v[20:23], a[44:47], a[140:143], v[20:23]
 ds_read_b128 a[12:15], v255 offset:29696
 v_lshlrev_b32 v14, 4, v6
 v_mfma_f32_16x16x32_bf16 v[20:23], a[40:43], a[132:135], v[20:23]
 v_mov_b32 v2, 0x7fff0000
 v_mfma_f32_16x16x32_bf16 v[20:23], a[36:39], a[124:127], v[20:23]
 v_cmp_gt_u32 vcc, 32, v1
 v_mfma_f32_16x16x32_bf16 v[20:23], a[32:35], a[164:167], v[20:23]
 s_waitcnt lgkmcnt(4)
 v_mul_u32_u24 v11, 18432, v7
 v_mfma_f32_16x16x32_bf16 v[24:27], a[48:51], a[160:163], v[24:27]
 ds_read_b128 a[16:19], v255 offset:3072
 s_add_u32 m0, s61, 114688
 s_add_u32 s60, s81, 222208
 buffer_load_dwordx4 v9, s[48:51], s60 offen offset:0 sc1 lds
 v_mfma_f32_16x16x32_bf16 v[24:27], a[52:55], a[120:123], v[24:27]
 ds_read_b128 a[20:23], v255 offset:12288
 v_mul_u32_u24 v8, 1152, v6
 v_mfma_f32_16x16x32_bf16 v[24:27], a[56:59], a[128:131], v[24:27]
 v_add_u32 v8, v8, v11
 v_mfma_f32_16x16x32_bf16 v[24:27], a[60:63], a[136:139], v[24:27]
 ds_read_b128 a[24:27], v255 offset:21504
 s_add_u32 s27, s79, 8192
 buffer_load_dwordx4 v[164:167], v9, s[8:11], s27 offen sc1
 v_add_u32 v11, v11, v14
 v_mfma_f32_16x16x32_bf16 v[28:31], a[60:63], a[140:143], v[28:31]
 ds_read_b128 a[28:31], v255 offset:30720
 v_lshl_add_u32 v14, v7, 10, v14
 v_mfma_f32_16x16x32_bf16 v[28:31], a[56:59], a[132:135], v[28:31]
 v_cndmask_b32 v11, v2, v11, vcc
 v_mfma_f32_16x16x32_bf16 v[28:31], a[52:55], a[124:127], v[28:31]
 s_add_u32 s60, s82, 220160
 buffer_load_dwordx4 v9, s[48:51], s60 offen offset:1024 sc1 lds
 v_mfma_f32_16x16x32_bf16 v[28:31], a[48:51], a[164:167], v[28:31]
 s_waitcnt lgkmcnt(4)
 v_cndmask_b32 v8, v2, v8, vcc
 v_mfma_f32_16x16x32_bf16 v[32:35], a[0:3], a[160:163], v[32:35]
 ds_read_b128 a[32:35], v255 offset:4096
 v_mul_u32_u24 v15, 1152, v6
 v_mfma_f32_16x16x32_bf16 v[32:35], a[4:7], a[120:123], v[32:35]
 ds_read_b128 a[36:39], v255 offset:13312
 v_bfe_u32 v2, v1, 4, 1
 v_mfma_f32_16x16x32_bf16 v[32:35], a[8:11], a[128:131], v[32:35]
 v_lshl_add_u32 v15, v2, 5, v15
 v_mfma_f32_16x16x32_bf16 v[32:35], a[12:15], a[136:139], v[32:35]
 ds_read_b128 a[40:43], v255 offset:22528
 v_mfma_f32_16x16x32_bf16 v[36:39], a[12:15], a[140:143], v[36:39]
 ds_read_b128 a[44:47], v255 offset:31744
 s_add_u32 s60, s82, 220160
 buffer_load_dwordx4 v9, s[48:51], s60 offen offset:2048 sc1 lds
 buffer_load_dwordx4 v[168:171], v9, s[8:11], s27 offen offset:1024 sc1
 v_lshrrev_b32 v2, 5, v1
 v_mfma_f32_16x16x32_bf16 v[36:39], a[8:11], a[132:135], v[36:39]
 v_lshl_add_u32 v15, v2, 4, v15
 v_mfma_f32_16x16x32_bf16 v[36:39], a[4:7], a[124:127], v[36:39]
 buffer_load_dword v13, v12, s[96:99], s70 offen sc1
 v_bfe_u32 v2, v1, 2, 1
 v_mfma_f32_16x16x32_bf16 v[36:39], a[0:3], a[164:167], v[36:39]
 s_waitcnt lgkmcnt(4)
 v_mov_b32 v5, s22
 v_mfma_f32_16x16x32_bf16 v[40:43], a[16:19], a[160:163], v[40:43]
 ds_read_b128 a[48:51], v255 offset:5120
 v_mov_b32 v10, s25
 v_mfma_f32_16x16x32_bf16 v[40:43], a[20:23], a[120:123], v[40:43]
 ds_read_b128 a[52:55], v255 offset:14336
 s_add_u32 s60, s84, 218112
 buffer_load_dwordx4 v9, s[48:51], s60 offen offset:3072 sc1 lds
 v_mfma_f32_16x16x32_bf16 v[40:43], a[24:27], a[128:131], v[40:43]
 v_cmp_eq_u32 vcc, 0, v2
 v_mfma_f32_16x16x32_bf16 v[40:43], a[28:31], a[136:139], v[40:43]
 ds_read_b128 a[56:59], v255 offset:23552
 v_cndmask_b32 v10, v10, v5, vcc
 v_mfma_f32_16x16x32_bf16 v[44:47], a[28:31], a[140:143], v[44:47]
 ds_read_b128 a[60:63], v255 offset:32768
 v_lshlrev_b32 v10, 9, v10
 v_mfma_f32_16x16x32_bf16 v[44:47], a[24:27], a[132:135], v[44:47]
 v_add_u32 v10, v10, v12
 v_mfma_f32_16x16x32_bf16 v[44:47], a[20:23], a[124:127], v[44:47]
 v_mfma_f32_16x16x32_bf16 v[44:47], a[16:19], a[164:167], v[44:47]
 s_waitcnt lgkmcnt(4)
 s_add_u32 m0, s61, 118784
 s_add_u32 s60, s80, 258048
 buffer_load_dwordx4 v9, s[48:51], s60 offen offset:0 sc1 lds
 v_mfma_f32_16x16x32_bf16 v[48:51], a[32:35], a[160:163], v[48:51]
 ds_read_b128 a[0:3], v255 offset:6144
 s_add_u32 s27, s77, 10240
 buffer_load_dwordx4 v[172:175], v9, s[8:11], s27 offen sc1
 v_mfma_f32_16x16x32_bf16 v[48:51], a[36:39], a[120:123], v[48:51]
 ds_read_b128 a[4:7], v255 offset:15360
 v_mfma_f32_16x16x32_bf16 v[48:51], a[40:43], a[128:131], v[48:51]
 v_mfma_f32_16x16x32_bf16 v[48:51], a[44:47], a[136:139], v[48:51]
 ds_read_b128 a[8:11], v255 offset:24576
 v_mfma_f32_16x16x32_bf16 v[52:55], a[44:47], a[140:143], v[52:55]
 ds_read_b128 a[12:15], v255 offset:33792
 v_mfma_f32_16x16x32_bf16 v[52:55], a[40:43], a[132:135], v[52:55]
 v_mfma_f32_16x16x32_bf16 v[52:55], a[36:39], a[124:127], v[52:55]
 v_mfma_f32_16x16x32_bf16 v[52:55], a[32:35], a[164:167], v[52:55]
 s_waitcnt lgkmcnt(4)
 v_mfma_f32_16x16x32_bf16 v[56:59], a[48:51], a[160:163], v[56:59]
 ds_read_b128 a[16:19], v255 offset:7168
 buffer_load_dwordx4 v[176:179], v9, s[8:11], s27 offen offset:1024 sc1
 s_add_u32 s40, s20, 0x2400000
 s_addc_u32 s41, s21, 0
 s_and_b32 s41, s41, 0xffff
 s_mov_b32 s42, 0xd00000
 s_mov_b32 s43, 0x20000
 v_mfma_f32_16x16x32_bf16 v[56:59], a[52:55], a[120:123], v[56:59]
 ds_read_b128 a[20:23], v255 offset:16384
 v_mfma_f32_16x16x32_bf16 v[56:59], a[56:59], a[128:131], v[56:59]
 v_mfma_f32_16x16x32_bf16 v[56:59], a[60:63], a[136:139], v[56:59]
 ds_read_b128 a[24:27], v255 offset:25600
 v_mfma_f32_16x16x32_bf16 v[60:63], a[60:63], a[140:143], v[60:63]
 ds_read_b128 a[28:31], v255 offset:34816
 v_mfma_f32_16x16x32_bf16 v[60:63], a[56:59], a[132:135], v[60:63]
 v_mfma_f32_16x16x32_bf16 v[60:63], a[52:55], a[124:127], v[60:63]
 v_mfma_f32_16x16x32_bf16 v[60:63], a[48:51], a[164:167], v[60:63]
 s_waitcnt lgkmcnt(4)
 v_mfma_f32_16x16x32_bf16 v[80:83], a[0:3], a[160:163], v[80:83]
 ds_read_b128 a[32:35], v255 offset:8192
 v_mfma_f32_16x16x32_bf16 v[80:83], a[4:7], a[120:123], v[80:83]
 ds_read_b128 a[36:39], v255 offset:17408
 s_add_u32 s27, s78, 10240
 buffer_load_dwordx4 v[180:183], v9, s[8:11], s27 offen sc1
 v_mfma_f32_16x16x32_bf16 v[80:83], a[8:11], a[128:131], v[80:83]
 v_mfma_f32_16x16x32_bf16 v[80:83], a[12:15], a[136:139], v[80:83]
 ds_read_b128 a[40:43], v255 offset:26624
 v_mfma_f32_16x16x32_bf16 v[84:87], a[12:15], a[140:143], v[84:87]
 ds_read_b128 a[44:47], v255 offset:35840
 v_mfma_f32_16x16x32_bf16 v[84:87], a[8:11], a[132:135], v[84:87]
 v_mfma_f32_16x16x32_bf16 v[84:87], a[4:7], a[124:127], v[84:87]
 v_mfma_f32_16x16x32_bf16 v[84:87], a[0:3], a[164:167], v[84:87]
 s_waitcnt lgkmcnt(0)
 s_barrier
 v_mfma_f32_16x16x32_bf16 v[16:19], a[16:19], a[168:171], v[16:19]
 v_add_u32 v255, 36864, v255
 ds_read_b128 a[48:51], v255 offset:0
 s_waitcnt vmcnt(32)
 v_mfma_f32_16x16x32_bf16 v[16:19], a[20:23], a[216:219], v[16:19]
 ds_read_b128 a[52:55], v255 offset:9216
 s_waitcnt vmcnt(27)
 v_mfma_f32_16x16x32_bf16 v[16:19], a[24:27], a[224:227], v[16:19]
 s_add_u32 m0, s61, 0
 s_add_u32 s60, s80, 259072
 buffer_load_dwordx4 v9, s[48:51], s60 offen offset:0 sc1 lds
 buffer_load_dwordx4 v[184:187], v9, s[8:11], s27 offen offset:1024 sc1
 s_waitcnt vmcnt(23)
 v_mfma_f32_16x16x32_bf16 v[16:19], a[28:31], a[232:235], v[16:19]
 ds_read_b128 a[56:59], v255 offset:18432
 s_waitcnt vmcnt(21)
 v_mfma_f32_16x16x32_bf16 v[20:23], a[28:31], a[236:239], v[20:23]
 ds_read_b128 a[60:63], v255 offset:27648
 v_mfma_f32_16x16x32_bf16 v[20:23], a[24:27], a[228:231], v[20:23]
 v_mfma_f32_16x16x32_bf16 v[20:23], a[20:23], a[220:223], v[20:23]
 v_mfma_f32_16x16x32_bf16 v[20:23], a[16:19], a[172:175], v[20:23]
 s_add_u32 s60, s81, 257024
 buffer_load_dwordx4 v9, s[48:51], s60 offen offset:1024 sc1 lds
 v_mfma_f32_16x16x32_bf16 v[24:27], a[32:35], a[168:171], v[24:27]
 ds_read_b128 a[0:3], v255 offset:1024
 v_mfma_f32_16x16x32_bf16 v[24:27], a[36:39], a[216:219], v[24:27]
 ds_read_b128 a[4:7], v255 offset:10240
 v_mfma_f32_16x16x32_bf16 v[24:27], a[40:43], a[224:227], v[24:27]
 v_mfma_f32_16x16x32_bf16 v[24:27], a[44:47], a[232:235], v[24:27]
 ds_read_b128 a[8:11], v255 offset:19456
 s_add_u32 s27, s79, 10240
 buffer_load_dwordx4 v[188:191], v9, s[8:11], s27 offen sc1
 v_mfma_f32_16x16x32_bf16 v[28:31], a[44:47], a[236:239], v[28:31]
 ds_read_b128 a[12:15], v255 offset:28672
 v_mfma_f32_16x16x32_bf16 v[28:31], a[40:43], a[228:231], v[28:31]
 s_add_u32 s60, s81, 257024
 buffer_load_dwordx4 v9, s[48:51], s60 offen offset:2048 sc1 lds
 v_mfma_f32_16x16x32_bf16 v[28:31], a[36:39], a[220:223], v[28:31]
 v_mfma_f32_16x16x32_bf16 v[28:31], a[32:35], a[172:175], v[28:31]
 s_waitcnt lgkmcnt(4)
 v_mfma_f32_16x16x32_bf16 v[32:35], a[48:51], a[168:171], v[32:35]
 ds_read_b128 a[16:19], v255 offset:2048
 v_mfma_f32_16x16x32_bf16 v[32:35], a[52:55], a[216:219], v[32:35]
 ds_read_b128 a[20:23], v255 offset:11264
 v_mfma_f32_16x16x32_bf16 v[32:35], a[56:59], a[224:227], v[32:35]
 v_mfma_f32_16x16x32_bf16 v[32:35], a[60:63], a[232:235], v[32:35]
 ds_read_b128 a[24:27], v255 offset:20480
 s_add_u32 s60, s82, 254976
 buffer_load_dwordx4 v9, s[48:51], s60 offen offset:3072 sc1 lds
 v_mfma_f32_16x16x32_bf16 v[36:39], a[60:63], a[236:239], v[36:39]
 ds_read_b128 a[28:31], v255 offset:29696
 buffer_load_dwordx4 v[192:195], v9, s[8:11], s27 offen offset:1024 sc1
 v_mfma_f32_16x16x32_bf16 v[36:39], a[56:59], a[228:231], v[36:39]
 v_mfma_f32_16x16x32_bf16 v[36:39], a[52:55], a[220:223], v[36:39]
 v_mfma_f32_16x16x32_bf16 v[36:39], a[48:51], a[172:175], v[36:39]
 s_waitcnt lgkmcnt(4)
 v_mfma_f32_16x16x32_bf16 v[40:43], a[0:3], a[168:171], v[40:43]
 ds_read_b128 a[32:35], v255 offset:3072
 s_add_u32 m0, s61, 4096
 s_add_u32 s60, s82, 259072
 buffer_load_dwordx4 v9, s[48:51], s60 offen offset:0 sc1 lds
 v_mfma_f32_16x16x32_bf16 v[40:43], a[4:7], a[216:219], v[40:43]
 ds_read_b128 a[36:39], v255 offset:12288
 v_mfma_f32_16x16x32_bf16 v[40:43], a[8:11], a[224:227], v[40:43]
 v_mfma_f32_16x16x32_bf16 v[40:43], a[12:15], a[232:235], v[40:43]
 ds_read_b128 a[40:43], v255 offset:21504
 v_mfma_f32_16x16x32_bf16 v[44:47], a[12:15], a[236:239], v[44:47]
 ds_read_b128 a[44:47], v255 offset:30720
 v_mfma_f32_16x16x32_bf16 v[44:47], a[8:11], a[228:231], v[44:47]
 s_waitcnt vmcnt(13)
 v_cmp_ne_u32 vcc, s3, v13
 s_nop 4
 s_cbranch_vccnz L_slow_b
L_back_b:
 s_add_u32 s70, s70, 0x20000
 v_mfma_f32_16x16x32_bf16 v[44:47], a[4:7], a[220:223], v[44:47]
 s_add_u32 s60, s84, 257024
 buffer_load_dwordx4 v9, s[48:51], s60 offen offset:1024 sc1 lds
 v_mfma_f32_16x16x32_bf16 v[44:47], a[0:3], a[172:175], v[44:47]
 s_waitcnt lgkmcnt(4)
 v_mfma_f32_16x16x32_bf16 v[48:51], a[16:19], a[168:171], v[48:51]
 ds_read_b128 a[48:51], v255 offset:4096
 s_add_u32 s27, s77, 12288
 buffer_load_dwordx4 v[196:199], v9, s[8:11], s27 offen sc1
 v_mfma_f32_16x16x32_bf16 v[48:51], a[20:23], a[216:219], v[48:51]
 ds_read_b128 a[52:55], v255 offset:13312
 v_mfma_f32_16x16x32_bf16 v[48:51], a[24:27], a[224:227], v[48:51]
 v_mfma_f32_16x16x32_bf16 v[48:51], a[28:31], a[232:235], v[48:51]
 ds_read_b128 a[56:59], v255 offset:22528
 v_mfma_f32_16x16x32_bf16 v[52:55], a[28:31], a[236:239], v[52:55]
 ds_read_b128 a[60:63], v255 offset:31744
 s_add_u32 s60, s4, 2048
 buffer_load_dwordx4 v9, s[48:51], s60 offen offset:2048 sc1 lds
 v_mfma_f32_16x16x32_bf16 v[52:55], a[24:27], a[228:231], v[52:55]
 v_mfma_f32_16x16x32_bf16 v[52:55], a[20:23], a[220:223], v[52:55]
 v_mfma_f32_16x16x32_bf16 v[52:55], a[16:19], a[172:175], v[52:55]
 s_waitcnt lgkmcnt(4)
 v_mfma_f32_16x16x32_bf16 v[56:59], a[32:35], a[168:171], v[56:59]
 ds_read_b128 a[0:3], v255 offset:5120
 buffer_load_dwordx4 v[200:203], v9, s[8:11], s27 offen offset:1024 sc1
 v_mfma_f32_16x16x32_bf16 v[56:59], a[36:39], a[216:219], v[56:59]
 ds_read_b128 a[4:7], v255 offset:14336
 s_add_u32 s60, s4, 2048
 buffer_load_dwordx4 v9, s[48:51], s60 offen offset:3072 sc1 lds
 v_mfma_f32_16x16x32_bf16 v[56:59], a[40:43], a[224:227], v[56:59]
 v_mfma_f32_16x16x32_bf16 v[56:59], a[44:47], a[232:235], v[56:59]
 ds_read_b128 a[8:11], v255 offset:23552
 v_mfma_f32_16x16x32_bf16 v[60:63], a[44:47], a[236:239], v[60:63]
 ds_read_b128 a[12:15], v255 offset:32768
 v_mfma_f32_16x16x32_bf16 v[60:63], a[40:43], a[228:231], v[60:63]
 v_mfma_f32_16x16x32_bf16 v[60:63], a[36:39], a[220:223], v[60:63]
 v_mfma_f32_16x16x32_bf16 v[60:63], a[32:35], a[172:175], v[60:63]
 s_waitcnt lgkmcnt(4)
 s_add_u32 m0, s61, 8192
 s_add_u32 s60, s5, 4096
 buffer_load_dwordx4 v9, s[48:51], s60 offen offset:0 sc1 lds
 v_mfma_f32_16x16x32_bf16 v[80:83], a[48:51], a[168:171], v[80:83]
 ds_read_b128 a[16:19], v255 offset:6144
 v_mfma_f32_16x16x32_bf16 v[80:83], a[52:55], a[216:219], v[80:83]
 ds_read_b128 a[20:23], v255 offset:15360
 s_add_u32 s27, s78, 12288
 buffer_load_dwordx4 v[204:207], v9, s[8:11], s27 offen sc1
 v_mfma_f32_16x16x32_bf16 v[80:83], a[56:59], a[224:227], v[80:83]
 v_mfma_f32_16x16x32_bf16 v[80:83], a[60:63], a[232:235], v[80:83]
 ds_read_b128 a[24:27], v255 offset:24576
 v_mfma_f32_16x16x32_bf16 v[84:87], a[60:63], a[236:239], v[84:87]
 ds_read_b128 a[28:31], v255 offset:33792
 v_mfma_f32_16x16x32_bf16 v[84:87], a[56:59], a[228:231], v[84:87]
 v_mfma_f32_16x16x32_bf16 v[84:87], a[52:55], a[220:223], v[84:87]
 v_mfma_f32_16x16x32_bf16 v[84:87], a[48:51], a[172:175], v[84:87]
 s_waitcnt lgkmcnt(4)
 v_mfma_f32_16x16x32_bf16 v[16:19], a[0:3], a[176:179], v[16:19]
 ds_read_b128 a[32:35], v255 offset:7168
 v_mfma_f32_16x16x32_bf16 v[16:19], a[4:7], v[148:151], v[16:19]
 ds_read_b128 a[36:39], v255 offset:16384
 v_mfma_f32_16x16x32_bf16 v[16:19], a[8:11], v[156:159], v[16:19]
 buffer_load_dwordx4 v[208:211], v9, s[8:11], s27 offen offset:1024 sc1
 v_mfma_f32_16x16x32_bf16 v[16:19], a[12:15], v[164:167], v[16:19]
 ds_read_b128 a[40:43], v255 offset:25600
 v_mfma_f32_16x16x32_bf16 v[20:23], a[12:15], v[168:171], v[20:23]
 ds_read_b128 a[44:47], v255 offset:34816
 v_mfma_f32_16x16x32_bf16 v[20:23], a[8:11], v[160:163], v[20:23]
 v_mfma_f32_16x16x32_bf16 v[20:23], a[4:7], v[152:155], v[20:23]
 v_mfma_f32_16x16x32_bf16 v[20:23], a[0:3], a[180:183], v[20:23]
 s_waitcnt lgkmcnt(4)
 v_mfma_f32_16x16x32_bf16 v[24:27], a[16:19], a[176:179], v[24:27]
 ds_read_b128 a[48:51], v255 offset:8192
 v_mfma_f32_16x16x32_bf16 v[24:27], a[20:23], v[148:151], v[24:27]
 ds_read_b128 a[52:55], v255 offset:17408
 v_mfma_f32_16x16x32_bf16 v[24:27], a[24:27], v[156:159], v[24:27]
 v_mfma_f32_16x16x32_bf16 v[24:27], a[28:31], v[164:167], v[24:27]
 ds_read_b128 a[56:59], v255 offset:26624
 s_add_u32 s27, s79, 12288
 buffer_load_dwordx4 v[212:215], v9, s[8:11], s27 offen sc1
 v_mfma_f32_16x16x32_bf16 v[28:31], a[28:31], v[168:171], v[28:31]
 ds_read_b128 a[60:63], v255 offset:35840
 v_mfma_f32_16x16x32_bf16 v[28:31], a[24:27], v[160:163], v[28:31]
 v_mfma_f32_16x16x32_bf16 v[28:31], a[20:23], v[152:155], v[28:31]
 v_mfma_f32_16x16x32_bf16 v[28:31], a[16:19], a[180:183], v[28:31]
 s_waitcnt lgkmcnt(0)
 s_barrier
 v_mfma_f32_16x16x32_bf16 v[32:35], a[32:35], a[176:179], v[32:35]
 v_add_u32 v255, 36864, v255
 ds_read_b128 a[0:3], v255 offset:0
 v_mfma_f32_16x16x32_bf16 v[32:35], a[36:39], v[148:151], v[32:35]
 ds_read_b128 a[4:7], v255 offset:9216
 v_mfma_f32_16x16x32_bf16 v[32:35], a[40:43], v[156:159], v[32:35]
 s_add_u32 m0, s61, 36864
 s_add_u32 s60, s5, 5120
 buffer_load_dwordx4 v9, s[48:51], s60 offen offset:0 sc1 lds
 v_mfma_f32_16x16x32_bf16 v[32:35], a[44:47], v[164:167], v[32:35]
 ds_read_b128 a[8:11], v255 offset:18432
 v_mfma_f32_16x16x32_bf16 v[36:39], a[44:47], v[168:171], v[36:39]
 ds_read_b128 a[12:15], v255 offset:27648
 buffer_load_dwordx4 v[216:219], v9, s[8:11], s27 offen offset:1024 sc1
 v_mfma_f32_16x16x32_bf16 v[36:39], a[40:43], v[160:163], v[36:39]
 v_mfma_f32_16x16x32_bf16 v[36:39], a[36:39], v[152:155], v[36:39]
 buffer_load_dword v13, v12, s[96:99], s70 offen sc1
 v_mfma_f32_16x16x32_bf16 v[36:39], a[32:35], a[180:183], v[36:39]
 s_add_u32 s60, s6, 3072
 buffer_load_dwordx4 v9, s[48:51], s60 offen offset:1024 sc1 lds
 v_mfma_f32_16x16x32_bf16 v[40:43], a[48:51], a[176:179], v[40:43]
 ds_read_b128 a[16:19], v255 offset:1024
 v_mfma_f32_16x16x32_bf16 v[40:43], a[52:55], v[148:151], v[40:43]
 ds_read_b128 a[20:23], v255 offset:10240
 v_mfma_f32_16x16x32_bf16 v[40:43], a[56:59], v[156:159], v[40:43]
 v_mfma_f32_16x16x32_bf16 v[40:43], a[60:63], v[164:167], v[40:43]
 ds_read_b128 a[24:27], v255 offset:19456
 v_mfma_f32_16x16x32_bf16 v[44:47], a[60:63], v[168:171], v[44:47]
 ds_read_b128 a[28:31], v255 offset:28672
 v_mfma_f32_16x16x32_bf16 v[44:47], a[56:59], v[160:163], v[44:47]
 s_add_u32 s60, s6, 3072
 buffer_load_dwordx4 v9, s[48:51], s60 offen offset:2048 sc1 lds
 v_mfma_f32_16x16x32_bf16 v[44:47], a[52:55], v[152:155], v[44:47]
 v_mfma_f32_16x16x32_bf16 v[44:47], a[48:51], a[180:183], v[44:47]
 s_waitcnt lgkmcnt(4)
 v_mfma_f32_16x16x32_bf16 v[48:51], a[0:3], a[176:179], v[48:51]
 ds_read_b128 a[32:35], v255 offset:2048
 s_add_u32 s27, s77, 14336
 buffer_load_dwordx4 a[72:75], v9, s[8:11], s27 offen sc1
 v_mfma_f32_16x16x32_bf16 v[48:51], a[4:7], v[148:151], v[48:51]
 ds_read_b128 a[36:39], v255 offset:11264
 v_mfma_f32_16x16x32_bf16 v[48:51], a[8:11], v[156:159], v[48:51]
 v_mfma_f32_16x16x32_bf16 v[48:51], a[12:15], v[164:167], v[48:51]
 ds_read_b128 a[40:43], v255 offset:20480
 s_add_u32 s60, s36, 1024
 buffer_load_dwordx4 v9, s[48:51], s60 offen offset:3072 sc1 lds
 v_mfma_f32_16x16x32_bf16 v[52:55], a[12:15], v[168:171], v[52:55]
 ds_read_b128 a[44:47], v255 offset:29696
 v_mfma_f32_16x16x32_bf16 v[52:55], a[8:11], v[160:163], v[52:55]
 v_mfma_f32_16x16x32_bf16 v[52:55], a[4:7], v[152:155], v[52:55]
 v_mfma_f32_16x16x32_bf16 v[52:55], a[0:3], a[180:183], v[52:55]
 s_waitcnt lgkmcnt(4)
 v_mfma_f32_16x16x32_bf16 v[56:59], a[16:19], a[176:179], v[56:59]
 ds_read_b128 a[48:51], v255 offset:3072
 s_add_u32 m0, s61, 40960
 s_add_u32 s60, s83, 73728
 buffer_load_dwordx4 v9, s[48:51], s60 offen offset:0 sc1 lds
 buffer_load_dwordx4 a[76:79], v9, s[8:11], s27 offen offset:1024 sc1
 v_mfma_f32_16x16x32_bf16 v[56:59], a[20:23], v[148:151], v[56:59]
 ds_read_b128 a[52:55], v255 offset:12288
 v_mfma_f32_16x16x32_bf16 v[56:59], a[24:27], v[156:159], v[56:59]
 v_mfma_f32_16x16x32_bf16 v[56:59], a[28:31], v[164:167], v[56:59]
 ds_read_b128 a[56:59], v255 offset:21504
 v_mfma_f32_16x16x32_bf16 v[60:63], a[28:31], v[168:171], v[60:63]
 ds_read_b128 a[60:63], v255 offset:30720
 v_mfma_f32_16x16x32_bf16 v[60:63], a[24:27], v[160:163], v[60:63]
 v_mfma_f32_16x16x32_bf16 v[60:63], a[20:23], v[152:155], v[60:63]
 s_add_u32 s60, s83, 109568
 buffer_load_dwordx4 v9, s[48:51], s60 offen offset:1024 sc1 lds
 v_mfma_f32_16x16x32_bf16 v[60:63], a[16:19], a[180:183], v[60:63]
 s_waitcnt lgkmcnt(4)
 v_mfma_f32_16x16x32_bf16 v[80:83], a[32:35], a[176:179], v[80:83]
 ds_read_b128 a[0:3], v255 offset:4096
 v_mfma_f32_16x16x32_bf16 v[80:83], a[36:39], v[148:151], v[80:83]
 ds_read_b128 a[4:7], v255 offset:13312
 s_add_u32 s27, s78, 14336
 buffer_load_dwordx4 a[80:83], v9, s[8:11], s27 offen sc1
 v_mfma_f32_16x16x32_bf16 v[80:83], a[40:43], v[156:159], v[80:83]
 s_branch L_c4_p4_s
L_c4_p4:
 s_branch L_c4_ret
L_c4_p4_s:
 v_mfma_f32_16x16x32_bf16 v[80:83], a[44:47], v[164:167], v[80:83]
 ds_read_b128 a[8:11], v255 offset:22528
 v_mfma_f32_16x16x32_bf16 v[84:87], a[44:47], v[168:171], v[84:87]
 ds_read_b128 a[12:15], v255 offset:31744
 s_add_u32 s60, s83, 145408
 buffer_load_dwordx4 v9, s[48:51], s60 offen offset:2048 sc1 lds
 v_mfma_f32_16x16x32_bf16 v[84:87], a[40:43], v[160:163], v[84:87]
 v_mfma_f32_16x16x32_bf16 v[84:87], a[36:39], v[152:155], v[84:87]
 v_mfma_f32_16x16x32_bf16 v[84:87], a[32:35], a[180:183], v[84:87]
 s_waitcnt lgkmcnt(4)
 v_mfma_f32_16x16x32_bf16 v[16:19], a[48:51], a[184:187], v[16:19]
 ds_read_b128 a[16:19], v255 offset:5120
 s_waitcnt vmcnt(31)
 v_mfma_f32_16x16x32_bf16 v[16:19], a[52:55], v[172:175], v[16:19]
 ds_read_b128 a[20:23], v255 offset:14336
 s_add_u32 s60, s83, 181248
 buffer_load_dwordx4 v9, s[48:51], s60 offen offset:3072 sc1 lds
 s_waitcnt vmcnt(30)
 v_mfma_f32_16x16x32_bf16 v[16:19], a[56:59], v[180:183], v[16:19]
 buffer_load_dwordx4 a[84:87], v9, s[8:11], s27 offen offset:1024 sc1
 s_waitcnt vmcnt(27)
 v_mfma_f32_16x16x32_bf16 v[16:19], a[60:63], v[188:191], v[16:19]
 ds_read_b128 a[24:27], v255 offset:23552
 s_waitcnt vmcnt(24)
 v_mfma_f32_16x16x32_bf16 v[20:23], a[60:63], v[192:195], v[20:23]
 ds_read_b128 a[28:31], v255 offset:32768
 v_mfma_f32_16x16x32_bf16 v[20:23], a[56:59], v[184:187], v[20:23]
 v_mfma_f32_16x16x32_bf16 v[20:23], a[52:55], v[176:179], v[20:23]
 v_mfma_f32_16x16x32_bf16 v[20:23], a[48:51], a[188:191], v[20:23]
 s_waitcnt lgkmcnt(4)
 s_add_u32 m0, s61, 45056
 s_add_u32 s60, s83, 221184
 buffer_load_dwordx4 v9, s[48:51], s60 offen offset:0 sc1 lds
 v_mfma_f32_16x16x32_bf16 v[24:27], a[0:3], a[184:187], v[24:27]
 ds_read_b128 a[32:35], v255 offset:6144
 v_mfma_f32_16x16x32_bf16 v[24:27], a[4:7], v[172:175], v[24:27]
 ds_read_b128 a[36:39], v255 offset:15360
 v_mfma_f32_16x16x32_bf16 v[24:27], a[8:11], v[180:183], v[24:27]
 v_mfma_f32_16x16x32_bf16 v[24:27], a[12:15], v[188:191], v[24:27]
 ds_read_b128 a[40:43], v255 offset:24576
 s_add_u32 s27, s79, 14336
 buffer_load_dwordx4 a[88:91], v9, s[8:11], s27 offen sc1
 v_mfma_f32_16x16x32_bf16 v[28:31], a[12:15], v[192:195], v[28:31]
 ds_read_b128 a[44:47], v255 offset:33792
 v_mfma_f32_16x16x32_bf16 v[28:31], a[8:11], v[184:187], v[28:31]
 v_mfma_f32_16x16x32_bf16 v[28:31], a[4:7], v[176:179], v[28:31]
 v_mfma_f32_16x16x32_bf16 v[28:31], a[0:3], a[188:191], v[28:31]
 s_waitcnt lgkmcnt(4)
 v_mfma_f32_16x16x32_bf16 v[32:35], a[16:19], a[184:187], v[32:35]
 ds_read_b128 a[48:51], v255 offset:7168
 v_mfma_f32_16x16x32_bf16 v[32:35], a[20:23], v[172:175], v[32:35]
 ds_read_b128 a[52:55], v255 offset:16384
 v_mfma_f32_16x16x32_bf16 v[32:35], a[24:27], v[180:183], v[32:35]
 v_mfma_f32_16x16x32_bf16 v[32:35], a[28:31], v[188:191], v[32:35]
 ds_read_b128 a[56:59], v255 offset:25600
 v_mfma_f32_16x16x32_bf16 v[36:39], a[28:31], v[192:195], v[36:39]
 ds_read_b128 a[60:63], v255 offset:34816
 buffer_load_dwordx4 a[92:95], v9, s[8:11], s27 offen offset:1024 sc1
 v_mfma_f32_16x16x32_bf16 v[36:39], a[24:27], v[184:187], v[36:39]
 v_mfma_f32_16x16x32_bf16 v[36:39], a[20:23], v[176:179], v[36:39]
 v_mfma_f32_16x16x32_bf16 v[36:39], a[16:19], a[188:191], v[36:39]
 s_waitcnt lgkmcnt(4)
 v_mfma_f32_16x16x32_bf16 v[40:43], a[32:35], a[184:187], v[40:43]
 ds_read_b128 a[0:3], v255 offset:8192
 v_mfma_f32_16x16x32_bf16 v[40:43], a[36:39], v[172:175], v[40:43]
 ds_read_b128 a[4:7], v255 offset:17408
 v_mfma_f32_16x16x32_bf16 v[40:43], a[40:43], v[180:183], v[40:43]
 v_mfma_f32_16x16x32_bf16 v[40:43], a[44:47], v[188:191], v[40:43]
 ds_read_b128 a[8:11], v255 offset:26624
 v_mfma_f32_16x16x32_bf16 v[44:47], a[44:47], v[192:195], v[44:47]
 ds_read_b128 a[12:15], v255 offset:35840
 v_mfma_f32_16x16x32_bf16 v[44:47], a[40:43], v[184:187], v[44:47]
 s_waitcnt vmcnt(14)
 v_cmp_ne_u32 vcc, s3, v13
 s_nop 4
 s_cbranch_vccnz L_slow_c
L_back_c:
 v_mfma_f32_16x16x32_bf16 v[44:47], a[36:39], v[176:179], v[44:47]
 v_mfma_f32_16x16x32_bf16 v[44:47], a[32:35], a[188:191], v[44:47]
 s_waitcnt lgkmcnt(0)
 s_barrier
 v_mfma_f32_16x16x32_bf16 v[48:51], a[48:51], a[184:187], v[48:51]
 v_add_u32 v255, 36864, v255
 ds_read_b128 a[16:19], v255 offset:0
 s_add_u32 s27, s77, 16384
 buffer_load_dwordx4 a[96:99], v9, s[8:11], s27 offen sc1
 v_mfma_f32_16x16x32_bf16 v[48:51], a[52:55], v[172:175], v[48:51]
 ds_read_b128 a[20:23], v255 offset:9216
 v_mfma_f32_16x16x32_bf16 v[48:51], a[56:59], v[180:183], v[48:51]
 s_add_u32 m0, s61, 73728
 s_add_u32 s60, s83, 258048
 buffer_load_dwordx4 v9, s[48:51], s60 offen offset:0 sc1 lds
 v_mfma_f32_16x16x32_bf16 v[48:51], a[60:63], v[188:191], v[48:51]
 ds_read_b128 a[24:27], v255 offset:18432
 v_mfma_f32_16x16x32_bf16 v[52:55], a[60:63], v[192:195], v[52:55]
 ds_read_b128 a[28:31], v255 offset:27648
 v_mfma_f32_16x16x32_bf16 v[52:55], a[56:59], v[184:187], v[52:55]
 v_mfma_f32_16x16x32_bf16 v[52:55], a[52:55], v[176:179], v[52:55]
 v_mfma_f32_16x16x32_bf16 v[52:55], a[48:51], a[188:191], v[52:55]
 s_add_u32 s60, s7, 3072
 buffer_load_dwordx4 v9, s[48:51], s60 offen offset:1024 sc1 lds
 v_mfma_f32_16x16x32_bf16 v[56:59], a[0:3], a[184:187], v[56:59]
 ds_read_b128 a[32:35], v255 offset:1024
 buffer_load_dwordx4 a[100:103], v9, s[8:11], s27 offen offset:1024 sc1
 v_mfma_f32_16x16x32_bf16 v[56:59], a[4:7], v[172:175], v[56:59]
 ds_read_b128 a[36:39], v255 offset:10240
 v_mfma_f32_16x16x32_bf16 v[56:59], a[8:11], v[180:183], v[56:59]
 v_mfma_f32_16x16x32_bf16 v[56:59], a[12:15], v[188:191], v[56:59]
 ds_read_b128 a[40:43], v255 offset:19456
 v_mfma_f32_16x16x32_bf16 v[60:63], a[12:15], v[192:195], v[60:63]
 ds_read_b128 a[44:47], v255 offset:28672
 v_mfma_f32_16x16x32_bf16 v[60:63], a[8:11], v[184:187], v[60:63]
 s_add_u32 s60, s83, 72704
 buffer_load_dwordx4 v9, s[48:51], s60 offen offset:2048 sc1 lds
 v_mfma_f32_16x16x32_bf16 v[60:63], a[4:7], v[176:179], v[60:63]
 v_mfma_f32_16x16x32_bf16 v[60:63], a[0:3], a[188:191], v[60:63]
 s_waitcnt lgkmcnt(4)
 v_mfma_f32_16x16x32_bf16 v[80:83], a[16:19], a[184:187], v[80:83]
 ds_read_b128 a[48:51], v255 offset:2048
 v_mfma_f32_16x16x32_bf16 v[80:83], a[20:23], v[172:175], v[80:83]
 ds_read_b128 a[52:55], v255 offset:11264
 s_add_u32 s27, s78, 16384
 buffer_load_dwordx4 a[104:107], v9, s[8:11], s27 offen sc1
 v_mfma_f32_16x16x32_bf16 v[80:83], a[24:27], v[180:183], v[80:83]
 v_mfma_f32_16x16x32_bf16 v[80:83], a[28:31], v[188:191], v[80:83]
 ds_read_b128 a[56:59], v255 offset:20480
 s_add_u32 s60, s83, 108544
 buffer_load_dwordx4 v9, s[48:51], s60 offen offset:3072 sc1 lds
 v_mfma_f32_16x16x32_bf16 v[84:87], a[28:31], v[192:195], v[84:87]
 ds_read_b128 a[60:63], v255 offset:29696
 v_mfma_f32_16x16x32_bf16 v[84:87], a[24:27], v[184:187], v[84:87]
 v_mfma_f32_16x16x32_bf16 v[84:87], a[20:23], v[176:179], v[84:87]
 v_mfma_f32_16x16x32_bf16 v[84:87], a[16:19], a[188:191], v[84:87]
 s_waitcnt lgkmcnt(4)
 v_mfma_f32_16x16x32_bf16 v[16:19], a[32:35], a[192:195], v[16:19]
 ds_read_b128 a[0:3], v255 offset:3072
 s_add_u32 m0, s61, 77824
 s_add_u32 s60, s83, 148480
 buffer_load_dwordx4 v9, s[48:51], s60 offen offset:0 sc1 lds
 v_mfma_f32_16x16x32_bf16 v[16:19], a[36:39], v[196:199], v[16:19]
 ds_read_b128 a[4:7], v255 offset:12288
 v_mfma_f32_16x16x32_bf16 v[16:19], a[40:43], v[204:207], v[16:19]
 buffer_load_dwordx4 a[108:111], v9, s[8:11], s27 offen offset:1024 sc1
 buffer_load_dwordx4 v[108:111], v9, s[12:15], s90 offen sc1
 v_mfma_f32_16x16x32_bf16 v[16:19], a[44:47], v[212:215], v[16:19]
 ds_read_b128 a[8:11], v255 offset:21504
 v_mfma_f32_16x16x32_bf16 v[20:23], a[44:47], v[216:219], v[20:23]
 ds_read_b128 a[12:15], v255 offset:30720
 v_mfma_f32_16x16x32_bf16 v[20:23], a[40:43], v[208:211], v[20:23]
 v_mfma_f32_16x16x32_bf16 v[20:23], a[36:39], v[200:203], v[20:23]
 s_add_u32 s60, s83, 184320
 buffer_load_dwordx4 v9, s[48:51], s60 offen offset:1024 sc1 lds
 v_mfma_f32_16x16x32_bf16 v[20:23], a[32:35], a[196:199], v[20:23]
 s_waitcnt lgkmcnt(4)
 v_mfma_f32_16x16x32_bf16 v[24:27], a[48:51], a[192:195], v[24:27]
 ds_read_b128 a[16:19], v255 offset:4096
 v_mfma_f32_16x16x32_bf16 v[24:27], a[52:55], v[196:199], v[24:27]
 ds_read_b128 a[20:23], v255 offset:13312
 s_add_u32 s67, s90, 18432
 buffer_load_dwordx4 v[112:115], v9, s[12:15], s67 offen sc1
 v_mfma_f32_16x16x32_bf16 v[24:27], a[56:59], v[204:207], v[24:27]
 v_mfma_f32_16x16x32_bf16 v[24:27], a[60:63], v[212:215], v[24:27]
 ds_read_b128 a[24:27], v255 offset:22528
 s_add_u32 s27, s79, 16384
 buffer_load_dwordx4 a[112:115], v9, s[8:11], s27 offen sc1
 v_mfma_f32_16x16x32_bf16 v[28:31], a[60:63], v[216:219], v[28:31]
 ds_read_b128 a[28:31], v255 offset:31744
 s_add_u32 s60, s83, 220160
 buffer_load_dwordx4 v9, s[48:51], s60 offen offset:2048 sc1 lds
 v_mfma_f32_16x16x32_bf16 v[28:31], a[56:59], v[208:211], v[28:31]
 v_mfma_f32_16x16x32_bf16 v[28:31], a[52:55], v[200:203], v[28:31]
 v_mfma_f32_16x16x32_bf16 v[28:31], a[48:51], a[196:199], v[28:31]
 s_waitcnt lgkmcnt(4)
 v_mfma_f32_16x16x32_bf16 v[32:35], a[0:3], a[192:195], v[32:35]
 ds_read_b128 a[32:35], v255 offset:5120
 buffer_load_dwordx2 v[118:119], v11, s[12:15], s91 offen sc1
 v_mfma_f32_16x16x32_bf16 v[32:35], a[4:7], v[196:199], v[32:35]
 ds_read_b128 a[36:39], v255 offset:14336
 s_add_u32 s60, s83, 256000
 buffer_load_dwordx4 v9, s[48:51], s60 offen offset:3072 sc1 lds
 v_mfma_f32_16x16x32_bf16 v[32:35], a[8:11], v[204:207], v[32:35]
 v_mfma_f32_16x16x32_bf16 v[32:35], a[12:15], v[212:215], v[32:35]
 ds_read_b128 a[40:43], v255 offset:23552
 v_mfma_f32_16x16x32_bf16 v[36:39], a[12:15], v[216:219], v[36:39]
 ds_read_b128 a[44:47], v255 offset:32768
 buffer_load_dwordx4 a[116:119], v9, s[8:11], s27 offen offset:1024 sc1
 v_mfma_f32_16x16x32_bf16 v[36:39], a[8:11], v[208:211], v[36:39]
 v_mfma_f32_16x16x32_bf16 v[36:39], a[4:7], v[200:203], v[36:39]
 v_mfma_f32_16x16x32_bf16 v[36:39], a[0:3], a[196:199], v[36:39]
 s_waitcnt lgkmcnt(4)
 s_add_u32 m0, s61, 81920
 s_add_u32 s60, s7, 5120
 buffer_load_dwordx4 v9, s[48:51], s60 offen offset:0 sc1 lds
 v_mfma_f32_16x16x32_bf16 v[40:43], a[16:19], a[192:195], v[40:43]
 ds_read_b128 a[48:51], v255 offset:6144
 v_mfma_f32_16x16x32_bf16 v[40:43], a[20:23], v[196:199], v[40:43]
 ds_read_b128 a[52:55], v255 offset:15360
 v_mfma_f32_16x16x32_bf16 v[40:43], a[24:27], v[204:207], v[40:43]
 v_mfma_f32_16x16x32_bf16 v[40:43], a[28:31], v[212:215], v[40:43]
 ds_read_b128 a[56:59], v255 offset:24576
 v_mfma_f32_16x16x32_bf16 v[44:47], a[28:31], v[216:219], v[44:47]
 ds_read_b128 a[60:63], v255 offset:33792
 v_mfma_f32_16x16x32_bf16 v[44:47], a[24:27], v[208:211], v[44:47]
 v_mfma_f32_16x16x32_bf16 v[44:47], a[20:23], v[200:203], v[44:47]
 v_mfma_f32_16x16x32_bf16 v[44:47], a[16:19], a[196:199], v[44:47]
 s_waitcnt lgkmcnt(4)
 v_mfma_f32_16x16x32_bf16 v[48:51], a[32:35], a[192:195], v[48:51]
 ds_read_b128 a[0:3], v255 offset:7168
 v_mfma_f32_16x16x32_bf16 v[48:51], a[36:39], v[196:199], v[48:51]
 ds_read_b128 a[4:7], v255 offset:16384
 v_mfma_f32_16x16x32_bf16 v[48:51], a[40:43], v[204:207], v[48:51]
 v_mfma_f32_16x16x32_bf16 v[48:51], a[44:47], v[212:215], v[48:51]
 ds_read_b128 a[8:11], v255 offset:25600
 v_mfma_f32_16x16x32_bf16 v[52:55], a[44:47], v[216:219], v[52:55]
 ds_read_b128 a[12:15], v255 offset:34816
 v_mfma_f32_16x16x32_bf16 v[52:55], a[40:43], v[208:211], v[52:55]
 v_mfma_f32_16x16x32_bf16 v[52:55], a[36:39], v[200:203], v[52:55]
 v_mfma_f32_16x16x32_bf16 v[52:55], a[32:35], a[196:199], v[52:55]
 s_waitcnt lgkmcnt(4)
 v_mfma_f32_16x16x32_bf16 v[56:59], a[48:51], a[192:195], v[56:59]
 ds_read_b128 a[16:19], v255 offset:8192
 v_mfma_f32_16x16x32_bf16 v[56:59], a[52:55], v[196:199], v[56:59]
 ds_read_b128 a[20:23], v255 offset:17408
 v_mfma_f32_16x16x32_bf16 v[56:59], a[56:59], v[204:207], v[56:59]
 v_mfma_f32_16x16x32_bf16 v[56:59], a[60:63], v[212:215], v[56:59]
 ds_read_b128 a[24:27], v255 offset:26624
 v_mfma_f32_16x16x32_bf16 v[60:63], a[60:63], v[216:219], v[60:63]
 ds_read_b128 a[28:31], v255 offset:35840
 v_mfma_f32_16x16x32_bf16 v[60:63], a[56:59], v[208:211], v[60:63]
 v_mfma_f32_16x16x32_bf16 v[60:63], a[52:55], v[200:203], v[60:63]
 v_mfma_f32_16x16x32_bf16 v[60:63], a[48:51], a[196:199], v[60:63]
 s_waitcnt lgkmcnt(0)
 s_barrier
 v_mfma_f32_16x16x32_bf16 v[80:83], a[0:3], a[192:195], v[80:83]
 v_subrev_u32 v255, 110592, v255
 ds_read_b128 a[32:35], v255 offset:0
 v_mfma_f32_16x16x32_bf16 v[80:83], a[4:7], v[196:199], v[80:83]
 ds_read_b128 a[36:39], v255 offset:9216
 v_mfma_f32_16x16x32_bf16 v[80:83], a[8:11], v[204:207], v[80:83]
 v_mfma_f32_16x16x32_bf16 v[80:83], a[12:15], v[212:215], v[80:83]
 ds_read_b128 a[40:43], v255 offset:18432
 v_mfma_f32_16x16x32_bf16 v[84:87], a[12:15], v[216:219], v[84:87]
 ds_read_b128 a[44:47], v255 offset:27648
 v_mfma_f32_16x16x32_bf16 v[84:87], a[8:11], v[208:211], v[84:87]
 v_mfma_f32_16x16x32_bf16 v[84:87], a[4:7], v[200:203], v[84:87]
 v_mfma_f32_16x16x32_bf16 v[84:87], a[0:3], a[196:199], v[84:87]
 v_mfma_f32_16x16x32_bf16 v[16:19], a[16:19], a[200:203], v[16:19]
 ds_read_b128 a[48:51], v255 offset:1024
 s_waitcnt vmcnt(29)
 v_mfma_f32_16x16x32_bf16 v[16:19], a[20:23], a[72:75], v[16:19]
 ds_read_b128 a[52:55], v255 offset:10240
 s_waitcnt vmcnt(24)
 v_mfma_f32_16x16x32_bf16 v[16:19], a[24:27], a[80:83], v[16:19]
 s_waitcnt vmcnt(19)
 v_mfma_f32_16x16x32_bf16 v[16:19], a[28:31], a[88:91], v[16:19]
 ds_read_b128 a[56:59], v255 offset:19456
 s_waitcnt vmcnt(18)
 v_mfma_f32_16x16x32_bf16 v[20:23], a[28:31], a[92:95], v[20:23]
 ds_read_b128 a[60:63], v255 offset:28672
 v_mfma_f32_16x16x32_bf16 v[20:23], a[24:27], a[84:87], v[20:23]
 v_mfma_f32_16x16x32_bf16 v[20:23], a[20:23], a[76:79], v[20:23]
 v_mfma_f32_16x16x32_bf16 v[20:23], a[16:19], a[204:207], v[20:23]
 s_waitcnt lgkmcnt(4)
 v_mfma_f32_16x16x32_bf16 v[24:27], a[32:35], a[200:203], v[24:27]
 ds_read_b128 a[0:3], v255 offset:2048
 v_mfma_f32_16x16x32_bf16 v[24:27], a[36:39], a[72:75], v[24:27]
 ds_read_b128 a[4:7], v255 offset:11264
 v_mfma_f32_16x16x32_bf16 v[24:27], a[40:43], a[80:83], v[24:27]
 v_mfma_f32_16x16x32_bf16 v[24:27], a[44:47], a[88:91], v[24:27]
 ds_read_b128 a[8:11], v255 offset:20480
 v_mfma_f32_16x16x32_bf16 v[28:31], a[44:47], a[92:95], v[28:31]
 ds_read_b128 a[12:15], v255 offset:29696
 v_mfma_f32_16x16x32_bf16 v[28:31], a[40:43], a[84:87], v[28:31]
 v_mfma_f32_16x16x32_bf16 v[28:31], a[36:39], a[76:79], v[28:31]
 v_mfma_f32_16x16x32_bf16 v[28:31], a[32:35], a[204:207], v[28:31]
 s_waitcnt lgkmcnt(4)
 v_mfma_f32_16x16x32_bf16 v[32:35], a[48:51], a[200:203], v[32:35]
 ds_read_b128 a[16:19], v255 offset:3072
 v_mfma_f32_16x16x32_bf16 v[32:35], a[52:55], a[72:75], v[32:35]
 ds_read_b128 a[20:23], v255 offset:12288
 v_mfma_f32_16x16x32_bf16 v[32:35], a[56:59], a[80:83], v[32:35]
 v_mfma_f32_16x16x32_bf16 v[32:35], a[60:63], a[88:91], v[32:35]
 ds_read_b128 a[24:27], v255 offset:21504
 v_mfma_f32_16x16x32_bf16 v[36:39], a[60:63], a[92:95], v[36:39]
 ds_read_b128 a[28:31], v255 offset:30720
 v_mfma_f32_16x16x32_bf16 v[36:39], a[56:59], a[84:87], v[36:39]
 v_mfma_f32_16x16x32_bf16 v[36:39], a[52:55], a[76:79], v[36:39]
 v_mfma_f32_16x16x32_bf16 v[36:39], a[48:51], a[204:207], v[36:39]
 s_waitcnt lgkmcnt(4)
 v_mfma_f32_16x16x32_bf16 v[40:43], a[0:3], a[200:203], v[40:43]
 ds_read_b128 a[32:35], v255 offset:4096
 v_mfma_f32_16x16x32_bf16 v[40:43], a[4:7], a[72:75], v[40:43]
 ds_read_b128 a[36:39], v255 offset:13312
 v_mfma_f32_16x16x32_bf16 v[40:43], a[8:11], a[80:83], v[40:43]
 v_mfma_f32_16x16x32_bf16 v[40:43], a[12:15], a[88:91], v[40:43]
 ds_read_b128 a[40:43], v255 offset:22528
 v_mfma_f32_16x16x32_bf16 v[44:47], a[12:15], a[92:95], v[44:47]
 ds_read_b128 a[44:47], v255 offset:31744
 s_waitcnt vmcnt(3)
 v_lshlrev_b32 v116, 16, v118
 v_and_b32 v117, 0xffff0000, v118
 v_lshlrev_b32 v118, 16, v119
 v_mfma_f32_16x16x32_bf16 v[44:47], a[8:11], a[84:87], v[44:47]
 v_and_b32 v119, 0xffff0000, v119
 v_mfma_f32_16x16x32_bf16 v[44:47], a[4:7], a[76:79], v[44:47]
 v_mfma_f32_16x16x32_bf16 v[44:47], a[0:3], a[204:207], v[44:47]
 s_waitcnt lgkmcnt(4)
 v_mfma_f32_16x16x32_bf16 v[48:51], a[16:19], a[200:203], v[48:51]
 ds_read_b128 a[48:51], v255 offset:5120
 v_mfma_f32_16x16x32_bf16 v[48:51], a[20:23], a[72:75], v[48:51]
 ds_read_b128 a[52:55], v255 offset:14336
 v_mfma_f32_16x16x32_bf16 v[48:51], a[24:27], a[80:83], v[48:51]
 v_mfma_f32_16x16x32_bf16 v[48:51], a[28:31], a[88:91], v[48:51]
 ds_read_b128 a[56:59], v255 offset:23552
 v_mfma_f32_16x16x32_bf16 v[52:55], a[28:31], a[92:95], v[52:55]
 ds_read_b128 a[60:63], v255 offset:32768
 v_mfma_f32_16x16x32_bf16 v[52:55], a[24:27], a[84:87], v[52:55]
 v_mfma_f32_16x16x32_bf16 v[52:55], a[20:23], a[76:79], v[52:55]
 v_mfma_f32_16x16x32_bf16 v[52:55], a[16:19], a[204:207], v[52:55]
 s_waitcnt lgkmcnt(4)
 v_mfma_f32_16x16x32_bf16 v[64:67], v[102:105], v[108:111], v[64:67]
 v_mfma_f32_16x16x32_bf16 v[72:75], v[100:103], v[108:111], v[72:75]
 v_mfma_f32_16x16x32_bf16 v[68:71], v[102:105], v[112:115], v[68:71]
 v_mfma_f32_16x16x32_bf16 v[76:79], v[100:103], v[112:115], v[76:79]
 v_mfma_f32_16x16x32_bf16 v[56:59], a[32:35], a[200:203], v[56:59]
 ds_read_b128 a[0:3], v255 offset:6144
 v_mfma_f32_16x16x32_bf16 v[56:59], a[36:39], a[72:75], v[56:59]
 ds_read_b128 a[4:7], v255 offset:15360
 v_mfma_f32_16x16x32_bf16 v[56:59], a[40:43], a[80:83], v[56:59]
 v_mfma_f32_16x16x32_bf16 v[56:59], a[44:47], a[88:91], v[56:59]
 ds_read_b128 a[8:11], v255 offset:24576
 v_mfma_f32_16x16x32_bf16 v[60:63], a[44:47], a[92:95], v[60:63]
 ds_read_b128 a[12:15], v255 offset:33792
 v_mfma_f32_16x16x32_bf16 v[60:63], a[40:43], a[84:87], v[60:63]
 v_mfma_f32_16x16x32_bf16 v[60:63], a[36:39], a[76:79], v[60:63]
 v_mfma_f32_16x16x32_bf16 v[60:63], a[32:35], a[204:207], v[60:63]
 s_waitcnt lgkmcnt(4)
 v_mfma_f32_16x16x32_bf16 v[80:83], a[48:51], a[200:203], v[80:83]
 ds_read_b128 a[16:19], v255 offset:7168
 v_mfma_f32_16x16x32_bf16 v[80:83], a[52:55], a[72:75], v[80:83]
 ds_read_b128 a[20:23], v255 offset:16384
 v_mfma_f32_16x16x32_bf16 v[80:83], a[56:59], a[80:83], v[80:83]
 v_mfma_f32_16x16x32_bf16 v[80:83], a[60:63], a[88:91], v[80:83]
 ds_read_b128 a[24:27], v255 offset:25600
 v_mfma_f32_16x16x32_bf16 v[84:87], a[60:63], a[92:95], v[84:87]
 ds_read_b128 a[28:31], v255 offset:34816
 v_mfma_f32_16x16x32_bf16 v[84:87], a[56:59], a[84:87], v[84:87]
 v_mfma_f32_16x16x32_bf16 v[84:87], a[52:55], a[76:79], v[84:87]
 v_mfma_f32_16x16x32_bf16 v[84:87], a[48:51], a[204:207], v[84:87]
 s_waitcnt lgkmcnt(4)
 v_mfma_f32_16x16x32_bf16 v[16:19], a[0:3], a[208:211], v[16:19]
 ds_read_b128 a[32:35], v255 offset:8192
 v_mfma_f32_16x16x32_bf16 v[16:19], a[4:7], a[96:99], v[16:19]
 ds_read_b128 a[36:39], v255 offset:17408
 v_mfma_f32_16x16x32_bf16 v[16:19], a[8:11], a[104:107], v[16:19]
 v_mfma_f32_16x16x32_bf16 v[16:19], a[12:15], a[112:115], v[16:19]
 ds_read_b128 a[40:43], v255 offset:26624
 s_waitcnt vmcnt(1)
 v_mfma_f32_16x16x32_bf16 v[20:23], a[12:15], a[116:119], v[20:23]
 ds_read_b128 a[44:47], v255 offset:35840
 v_mfma_f32_16x16x32_bf16 v[20:23], a[8:11], a[108:111], v[20:23]
 v_mfma_f32_16x16x32_bf16 v[20:23], a[4:7], a[100:103], v[20:23]
 s_nop 1
 v_cvt_pk_bf16_f32 v16, v16, v17
 v_cvt_pk_bf16_f32 v17, v18, v19
 v_mfma_f32_16x16x32_bf16 v[20:23], a[0:3], a[212:215], v[20:23]
 s_waitcnt lgkmcnt(0)
 s_barrier
 v_mfma_f32_16x16x32_bf16 v[24:27], a[16:19], a[208:211], v[24:27]
 v_add_u32 v255, 36864, v255
 ds_read_b128 a[48:51], v255 offset:0
 v_mfma_f32_16x16x32_bf16 v[24:27], a[20:23], a[96:99], v[24:27]
 ds_read_b128 a[52:55], v255 offset:9216
 v_mfma_f32_16x16x32_bf16 v[24:27], a[24:27], a[104:107], v[24:27]
 v_cvt_pk_bf16_f32 v20, v20, v21
 v_cvt_pk_bf16_f32 v21, v22, v23
 v_mfma_f32_16x16x32_bf16 v[24:27], a[28:31], a[112:115], v[24:27]
 ds_read_b128 a[56:59], v255 offset:18432
 v_mfma_f32_16x16x32_bf16 v[28:31], a[28:31], a[116:119], v[28:31]
 ds_read_b128 a[60:63], v255 offset:27648
 v_mfma_f32_16x16x32_bf16 v[28:31], a[24:27], a[108:111], v[28:31]
 v_mfma_f32_16x16x32_bf16 v[28:31], a[20:23], a[100:103], v[28:31]
 s_nop 2
 v_cvt_pk_bf16_f32 v18, v24, v25
 v_cvt_pk_bf16_f32 v19, v26, v27
 v_mfma_f32_16x16x32_bf16 v[28:31], a[16:19], a[212:215], v[28:31]
 s_add_u32 s67, s85, 0
 buffer_store_dwordx4 v[16:19], v9, s[40:43], s67 offen sc1
 v_mfma_f32_16x16x32_bf16 v[32:35], a[32:35], a[208:211], v[32:35]
 ds_read_b128 a[0:3], v255 offset:1024
 v_mfma_f32_16x16x32_bf16 v[32:35], a[36:39], a[96:99], v[32:35]
 ds_read_b128 a[4:7], v255 offset:10240
 v_mfma_f32_16x16x32_bf16 v[32:35], a[40:43], a[104:107], v[32:35]
 s_nop 0
 v_cvt_pk_bf16_f32 v22, v28, v29
 v_cvt_pk_bf16_f32 v23, v30, v31
 v_mfma_f32_16x16x32_bf16 v[32:35], a[44:47], a[112:115], v[32:35]
 ds_read_b128 a[8:11], v255 offset:19456
 s_add_u32 s67, s85, 1024
 buffer_store_dwordx4 v[20:23], v9, s[40:43], s67 offen sc1
 v_mfma_f32_16x16x32_bf16 v[36:39], a[44:47], a[116:119], v[36:39]
 ds_read_b128 a[12:15], v255 offset:28672
 v_mfma_f32_16x16x32_bf16 v[36:39], a[40:43], a[108:111], v[36:39]
 v_mfma_f32_16x16x32_bf16 v[36:39], a[36:39], a[100:103], v[36:39]
 s_nop 0
 v_cvt_pk_bf16_f32 v32, v32, v33
 v_cvt_pk_bf16_f32 v33, v34, v35
 v_mfma_f32_16x16x32_bf16 v[36:39], a[32:35], a[212:215], v[36:39]
 s_waitcnt lgkmcnt(4)
 v_mfma_f32_16x16x32_bf16 v[40:43], a[48:51], a[208:211], v[40:43]
 ds_read_b128 a[16:19], v255 offset:2048
 v_mfma_f32_16x16x32_bf16 v[40:43], a[52:55], a[96:99], v[40:43]
 ds_read_b128 a[20:23], v255 offset:11264
 v_mfma_f32_16x16x32_bf16 v[40:43], a[56:59], a[104:107], v[40:43]
 s_nop 1
 v_cvt_pk_bf16_f32 v36, v36, v37
 v_cvt_pk_bf16_f32 v37, v38, v39
 v_mfma_f32_16x16x32_bf16 v[40:43], a[60:63], a[112:115], v[40:43]
 ds_read_b128 a[24:27], v255 offset:20480
 v_mfma_f32_16x16x32_bf16 v[44:47], a[60:63], a[116:119], v[44:47]
 ds_read_b128 a[28:31], v255 offset:29696
 v_mfma_f32_16x16x32_bf16 v[44:47], a[56:59], a[108:111], v[44:47]
 v_mfma_f32_16x16x32_bf16 v[44:47], a[52:55], a[100:103], v[44:47]
 s_nop 2
 v_cvt_pk_bf16_f32 v34, v40, v41
 v_cvt_pk_bf16_f32 v35, v42, v43
 v_mfma_f32_16x16x32_bf16 v[44:47], a[48:51], a[212:215], v[44:47]
 s_waitcnt lgkmcnt(4)
 s_add_u32 s67, s86, 2048
 buffer_store_dwordx4 v[32:35], v9, s[40:43], s67 offen sc1
 v_mfma_f32_16x16x32_bf16 v[48:51], a[0:3], a[208:211], v[48:51]
 ds_read_b128 a[32:35], v255 offset:3072
 v_mfma_f32_16x16x32_bf16 v[48:51], a[4:7], a[96:99], v[48:51]
 ds_read_b128 a[36:39], v255 offset:12288
 v_mfma_f32_16x16x32_bf16 v[48:51], a[8:11], a[104:107], v[48:51]
 v_cvt_pk_bf16_f32 v38, v44, v45
 v_cvt_pk_bf16_f32 v39, v46, v47
 v_mfma_f32_16x16x32_bf16 v[48:51], a[12:15], a[112:115], v[48:51]
 ds_read_b128 a[40:43], v255 offset:21504
 s_add_u32 s67, s86, 3072
 buffer_store_dwordx4 v[36:39], v9, s[40:43], s67 offen sc1
 v_mfma_f32_16x16x32_bf16 v[52:55], a[12:15], a[116:119], v[52:55]
 ds_read_b128 a[44:47], v255 offset:30720
 v_mfma_f32_16x16x32_bf16 v[52:55], a[8:11], a[108:111], v[52:55]
 v_mfma_f32_16x16x32_bf16 v[52:55], a[4:7], a[100:103], v[52:55]
 s_nop 0
 v_cvt_pk_bf16_f32 v48, v48, v49
 v_cvt_pk_bf16_f32 v49, v50, v51
 v_mfma_f32_16x16x32_bf16 v[52:55], a[0:3], a[212:215], v[52:55]
 s_waitcnt lgkmcnt(4)
 v_mfma_f32_16x16x32_bf16 v[56:59], a[16:19], a[208:211], v[56:59]
 ds_read_b128 a[48:51], v255 offset:4096
 v_mfma_f32_16x16x32_bf16 v[56:59], a[20:23], a[96:99], v[56:59]
 ds_read_b128 a[52:55], v255 offset:13312
 v_mfma_f32_16x16x32_bf16 v[56:59], a[24:27], a[104:107], v[56:59]
 s_nop 1
 v_cvt_pk_bf16_f32 v52, v52, v53
 v_cvt_pk_bf16_f32 v53, v54, v55
 v_mfma_f32_16x16x32_bf16 v[56:59], a[28:31], a[112:115], v[56:59]
 ds_read_b128 a[56:59], v255 offset:22528
 v_mfma_f32_16x16x32_bf16 v[60:63], a[28:31], a[116:119], v[60:63]
 ds_read_b128 a[60:63], v255 offset:31744
 v_mfma_f32_16x16x32_bf16 v[60:63], a[24:27], a[108:111], v[60:63]
 v_mfma_f32_16x16x32_bf16 v[60:63], a[20:23], a[100:103], v[60:63]
 s_nop 2
 v_cvt_pk_bf16_f32 v50, v56, v57
 v_cvt_pk_bf16_f32 v51, v58, v59
 v_mfma_f32_16x16x32_bf16 v[60:63], a[16:19], a[212:215], v[60:63]
 s_waitcnt lgkmcnt(4)
 s_add_u32 s67, s87, 4096
 buffer_store_dwordx4 v[48:51], v9, s[40:43], s67 offen sc1
 v_mfma_f32_16x16x32_bf16 v[80:83], a[32:35], a[208:211], v[80:83]
 ds_read_b128 a[0:3], v255 offset:5120
 v_mfma_f32_16x16x32_bf16 v[80:83], a[36:39], a[96:99], v[80:83]
 ds_read_b128 a[4:7], v255 offset:14336
 v_mfma_f32_16x16x32_bf16 v[80:83], a[40:43], a[104:107], v[80:83]
 v_cvt_pk_bf16_f32 v54, v60, v61
 v_cvt_pk_bf16_f32 v55, v62, v63
 v_mfma_f32_16x16x32_bf16 v[80:83], a[44:47], a[112:115], v[80:83]
 ds_read_b128 a[8:11], v255 offset:23552
 s_add_u32 s67, s87, 5120
 buffer_store_dwordx4 v[52:55], v9, s[40:43], s67 offen sc1
 v_mfma_f32_16x16x32_bf16 v[84:87], a[44:47], a[116:119], v[84:87]
 ds_read_b128 a[12:15], v255 offset:32768
 v_mfma_f32_16x16x32_bf16 v[84:87], a[40:43], a[108:111], v[84:87]
 v_mfma_f32_16x16x32_bf16 v[84:87], a[36:39], a[100:103], v[84:87]
 s_nop 0
 v_cvt_pk_bf16_f32 v80, v80, v81
 v_cvt_pk_bf16_f32 v81, v82, v83
 v_mfma_f32_16x16x32_bf16 v[84:87], a[32:35], a[212:215], v[84:87]
 s_waitcnt lgkmcnt(4)
 v_mfma_f32_16x16x32_bf16 v[64:67], a[48:51], a[160:163], v[64:67]
 ds_read_b128 a[16:19], v255 offset:6144
 v_mfma_f32_16x16x32_bf16 v[64:67], a[52:55], a[120:123], v[64:67]
 ds_read_b128 a[20:23], v255 offset:15360
 v_mfma_f32_16x16x32_bf16 v[64:67], a[56:59], a[128:131], v[64:67]
 s_nop 1
 v_cvt_pk_bf16_f32 v82, v84, v85
 v_cvt_pk_bf16_f32 v83, v86, v87
 buffer_store_dwordx4 v[80:83], v9, s[40:43], s71 offen sc1
 v_mfma_f32_16x16x32_bf16 v[64:67], a[60:63], a[136:139], v[64:67]
 ds_read_b128 a[24:27], v255 offset:24576
 v_mfma_f32_16x16x32_bf16 v[68:71], a[60:63], a[140:143], v[68:71]
 ds_read_b128 a[28:31], v255 offset:33792
 v_mfma_f32_16x16x32_bf16 v[68:71], a[56:59], a[132:135], v[68:71]
 v_mfma_f32_16x16x32_bf16 v[68:71], a[52:55], a[124:127], v[68:71]
 v_mfma_f32_16x16x32_bf16 v[68:71], a[48:51], a[164:167], v[68:71]
 s_waitcnt lgkmcnt(4)
 v_mfma_f32_16x16x32_bf16 v[64:67], a[0:3], a[168:171], v[64:67]
 ds_read_b128 a[32:35], v255 offset:7168
 v_mfma_f32_16x16x32_bf16 v[64:67], a[4:7], a[216:219], v[64:67]
 ds_read_b128 a[36:39], v255 offset:16384
 v_mfma_f32_16x16x32_bf16 v[64:67], a[8:11], a[224:227], v[64:67]
 v_mfma_f32_16x16x32_bf16 v[64:67], a[12:15], a[232:235], v[64:67]
 ds_read_b128 a[40:43], v255 offset:25600
 v_mfma_f32_16x16x32_bf16 v[68:71], a[12:15], a[236:239], v[68:71]
 ds_read_b128 a[44:47], v255 offset:34816
 v_mfma_f32_16x16x32_bf16 v[68:71], a[8:11], a[228:231], v[68:71]
 v_mfma_f32_16x16x32_bf16 v[68:71], a[4:7], a[220:223], v[68:71]
 v_mfma_f32_16x16x32_bf16 v[68:71], a[0:3], a[172:175], v[68:71]
 s_waitcnt lgkmcnt(4)
 v_mfma_f32_16x16x32_bf16 v[64:67], a[16:19], a[176:179], v[64:67]
 ds_read_b128 a[48:51], v255 offset:8192
 v_mfma_f32_16x16x32_bf16 v[64:67], a[20:23], v[148:151], v[64:67]
 ds_read_b128 a[52:55], v255 offset:17408
 v_mfma_f32_16x16x32_bf16 v[64:67], a[24:27], v[156:159], v[64:67]
 v_mfma_f32_16x16x32_bf16 v[64:67], a[28:31], v[164:167], v[64:67]
 ds_read_b128 a[56:59], v255 offset:26624
 v_mfma_f32_16x16x32_bf16 v[68:71], a[28:31], v[168:171], v[68:71]
 ds_read_b128 a[60:63], v255 offset:35840
 v_mfma_f32_16x16x32_bf16 v[68:71], a[24:27], v[160:163], v[68:71]
 v_mfma_f32_16x16x32_bf16 v[68:71], a[20:23], v[152:155], v[68:71]
 v_mfma_f32_16x16x32_bf16 v[68:71], a[16:19], a[180:183], v[68:71]
 s_waitcnt vmcnt(7) lgkmcnt(0)
 s_barrier
 v_mfma_f32_16x16x32_bf16 v[64:67], a[32:35], a[184:187], v[64:67]
 v_add_u32 v255, 36864, v255
 ds_read_b128 a[0:3], v255 offset:0
 v_mfma_f32_16x16x32_bf16 v[64:67], a[36:39], v[172:175], v[64:67]
 ds_read_b128 a[4:7], v255 offset:9216
 v_mfma_f32_16x16x32_bf16 v[64:67], a[40:43], v[180:183], v[64:67]
 v_mfma_f32_16x16x32_bf16 v[64:67], a[44:47], v[188:191], v[64:67]
 ds_read_b128 a[8:11], v255 offset:18432
 s_branch L_c4_p5_s
L_c4_p5:
 s_branch L_c4_ret
L_c4_p5_s:
 v_mfma_f32_16x16x32_bf16 v[68:71], a[44:47], v[192:195], v[68:71]
 ds_read_b128 a[12:15], v255 offset:27648
 v_mfma_f32_16x16x32_bf16 v[68:71], a[40:43], v[184:187], v[68:71]
 v_mfma_f32_16x16x32_bf16 v[68:71], a[36:39], v[176:179], v[68:71]
 v_mfma_f32_16x16x32_bf16 v[68:71], a[32:35], a[188:191], v[68:71]
 v_mfma_f32_16x16x32_bf16 v[64:67], a[48:51], a[192:195], v[64:67]
 ds_read_b128 a[16:19], v255 offset:1024
 v_mfma_f32_16x16x32_bf16 v[64:67], a[52:55], v[196:199], v[64:67]
 ds_read_b128 a[20:23], v255 offset:10240
 v_mfma_f32_16x16x32_bf16 v[64:67], a[56:59], v[204:207], v[64:67]
 s_waitcnt vmcnt(0)
 v_mov_b32 v4, s3
 buffer_store_dword v4, v3, s[96:99], s73 offen sc1
 v_mfma_f32_16x16x32_bf16 v[64:67], a[60:63], v[212:215], v[64:67]
 ds_read_b128 a[24:27], v255 offset:19456
 v_mfma_f32_16x16x32_bf16 v[68:71], a[60:63], v[216:219], v[68:71]
 ds_read_b128 a[28:31], v255 offset:28672
 v_mfma_f32_16x16x32_bf16 v[68:71], a[56:59], v[208:211], v[68:71]
 v_mfma_f32_16x16x32_bf16 v[68:71], a[52:55], v[200:203], v[68:71]
 v_mfma_f32_16x16x32_bf16 v[68:71], a[48:51], a[196:199], v[68:71]
 s_waitcnt lgkmcnt(4)
 v_mfma_f32_16x16x32_bf16 v[64:67], a[0:3], a[200:203], v[64:67]
 ds_read_b128 a[32:35], v255 offset:2048
 v_mfma_f32_16x16x32_bf16 v[64:67], a[4:7], a[72:75], v[64:67]
 ds_read_b128 a[36:39], v255 offset:11264
 v_mfma_f32_16x16x32_bf16 v[64:67], a[8:11], a[80:83], v[64:67]
 v_mfma_f32_16x16x32_bf16 v[64:67], a[12:15], a[88:91], v[64:67]
 ds_read_b128 a[40:43], v255 offset:20480
 v_mfma_f32_16x16x32_bf16 v[68:71], a[12:15], a[92:95], v[68:71]
 ds_read_b128 a[44:47], v255 offset:29696
 v_mfma_f32_16x16x32_bf16 v[68:71], a[8:11], a[84:87], v[68:71]
 v_mfma_f32_16x16x32_bf16 v[68:71], a[4:7], a[76:79], v[68:71]
 v_mfma_f32_16x16x32_bf16 v[68:71], a[0:3], a[204:207], v[68:71]
 s_waitcnt lgkmcnt(4)
 v_mfma_f32_16x16x32_bf16 v[64:67], a[16:19], a[208:211], v[64:67]
 ds_read_b128 a[48:51], v255 offset:3072
 v_mfma_f32_16x16x32_bf16 v[64:67], a[20:23], a[96:99], v[64:67]
 ds_read_b128 a[52:55], v255 offset:12288
 v_mfma_f32_16x16x32_bf16 v[64:67], a[24:27], a[104:107], v[64:67]
 v_mfma_f32_16x16x32_bf16 v[64:67], a[28:31], a[112:115], v[64:67]
 ds_read_b128 a[56:59], v255 offset:21504
 v_mfma_f32_16x16x32_bf16 v[68:71], a[28:31], a[116:119], v[68:71]
 ds_read_b128 a[60:63], v255 offset:30720
 v_mfma_f32_16x16x32_bf16 v[68:71], a[24:27], a[108:111], v[68:71]
 v_mfma_f32_16x16x32_bf16 v[68:71], a[20:23], a[100:103], v[68:71]
 v_mfma_f32_16x16x32_bf16 v[68:71], a[16:19], a[212:215], v[68:71]
 s_waitcnt lgkmcnt(4)
 v_mfma_f32_16x16x32_bf16 v[72:75], a[32:35], a[160:163], v[72:75]
 ds_read_b128 a[0:3], v255 offset:4096
 v_mfma_f32_16x16x32_bf16 v[72:75], a[36:39], a[120:123], v[72:75]
 ds_read_b128 a[4:7], v255 offset:13312
 v_mfma_f32_16x16x32_bf16 v[72:75], a[40:43], a[128:131], v[72:75]
 v_mfma_f32_16x16x32_bf16 v[72:75], a[44:47], a[136:139], v[72:75]
 ds_read_b128 a[8:11], v255 offset:22528
 v_mfma_f32_16x16x32_bf16 v[76:79], a[44:47], a[140:143], v[76:79]
 ds_read_b128 a[12:15], v255 offset:31744
 v_mfma_f32_16x16x32_bf16 v[76:79], a[40:43], a[132:135], v[76:79]
 v_mfma_f32_16x16x32_bf16 v[76:79], a[36:39], a[124:127], v[76:79]
 v_mfma_f32_16x16x32_bf16 v[76:79], a[32:35], a[164:167], v[76:79]
 s_waitcnt lgkmcnt(4)
 v_mfma_f32_16x16x32_bf16 v[72:75], a[48:51], a[168:171], v[72:75]
 ds_read_b128 a[16:19], v255 offset:5120
 v_mfma_f32_16x16x32_bf16 v[72:75], a[52:55], a[216:219], v[72:75]
 ds_read_b128 a[20:23], v255 offset:14336
 v_mfma_f32_16x16x32_bf16 v[72:75], a[56:59], a[224:227], v[72:75]
 v_mfma_f32_16x16x32_bf16 v[72:75], a[60:63], a[232:235], v[72:75]
 ds_read_b128 a[24:27], v255 offset:23552
 v_mfma_f32_16x16x32_bf16 v[76:79], a[60:63], a[236:239], v[76:79]
 ds_read_b128 a[28:31], v255 offset:32768
 v_mfma_f32_16x16x32_bf16 v[76:79], a[56:59], a[228:231], v[76:79]
 v_mfma_f32_16x16x32_bf16 v[76:79], a[52:55], a[220:223], v[76:79]
 v_mfma_f32_16x16x32_bf16 v[76:79], a[48:51], a[172:175], v[76:79]
 s_waitcnt lgkmcnt(4)
 v_mfma_f32_16x16x32_bf16 v[72:75], a[0:3], a[176:179], v[72:75]
 ds_read_b128 a[32:35], v255 offset:6144
 v_mfma_f32_16x16x32_bf16 v[72:75], a[4:7], v[148:151], v[72:75]
 ds_read_b128 a[36:39], v255 offset:15360
 v_mfma_f32_16x16x32_bf16 v[72:75], a[8:11], v[156:159], v[72:75]
 v_mfma_f32_16x16x32_bf16 v[72:75], a[12:15], v[164:167], v[72:75]
 ds_read_b128 a[40:43], v255 offset:24576
 v_mfma_f32_16x16x32_bf16 v[76:79], a[12:15], v[168:171], v[76:79]
 ds_read_b128 a[44:47], v255 offset:33792
 buffer_load_dword v13, v10, s[96:99], s75 offen sc1
 v_mfma_f32_16x16x32_bf16 v[76:79], a[8:11], v[160:163], v[76:79]
 v_mfma_f32_16x16x32_bf16 v[76:79], a[4:7], v[152:155], v[76:79]
 v_mfma_f32_16x16x32_bf16 v[76:79], a[0:3], a[180:183], v[76:79]
 s_waitcnt lgkmcnt(4)
 v_mfma_f32_16x16x32_bf16 v[72:75], a[16:19], a[184:187], v[72:75]
 ds_read_b128 a[48:51], v255 offset:7168
 v_mfma_f32_16x16x32_bf16 v[72:75], a[20:23], v[172:175], v[72:75]
 ds_read_b128 a[52:55], v255 offset:16384
 v_mfma_f32_16x16x32_bf16 v[72:75], a[24:27], v[180:183], v[72:75]
 v_mfma_f32_16x16x32_bf16 v[72:75], a[28:31], v[188:191], v[72:75]
 ds_read_b128 a[56:59], v255 offset:25600
 v_mfma_f32_16x16x32_bf16 v[76:79], a[28:31], v[192:195], v[76:79]
 ds_read_b128 a[60:63], v255 offset:34816
 v_mfma_f32_16x16x32_bf16 v[76:79], a[24:27], v[184:187], v[76:79]
 v_mfma_f32_16x16x32_bf16 v[76:79], a[20:23], v[176:179], v[76:79]
 v_mfma_f32_16x16x32_bf16 v[76:79], a[16:19], a[188:191], v[76:79]
 s_waitcnt lgkmcnt(4)
 v_mfma_f32_16x16x32_bf16 v[72:75], a[32:35], a[192:195], v[72:75]
 ds_read_b128 a[0:3], v255 offset:8192
 v_mfma_f32_16x16x32_bf16 v[72:75], a[36:39], v[196:199], v[72:75]
 ds_read_b128 a[4:7], v255 offset:17408
 v_mfma_f32_16x16x32_bf16 v[72:75], a[40:43], v[204:207], v[72:75]
 v_mfma_f32_16x16x32_bf16 v[72:75], a[44:47], v[212:215], v[72:75]
 ds_read_b128 a[8:11], v255 offset:26624
 v_mfma_f32_16x16x32_bf16 v[76:79], a[44:47], v[216:219], v[76:79]
 ds_read_b128 a[12:15], v255 offset:35840
 v_mfma_f32_16x16x32_bf16 v[76:79], a[40:43], v[208:211], v[76:79]
 v_mfma_f32_16x16x32_bf16 v[76:79], a[36:39], v[200:203], v[76:79]
 v_mfma_f32_16x16x32_bf16 v[76:79], a[32:35], a[196:199], v[76:79]
 s_waitcnt lgkmcnt(4)
 v_mfma_f32_16x16x32_bf16 v[72:75], a[48:51], a[200:203], v[72:75]
 v_mfma_f32_16x16x32_bf16 v[72:75], a[52:55], a[72:75], v[72:75]
 v_mfma_f32_16x16x32_bf16 v[72:75], a[56:59], a[80:83], v[72:75]
 v_mfma_f32_16x16x32_bf16 v[72:75], a[60:63], a[88:91], v[72:75]
 v_mfma_f32_16x16x32_bf16 v[76:79], a[60:63], a[92:95], v[76:79]
 v_mfma_f32_16x16x32_bf16 v[76:79], a[56:59], a[84:87], v[76:79]
 v_mfma_f32_16x16x32_bf16 v[76:79], a[52:55], a[76:79], v[76:79]
 v_mfma_f32_16x16x32_bf16 v[76:79], a[48:51], a[204:207], v[76:79]
 s_waitcnt lgkmcnt(0)
 v_mfma_f32_16x16x32_bf16 v[72:75], a[0:3], a[208:211], v[72:75]
 v_mfma_f32_16x16x32_bf16 v[72:75], a[4:7], a[96:99], v[72:75]
 v_mfma_f32_16x16x32_bf16 v[72:75], a[8:11], a[104:107], v[72:75]
 v_mfma_f32_16x16x32_bf16 v[72:75], a[12:15], a[112:115], v[72:75]
 v_mfma_f32_16x16x32_bf16 v[76:79], a[12:15], a[116:119], v[76:79]
 v_mfma_f32_16x16x32_bf16 v[76:79], a[8:11], a[108:111], v[76:79]
 v_mfma_f32_16x16x32_bf16 v[76:79], a[4:7], a[100:103], v[76:79]
 v_mfma_f32_16x16x32_bf16 v[76:79], a[0:3], a[212:215], v[76:79]
 s_waitcnt vmcnt(0)
 v_cmp_ne_u32 vcc, s3, v13
 s_nop 4
 s_cbranch_vccnz L_slow_p5
L_back_p5:
 s_add_u32 s27, s74, 0
 buffer_load_dwordx4 v[120:123], v9, s[40:43], s27 offen offset:0 sc1
 buffer_load_dwordx4 v[124:127], v9, s[40:43], s27 offen offset:1024 sc1
 buffer_load_dwordx4 v[128:131], v9, s[40:43], s27 offen offset:2048 sc1
 buffer_load_dwordx4 v[132:135], v9, s[40:43], s27 offen offset:3072 sc1
 s_add_u32 s27, s74, 4096
 buffer_load_dwordx4 v[136:139], v9, s[40:43], s27 offen offset:0 sc1
 buffer_load_dwordx4 v[140:143], v9, s[40:43], s27 offen offset:1024 sc1
 buffer_load_dwordx4 v[144:147], v14, s[40:43], s72 offen sc1
 s_waitcnt vmcnt(6)
 v_mfma_f32_16x16x32_bf16 v[64:67], v[102:105], v[120:123], v[64:67]
 v_mfma_f32_16x16x32_bf16 v[72:75], v[100:103], v[120:123], v[72:75]
 s_waitcnt vmcnt(5)
 v_mfma_f32_16x16x32_bf16 v[68:71], v[102:105], v[124:127], v[68:71]
 v_mfma_f32_16x16x32_bf16 v[76:79], v[100:103], v[124:127], v[76:79]
 s_waitcnt vmcnt(4)
 v_mfma_f32_16x16x32_bf16 v[64:67], v[102:105], v[128:131], v[64:67]
 v_mfma_f32_16x16x32_bf16 v[72:75], v[100:103], v[128:131], v[72:75]
 s_waitcnt vmcnt(3)
 v_mfma_f32_16x16x32_bf16 v[68:71], v[102:105], v[132:135], v[68:71]
 v_mfma_f32_16x16x32_bf16 v[76:79], v[100:103], v[132:135], v[76:79]
 s_waitcnt vmcnt(2)
 v_mfma_f32_16x16x32_bf16 v[64:67], v[102:105], v[136:139], v[64:67]
 v_mfma_f32_16x16x32_bf16 v[72:75], v[100:103], v[136:139], v[72:75]
 s_waitcnt vmcnt(1)
 v_mfma_f32_16x16x32_bf16 v[68:71], v[102:105], v[140:143], v[68:71]
 v_mfma_f32_16x16x32_bf16 v[76:79], v[100:103], v[140:143], v[76:79]
 s_waitcnt vmcnt(0)
 v_mfma_f32_16x16x32_bf16 v[116:119], v[96:99], v[144:147], v[116:119]
 s_nop 1
 v_cvt_pk_bf16_f32 v120, v64, v65
 v_cvt_pk_bf16_f32 v121, v66, v67
 v_cvt_pk_bf16_f32 v122, v72, v73
 v_cvt_pk_bf16_f32 v123, v74, v75
 s_nop 0
 v_permlane16_swap_b32 v120, v122
 v_permlane16_swap_b32 v121, v123
 s_add_u32 s67, s31, 0
 buffer_store_dwordx4 v[120:123], v15, s[16:19], s67 offen
 v_cvt_pk_bf16_f32 v124, v68, v69
 v_cvt_pk_bf16_f32 v125, v70, v71
 v_cvt_pk_bf16_f32 v126, v76, v77
 v_cvt_pk_bf16_f32 v127, v78, v79
 s_nop 0
 v_permlane16_swap_b32 v124, v126
 v_permlane16_swap_b32 v125, v127
 s_add_u32 s67, s31, 18432
 buffer_store_dwordx4 v[124:127], v15, s[16:19], s67 offen
 v_cvt_pk_bf16_f32 v116, v116, v117
 v_cvt_pk_bf16_f32 v117, v118, v119
 buffer_store_dwordx2 v[116:117], v8, s[16:19], s30 offen
L_exit:
 s_endpgm
L_tagslow_p1:
 v_mov_b32 v248, 0
 global_load_dword v248, v248, s[92:93] sc1
 s_waitcnt vmcnt(0)
 v_readfirstlane_b32 s3, v248
 s_sub_u32 s100, s100, 1
 s_cbranch_scc1 L_tagback_p1
 s_cmp_eq_u32 s3, 0
 s_cbranch_scc1 L_tagslow_p1
 s_branch L_tagback_p1
L_slow_p2:
 s_mov_b64 exec, vcc
 buffer_load_dword v16, v14, s[96:99], 0 offen sc1
 s_waitcnt vmcnt(0)
 v_cmp_ne_u32 vcc, s3, v16
 s_sub_u32 s100, s100, 1
 s_cbranch_scc1 L_out_p2
 s_nop 2
 s_cbranch_vccnz L_slow_p2
L_out_p2:
 s_mov_b64 exec, -1
 s_branch L_back_p2
L_pf3:
 s_sub_u32 s23, s2, 192
 s_lshl_b32 s23, s23, 2
 s_add_u32 s23, s23, s22
 s_mov_b32 s8, s36
 s_and_b32 s9, s37, 0xffff
 s_mov_b32 s10, 0x510000
 s_mov_b32 s11, 0x20000
 s_add_u32 s12, s20, 0x3400000
 s_addc_u32 s13, s21, 0
 s_and_b32 s13, s13, 0xffff
 s_mov_b32 s14, 0x510000
 s_mov_b32 s15, 0x20000
 v_lshrrev_b32 v2, 3, v1
 v_and_b32 v4, 6, v2
 v_and_b32 v3, 7, v1
 v_xor_b32 v4, v4, v3
 v_lshlrev_b32 v4, 4, v4
 v_mul_u32_u24 v5, 1152, v2
 v_add_u32 v5, v5, v4
 v_add_u32 v16, 0, v5
 v_add_u32 v17, 8192, v5
 v_add_u32 v18, 16384, v5
 v_add_u32 v19, 24576, v5
 s_mul_i32 s24, s22, 20480
 s_add_u32 s24, s24, 73728
 v_bfe_u32 v2, v1, 2, 3
 v_lshrrev_b32 v3, 5, v1
 v_lshlrev_b32 v3, 10, v3
 v_lshl_add_u32 v3, v2, 7, v3
 v_and_b32 v4, 3, v1
 v_lshl_add_u32 v3, v4, 3, v3
 v_add_u32 v3, s24, v3
 v_lshrrev_b32 v2, 1, v2
 v_xor_b32 v4, 0, v2
 v_lshl_add_u32 v20, v4, 5, v3
 v_xor_b32 v4, 1, v2
 v_lshl_add_u32 v21, v4, 5, v3
 v_xor_b32 v4, 2, v2
 v_lshl_add_u32 v22, v4, 5, v3
 v_xor_b32 v4, 3, v2
 v_lshl_add_u32 v23, v4, 5, v3
 v_lshlrev_b32 v24, 4, v1
 s_add_u32 s25, s23, 0
 s_mul_i32 s26, s25, 7282
 s_lshr_b32 s26, s26, 16
 s_mul_i32 s27, s26, 9
 s_sub_u32 s27, s25, s27
 s_mul_i32 s26, s26, 36864
 s_lshl_b32 s27, s27, 7
 s_add_u32 s26, s26, s27
 s_add_u32 m0, s24, 0
 s_nop 0
 buffer_load_dwordx4 v16, s[8:11], s26 offen offset:0 lds
 buffer_load_dwordx4 v17, s[8:11], s26 offen offset:1024 lds
 buffer_load_dwordx4 v18, s[8:11], s26 offen offset:2048 lds
 buffer_load_dwordx4 v19, s[8:11], s26 offen offset:3072 lds
 s_add_u32 s25, s23, 256
 s_mul_i32 s26, s25, 7282
 s_lshr_b32 s26, s26, 16
 s_mul_i32 s27, s26, 9
 s_sub_u32 s27, s25, s27
 s_mul_i32 s26, s26, 36864
 s_lshl_b32 s27, s27, 7
 s_add_u32 s26, s26, s27
 s_add_u32 m0, s24, 4096
 s_nop 0
 buffer_load_dwordx4 v16, s[8:11], s26 offen offset:0 lds
 buffer_load_dwordx4 v17, s[8:11], s26 offen offset:1024 lds
 buffer_load_dwordx4 v18, s[8:11], s26 offen offset:2048 lds
 buffer_load_dwordx4 v19, s[8:11], s26 offen offset:3072 lds
 s_add_u32 s25, s23, 512
 s_mul_i32 s26, s25, 7282
 s_lshr_b32 s26, s26, 16
 s_mul_i32 s27, s26, 9
 s_sub_u32 s27, s25, s27
 s_mul_i32 s26, s26, 36864
 s_lshl_b32 s27, s27, 7
 s_add_u32 s26, s26, s27
 s_add_u32 m0, s24, 8192
 s_nop 0
 buffer_load_dwordx4 v16, s[8:11], s26 offen offset:0 lds
 buffer_load_dwordx4 v17, s[8:11], s26 offen offset:1024 lds
 buffer_load_dwordx4 v18, s[8:11], s26 offen offset:2048 lds
 buffer_load_dwordx4 v19, s[8:11], s26 offen offset:3072 lds
 s_add_u32 s25, s23, 768
 s_mul_i32 s26, s25, 7282
 s_lshr_b32 s26, s26, 16
 s_mul_i32 s27, s26, 9
 s_sub_u32 s27, s25, s27
 s_mul_i32 s26, s26, 36864
 s_lshl_b32 s27, s27, 7
 s_add_u32 s26, s26, s27
 s_add_u32 m0, s24, 12288
 s_nop 0
 buffer_load_dwordx4 v16, s[8:11], s26 offen offset:0 lds
 buffer_load_dwordx4 v17, s[8:11], s26 offen offset:1024 lds
 buffer_load_dwordx4 v18, s[8:11], s26 offen offset:2048 lds
 buffer_load_dwordx4 v19, s[8:11], s26 offen offset:3072 lds
 s_add_u32 s25, s23, 1024
 s_mul_i32 s26, s25, 7282
 s_lshr_b32 s26, s26, 16
 s_mul_i32 s27, s26, 9
 s_sub_u32 s27, s25, s27
 s_mul_i32 s26, s26, 36864
 s_lshl_b32 s27, s27, 7
 s_add_u32 s26, s26, s27
 s_add_u32 m0, s24, 16384
 s_nop 0
 buffer_load_dwordx4 v16, s[8:11], s26 offen offset:0 lds
 buffer_load_dwordx4 v17, s[8:11], s26 offen offset:1024 lds
 buffer_load_dwordx4 v18, s[8:11], s26 offen offset:2048 lds
 buffer_load_dwordx4 v19, s[8:11], s26 offen offset:3072 lds
 s_lshl_b32 s28, s23, 12
 s_waitcnt vmcnt(16)
 ds_read_b64_tr_b16 v[32:33], v20 offset:0
 ds_read_b64_tr_b16 v[34:35], v20 offset:2048
 ds_read_b64_tr_b16 v[36:37], v21 offset:0
 ds_read_b64_tr_b16 v[38:39], v21 offset:2048
 ds_read_b64_tr_b16 v[40:41], v22 offset:0
 ds_read_b64_tr_b16 v[42:43], v22 offset:2048
 ds_read_b64_tr_b16 v[44:45], v23 offset:0
 ds_read_b64_tr_b16 v[46:47], v23 offset:2048
 s_waitcnt lgkmcnt(0)
 s_add_u32 s25, s23, 1280
 s_mul_i32 s26, s25, 7282
 s_lshr_b32 s26, s26, 16
 s_mul_i32 s27, s26, 9
 s_sub_u32 s27, s25, s27
 s_mul_i32 s26, s26, 36864
 s_lshl_b32 s27, s27, 7
 s_add_u32 s26, s26, s27
 s_add_u32 m0, s24, 0
 s_nop 0
 buffer_load_dwordx4 v16, s[8:11], s26 offen offset:0 lds
 buffer_load_dwordx4 v17, s[8:11], s26 offen offset:1024 lds
 buffer_load_dwordx4 v18, s[8:11], s26 offen offset:2048 lds
 buffer_load_dwordx4 v19, s[8:11], s26 offen offset:3072 lds
 buffer_store_dwordx4 v[32:35], v24, s[12:15], s28 offen offset:0 sc1
 buffer_store_dwordx4 v[36:39], v24, s[12:15], s28 offen offset:1024 sc1
 buffer_store_dwordx4 v[40:43], v24, s[12:15], s28 offen offset:2048 sc1
 buffer_store_dwordx4 v[44:47], v24, s[12:15], s28 offen offset:3072 sc1
 s_add_u32 s28, s28, 0x100000
 s_waitcnt vmcnt(20)
 ds_read_b64_tr_b16 v[48:49], v20 offset:4096
 ds_read_b64_tr_b16 v[50:51], v20 offset:6144
 ds_read_b64_tr_b16 v[52:53], v21 offset:4096
 ds_read_b64_tr_b16 v[54:55], v21 offset:6144
 ds_read_b64_tr_b16 v[56:57], v22 offset:4096
 ds_read_b64_tr_b16 v[58:59], v22 offset:6144
 ds_read_b64_tr_b16 v[60:61], v23 offset:4096
 ds_read_b64_tr_b16 v[62:63], v23 offset:6144
 s_waitcnt lgkmcnt(6)
 buffer_store_dwordx4 v[48:51], v24, s[12:15], s28 offen offset:0 sc1
 s_waitcnt lgkmcnt(4)
 buffer_store_dwordx4 v[52:55], v24, s[12:15], s28 offen offset:1024 sc1
 s_waitcnt lgkmcnt(2)
 buffer_store_dwordx4 v[56:59], v24, s[12:15], s28 offen offset:2048 sc1
 s_waitcnt lgkmcnt(0)
 buffer_store_dwordx4 v[60:63], v24, s[12:15], s28 offen offset:3072 sc1
 s_add_u32 s28, s28, 0x100000
 s_waitcnt vmcnt(20)
 ds_read_b64_tr_b16 v[64:65], v20 offset:8192
 ds_read_b64_tr_b16 v[66:67], v20 offset:10240
 ds_read_b64_tr_b16 v[68:69], v21 offset:8192
 ds_read_b64_tr_b16 v[70:71], v21 offset:10240
 ds_read_b64_tr_b16 v[72:73], v22 offset:8192
 ds_read_b64_tr_b16 v[74:75], v22 offset:10240
 ds_read_b64_tr_b16 v[76:77], v23 offset:8192
 ds_read_b64_tr_b16 v[78:79], v23 offset:10240
 s_waitcnt lgkmcnt(6)
 buffer_store_dwordx4 v[64:67], v24, s[12:15], s28 offen offset:0 sc1
 s_waitcnt lgkmcnt(4)
 buffer_store_dwordx4 v[68:71], v24, s[12:15], s28 offen offset:1024 sc1
 s_waitcnt lgkmcnt(2)
 buffer_store_dwordx4 v[72:75], v24, s[12:15], s28 offen offset:2048 sc1
 s_waitcnt lgkmcnt(0)
 buffer_store_dwordx4 v[76:79], v24, s[12:15], s28 offen offset:3072 sc1
 s_add_u32 s28, s28, 0x100000
 s_waitcnt vmcnt(20)
 ds_read_b64_tr_b16 v[32:33], v20 offset:12288
 ds_read_b64_tr_b16 v[34:35], v20 offset:14336
 ds_read_b64_tr_b16 v[36:37], v21 offset:12288
 ds_read_b64_tr_b16 v[38:39], v21 offset:14336
 ds_read_b64_tr_b16 v[40:41], v22 offset:12288
 ds_read_b64_tr_b16 v[42:43], v22 offset:14336
 ds_read_b64_tr_b16 v[44:45], v23 offset:12288
 ds_read_b64_tr_b16 v[46:47], v23 offset:14336
 s_waitcnt lgkmcnt(6)
 buffer_store_dwordx4 v[32:35], v24, s[12:15], s28 offen offset:0 sc1
 s_waitcnt lgkmcnt(4)
 buffer_store_dwordx4 v[36:39], v24, s[12:15], s28 offen offset:1024 sc1
 s_waitcnt lgkmcnt(2)
 buffer_store_dwordx4 v[40:43], v24, s[12:15], s28 offen offset:2048 sc1
 s_waitcnt lgkmcnt(0)
 buffer_store_dwordx4 v[44:47], v24, s[12:15], s28 offen offset:3072 sc1
 s_add_u32 s28, s28, 0x100000
 s_waitcnt vmcnt(20)
 ds_read_b64_tr_b16 v[48:49], v20 offset:16384
 ds_read_b64_tr_b16 v[50:51], v20 offset:18432
 ds_read_b64_tr_b16 v[52:53], v21 offset:16384
 ds_read_b64_tr_b16 v[54:55], v21 offset:18432
 ds_read_b64_tr_b16 v[56:57], v22 offset:16384
 ds_read_b64_tr_b16 v[58:59], v22 offset:18432
 ds_read_b64_tr_b16 v[60:61], v23 offset:16384
 ds_read_b64_tr_b16 v[62:63], v23 offset:18432
 s_waitcnt lgkmcnt(6)
 buffer_store_dwordx4 v[48:51], v24, s[12:15], s28 offen offset:0 sc1
 s_waitcnt lgkmcnt(4)
 buffer_store_dwordx4 v[52:55], v24, s[12:15], s28 offen offset:1024 sc1
 s_waitcnt lgkmcnt(2)
 buffer_store_dwordx4 v[56:59], v24, s[12:15], s28 offen offset:2048 sc1
 s_waitcnt lgkmcnt(0)
 buffer_store_dwordx4 v[60:63], v24, s[12:15], s28 offen offset:3072 sc1
 s_add_u32 s28, s28, 0x100000
 s_waitcnt vmcnt(20)
 ds_read_b64_tr_b16 v[64:65], v20 offset:0
 ds_read_b64_tr_b16 v[66:67], v20 offset:2048
 ds_read_b64_tr_b16 v[68:69], v21 offset:0
 ds_read_b64_tr_b16 v[70:71], v21 offset:2048
 ds_read_b64_tr_b16 v[72:73], v22 offset:0
 ds_read_b64_tr_b16 v[74:75], v22 offset:2048
 ds_read_b64_tr_b16 v[76:77], v23 offset:0
 ds_read_b64_tr_b16 v[78:79], v23 offset:2048
 s_waitcnt lgkmcnt(6)
 buffer_store_dwordx4 v[64:67], v24, s[12:15], s28 offen offset:0 sc1
 s_waitcnt lgkmcnt(4)
 buffer_store_dwordx4 v[68:71], v24, s[12:15], s28 offen offset:1024 sc1
 s_waitcnt lgkmcnt(2)
 buffer_store_dwordx4 v[72:75], v24, s[12:15], s28 offen offset:2048 sc1
 s_waitcnt lgkmcnt(0)
 buffer_store_dwordx4 v[76:79], v24, s[12:15], s28 offen offset:3072 sc1
 s_lshl_b32 s101, s23, 7
 s_add_u32 s101, s101, 950272
 s_mov_b64 exec, -1
 s_and_b32 s23, s2, 1
 s_lshl_b32 s23, s23, 3
 s_bfe_u32 s25, s2, 0x30003
 s_add_u32 s23, s23, s25
 s_bfe_u32 s24, s2, 0x20001
 s_lshl_b32 s24, s24, 2
 s_lshr_b32 s25, s2, 6
 s_add_u32 s24, s24, s25
 s_and_b32 s25, s24, 1
 s_mul_i32 s26, s24, 576
 s_lshl_b32 s27, s25, 6
 s_add_u32 s27, s27, s26
 s_xor_b32 s25, s25, 1
 s_lshl_b32 s25, s25, 9
 s_add_u32 s28, s25, s26
 s_lshl_b32 s29, s23, 3
 s_lshl_b32 s30, s22, 1
 s_add_u32 s29, s29, s30
 v_lshrrev_b32 v2, 3, v1
 v_and_b32 v4, 6, v2
 v_and_b32 v3, 7, v1
 v_xor_b32 v4, v4, v3
 v_lshlrev_b32 v4, 4, v4
 v_mul_u32_u24 v5, 9216, v2
 v_add_u32 v5, v5, v4
 v_add_u32 v224, 0, v5
 v_add_u32 v225, 72704, v5
 v_add_u32 v226, 145408, v5
 v_add_u32 v227, 218112, v5
 s_mul_i32 s56, s22, 589824
 s_add_u32 s56, s56, s27
 s_mul_i32 s57, s22, 73728
 s_add_u32 s57, s57, s27
 s_add_u32 s57, s57, 2359296
 s_lshl_b32 s58, s22, 13
 s_lshl_b32 s59, s22, 10
 s_add_u32 s59, s59, 32768
 s_mov_b32 s40, s4
 s_and_b32 s41, s5, 0xffff
 s_mov_b32 s42, 0x510000
 s_mov_b32 s43, 0x20000
 s_mov_b32 s44, s6
 s_and_b32 s45, s7, 0xffff
 s_mov_b32 s46, 0x510000
 s_mov_b32 s47, 0x20000
 s_lshl_b32 s30, s29, 7
 s_mul_i32 s31, s29, 18432
 s_add_u32 s48, s20, 0x3400000
 s_addc_u32 s49, s21, 0
 s_and_b32 s49, s49, 0xffff
 s_mov_b32 s50, 0x510000
 s_mov_b32 s51, 0x20000
 s_cmp_lt_u32 s22, 2
 s_cselect_b32 s52, s40, s44
 s_cselect_b32 s53, s41, s45
 s_mov_b32 s54, 0x510000
 s_mov_b32 s55, 0x20000
 v_lshrrev_b32 v2, 2, v1
 v_mul_u32_u24 v5, 9216, v2
 v_bfe_u32 v3, v1, 4, 1
 v_lshlrev_b32 v3, 1, v3
 v_and_b32 v4, 3, v1
 v_xor_b32 v3, v3, v4
 v_lshl_add_u32 v5, v3, 4, v5
 v_add_u32 v228, 0, v5
 v_add_u32 v229, 146432, v5
 v_add_u32 v230, 292864, v5
 v_add_u32 v231, 439296, v5
 s_mul_i32 s61, s22, 9216
 s_and_b32 s62, s22, 1
 s_mul_i32 s62, s62, 1327104
 s_add_u32 s62, s62, s28
 s_lshr_b32 s25, s24, 2
 s_and_b32 s26, s24, 3
 s_and_b32 s35, s26, 1
 s_mul_i32 s34, s26, 288
 s_lshl_b32 s67, s35, 5
 s_add_u32 s33, s34, s67
 s_xor_b32 s67, s35, 1
 s_lshl_b32 s67, s67, 8
 s_add_u32 s34, s34, s67
 s_add_u32 s63, s26, s22
 s_and_b32 s63, s63, 3
 s_and_b32 s67, s24, 12
 s_add_u32 s67, s67, s63
 s_mul_i32 s63, s67, 288
 s_and_b32 s67, s67, 1
 s_xor_b32 s64, s67, 1
 s_lshl_b32 s64, s64, 8
 s_add_u32 s64, s64, s63
 s_lshl_b32 s67, s67, 5
 s_add_u32 s63, s63, s67
 s_mul_i32 s67, s26, 9216
 s_mul_i32 s63, s63, 1152
 s_add_u32 s63, s63, s67
 s_mul_i32 s64, s64, 1152
 s_add_u32 s64, s64, s67
 v_bfe_u32 v2, v1, 2, 3
 v_lshrrev_b32 v3, 5, v1
 v_lshlrev_b32 v3, 10, v3
 v_lshl_add_u32 v3, v2, 7, v3
 v_and_b32 v4, 3, v1
 v_lshl_add_u32 v3, v4, 3, v3
 v_lshrrev_b32 v2, 1, v2
 v_xor_b32 v4, 0, v2
 v_lshl_add_u32 v236, v4, 5, v3
 v_xor_b32 v4, 1, v2
 v_lshl_add_u32 v237, v4, 5, v3
 v_xor_b32 v4, 2, v2
 v_lshl_add_u32 v238, v4, 5, v3
 v_xor_b32 v4, 3, v2
 v_lshl_add_u32 v239, v4, 5, v3
 v_lshrrev_b32 v2, 2, v1
 v_lshlrev_b32 v2, 6, v2
 v_and_b32 v3, 3, v1
 v_lshl_add_u32 v2, v3, 3, v2
 v_bfe_u32 v3, v1, 4, 1
 v_lshl_add_u32 v240, v3, 5, v2
 v_xor_b32 v241, 32, v240
 s_mov_b32 s88, 0x00003f80
 s_mov_b32 s89, 0x3f800000
 s_mov_b32 s65, 0x3ae38e39
 s_lshl_b32 s67, s23, 4
 s_add_u32 s66, s67, s24
 s_lshl_b32 s66, s66, 2
 s_add_u32 s66, s66, s22
 s_mul_i32 s66, s66, 18432
 s_and_b32 s68, s24, 12
 s_add_u32 s68, s68, s67
 s_lshl_b32 s68, s68, 2
 s_add_u32 s68, s68, s22
 s_mul_i32 s68, s68, 18432
 s_lshl_b32 s69, s23, 2
 s_add_u32 s69, s69, s22
 s_lshl_b32 s69, s69, 11
 s_add_u32 s69, s69, 393216
 s_and_b32 s70, s24, 12
 s_lshl_b32 s70, s70, 7
 s_add_u32 s70, s70, s69
 s_lshl_b32 s67, s24, 7
 s_add_u32 s69, s69, s67
 s_lshl_b32 s75, s29, 10
 s_add_u32 s75, s75, 262144
 s_branch L_p4
L_slow_p3:
 s_mov_b64 exec, vcc
 buffer_load_dword v15, v11, s[96:99], s83 offen sc1
 s_waitcnt vmcnt(0)
 v_cmp_ne_u32 vcc, s3, v15
 s_sub_u32 s100, s100, 1
 s_cbranch_scc1 L_out_p3
 s_nop 2
 s_cbranch_vccnz L_slow_p3
L_out_p3:
 s_mov_b64 exec, -1
 s_branch L_back_p3
L_slow_p4:
 s_mov_b64 exec, vcc
 buffer_load_dword v13, v14, s[96:99], s75 offen sc1
 s_waitcnt vmcnt(0)
 v_cmp_ne_u32 vcc, s3, v13
 s_sub_u32 s100, s100, 1
 s_cbranch_scc1 L_out_p4
 s_nop 2
 s_cbranch_vccnz L_slow_p4
L_out_p4:
 s_mov_b64 exec, -1
 s_branch L_back_p4
L_slow_w:
 s_mov_b64 exec, vcc
 buffer_load_dword v13, v14, s[96:99], s32 offen sc1
 s_waitcnt vmcnt(0)
 v_cmp_ne_u32 vcc, s3, v13
 s_sub_u32 s100, s100, 1
 s_cbranch_scc1 L_out_w
 s_nop 2
 s_cbranch_vccnz L_slow_w
L_out_w:
 s_mov_b64 exec, -1
 s_branch L_back_w
L_slow_a:
 s_mov_b64 exec, vcc
 buffer_load_dword v13, v12, s[96:99], s70 offen sc1
 s_waitcnt vmcnt(0)
 v_cmp_ne_u32 vcc, s3, v13
 s_sub_u32 s100, s100, 1
 s_cbranch_scc1 L_out_a
 s_nop 2
 s_cbranch_vccnz L_slow_a
L_out_a:
 s_mov_b64 exec, -1
 s_branch L_back_a
L_slow_b:
 s_mov_b64 exec, vcc
 buffer_load_dword v13, v12, s[96:99], s70 offen sc1
 s_waitcnt vmcnt(0)
 v_cmp_ne_u32 vcc, s3, v13
 s_sub_u32 s100, s100, 1
 s_cbranch_scc1 L_out_b
 s_nop 2
 s_cbranch_vccnz L_slow_b
L_out_b:
 s_mov_b64 exec, -1
 s_branch L_back_b
L_slow_c:
 s_mov_b64 exec, vcc
 buffer_load_dword v13, v12, s[96:99], s70 offen sc1
 s_waitcnt vmcnt(0)
 v_cmp_ne_u32 vcc, s3, v13
 s_sub_u32 s100, s100, 1
 s_cbranch_scc1 L_out_c
 s_nop 2
 s_cbranch_vccnz L_slow_c
L_out_c:
 s_mov_b64 exec, -1
 s_branch L_back_c
L_slow_p5:
 s_mov_b64 exec, vcc
 buffer_load_dword v13, v10, s[96:99], s75 offen sc1
 s_waitcnt vmcnt(0)
 v_cmp_ne_u32 vcc, s3, v13
 s_sub_u32 s100, s100, 1
 s_cbranch_scc1 L_out_p5
 s_nop 2
 s_cbranch_vccnz L_slow_p5
L_out_p5:
 s_mov_b64 exec, -1
 s_branch L_back_p5
L_tagslow_pf:
 v_mov_b32 v248, 0
 global_load_dword v248, v248, s[92:93] sc1
 s_waitcnt vmcnt(0)
 v_readfirstlane_b32 s3, v248
 s_sub_u32 s100, s100, 1
 s_cbranch_scc1 L_tagback_pf
 s_cmp_eq_u32 s3, 0
 s_branch L_c4_p6_s
L_c4_p6:
 s_branch L_c4_ret
L_c4_p6_s:
 s_cbranch_scc1 L_tagslow_pf
 s_branch L_tagback_pf
L_s5:
L_pf0:
 s_add_u32 s96, s20, 0xe00000
 s_addc_u32 s97, s21, 0
 s_and_b32 s97, s97, 0xffff
 s_mov_b32 s98, 0x110000
 s_mov_b32 s99, 0x20000
L_pf:
 s_load_dwordx2 s[8:9], s[0:1], 16
 s_load_dwordx4 s[12:15], s[0:1], 32
 s_load_dwordx2 s[16:17], s[0:1], 48
 s_sub_u32 s23, s2, 224
 s_lshl_b32 s24, s23, 2
 s_add_u32 s24, s24, s22
 v_lshlrev_b32 v2, 7, v1
 s_mov_b32 s28, s6
 s_and_b32 s29, s7, 0xffff
 s_mov_b32 s30, 0x1e6000
 s_mov_b32 s31, 0x20000
 s_mul_i32 s25, s24, 15616
 buffer_load_dword v10, v2, s[28:31], s25 offen
 s_add_u32 s25, s25, 8192
 buffer_load_dword v11, v2, s[28:31], s25 offen
 s_cmp_lg_u32 s24, 0
 s_cbranch_scc1 L_pf_notag
 v_mov_b32 v4, 917504
 buffer_load_dword v5, v4, s[96:99], 0 offen sc1
 s_waitcnt vmcnt(0)
 v_add_u32 v5, 1, v5
 v_max_u32 v5, 1, v5
 v_mov_b32 v6, 0
 global_store_dword v6, v5, s[92:93] sc1
 buffer_store_dword v5, v4, s[96:99], 0 offen sc1
L_pf_notag:
 s_getpc_b64 s[32:33]
L_pc:
 s_sub_u32 s32, s32, L_pc-L_main
 s_subb_u32 s33, s33, 0
 s_lshr_b32 s25, s23, 3
 s_lshl_b32 s25, s25, 2
 s_add_u32 s25, s25, s22
 s_lshl_b32 s25, s25, 13
 v_add_u32 v3, s25, v2
 s_mov_b32 s25, L_code_end-L_main-4
 v_min_u32 v3, s25, v3
 global_load_dword v12, v3, s[32:33]
 s_waitcnt vmcnt(0) lgkmcnt(0)
 s_mov_b32 s28, s8
 s_and_b32 s29, s9, 0xffff
 s_mov_b32 s30, 0xa2000
 s_mov_b32 s31, 0x20000
 s_mul_i32 s25, s24, 5248
 v_cmp_gt_u32 vcc, 41, v1
 v_mov_b32 v4, 0x7fff0000
 s_nop 0
 v_cndmask_b32 v4, v4, v2, vcc
 buffer_load_dword v10, v4, s[28:31], s25 offen
 s_waitcnt vmcnt(0)
 s_mov_b32 s28, s12
 s_and_b32 s29, s13, 0xffff
 s_mov_b32 s30, 0x510000
 s_mov_b32 s31, 0x20000
 s_lshl_b32 s25, s24, 15
 buffer_load_dword v11, v2, s[28:31], s25 offen
 s_add_u32 s25, s25, 8192
 buffer_load_dword v12, v2, s[28:31], s25 offen
 s_add_u32 s25, s25, 8192
 buffer_load_dword v13, v2, s[28:31], s25 offen
 s_add_u32 s25, s25, 8192
 buffer_load_dword v14, v2, s[28:31], s25 offen
 s_add_u32 s25, s25, 8192
 v_mov_b32 v2, 0x7fff0000
 v_cmp_eq_u32 vcc, 0, v1
 s_nop 1
 v_cndmask_b32 v250, v2, v1, vcc
 s_load_dwordx2 s[90:91], s[0:1], 16
 s_lshr_b32 s80, s2, 5
 s_and_b32 s81, s2, 7
 s_lshl_b32 s81, s81, 2
 s_bfe_u32 s68, s2, 0x20003
 s_add_u32 s81, s81, s68
 s_mul_i32 s68, s81, 18
 s_and_b32 s82, s68, 3
 s_lshr_b32 s68, s68, 2
 s_add_u32 s83, s68, 144
 s_mul_i32 s83, s83, 16512
 s_lshl_b32 s84, s80, 1
 s_add_u32 s84, s84, s22
 s_cmp_lt_u32 s84, 2
 s_cselect_b32 s69, 0, 2
 s_sub_u32 s84, s84, s69
 s_lshl_b32 s84, s84, 10
 s_add_u32 s83, s83, s84
 s_lshl_b32 s84, s22, 10
 s_mul_i32 s85, s68, 16512
 s_lshl_b32 s69, s80, 11
 s_add_u32 s85, s85, s69
 s_lshl_b32 s87, s22, 9
 s_add_u32 s85, s85, s87
 s_mul_i32 s86, s22, 3072
 s_add_u32 s86, s86, 151552
 s_waitcnt vmcnt(2)
 v_lshrrev_b32 v12, 5, v1
 v_lshlrev_b32 v12, 3, v12
 s_waitcnt vmcnt(1)
 v_and_b32 v13, 31, v1
 v_sub_u32 v12, v13, v12
 v_cmp_le_i32 s[36:37], 0, v12
 v_cmp_le_i32 s[38:39], 1, v12
 v_cmp_le_i32 s[40:41], 2, v12
 v_cmp_le_i32 s[42:43], 3, v12
 v_cmp_le_i32 s[44:45], 4, v12
 v_cmp_le_i32 s[46:47], 5, v12
 v_cmp_le_i32 s[48:49], 6, v12
 v_cmp_le_i32 s[50:51], 7, v12
 v_cmp_le_i32 s[52:53], 16, v12
 v_cmp_le_i32 s[54:55], 17, v12
 v_cmp_le_i32 s[56:57], 18, v12
 v_cmp_le_i32 s[58:59], 19, v12
 v_cmp_le_i32 s[60:61], 20, v12
 v_cmp_le_i32 s[62:63], 21, v12
 v_cmp_le_i32 s[64:65], 22, v12
 v_cmp_le_i32 s[66:67], 23, v12
 s_lshl_b32 s68, s80, 8
 s_lshl_b32 s69, s22, 6
 s_add_u32 s68, s68, s69
 s_mul_i32 s69, s81, 68096
 s_lshl_b32 s70, s68, 4
 s_add_u32 s69, s69, s70
 s_mul_i32 s70, s81, 8448
 s_lshl_b32 s68, s68, 2
 s_add_u32 s70, s70, s68
 s_lshr_b32 s73, s2, 5
 s_mul_i32 s72, s73, 192
 s_and_b32 s73, s73, 1
 s_lshl_b32 s74, s73, 6
 s_xor_b32 s73, s73, 1
 s_lshl_b32 s73, s73, 7
 s_add_u32 s73, s73, s72
 s_add_u32 s72, s72, s74
 s_lshl_b32 s71, s80, 1
 s_lshr_b32 s74, s22, 1
 s_add_u32 s71, s71, s74
 s_cmp_eq_u32 s71, 0
 s_cselect_b32 s71, 0xff7fff7f, 0
 s_mov_b32 s75, 0xbeae1a93
 s_mov_b32 s88, 0x3eae1a93
 s_mov_b32 s89, s88
 s_waitcnt lgkmcnt(0)
 s_mov_b32 s76, s90
 s_and_b32 s77, s91, 0xffff
 s_mov_b32 s78, 0xa2000
 s_mov_b32 s79, 0x20000
 s_cmp_ge_u32 s2, 192
 s_cselect_b32 s78, 0, s78
 s_mul_i32 s90, s22, 41472
 s_mul_i32 s91, s22, 6144
 s_add_u32 s91, s91, 53248
 v_mov_b32 v248, 0
 global_load_dword v248, v248, s[92:93] sc1
 s_waitcnt vmcnt(0)
 v_readfirstlane_b32 s3, v248
 s_nop 0
 s_cmp_eq_u32 s3, 0
 s_cbranch_scc1 L_tagslow_pf
L_tagback_pf:
 s_branch L_p2v
L_code_end:
.section .rodata,"a"
.p2align 6
.amdhsa_kernel sequential_preLN__sliding_block__swiglu_ffn__prompt_kernel
  .amdhsa_next_free_vgpr 512
  .amdhsa_next_free_sgpr 102
  .amdhsa_accum_offset 256
  .amdhsa_group_segment_fixed_size 0
  .amdhsa_kernarg_size 80
  .amdhsa_user_sgpr_count 2
  .amdhsa_user_sgpr_kernarg_segment_ptr 1
  .amdhsa_system_sgpr_workgroup_id_x 1
  .amdhsa_float_denorm_mode_32 3
  .amdhsa_float_denorm_mode_16_64 3
  .amdhsa_ieee_mode 0
  .amdhsa_dx10_clamp 0
.end_amdhsa_kernel
```
